```python
import torch

def _softmax(x, axis=-1):
    return torch.softmax(x, dim=axis)
def _gelu(x):
    return torch.nn.functional.gelu(x, approximate="tanh")
def _silu(x):
    return torch.nn.functional.silu(x)
def _sigmoid(x):
    return torch.sigmoid(x)
def _layernorm(x, axis=-1, eps=1e-5):
    m = x.mean(dim=axis, keepdim=True)
    v = x.var(dim=axis, keepdim=True, unbiased=False)
    return (x - m) / torch.sqrt(v + eps)
def _scatter_add(tgt, idx, src, axis=0):
    return tgt.clone().index_add_(axis, idx, src)
def _segment_sum(src, seg, n):
    out = torch.zeros((n,) + src.shape[1:], dtype=src.dtype)
    return out.index_add_(0, seg, src)
def _pad(x, pw):
    flat = tuple(v for pair in reversed(pw) for v in pair)
    return torch.nn.functional.pad(x, flat)

kernel_name = 'concat_heads__mha_block_cached__gqa_block_cached__near_ridge'

def setup_inputs():

    _w = (lambda a: (lambda t: t.to(torch.bfloat16) if t.is_floating_point() else t)(torch.as_tensor(a)))
    def _A_setup():
        B, Sq, D = 8, 288, 576
        H, Sk, Dh = 32, 1024, 128
        return {
            "x": _w((lambda *s: torch.randn(*s, dtype=torch.bfloat16) * 0.8)(B, Sq, D)),
            "k_cache": _w((lambda *s: torch.randn(*s, dtype=torch.bfloat16) * 0.8)(B, H, Sk, Dh)),
            "v_cache": _w((lambda *s: torch.randn(*s, dtype=torch.bfloat16) * 0.05)(B, H, Sk, Dh)),
            "wq": _w((lambda *s: torch.randn(*s, dtype=torch.bfloat16) * 0.8)(D, H * Dh) * (D ** -0.5)),
            "wo": _w((lambda *s: torch.randn(*s, dtype=torch.bfloat16) * 0.05)(H * Dh, D) * ((H * Dh) ** -0.5)),
        }
    _A_in = _A_setup()

    def _B_setup():
        B, Sq, D = 8, 288, 576
        Hq, Hkv, Sk, Dh = 32, 32, 1024, 128
        assert Hq % Hkv == 0, (Hq, Hkv)
        return {
            "x": _w((lambda *s: torch.randn(*s, dtype=torch.bfloat16) * 0.8)(B, Sq, D)),
            "k_cache": _w((lambda *s: torch.randn(*s, dtype=torch.bfloat16) * 0.8)(B, Hkv, Sk, Dh)),
            "v_cache": _w((lambda *s: torch.randn(*s, dtype=torch.bfloat16) * 0.05)(B, Hkv, Sk, Dh)),
            "wq": _w((lambda *s: torch.randn(*s, dtype=torch.bfloat16) * 0.8)(D, Hq * Dh) * (D ** -0.5)),
            "wo": _w((lambda *s: torch.randn(*s, dtype=torch.bfloat16) * 0.05)(Hq * Dh, D) * ((Hq * Dh) ** -0.5)),
        }
    _B_in = _B_setup()

    return {
        "A_x": _A_in["x"],
        "A_k_cache": _A_in["k_cache"],
        "A_v_cache": _A_in["v_cache"],
        "A_wq": _A_in["wq"],
        "A_wo": _A_in["wo"],
        "B_x": _B_in["x"],
        "B_k_cache": _B_in["k_cache"],
        "B_v_cache": _B_in["v_cache"],
        "B_wq": _B_in["wq"],
        "B_wo": _B_in["wo"],
    }

def reference(A_x, A_k_cache, A_v_cache, A_wq, A_wo, B_x, B_k_cache, B_v_cache, B_wq, B_wo):
    def _A_ref(x, k_cache, v_cache, wq, wo):
        B, Sq, D = x.shape
        H, Dh = 32, 128
        q = (lambda x, *d: x.permute(*d))((x @ wq).reshape(B, Sq, H, Dh), 0, 2, 1, 3)
        scores = torch.einsum("bhqd,bhkd->bhqk", q, k_cache) * (Dh ** -0.5)
        p = _softmax(scores, axis=-1)
        o = torch.einsum("bhqk,bhkd->bhqd", p, v_cache)
        return (lambda x, *d: x.permute(*d))(o, 0, 2, 1, 3).reshape(B, Sq, H * Dh) @ wo

    def _B_ref(x, k_cache, v_cache, wq, wo):
        B, Sq, D = x.shape
        Hq, Dh = 32, 128
        Hkv = k_cache.shape[1]
        rep = Hq // Hkv
        q = (lambda x, *d: x.permute(*d))((x @ wq).reshape(B, Sq, Hq, Dh), 0, 2, 1, 3)
        k = (lambda x, n, axis: torch.repeat_interleave(x, n, dim=axis))(k_cache, rep, axis=1)
        v = (lambda x, n, axis: torch.repeat_interleave(x, n, dim=axis))(v_cache, rep, axis=1)
        scores = torch.einsum("bhqd,bhkd->bhqk", q, k) * (Dh ** -0.5)
        p = _softmax(scores, axis=-1)
        o = torch.einsum("bhqk,bhkd->bhqd", p, v)
        return (lambda x, *d: x.permute(*d))(o, 0, 2, 1, 3).reshape(B, Sq, Hq * Dh) @ wo

    a = _A_ref(A_x, A_k_cache, A_v_cache, A_wq, A_wo)
    b = _B_ref(B_x, B_k_cache, B_v_cache, B_wq, B_wo)
    return torch.concatenate([a, b], axis=-1)
```

```asm
; @launch grid=(256,1,1) block=(256,1,1) lds=163840
.amdgcn_target "amdgcn-amd-amdhsa--gfx950"
.text
.globl concat_heads__mha_block_cached__gqa_block_cached__near_ridge_kernel
.p2align 8
.type concat_heads__mha_block_cached__gqa_block_cached__near_ridge_kernel,@function
concat_heads__mha_block_cached__gqa_block_cached__near_ridge_kernel:
    s_cmp_ge_u32 s2, 256
    s_cbranch_scc1 L_end
    s_load_dwordx16 s[64:79], s[0:1], 0
    s_load_dwordx8 s[80:87], s[0:1], 64
    s_load_dwordx2 s[88:89], s[0:1], 96
    v_lshrrev_b32 v9, 6, v0
    v_and_b32 v0, 63, v0
    s_and_b32 s3, s2, 3
    s_bcnt1_i32_b32 s3, s3
    s_lshl_b32 s3, s3, 2
    s_and_b32 s3, s3, 4
    s_xor_b32 s2, s2, s3
    s_and_b32 s3, s2, 7
    v_readfirstlane_b32 s36, v9
    s_lshr_b32 s41, s3, 2
    s_and_b32 s38, s3, 3
    s_lshr_b32 s3, s2, 3
    s_lshr_b32 s39, s3, 2
    s_and_b32 s40, s3, 3
    s_and_b32 s37, s36, 1
    s_mov_b32 s50, 0
    s_getpc_b64 s[100:101]
L_pc:
    s_mov_b32 s92, s100
    s_mov_b32 s93, s101
    s_mov_b32 s94, L_end-L_pc
    s_mov_b32 s95, 0x20000
    s_and_b32 s3, s3, 7
    s_lshl_b32 s3, s3, 2
    s_add_u32 s50, s3, s36
    v_cmp_gt_u32 vcc, 20, v0
    s_mul_i32 s3, s50, 2560
    v_lshlrev_b32 v10, 7, v0
    v_mov_b32 v11, 0x1000000
    v_cndmask_b32 v10, v11, v10, vcc
    buffer_load_dword v15, v10, s[92:95], s3 offen
    v_lshrrev_b32 v9, 2, v0
    v_mul_u32_u24 v4, 1152, v9
    v_lshrrev_b32 v9, 4, v0
    v_and_b32 v9, 2, v9
    v_xor_b32 v9, v9, v0
    v_and_b32 v9, 3, v9
    v_lshl_add_u32 v4, v9, 4, v4
    v_lshrrev_b32 v9, 5, v0
    v_lshlrev_b32 v9, 15, v9
    v_and_b32 v14, 31, v0
    v_lshl_add_u32 v9, v14, 4, v9
    s_lshl_b32 s3, s36, 16
    v_add_u32 v5, s3, v9
    s_mul_i32 s61, s36, 10240
    s_add_u32 s61, s61, 80896
    s_mul_i32 s55, s36, 4352
    s_lshr_b32 s3, s36, 1
    s_mul_i32 s3, s3, 144
    s_add_u32 s46, s3, 128
    s_mul_i32 s46, s46, 1152
    s_lshl_b32 s53, s37, 6
    s_add_u32 s3, s3, s53
    s_xor_b32 s53, s38, 0
    s_lshl_b32 s53, s53, 4
    s_add_u32 s53, s53, s3
    s_mul_i32 s42, s53, 1152
    s_xor_b32 s53, s38, 1
    s_lshl_b32 s53, s53, 4
    s_add_u32 s53, s53, s3
    s_mul_i32 s43, s53, 1152
    s_xor_b32 s53, s38, 2
    s_lshl_b32 s53, s53, 4
    s_add_u32 s53, s53, s3
    s_mul_i32 s44, s53, 1152
    s_xor_b32 s53, s38, 3
    s_lshl_b32 s53, s53, 4
    s_add_u32 s53, s53, s3
    s_mul_i32 s45, s53, 1152
    s_mov_b32 s59, 0
    s_mov_b32 s60, 0
    s_waitcnt lgkmcnt(0)
    s_cmp_eq_u32 s41, 0
    s_cselect_b64 s[4:5], s[64:65], s[74:75]
    s_cselect_b64 s[8:9], s[70:71], s[80:81]
    s_mul_i32 s3, s39, 331776
    s_add_u32 s4, s4, s3
    s_addc_u32 s5, s5, 0
    s_mov_b32 s6, 331776
    s_mov_b32 s7, 0x20000
    s_lshl_b32 s53, s38, 2
    s_add_u32 s53, s53, s40
    s_lshl_b32 s3, s53, 9
    s_add_u32 s8, s8, s3
    s_addc_u32 s9, s9, 0
    s_sub_u32 s10, 4718592, s3
    s_mov_b32 s11, 0x20000
    s_add_u32 m0, s55, 34816
    s_nop 0
    buffer_load_dwordx4 v5, s[8:11], s60 offen lds
    s_add_u32 s60, s60, 8192
    s_add_u32 m0, s55, 35904
    s_nop 0
    buffer_load_dwordx4 v5, s[8:11], s60 offen lds
    s_add_u32 s60, s60, 8192
    s_add_u32 m0, s55, 36992
    s_nop 0
    buffer_load_dwordx4 v5, s[8:11], s60 offen lds
    s_add_u32 s60, s60, 8192
    s_add_u32 m0, s55, 38080
    s_nop 0
    buffer_load_dwordx4 v5, s[8:11], s60 offen lds
    s_add_u32 s60, s60, 237568
    s_add_u32 m0, s61, 40960
    s_add_u32 s54, s42, s59
    buffer_load_dwordx4 v4, s[4:7], s54 offen lds
    s_add_u32 m0, s61, 41920
    s_nop 0
    buffer_load_dwordx4 v4, s[4:7], s54 offen offset:64 lds
    s_add_u32 m0, s61, 43008
    s_add_u32 s54, s43, s59
    buffer_load_dwordx4 v4, s[4:7], s54 offen lds
    s_add_u32 m0, s61, 43968
    s_nop 0
    buffer_load_dwordx4 v4, s[4:7], s54 offen offset:64 lds
    s_add_u32 m0, s61, 45056
    s_add_u32 s54, s44, s59
    buffer_load_dwordx4 v4, s[4:7], s54 offen lds
    s_add_u32 m0, s61, 46016
    s_nop 0
    buffer_load_dwordx4 v4, s[4:7], s54 offen offset:64 lds
    s_cmp_eq_u32 s41, 0
    s_cselect_b64 s[12:13], s[66:67], s[76:77]
    s_cselect_b64 s[16:17], s[68:69], s[78:79]
    s_cselect_b64 s[20:21], s[72:73], s[82:83]
    s_mul_i32 s63, s36, 4224
    v_lshrrev_b32 v9, 2, v0
    v_and_b32 v9, 2, v9
    v_lshrrev_b32 v14, 4, v0
    v_xor_b32 v9, v9, v14
    v_and_b32 v14, 15, v0
    v_lshl_add_u32 v9, v14, 2, v9
    v_lshlrev_b32 v9, 4, v9
    v_add_u32 v6, s61, v9
    v_lshrrev_b32 v9, 2, v0
    v_mul_u32_u24 v9, 1088, v9
    v_and_b32 v14, 3, v0
    v_lshl_add_u32 v9, v14, 4, v9
    s_lshl_b32 s3, s37, 8
    v_add_u32 v7, s3, v9
    s_xor_b32 s3, s3, 256
    v_add_u32 v8, s3, v9
    s_lshl_b32 s3, s36, 12
    v_lshlrev_b32 v9, 4, v0
    v_add_u32 v1, s3, v9
    s_mov_b32 s56, 0x3e0293ee
    s_mov_b32 s57, 0x3e0293ee
    s_mov_b32 s58, 0x4e800000
    s_mul_i32 s47, s37, -16896
    s_add_u32 s47, s47, 8448
    s_sub_u32 s48, 17408, s47
    s_sub_u32 s49, -52224, s47
    s_lshl_b32 s53, s38, 2
    s_add_u32 s53, s53, s40
    s_lshl_b32 s3, s39, 4
    s_add_u32 s53, s53, s3
    s_lshl_b32 s3, s53, 19
    s_add_u32 s12, s12, s3
    s_addc_u32 s13, s13, 0
    s_mov_b32 s14, 524288
    s_mov_b32 s15, 0x20000
    s_add_u32 s16, s16, s3
    s_addc_u32 s17, s17, 0
    s_mov_b32 s18, 524288
    s_mov_b32 s19, 0x20000
    s_mov_b32 s22, 4718592
    s_mov_b32 s23, 0x20000
    s_mov_b32 s28, s84
    s_mov_b32 s29, s85
    s_mov_b32 s30, 5308416
    s_mov_b32 s31, 0x20000
    s_mov_b32 s32, s86
    s_mov_b32 s33, s87
    s_mov_b32 s34, 256
    s_mov_b32 s35, 0x20000
    s_add_u32 s24, s88, 0
    s_addc_u32 s25, s89, 0
    s_mov_b32 s26, 292618240
    s_mov_b32 s27, 0x20000
    s_lshl_b32 s3, s41, 7
    s_add_u32 s53, s53, s3
    s_mul_i32 s64, s53, 147456
    s_lshr_b32 s3, s36, 1
    s_mul_i32 s3, s3, 36864
    s_add_u32 s64, s64, s3
    s_add_u32 s65, s64, 32768
    s_lshl_b32 s3, s37, 14
    s_add_u32 s64, s64, s3
    s_mov_b32 s66, s50
    s_lshl_b32 s3, s2, 2
    s_add_u32 s3, s3, s36
    s_lshl_b32 s3, s3, 8
    s_add_u32 s70, s3, 67108864
    s_mov_b32 s62, 0
    s_mul_i32 s3, s40, 288
    s_add_u32 s20, s20, s3
    s_addc_u32 s21, s21, 0
    s_sub_u32 s22, s22, s3
    s_lshl_b32 s71, s2, 7
    s_add_u32 s71, s71, 66060288
    s_mul_i32 s86, s36, 9216
    s_mul_i32 s54, s36, 36864
    s_mul_i32 s3, s38, 1179648
    s_add_u32 s54, s54, s3
    s_xor_b32 s3, s40, 0
    s_mul_i32 s53, s3, 294912
    s_add_u32 s81, s53, s54
    s_xor_b32 s3, s40, 1
    s_mul_i32 s53, s3, 294912
    s_add_u32 s82, s53, s54
    s_xor_b32 s75, s71, 128
    s_xor_b32 s76, s71, 256
    s_xor_b32 s77, s71, 384
    s_lshr_b32 s3, s2, 3
    s_lshl_b32 s53, s41, 5
    s_add_u32 s3, s3, s53
    s_mul_i32 s85, s3, 327680
    s_mul_i32 s53, s36, 5120
    s_add_u32 s85, s85, s53
    s_add_u32 s85, s85, 41943040
    v_add_u32 v9, 0, v0
    v_mul_u32_u24 v9, 3641, v9
    v_lshrrev_b32 v9, 16, v9
    v_mul_u32_u24 v9, 864, v9
    v_lshl_add_u32 v9, v0, 4, v9
    v_accvgpr_write_b32 a240, v9
    v_add_u32 v9, 64, v0
    v_mul_u32_u24 v9, 3641, v9
    v_lshrrev_b32 v9, 16, v9
    v_mul_u32_u24 v9, 864, v9
    v_lshl_add_u32 v9, v0, 4, v9
    v_accvgpr_write_b32 a241, v9
    v_add_u32 v9, 128, v0
    v_mul_u32_u24 v9, 3641, v9
    v_lshrrev_b32 v9, 16, v9
    v_mul_u32_u24 v9, 864, v9
    v_lshl_add_u32 v9, v0, 4, v9
    v_accvgpr_write_b32 a242, v9
    v_add_u32 v9, 192, v0
    v_mul_u32_u24 v9, 3641, v9
    v_lshrrev_b32 v9, 16, v9
    v_mul_u32_u24 v9, 864, v9
    v_lshl_add_u32 v9, v0, 4, v9
    v_accvgpr_write_b32 a243, v9
    v_add_u32 v9, 256, v0
    v_mul_u32_u24 v9, 3641, v9
    v_lshrrev_b32 v9, 16, v9
    v_mul_u32_u24 v9, 864, v9
    v_lshl_add_u32 v9, v0, 4, v9
    v_add_u32 v9, 4096, v9
    v_accvgpr_write_b32 a244, v9
    v_add_u32 v9, 320, v0
    v_mul_u32_u24 v9, 3641, v9
    v_lshrrev_b32 v9, 16, v9
    v_mul_u32_u24 v9, 864, v9
    v_lshl_add_u32 v9, v0, 4, v9
    v_add_u32 v9, 4096, v9
    v_accvgpr_write_b32 a245, v9
    v_add_u32 v9, 384, v0
    v_mul_u32_u24 v9, 3641, v9
    v_lshrrev_b32 v9, 16, v9
    v_mul_u32_u24 v9, 864, v9
    v_lshl_add_u32 v9, v0, 4, v9
    v_add_u32 v9, 4096, v9
    v_accvgpr_write_b32 a246, v9
    v_add_u32 v9, 448, v0
    v_mul_u32_u24 v9, 3641, v9
    v_lshrrev_b32 v9, 16, v9
    v_mul_u32_u24 v9, 864, v9
    v_lshl_add_u32 v9, v0, 4, v9
    v_add_u32 v9, 4096, v9
    v_accvgpr_write_b32 a247, v9
    v_add_u32 v9, 512, v0
    v_mul_u32_u24 v9, 3641, v9
    v_lshrrev_b32 v9, 16, v9
    v_mul_u32_u24 v9, 864, v9
    v_lshl_add_u32 v9, v0, 4, v9
    v_add_u32 v9, 8192, v9
    v_accvgpr_write_b32 a248, v9
    v_and_b32 v9, 15, v0
    v_cmp_eq_u32 vcc, 0, v9
    v_mov_b32 v9, 0x3f803f80
    s_nop 0
    v_cndmask_b32 v9, 0, v9, vcc
    v_accvgpr_write_b32 a228, v9
    v_accvgpr_write_b32 a229, v9
    v_accvgpr_write_b32 a230, v9
    v_accvgpr_write_b32 a231, v9
    v_mov_b32 v9, 0
    v_and_b32 v10, 7, v0
    v_lshlrev_b32 v10, 2, v10
    buffer_store_dword v9, v10, s[24:27], s71 offen sc1
    v_and_b32 v9, 7, v0
    v_mul_u32_u24 v9, 1056, v9
    v_and_b32 v14, 8, v0
    v_lshl_add_u32 v9, v14, 5, v9
    v_and_b32 v14, 48, v0
    s_mul_i32 s3, s37, 8448
    v_add3_u32 v2, v9, v14, s3
    v_bfe_u32 v9, v0, 2, 3
    v_mul_u32_u24 v9, 1056, v9
    v_and_b32 v14, 32, v0
    v_lshl_add_u32 v9, v14, 3, v9
    v_and_b32 v14, 3, v0
    v_lshl_add_u32 v9, v14, 3, v9
    s_add_u32 s3, s3, 69632
    v_add_u32 v3, s3, v9
    s_add_u32 m0, s61, 47104
    s_add_u32 s54, s45, s59
    buffer_load_dwordx4 v4, s[4:7], s54 offen lds
    s_add_u32 m0, s61, 48064
    s_nop 0
    buffer_load_dwordx4 v4, s[4:7], s54 offen offset:64 lds
    s_add_u32 m0, s61, 49152
    s_add_u32 s54, s46, s59
    buffer_load_dwordx4 v4, s[4:7], s54 offen lds
    s_add_u32 m0, s61, 50112
    s_nop 0
    buffer_load_dwordx4 v4, s[4:7], s54 offen offset:64 lds
    s_add_u32 s59, s59, 128
    s_add_u32 m0, s55, 52224
    s_nop 0
    buffer_load_dwordx4 v5, s[8:11], s60 offen lds
    s_add_u32 s60, s60, 8192
    s_add_u32 m0, s55, 53312
    s_nop 0
    buffer_load_dwordx4 v5, s[8:11], s60 offen lds
    s_add_u32 s60, s60, 8192
    s_add_u32 m0, s55, 54400
    s_nop 0
    buffer_load_dwordx4 v5, s[8:11], s60 offen lds
    s_add_u32 s60, s60, 8192
    s_add_u32 m0, s55, 55488
    s_nop 0
    buffer_load_dwordx4 v5, s[8:11], s60 offen lds
    s_add_u32 s60, s60, 237568
    s_add_u32 m0, s61, 0
    s_add_u32 s54, s42, s59
    buffer_load_dwordx4 v4, s[4:7], s54 offen lds
    s_add_u32 m0, s61, 960
    s_nop 0
    buffer_load_dwordx4 v4, s[4:7], s54 offen offset:64 lds
    s_add_u32 m0, s61, 2048
    s_add_u32 s54, s43, s59
    buffer_load_dwordx4 v4, s[4:7], s54 offen lds
    s_add_u32 m0, s61, 3008
    s_nop 0
    buffer_load_dwordx4 v4, s[4:7], s54 offen offset:64 lds
    s_add_u32 s51, s63, 69632
    s_mov_b32 s52, 0
    s_waitcnt vmcnt(18)
    ds_read_b128 a[0:3], v6 offset:40960
    s_waitcnt vmcnt(16)
    ds_read_b128 a[4:7], v6 offset:43008
    s_waitcnt vmcnt(14)
    ds_read_b128 a[8:11], v6 offset:45056
    s_waitcnt vmcnt(11)
    ds_read_b128 a[12:15], v6 offset:47104
    s_waitcnt vmcnt(9)
    ds_read_b128 a[16:19], v6 offset:49152
    s_barrier
    ds_read_b64_tr_b16 a[80:81], v7 offset:34816
    ds_read_b64_tr_b16 a[82:83], v7 offset:35328
    ds_read_b64_tr_b16 a[84:85], v7 offset:34824
    ds_read_b64_tr_b16 a[86:87], v7 offset:35336
    ds_read_b64_tr_b16 a[88:89], v7 offset:34880
    ds_read_b64_tr_b16 a[90:91], v7 offset:35392
    ds_read_b64_tr_b16 a[92:93], v7 offset:34888
    ds_read_b64_tr_b16 a[94:95], v7 offset:35400
    s_waitcnt lgkmcnt(6)
    v_mfma_f32_16x16x32_bf16 v[16:19], a[80:83], a[0:3], 0
    ds_read_b128 a[20:23], v6 offset:41984
    v_mfma_f32_16x16x32_bf16 v[20:23], a[80:83], a[4:7], 0
    ds_read_b64_tr_b16 a[96:97], v7 offset:34944
    v_mfma_f32_16x16x32_bf16 v[24:27], a[80:83], a[8:11], 0
    ds_read_b128 a[24:27], v6 offset:44032
    v_mfma_f32_16x16x32_bf16 v[28:31], a[80:83], a[12:15], 0
    ds_read_b64_tr_b16 a[98:99], v7 offset:35456
    v_mfma_f32_16x16x32_bf16 a[176:179], a[80:83], a[16:19], 0
    s_waitcnt lgkmcnt(8)
    ds_read_b128 a[28:31], v6 offset:46080
    v_mfma_f32_16x16x32_bf16 v[32:35], a[84:87], a[0:3], 0
    ds_read_b64_tr_b16 a[100:101], v7 offset:34952
    v_mfma_f32_16x16x32_bf16 v[36:39], a[84:87], a[4:7], 0
    ds_read_b64_tr_b16 a[102:103], v7 offset:35464
    v_mfma_f32_16x16x32_bf16 v[40:43], a[84:87], a[8:11], 0
    ds_read_b128 a[32:35], v6 offset:48128
    v_mfma_f32_16x16x32_bf16 v[44:47], a[84:87], a[12:15], 0
    ds_read_b64_tr_b16 a[104:105], v7 offset:35008
    v_mfma_f32_16x16x32_bf16 a[180:183], a[84:87], a[16:19], 0
    s_waitcnt vmcnt(8) lgkmcnt(11)
    ds_read_b128 a[36:39], v6 offset:50176
    v_mfma_f32_16x16x32_bf16 v[48:51], a[88:91], a[0:3], 0
    s_add_u32 m0, s61, 4096
    ds_read_b64_tr_b16 a[106:107], v7 offset:35520
    v_mfma_f32_16x16x32_bf16 v[52:55], a[88:91], a[4:7], 0
    s_add_u32 s54, s44, s59
    buffer_load_dwordx4 v4, s[4:7], s54 offen lds
    v_mfma_f32_16x16x32_bf16 v[56:59], a[88:91], a[8:11], 0
    s_add_u32 m0, s61, 5056
    ds_read_b64_tr_b16 a[108:109], v7 offset:35016
    v_mfma_f32_16x16x32_bf16 v[60:63], a[88:91], a[12:15], 0
    buffer_load_dwordx4 v4, s[4:7], s54 offen offset:64 lds
    v_mfma_f32_16x16x32_bf16 a[184:187], a[88:91], a[16:19], 0
    s_waitcnt lgkmcnt(12)
    s_add_u32 m0, s61, 6144
    ds_read_b64_tr_b16 a[110:111], v7 offset:35528
    v_mfma_f32_16x16x32_bf16 v[64:67], a[92:95], a[0:3], 0
    s_add_u32 s54, s45, s59
    buffer_load_dwordx4 v4, s[4:7], s54 offen lds
    v_mfma_f32_16x16x32_bf16 v[68:71], a[92:95], a[4:7], 0
    s_add_u32 m0, s61, 7104
    ds_read_b64_tr_b16 a[80:81], v8 offset:34816
    v_mfma_f32_16x16x32_bf16 v[72:75], a[92:95], a[8:11], 0
    ds_read_b64_tr_b16 a[82:83], v8 offset:35328
    v_mfma_f32_16x16x32_bf16 v[76:79], a[92:95], a[12:15], 0
    buffer_load_dwordx4 v4, s[4:7], s54 offen offset:64 lds
    v_mfma_f32_16x16x32_bf16 a[188:191], a[92:95], a[16:19], 0
    s_waitcnt lgkmcnt(11)
    s_add_u32 m0, s61, 8192
    ds_read_b64_tr_b16 a[84:85], v8 offset:34824
    v_mfma_f32_16x16x32_bf16 v[80:83], a[96:99], a[0:3], 0
    s_add_u32 s54, s46, s59
    buffer_load_dwordx4 v4, s[4:7], s54 offen lds
    v_mfma_f32_16x16x32_bf16 v[84:87], a[96:99], a[4:7], 0
    s_add_u32 m0, s61, 9152
    ds_read_b64_tr_b16 a[86:87], v8 offset:35336
    v_mfma_f32_16x16x32_bf16 v[88:91], a[96:99], a[8:11], 0
    buffer_load_dwordx4 v4, s[4:7], s54 offen offset:64 lds
    v_mfma_f32_16x16x32_bf16 v[92:95], a[96:99], a[12:15], 0
    s_add_u32 s59, s59, 128
    s_add_u32 m0, s55, 0
    ds_read_b64_tr_b16 a[88:89], v8 offset:34880
    v_mfma_f32_16x16x32_bf16 a[192:195], a[96:99], a[16:19], 0
    s_waitcnt lgkmcnt(11)
    buffer_load_dwordx4 v5, s[8:11], s60 offen lds
    v_mfma_f32_16x16x32_bf16 v[96:99], a[100:103], a[0:3], 0
    s_add_u32 s60, s60, 8192
    ds_read_b64_tr_b16 a[90:91], v8 offset:35392
    v_mfma_f32_16x16x32_bf16 v[100:103], a[100:103], a[4:7], 0
    s_add_u32 m0, s55, 1088
    ds_read_b64_tr_b16 a[92:93], v8 offset:34888
    v_mfma_f32_16x16x32_bf16 v[104:107], a[100:103], a[8:11], 0
    buffer_load_dwordx4 v5, s[8:11], s60 offen lds
    v_mfma_f32_16x16x32_bf16 v[108:111], a[100:103], a[12:15], 0
    s_add_u32 s60, s60, 8192
    s_add_u32 m0, s55, 2176
    ds_read_b64_tr_b16 a[94:95], v8 offset:35400
    v_mfma_f32_16x16x32_bf16 a[196:199], a[100:103], a[16:19], 0
    s_waitcnt lgkmcnt(10)
    buffer_load_dwordx4 v5, s[8:11], s60 offen lds
    v_mfma_f32_16x16x32_bf16 v[112:115], a[104:107], a[0:3], 0
    s_add_u32 s60, s60, 8192
    s_add_u32 m0, s55, 3264
    ds_read_b64_tr_b16 a[96:97], v8 offset:34944
    v_mfma_f32_16x16x32_bf16 v[116:119], a[104:107], a[4:7], 0
    buffer_load_dwordx4 v5, s[8:11], s60 offen lds
    v_mfma_f32_16x16x32_bf16 v[120:123], a[104:107], a[8:11], 0
    s_add_u32 s60, s60, 237568
    s_add_u32 m0, s55, 17408
    ds_read_b64_tr_b16 a[98:99], v8 offset:35456
    v_mfma_f32_16x16x32_bf16 v[124:127], a[104:107], a[12:15], 0
    buffer_load_dwordx4 v5, s[8:11], s60 offen lds
    v_mfma_f32_16x16x32_bf16 a[200:203], a[104:107], a[16:19], 0
    s_waitcnt lgkmcnt(10)
    ds_read_b64_tr_b16 a[100:101], v8 offset:34952
    v_mfma_f32_16x16x32_bf16 v[128:131], a[108:111], a[0:3], 0
    s_add_u32 s60, s60, 8192
    s_add_u32 m0, s55, 18496
    ds_read_b64_tr_b16 a[102:103], v8 offset:35464
    v_mfma_f32_16x16x32_bf16 v[132:135], a[108:111], a[4:7], 0
    buffer_load_dwordx4 v5, s[8:11], s60 offen lds
    v_mfma_f32_16x16x32_bf16 v[136:139], a[108:111], a[8:11], 0
    s_add_u32 s60, s60, 8192
    s_add_u32 m0, s61, 40960
    ds_read_b64_tr_b16 a[104:105], v8 offset:35008
    v_mfma_f32_16x16x32_bf16 v[140:143], a[108:111], a[12:15], 0
    s_add_u32 s54, s42, s59
    buffer_load_dwordx4 v4, s[4:7], s54 offen lds
    v_mfma_f32_16x16x32_bf16 a[204:207], a[108:111], a[16:19], 0
    s_waitcnt lgkmcnt(11)
    s_add_u32 m0, s55, 19584
    ds_read_b64_tr_b16 a[106:107], v8 offset:35520
    v_mfma_f32_16x16x32_bf16 v[144:147], a[80:83], a[0:3], 0
    buffer_load_dwordx4 v5, s[8:11], s60 offen lds
    v_mfma_f32_16x16x32_bf16 v[148:151], a[80:83], a[4:7], 0
    s_add_u32 s60, s60, 8192
    s_add_u32 m0, s61, 41920
    ds_read_b64_tr_b16 a[108:109], v8 offset:35016
    v_mfma_f32_16x16x32_bf16 v[152:155], a[80:83], a[8:11], 0
    buffer_load_dwordx4 v4, s[4:7], s54 offen offset:64 lds
    v_mfma_f32_16x16x32_bf16 v[156:159], a[80:83], a[12:15], 0
    s_waitcnt lgkmcnt(11)
    s_add_u32 m0, s55, 20672
    ds_read_b64_tr_b16 a[110:111], v8 offset:35528
    v_mfma_f32_16x16x32_bf16 v[160:163], a[84:87], a[0:3], 0
    buffer_load_dwordx4 v5, s[8:11], s60 offen lds
    v_mfma_f32_16x16x32_bf16 v[164:167], a[84:87], a[4:7], 0
    s_add_u32 s60, s60, 237568
    v_mfma_f32_16x16x32_bf16 v[168:171], a[84:87], a[8:11], 0
    v_mfma_f32_16x16x32_bf16 v[172:175], a[84:87], a[12:15], 0
    s_waitcnt lgkmcnt(10)
    v_mfma_f32_16x16x32_bf16 v[176:179], a[88:91], a[0:3], 0
    s_add_u32 m0, s61, 43008
    v_mfma_f32_16x16x32_bf16 v[180:183], a[88:91], a[4:7], 0
    s_add_u32 s54, s43, s59
    buffer_load_dwordx4 v4, s[4:7], s54 offen lds
    v_mfma_f32_16x16x32_bf16 v[184:187], a[88:91], a[8:11], 0
    s_add_u32 m0, s61, 43968
    v_mfma_f32_16x16x32_bf16 v[188:191], a[88:91], a[12:15], 0
    s_waitcnt lgkmcnt(8)
    v_mfma_f32_16x16x32_bf16 v[192:195], a[92:95], a[0:3], 0
    buffer_load_dwordx4 v4, s[4:7], s54 offen offset:64 lds
    v_mfma_f32_16x16x32_bf16 v[196:199], a[92:95], a[4:7], 0
    v_mfma_f32_16x16x32_bf16 v[200:203], a[92:95], a[8:11], 0
    v_mfma_f32_16x16x32_bf16 v[204:207], a[92:95], a[12:15], 0
    s_waitcnt lgkmcnt(6)
    v_mfma_f32_16x16x32_bf16 v[208:211], a[96:99], a[0:3], 0
    s_waitcnt vmcnt(22) lgkmcnt(0)
    v_mfma_f32_16x16x32_bf16 v[212:215], a[96:99], a[4:7], 0
    s_barrier
    v_mfma_f32_16x16x32_bf16 v[216:219], a[96:99], a[8:11], 0
    v_mfma_f32_16x16x32_bf16 v[220:223], a[96:99], a[12:15], 0
    s_add_u32 m0, s55, 34816
    ds_read_b64_tr_b16 a[80:81], v7 offset:52224
    v_mfma_f32_16x16x32_bf16 v[224:227], a[100:103], a[0:3], 0
    ds_read_b64_tr_b16 a[82:83], v7 offset:52736
    v_mfma_f32_16x16x32_bf16 v[228:231], a[100:103], a[4:7], 0
    buffer_load_dwordx4 v5, s[8:11], s60 offen lds
    v_mfma_f32_16x16x32_bf16 v[232:235], a[100:103], a[8:11], 0
    s_add_u32 s60, s60, 8192
    ds_read_b64_tr_b16 a[84:85], v7 offset:52232
    v_mfma_f32_16x16x32_bf16 v[236:239], a[100:103], a[12:15], 0
    v_mfma_f32_16x16x32_bf16 v[240:243], a[104:107], a[0:3], 0
    ds_read_b64_tr_b16 a[86:87], v7 offset:52744
    v_mfma_f32_16x16x32_bf16 v[244:247], a[104:107], a[4:7], 0
    v_mfma_f32_16x16x32_bf16 v[248:251], a[104:107], a[8:11], 0
    ds_read_b64_tr_b16 a[88:89], v7 offset:52288
    v_mfma_f32_16x16x32_bf16 v[252:255], a[104:107], a[12:15], 0
    v_mfma_f32_16x16x32_bf16 a[160:163], a[108:111], a[0:3], 0
    ds_read_b64_tr_b16 a[90:91], v7 offset:52800
    v_mfma_f32_16x16x32_bf16 a[164:167], a[108:111], a[4:7], 0
    ds_read_b64_tr_b16 a[92:93], v7 offset:52296
    v_mfma_f32_16x16x32_bf16 a[168:171], a[108:111], a[8:11], 0
    s_waitcnt lgkmcnt(5)
    ds_read_b64_tr_b16 a[94:95], v7 offset:52808
    v_mfma_f32_16x16x32_bf16 a[172:175], a[108:111], a[12:15], 0
    v_mfma_f32_16x16x32_bf16 v[16:19], a[80:83], a[20:23], v[16:19]
    s_add_u32 m0, s61, 45056
    v_mfma_f32_16x16x32_bf16 v[20:23], a[80:83], a[24:27], v[20:23]
    s_add_u32 s54, s44, s59
    ds_read_b64_tr_b16 a[96:97], v7 offset:52352
    v_mfma_f32_16x16x32_bf16 v[24:27], a[80:83], a[28:31], v[24:27]
    buffer_load_dwordx4 v4, s[4:7], s54 offen lds
    v_mfma_f32_16x16x32_bf16 v[28:31], a[80:83], a[32:35], v[28:31]
    ds_read_b64_tr_b16 a[98:99], v7 offset:52864
    v_mfma_f32_16x16x32_bf16 a[176:179], a[80:83], a[36:39], a[176:179]
    s_waitcnt lgkmcnt(6)
    v_mfma_f32_16x16x32_bf16 v[32:35], a[84:87], a[20:23], v[32:35]
    s_add_u32 m0, s55, 35904
    ds_read_b64_tr_b16 a[100:101], v7 offset:52360
    v_mfma_f32_16x16x32_bf16 v[36:39], a[84:87], a[24:27], v[36:39]
    ds_read_b64_tr_b16 a[102:103], v7 offset:52872
    v_mfma_f32_16x16x32_bf16 v[40:43], a[84:87], a[28:31], v[40:43]
    buffer_load_dwordx4 v5, s[8:11], s60 offen lds
    v_mfma_f32_16x16x32_bf16 v[44:47], a[84:87], a[32:35], v[44:47]
    s_add_u32 s60, s60, 8192
    ds_read_b64_tr_b16 a[104:105], v7 offset:52416
    v_mfma_f32_16x16x32_bf16 a[180:183], a[84:87], a[36:39], a[180:183]
    s_waitcnt lgkmcnt(7)
    v_mfma_f32_16x16x32_bf16 v[48:51], a[88:91], a[20:23], v[48:51]
    s_add_u32 m0, s61, 46016
    ds_read_b64_tr_b16 a[106:107], v7 offset:52928
    v_mfma_f32_16x16x32_bf16 v[52:55], a[88:91], a[24:27], v[52:55]
    buffer_load_dwordx4 v4, s[4:7], s54 offen offset:64 lds
    v_mfma_f32_16x16x32_bf16 v[56:59], a[88:91], a[28:31], v[56:59]
    ds_read_b64_tr_b16 a[108:109], v7 offset:52424
    v_mfma_f32_16x16x32_bf16 v[60:63], a[88:91], a[32:35], v[60:63]
    v_mfma_f32_16x16x32_bf16 a[184:187], a[88:91], a[36:39], a[184:187]
    s_waitcnt lgkmcnt(7)
    ds_read_b64_tr_b16 a[110:111], v7 offset:52936
    v_mfma_f32_16x16x32_bf16 v[64:67], a[92:95], a[20:23], v[64:67]
    v_mfma_f32_16x16x32_bf16 v[68:71], a[92:95], a[24:27], v[68:71]
    ds_read_b64_tr_b16 a[80:81], v8 offset:52224
    v_mfma_f32_16x16x32_bf16 v[72:75], a[92:95], a[28:31], v[72:75]
    ds_read_b64_tr_b16 a[82:83], v8 offset:52736
    v_mfma_f32_16x16x32_bf16 v[76:79], a[92:95], a[32:35], v[76:79]
    s_add_u32 m0, s55, 36992
    v_mfma_f32_16x16x32_bf16 a[188:191], a[92:95], a[36:39], a[188:191]
    s_waitcnt lgkmcnt(8)
    ds_read_b64_tr_b16 a[84:85], v8 offset:52232
    v_mfma_f32_16x16x32_bf16 v[80:83], a[96:99], a[20:23], v[80:83]
    buffer_load_dwordx4 v5, s[8:11], s60 offen lds
    v_mfma_f32_16x16x32_bf16 v[84:87], a[96:99], a[24:27], v[84:87]
    s_add_u32 s60, s60, 8192
    ds_read_b64_tr_b16 a[86:87], v8 offset:52744
    v_mfma_f32_16x16x32_bf16 v[88:91], a[96:99], a[28:31], v[88:91]
    v_mfma_f32_16x16x32_bf16 v[92:95], a[96:99], a[32:35], v[92:95]
    ds_read_b64_tr_b16 a[88:89], v8 offset:52288
    v_mfma_f32_16x16x32_bf16 a[192:195], a[96:99], a[36:39], a[192:195]
    s_waitcnt lgkmcnt(9)
    v_mfma_f32_16x16x32_bf16 v[96:99], a[100:103], a[20:23], v[96:99]
    s_add_u32 m0, s61, 47104
    ds_read_b64_tr_b16 a[90:91], v8 offset:52800
    v_mfma_f32_16x16x32_bf16 v[100:103], a[100:103], a[24:27], v[100:103]
    s_add_u32 s54, s45, s59
    ds_read_b64_tr_b16 a[92:93], v8 offset:52296
    v_mfma_f32_16x16x32_bf16 v[104:107], a[100:103], a[28:31], v[104:107]
    buffer_load_dwordx4 v4, s[4:7], s54 offen lds
    v_mfma_f32_16x16x32_bf16 v[108:111], a[100:103], a[32:35], v[108:111]
    ds_read_b64_tr_b16 a[94:95], v8 offset:52808
    v_mfma_f32_16x16x32_bf16 a[196:199], a[100:103], a[36:39], a[196:199]
    s_waitcnt lgkmcnt(10)
    v_mfma_f32_16x16x32_bf16 v[112:115], a[104:107], a[20:23], v[112:115]
    s_add_u32 m0, s61, 48064
    ds_read_b64_tr_b16 a[96:97], v8 offset:52352
    v_mfma_f32_16x16x32_bf16 v[116:119], a[104:107], a[24:27], v[116:119]
    buffer_load_dwordx4 v4, s[4:7], s54 offen offset:64 lds
    v_mfma_f32_16x16x32_bf16 v[120:123], a[104:107], a[28:31], v[120:123]
    ds_read_b64_tr_b16 a[98:99], v8 offset:52864
    v_mfma_f32_16x16x32_bf16 v[124:127], a[104:107], a[32:35], v[124:127]
    v_mfma_f32_16x16x32_bf16 a[200:203], a[104:107], a[36:39], a[200:203]
    s_waitcnt lgkmcnt(10)
    ds_read_b64_tr_b16 a[100:101], v8 offset:52360
    v_mfma_f32_16x16x32_bf16 v[128:131], a[108:111], a[20:23], v[128:131]
    ds_read_b64_tr_b16 a[102:103], v8 offset:52872
    v_mfma_f32_16x16x32_bf16 v[132:135], a[108:111], a[24:27], v[132:135]
    s_waitcnt vmcnt(28)
    ds_read_b128 a[40:43], v6 offset:0
    v_mfma_f32_16x16x32_bf16 v[136:139], a[108:111], a[28:31], v[136:139]
    ds_read_b64_tr_b16 a[104:105], v8 offset:52416
    v_mfma_f32_16x16x32_bf16 v[140:143], a[108:111], a[32:35], v[140:143]
    s_waitcnt vmcnt(27)
    s_add_u32 m0, s55, 38080
    ds_read_b128 a[60:63], v6 offset:1024
    v_mfma_f32_16x16x32_bf16 a[204:207], a[108:111], a[36:39], a[204:207]
    s_waitcnt lgkmcnt(13)
    ds_read_b64_tr_b16 a[106:107], v8 offset:52928
    v_mfma_f32_16x16x32_bf16 v[144:147], a[80:83], a[20:23], v[144:147]
    buffer_load_dwordx4 v5, s[8:11], s60 offen lds
    v_mfma_f32_16x16x32_bf16 v[148:151], a[80:83], a[24:27], v[148:151]
    s_add_u32 s60, s60, 237568
    ds_read_b64_tr_b16 a[108:109], v8 offset:52424
    v_mfma_f32_16x16x32_bf16 v[152:155], a[80:83], a[28:31], v[152:155]
    s_waitcnt vmcnt(27)
    ds_read_b128 a[44:47], v6 offset:2048
    v_mfma_f32_16x16x32_bf16 v[156:159], a[80:83], a[32:35], v[156:159]
    s_waitcnt lgkmcnt(14)
    ds_read_b64_tr_b16 a[110:111], v8 offset:52936
    v_mfma_f32_16x16x32_bf16 v[160:163], a[84:87], a[20:23], v[160:163]
    s_waitcnt vmcnt(26)
    ds_read_b128 a[64:67], v6 offset:3072
    v_mfma_f32_16x16x32_bf16 v[164:167], a[84:87], a[24:27], v[164:167]
    v_mfma_f32_16x16x32_bf16 v[168:171], a[84:87], a[28:31], v[168:171]
    s_waitcnt vmcnt(25)
    ds_read_b128 a[48:51], v6 offset:4096
    v_mfma_f32_16x16x32_bf16 v[172:175], a[84:87], a[32:35], v[172:175]
    s_waitcnt vmcnt(24) lgkmcnt(15)
    ds_read_b128 a[68:71], v6 offset:5120
    v_mfma_f32_16x16x32_bf16 v[176:179], a[88:91], a[20:23], v[176:179]
    v_mfma_f32_16x16x32_bf16 v[180:183], a[88:91], a[24:27], v[180:183]
    v_mfma_f32_16x16x32_bf16 v[184:187], a[88:91], a[28:31], v[184:187]
    v_mfma_f32_16x16x32_bf16 v[188:191], a[88:91], a[32:35], v[188:191]
    s_waitcnt vmcnt(23) lgkmcnt(14)
    s_add_u32 m0, s61, 49152
    ds_read_b128 a[52:55], v6 offset:6144
    v_mfma_f32_16x16x32_bf16 v[192:195], a[92:95], a[20:23], v[192:195]
    s_waitcnt vmcnt(22)
    ds_read_b128 a[72:75], v6 offset:7168
    v_mfma_f32_16x16x32_bf16 v[196:199], a[92:95], a[24:27], v[196:199]
    s_add_u32 s54, s46, s59
    buffer_load_dwordx4 v4, s[4:7], s54 offen lds
    v_mfma_f32_16x16x32_bf16 v[200:203], a[92:95], a[28:31], v[200:203]
    v_mfma_f32_16x16x32_bf16 v[204:207], a[92:95], a[32:35], v[204:207]
    s_waitcnt lgkmcnt(14)
    v_mfma_f32_16x16x32_bf16 v[208:211], a[96:99], a[20:23], v[208:211]
    s_waitcnt vmcnt(17) lgkmcnt(5)
    s_add_u32 m0, s61, 50112
    ds_read_b128 a[56:59], v6 offset:8192
    v_mfma_f32_16x16x32_bf16 v[212:215], a[96:99], a[24:27], v[212:215]
    s_barrier
    ds_read_b128 a[76:79], v6 offset:9216
    v_mfma_f32_16x16x32_bf16 v[216:219], a[96:99], a[28:31], v[216:219]
    buffer_load_dwordx4 v4, s[4:7], s54 offen offset:64 lds
    v_mfma_f32_16x16x32_bf16 v[220:223], a[96:99], a[32:35], v[220:223]
    s_add_u32 s59, s59, 128
    ds_read_b64_tr_b16 a[80:81], v7 offset:0
    v_mfma_f32_16x16x32_bf16 v[224:227], a[100:103], a[20:23], v[224:227]
    s_add_u32 m0, s55, 52224
    ds_read_b64_tr_b16 a[82:83], v7 offset:512
    v_mfma_f32_16x16x32_bf16 v[228:231], a[100:103], a[24:27], v[228:231]
    buffer_load_dwordx4 v5, s[8:11], s60 offen lds
    v_mfma_f32_16x16x32_bf16 v[232:235], a[100:103], a[28:31], v[232:235]
    s_add_u32 s60, s60, 8192
    ds_read_b64_tr_b16 a[84:85], v7 offset:8
    v_mfma_f32_16x16x32_bf16 v[236:239], a[100:103], a[32:35], v[236:239]
    v_mfma_f32_16x16x32_bf16 v[240:243], a[104:107], a[20:23], v[240:243]
    ds_read_b64_tr_b16 a[86:87], v7 offset:520
    v_mfma_f32_16x16x32_bf16 v[244:247], a[104:107], a[24:27], v[244:247]
    v_mfma_f32_16x16x32_bf16 v[248:251], a[104:107], a[28:31], v[248:251]
    ds_read_b64_tr_b16 a[88:89], v7 offset:64
    v_mfma_f32_16x16x32_bf16 v[252:255], a[104:107], a[32:35], v[252:255]
    v_mfma_f32_16x16x32_bf16 a[160:163], a[108:111], a[20:23], a[160:163]
    ds_read_b64_tr_b16 a[90:91], v7 offset:576
    v_mfma_f32_16x16x32_bf16 a[164:167], a[108:111], a[24:27], a[164:167]
    ds_read_b64_tr_b16 a[92:93], v7 offset:72
    v_mfma_f32_16x16x32_bf16 a[168:171], a[108:111], a[28:31], a[168:171]
    s_waitcnt lgkmcnt(5)
    ds_read_b64_tr_b16 a[94:95], v7 offset:584
    v_mfma_f32_16x16x32_bf16 a[172:175], a[108:111], a[32:35], a[172:175]
    s_branch L_qloop
    .p2align 6
L_qloop:
    v_mfma_f32_16x16x32_bf16 v[16:19], a[80:83], a[40:43], v[16:19]
    v_mfma_f32_16x16x32_bf16 v[20:23], a[80:83], a[44:47], v[20:23]
    ds_read_b64_tr_b16 a[96:97], v7 offset:128
    v_mfma_f32_16x16x32_bf16 v[24:27], a[80:83], a[48:51], v[24:27]
    s_add_u32 m0, s55, 53312
    v_mfma_f32_16x16x32_bf16 v[28:31], a[80:83], a[52:55], v[28:31]
    ds_read_b64_tr_b16 a[98:99], v7 offset:640
    v_mfma_f32_16x16x32_bf16 a[176:179], a[80:83], a[56:59], a[176:179]
    s_waitcnt lgkmcnt(6)
    buffer_load_dwordx4 v5, s[8:11], s60 offen lds
    v_mfma_f32_16x16x32_bf16 v[32:35], a[84:87], a[40:43], v[32:35]
    s_add_u32 s60, s60, 8192
    ds_read_b64_tr_b16 a[100:101], v7 offset:136
    v_mfma_f32_16x16x32_bf16 v[36:39], a[84:87], a[44:47], v[36:39]
    ds_read_b64_tr_b16 a[102:103], v7 offset:648
    v_mfma_f32_16x16x32_bf16 v[40:43], a[84:87], a[48:51], v[40:43]
    v_mfma_f32_16x16x32_bf16 v[44:47], a[84:87], a[52:55], v[44:47]
    ds_read_b64_tr_b16 a[104:105], v7 offset:192
    v_mfma_f32_16x16x32_bf16 a[180:183], a[84:87], a[56:59], a[180:183]
    s_waitcnt vmcnt(17) lgkmcnt(7)
    ds_read_b128 a[0:3], v6 offset:40960
    v_mfma_f32_16x16x32_bf16 v[48:51], a[88:91], a[40:43], v[48:51]
    ds_read_b64_tr_b16 a[106:107], v7 offset:704
    v_mfma_f32_16x16x32_bf16 v[52:55], a[88:91], a[44:47], v[52:55]
    s_waitcnt vmcnt(15)
    ds_read_b128 a[20:23], v6 offset:41984
    v_mfma_f32_16x16x32_bf16 v[56:59], a[88:91], a[48:51], v[56:59]
    ds_read_b64_tr_b16 a[108:109], v7 offset:200
    v_mfma_f32_16x16x32_bf16 v[60:63], a[88:91], a[52:55], v[60:63]
    v_mfma_f32_16x16x32_bf16 a[184:187], a[88:91], a[56:59], a[184:187]
    s_waitcnt lgkmcnt(9)
    ds_read_b64_tr_b16 a[110:111], v7 offset:712
    v_mfma_f32_16x16x32_bf16 v[64:67], a[92:95], a[40:43], v[64:67]
    v_mfma_f32_16x16x32_bf16 v[68:71], a[92:95], a[44:47], v[68:71]
    ds_read_b64_tr_b16 a[80:81], v8 offset:0
    v_mfma_f32_16x16x32_bf16 v[72:75], a[92:95], a[48:51], v[72:75]
    ds_read_b64_tr_b16 a[82:83], v8 offset:512
    v_mfma_f32_16x16x32_bf16 v[76:79], a[92:95], a[52:55], v[76:79]
    s_add_u32 m0, s61, 40960
    v_mfma_f32_16x16x32_bf16 a[188:191], a[92:95], a[56:59], a[188:191]
    s_waitcnt lgkmcnt(10)
    s_add_u32 s54, s42, s59
    ds_read_b64_tr_b16 a[84:85], v8 offset:8
    v_mfma_f32_16x16x32_bf16 v[80:83], a[96:99], a[40:43], v[80:83]
    s_waitcnt lgkmcnt(5)
    buffer_load_dwordx4 v4, s[4:7], s54 offen lds
    v_mfma_f32_16x16x32_bf16 v[84:87], a[96:99], a[44:47], v[84:87]
    ds_read_b64_tr_b16 a[86:87], v8 offset:520
    v_mfma_f32_16x16x32_bf16 v[88:91], a[96:99], a[48:51], v[88:91]
    s_add_u32 m0, s55, 54400
    v_mfma_f32_16x16x32_bf16 v[92:95], a[96:99], a[52:55], v[92:95]
    ds_read_b64_tr_b16 a[88:89], v8 offset:64
    v_mfma_f32_16x16x32_bf16 a[192:195], a[96:99], a[56:59], a[192:195]
    buffer_load_dwordx4 v5, s[8:11], s60 offen lds
    v_mfma_f32_16x16x32_bf16 v[96:99], a[100:103], a[40:43], v[96:99]
    s_add_u32 s60, s60, 8192
    ds_read_b64_tr_b16 a[90:91], v8 offset:576
    v_mfma_f32_16x16x32_bf16 v[100:103], a[100:103], a[44:47], v[100:103]
    s_add_u32 m0, s61, 41920
    ds_read_b64_tr_b16 a[92:93], v8 offset:72
    v_mfma_f32_16x16x32_bf16 v[104:107], a[100:103], a[48:51], v[104:107]
    buffer_load_dwordx4 v4, s[4:7], s54 offen offset:64 lds
    v_mfma_f32_16x16x32_bf16 v[108:111], a[100:103], a[52:55], v[108:111]
    ds_read_b64_tr_b16 a[94:95], v8 offset:584
    v_mfma_f32_16x16x32_bf16 a[196:199], a[100:103], a[56:59], a[196:199]
    v_mfma_f32_16x16x32_bf16 v[112:115], a[104:107], a[40:43], v[112:115]
    ds_read_b64_tr_b16 a[96:97], v8 offset:128
    v_mfma_f32_16x16x32_bf16 v[116:119], a[104:107], a[44:47], v[116:119]
    v_mfma_f32_16x16x32_bf16 v[120:123], a[104:107], a[48:51], v[120:123]
    ds_read_b64_tr_b16 a[98:99], v8 offset:640
    v_mfma_f32_16x16x32_bf16 v[124:127], a[104:107], a[52:55], v[124:127]
    v_mfma_f32_16x16x32_bf16 a[200:203], a[104:107], a[56:59], a[200:203]
    s_waitcnt lgkmcnt(10)
    ds_read_b64_tr_b16 a[100:101], v8 offset:136
    v_mfma_f32_16x16x32_bf16 v[128:131], a[108:111], a[40:43], v[128:131]
    ds_read_b64_tr_b16 a[102:103], v8 offset:648
    v_mfma_f32_16x16x32_bf16 v[132:135], a[108:111], a[44:47], v[132:135]
    s_waitcnt vmcnt(16)
    ds_read_b128 a[4:7], v6 offset:43008
    v_mfma_f32_16x16x32_bf16 v[136:139], a[108:111], a[48:51], v[136:139]
    ds_read_b64_tr_b16 a[104:105], v8 offset:192
    v_mfma_f32_16x16x32_bf16 v[140:143], a[108:111], a[52:55], v[140:143]
    s_waitcnt vmcnt(15)
    s_add_u32 m0, s55, 55488
    ds_read_b128 a[24:27], v6 offset:44032
    v_mfma_f32_16x16x32_bf16 a[204:207], a[108:111], a[56:59], a[204:207]
    s_waitcnt lgkmcnt(13)
    ds_read_b64_tr_b16 a[106:107], v8 offset:704
    v_mfma_f32_16x16x32_bf16 v[144:147], a[80:83], a[40:43], v[144:147]
    buffer_load_dwordx4 v5, s[8:11], s60 offen lds
    v_mfma_f32_16x16x32_bf16 v[148:151], a[80:83], a[44:47], v[148:151]
    s_add_u32 s60, s60, 237568
    ds_read_b64_tr_b16 a[108:109], v8 offset:200
    v_mfma_f32_16x16x32_bf16 v[152:155], a[80:83], a[48:51], v[152:155]
    v_mfma_f32_16x16x32_bf16 v[156:159], a[80:83], a[52:55], v[156:159]
    s_waitcnt lgkmcnt(13)
    ds_read_b64_tr_b16 a[110:111], v8 offset:712
    v_mfma_f32_16x16x32_bf16 v[160:163], a[84:87], a[40:43], v[160:163]
    s_add_u32 m0, s61, 43008
    v_mfma_f32_16x16x32_bf16 v[164:167], a[84:87], a[44:47], v[164:167]
    s_add_u32 s54, s43, s59
    v_mfma_f32_16x16x32_bf16 v[168:171], a[84:87], a[48:51], v[168:171]
    s_waitcnt lgkmcnt(3)
    buffer_load_dwordx4 v4, s[4:7], s54 offen lds
    v_mfma_f32_16x16x32_bf16 v[172:175], a[84:87], a[52:55], v[172:175]
    s_add_u32 m0, s61, 43968
    v_mfma_f32_16x16x32_bf16 v[176:179], a[88:91], a[40:43], v[176:179]
    v_mfma_f32_16x16x32_bf16 v[180:183], a[88:91], a[44:47], v[180:183]
    buffer_load_dwordx4 v4, s[4:7], s54 offen offset:64 lds
    v_mfma_f32_16x16x32_bf16 v[184:187], a[88:91], a[48:51], v[184:187]
    v_mfma_f32_16x16x32_bf16 v[188:191], a[88:91], a[52:55], v[188:191]
    v_mfma_f32_16x16x32_bf16 v[192:195], a[92:95], a[40:43], v[192:195]
    v_mfma_f32_16x16x32_bf16 v[196:199], a[92:95], a[44:47], v[196:199]
    v_mfma_f32_16x16x32_bf16 v[200:203], a[92:95], a[48:51], v[200:203]
    v_mfma_f32_16x16x32_bf16 v[204:207], a[92:95], a[52:55], v[204:207]
    v_mfma_f32_16x16x32_bf16 v[208:211], a[96:99], a[40:43], v[208:211]
    s_waitcnt lgkmcnt(0)
    v_mfma_f32_16x16x32_bf16 v[212:215], a[96:99], a[44:47], v[212:215]
    s_barrier
    v_mfma_f32_16x16x32_bf16 v[216:219], a[96:99], a[48:51], v[216:219]
    v_mfma_f32_16x16x32_bf16 v[220:223], a[96:99], a[52:55], v[220:223]
    ds_read_b64_tr_b16 a[80:81], v7 offset:17408
    v_mfma_f32_16x16x32_bf16 v[224:227], a[100:103], a[40:43], v[224:227]
    ds_read_b64_tr_b16 a[82:83], v7 offset:17920
    v_mfma_f32_16x16x32_bf16 v[228:231], a[100:103], a[44:47], v[228:231]
    s_waitcnt vmcnt(16)
    ds_read_b128 a[8:11], v6 offset:45056
    v_mfma_f32_16x16x32_bf16 v[232:235], a[100:103], a[48:51], v[232:235]
    ds_read_b64_tr_b16 a[84:85], v7 offset:17416
    v_mfma_f32_16x16x32_bf16 v[236:239], a[100:103], a[52:55], v[236:239]
    s_waitcnt vmcnt(14)
    ds_read_b128 a[28:31], v6 offset:46080
    v_mfma_f32_16x16x32_bf16 v[240:243], a[104:107], a[40:43], v[240:243]
    s_add_u32 m0, s55, 0
    ds_read_b64_tr_b16 a[86:87], v7 offset:17928
    v_mfma_f32_16x16x32_bf16 v[244:247], a[104:107], a[44:47], v[244:247]
    buffer_load_dwordx4 v5, s[8:11], s60 offen lds
    v_mfma_f32_16x16x32_bf16 v[248:251], a[104:107], a[48:51], v[248:251]
    s_add_u32 s60, s60, 8192
    ds_read_b64_tr_b16 a[88:89], v7 offset:17472
    v_mfma_f32_16x16x32_bf16 v[252:255], a[104:107], a[52:55], v[252:255]
    v_mfma_f32_16x16x32_bf16 a[160:163], a[108:111], a[40:43], a[160:163]
    ds_read_b64_tr_b16 a[90:91], v7 offset:17984
    v_mfma_f32_16x16x32_bf16 a[164:167], a[108:111], a[44:47], a[164:167]
    ds_read_b64_tr_b16 a[92:93], v7 offset:17480
    v_mfma_f32_16x16x32_bf16 a[168:171], a[108:111], a[48:51], a[168:171]
    s_waitcnt lgkmcnt(7)
    ds_read_b64_tr_b16 a[94:95], v7 offset:17992
    v_mfma_f32_16x16x32_bf16 a[172:175], a[108:111], a[52:55], a[172:175]
    s_add_u32 m0, s51, 0
    v_mfma_f32_16x16x32_bf16 v[16:19], a[80:83], a[60:63], v[16:19]
    buffer_load_dwordx4 v1, s[16:19], s52 offen offset:0 nt lds
    v_mfma_f32_16x16x32_bf16 v[20:23], a[80:83], a[64:67], v[20:23]
    ds_read_b64_tr_b16 a[96:97], v7 offset:17536
    v_mfma_f32_16x16x32_bf16 v[24:27], a[80:83], a[68:71], v[24:27]
    s_add_u32 m0, s61, 45056
    v_mfma_f32_16x16x32_bf16 v[28:31], a[80:83], a[72:75], v[28:31]
    s_add_u32 s54, s44, s59
    ds_read_b64_tr_b16 a[98:99], v7 offset:18048
    v_mfma_f32_16x16x32_bf16 a[176:179], a[80:83], a[76:79], a[176:179]
    s_waitcnt lgkmcnt(6)
    buffer_load_dwordx4 v4, s[4:7], s54 offen lds
    v_mfma_f32_16x16x32_bf16 v[32:35], a[84:87], a[60:63], v[32:35]
    s_add_u32 m0, s61, 46016
    ds_read_b64_tr_b16 a[100:101], v7 offset:17544
    v_mfma_f32_16x16x32_bf16 v[36:39], a[84:87], a[64:67], v[36:39]
    ds_read_b64_tr_b16 a[102:103], v7 offset:18056
    v_mfma_f32_16x16x32_bf16 v[40:43], a[84:87], a[68:71], v[40:43]
    buffer_load_dwordx4 v4, s[4:7], s54 offen offset:64 lds
    v_mfma_f32_16x16x32_bf16 v[44:47], a[84:87], a[72:75], v[44:47]
    ds_read_b64_tr_b16 a[104:105], v7 offset:17600
    v_mfma_f32_16x16x32_bf16 a[180:183], a[84:87], a[76:79], a[180:183]
    s_waitcnt lgkmcnt(7)
    v_mfma_f32_16x16x32_bf16 v[48:51], a[88:91], a[60:63], v[48:51]
    s_add_u32 m0, s55, 1088
    ds_read_b64_tr_b16 a[106:107], v7 offset:18112
    v_mfma_f32_16x16x32_bf16 v[52:55], a[88:91], a[64:67], v[52:55]
    buffer_load_dwordx4 v5, s[8:11], s60 offen lds
    v_mfma_f32_16x16x32_bf16 v[56:59], a[88:91], a[68:71], v[56:59]
    s_add_u32 s60, s60, 8192
    ds_read_b64_tr_b16 a[108:109], v7 offset:17608
    v_mfma_f32_16x16x32_bf16 v[60:63], a[88:91], a[72:75], v[60:63]
    v_mfma_f32_16x16x32_bf16 a[184:187], a[88:91], a[76:79], a[184:187]
    s_waitcnt lgkmcnt(7)
    ds_read_b64_tr_b16 a[110:111], v7 offset:18120
    v_mfma_f32_16x16x32_bf16 v[64:67], a[92:95], a[60:63], v[64:67]
    s_waitcnt vmcnt(17)
    ds_read_b128 a[12:15], v6 offset:47104
    v_mfma_f32_16x16x32_bf16 v[68:71], a[92:95], a[64:67], v[68:71]
    ds_read_b64_tr_b16 a[80:81], v8 offset:17408
    v_mfma_f32_16x16x32_bf16 v[72:75], a[92:95], a[68:71], v[72:75]
    ds_read_b64_tr_b16 a[82:83], v8 offset:17920
    v_mfma_f32_16x16x32_bf16 v[76:79], a[92:95], a[72:75], v[76:79]
    s_waitcnt vmcnt(16)
    s_add_u32 m0, s55, 2176
    ds_read_b128 a[32:35], v6 offset:48128
    v_mfma_f32_16x16x32_bf16 a[188:191], a[92:95], a[76:79], a[188:191]
    s_waitcnt lgkmcnt(10)
    ds_read_b64_tr_b16 a[84:85], v8 offset:17416
    v_mfma_f32_16x16x32_bf16 v[80:83], a[96:99], a[60:63], v[80:83]
    buffer_load_dwordx4 v5, s[8:11], s60 offen lds
    v_mfma_f32_16x16x32_bf16 v[84:87], a[96:99], a[64:67], v[84:87]
    s_add_u32 s60, s60, 8192
    ds_read_b64_tr_b16 a[86:87], v8 offset:17928
    v_mfma_f32_16x16x32_bf16 v[88:91], a[96:99], a[68:71], v[88:91]
    v_mfma_f32_16x16x32_bf16 v[92:95], a[96:99], a[72:75], v[92:95]
    ds_read_b64_tr_b16 a[88:89], v8 offset:17472
    v_mfma_f32_16x16x32_bf16 a[192:195], a[96:99], a[76:79], a[192:195]
    s_waitcnt lgkmcnt(11)
    v_mfma_f32_16x16x32_bf16 v[96:99], a[100:103], a[60:63], v[96:99]
    s_add_u32 m0, s61, 47104
    ds_read_b64_tr_b16 a[90:91], v8 offset:17984
    v_mfma_f32_16x16x32_bf16 v[100:103], a[100:103], a[64:67], v[100:103]
    s_add_u32 s54, s45, s59
    ds_read_b64_tr_b16 a[92:93], v8 offset:17480
    v_mfma_f32_16x16x32_bf16 v[104:107], a[100:103], a[68:71], v[104:107]
    s_waitcnt lgkmcnt(5)
    buffer_load_dwordx4 v4, s[4:7], s54 offen lds
    v_mfma_f32_16x16x32_bf16 v[108:111], a[100:103], a[72:75], v[108:111]
    ds_read_b64_tr_b16 a[94:95], v8 offset:17992
    v_mfma_f32_16x16x32_bf16 a[196:199], a[100:103], a[76:79], a[196:199]
    s_add_u32 m0, s61, 48064
    v_mfma_f32_16x16x32_bf16 v[112:115], a[104:107], a[60:63], v[112:115]
    ds_read_b64_tr_b16 a[96:97], v8 offset:17536
    v_mfma_f32_16x16x32_bf16 v[116:119], a[104:107], a[64:67], v[116:119]
    buffer_load_dwordx4 v4, s[4:7], s54 offen offset:64 lds
    v_mfma_f32_16x16x32_bf16 v[120:123], a[104:107], a[68:71], v[120:123]
    ds_read_b64_tr_b16 a[98:99], v8 offset:18048
    v_mfma_f32_16x16x32_bf16 v[124:127], a[104:107], a[72:75], v[124:127]
    v_mfma_f32_16x16x32_bf16 a[200:203], a[104:107], a[76:79], a[200:203]
    s_add_u32 m0, s55, 3264
    ds_read_b64_tr_b16 a[100:101], v8 offset:17544
    v_mfma_f32_16x16x32_bf16 v[128:131], a[108:111], a[60:63], v[128:131]
    ds_read_b64_tr_b16 a[102:103], v8 offset:18056
    v_mfma_f32_16x16x32_bf16 v[132:135], a[108:111], a[64:67], v[132:135]
    buffer_load_dwordx4 v5, s[8:11], s60 offen lds
    v_mfma_f32_16x16x32_bf16 v[136:139], a[108:111], a[68:71], v[136:139]
    s_add_u32 s60, s60, 237568
    ds_read_b64_tr_b16 a[104:105], v8 offset:17600
    v_mfma_f32_16x16x32_bf16 v[140:143], a[108:111], a[72:75], v[140:143]
    v_mfma_f32_16x16x32_bf16 a[204:207], a[108:111], a[76:79], a[204:207]
    ds_read_b64_tr_b16 a[106:107], v8 offset:18112
    v_mfma_f32_16x16x32_bf16 v[144:147], a[80:83], a[60:63], v[144:147]
    s_waitcnt vmcnt(18)
    ds_read_b128 a[16:19], v6 offset:49152
    v_mfma_f32_16x16x32_bf16 v[148:151], a[80:83], a[64:67], v[148:151]
    ds_read_b64_tr_b16 a[108:109], v8 offset:17608
    v_mfma_f32_16x16x32_bf16 v[152:155], a[80:83], a[68:71], v[152:155]
    s_waitcnt vmcnt(17)
    ds_read_b128 a[36:39], v6 offset:50176
    v_mfma_f32_16x16x32_bf16 v[156:159], a[80:83], a[72:75], v[156:159]
    s_waitcnt lgkmcnt(13)
    ds_read_b64_tr_b16 a[110:111], v8 offset:18120
    v_mfma_f32_16x16x32_bf16 v[160:163], a[84:87], a[60:63], v[160:163]
    v_mfma_f32_16x16x32_bf16 v[164:167], a[84:87], a[64:67], v[164:167]
    v_mfma_f32_16x16x32_bf16 v[168:171], a[84:87], a[68:71], v[168:171]
    v_mfma_f32_16x16x32_bf16 v[172:175], a[84:87], a[72:75], v[172:175]
    s_waitcnt lgkmcnt(12)
    v_mfma_f32_16x16x32_bf16 v[176:179], a[88:91], a[60:63], v[176:179]
    s_add_u32 m0, s61, 49152
    v_mfma_f32_16x16x32_bf16 v[180:183], a[88:91], a[64:67], v[180:183]
    s_add_u32 s54, s46, s59
    v_mfma_f32_16x16x32_bf16 v[184:187], a[88:91], a[68:71], v[184:187]
    s_waitcnt lgkmcnt(1)
    buffer_load_dwordx4 v4, s[4:7], s54 offen lds
    v_mfma_f32_16x16x32_bf16 v[188:191], a[88:91], a[72:75], v[188:191]
    s_add_u32 m0, s61, 50112
    v_mfma_f32_16x16x32_bf16 v[192:195], a[92:95], a[60:63], v[192:195]
    v_mfma_f32_16x16x32_bf16 v[196:199], a[92:95], a[64:67], v[196:199]
    buffer_load_dwordx4 v4, s[4:7], s54 offen offset:64 lds
    v_mfma_f32_16x16x32_bf16 v[200:203], a[92:95], a[68:71], v[200:203]
    s_add_u32 s59, s59, 128
    v_mfma_f32_16x16x32_bf16 v[204:207], a[92:95], a[72:75], v[204:207]
    v_mfma_f32_16x16x32_bf16 v[208:211], a[96:99], a[60:63], v[208:211]
    s_waitcnt lgkmcnt(0)
    v_mfma_f32_16x16x32_bf16 v[212:215], a[96:99], a[64:67], v[212:215]
    s_barrier
    v_mfma_f32_16x16x32_bf16 v[216:219], a[96:99], a[68:71], v[216:219]
    v_mfma_f32_16x16x32_bf16 v[220:223], a[96:99], a[72:75], v[220:223]
    s_add_u32 m0, s55, 17408
    ds_read_b64_tr_b16 a[80:81], v7 offset:34816
    v_mfma_f32_16x16x32_bf16 v[224:227], a[100:103], a[60:63], v[224:227]
    ds_read_b64_tr_b16 a[82:83], v7 offset:35328
    v_mfma_f32_16x16x32_bf16 v[228:231], a[100:103], a[64:67], v[228:231]
    buffer_load_dwordx4 v5, s[8:11], s60 offen lds
    v_mfma_f32_16x16x32_bf16 v[232:235], a[100:103], a[68:71], v[232:235]
    s_add_u32 s60, s60, 8192
    ds_read_b64_tr_b16 a[84:85], v7 offset:34824
    v_mfma_f32_16x16x32_bf16 v[236:239], a[100:103], a[72:75], v[236:239]
    s_add_u32 m0, s51, 32
    v_mfma_f32_16x16x32_bf16 v[240:243], a[104:107], a[60:63], v[240:243]
    ds_read_b64_tr_b16 a[86:87], v7 offset:35336
    v_mfma_f32_16x16x32_bf16 v[244:247], a[104:107], a[64:67], v[244:247]
    buffer_load_dwordx4 v1, s[16:19], s52 offen offset:1024 nt lds
    v_mfma_f32_16x16x32_bf16 v[248:251], a[104:107], a[68:71], v[248:251]
    ds_read_b64_tr_b16 a[88:89], v7 offset:34880
    v_mfma_f32_16x16x32_bf16 v[252:255], a[104:107], a[72:75], v[252:255]
    v_mfma_f32_16x16x32_bf16 a[160:163], a[108:111], a[60:63], a[160:163]
    ds_read_b64_tr_b16 a[90:91], v7 offset:35392
    v_mfma_f32_16x16x32_bf16 a[164:167], a[108:111], a[64:67], a[164:167]
    ds_read_b64_tr_b16 a[92:93], v7 offset:34888
    v_mfma_f32_16x16x32_bf16 a[168:171], a[108:111], a[68:71], a[168:171]
    s_waitcnt lgkmcnt(5)
    ds_read_b64_tr_b16 a[94:95], v7 offset:35400
    v_mfma_f32_16x16x32_bf16 a[172:175], a[108:111], a[72:75], a[172:175]
    v_mfma_f32_16x16x32_bf16 v[16:19], a[80:83], a[0:3], v[16:19]
    v_mfma_f32_16x16x32_bf16 v[20:23], a[80:83], a[4:7], v[20:23]
    ds_read_b64_tr_b16 a[96:97], v7 offset:34944
    v_mfma_f32_16x16x32_bf16 v[24:27], a[80:83], a[8:11], v[24:27]
    s_add_u32 m0, s55, 18496
    v_mfma_f32_16x16x32_bf16 v[28:31], a[80:83], a[12:15], v[28:31]
    ds_read_b64_tr_b16 a[98:99], v7 offset:35456
    v_mfma_f32_16x16x32_bf16 a[176:179], a[80:83], a[16:19], a[176:179]
    s_waitcnt lgkmcnt(6)
    buffer_load_dwordx4 v5, s[8:11], s60 offen lds
    v_mfma_f32_16x16x32_bf16 v[32:35], a[84:87], a[0:3], v[32:35]
    s_add_u32 s60, s60, 8192
    ds_read_b64_tr_b16 a[100:101], v7 offset:34952
    v_mfma_f32_16x16x32_bf16 v[36:39], a[84:87], a[4:7], v[36:39]
    ds_read_b64_tr_b16 a[102:103], v7 offset:35464
    v_mfma_f32_16x16x32_bf16 v[40:43], a[84:87], a[8:11], v[40:43]
    v_mfma_f32_16x16x32_bf16 v[44:47], a[84:87], a[12:15], v[44:47]
    ds_read_b64_tr_b16 a[104:105], v7 offset:35008
    v_mfma_f32_16x16x32_bf16 a[180:183], a[84:87], a[16:19], a[180:183]
    s_waitcnt vmcnt(19) lgkmcnt(7)
    ds_read_b128 a[40:43], v6 offset:40960
    v_mfma_f32_16x16x32_bf16 v[48:51], a[88:91], a[0:3], v[48:51]
    ds_read_b64_tr_b16 a[106:107], v7 offset:35520
    v_mfma_f32_16x16x32_bf16 v[52:55], a[88:91], a[4:7], v[52:55]
    s_waitcnt vmcnt(17)
    ds_read_b128 a[60:63], v6 offset:41984
    v_mfma_f32_16x16x32_bf16 v[56:59], a[88:91], a[8:11], v[56:59]
    ds_read_b64_tr_b16 a[108:109], v7 offset:35016
    v_mfma_f32_16x16x32_bf16 v[60:63], a[88:91], a[12:15], v[60:63]
    v_mfma_f32_16x16x32_bf16 a[184:187], a[88:91], a[16:19], a[184:187]
    s_waitcnt lgkmcnt(9)
    ds_read_b64_tr_b16 a[110:111], v7 offset:35528
    v_mfma_f32_16x16x32_bf16 v[64:67], a[92:95], a[0:3], v[64:67]
    v_mfma_f32_16x16x32_bf16 v[68:71], a[92:95], a[4:7], v[68:71]
    ds_read_b64_tr_b16 a[80:81], v8 offset:34816
    v_mfma_f32_16x16x32_bf16 v[72:75], a[92:95], a[8:11], v[72:75]
    ds_read_b64_tr_b16 a[82:83], v8 offset:35328
    v_mfma_f32_16x16x32_bf16 v[76:79], a[92:95], a[12:15], v[76:79]
    s_add_u32 m0, s61, 40960
    v_mfma_f32_16x16x32_bf16 a[188:191], a[92:95], a[16:19], a[188:191]
    s_waitcnt lgkmcnt(10)
    s_add_u32 s54, s42, s59
    ds_read_b64_tr_b16 a[84:85], v8 offset:34824
    v_mfma_f32_16x16x32_bf16 v[80:83], a[96:99], a[0:3], v[80:83]
    s_waitcnt lgkmcnt(5)
    buffer_load_dwordx4 v4, s[4:7], s54 offen lds
    v_mfma_f32_16x16x32_bf16 v[84:87], a[96:99], a[4:7], v[84:87]
    ds_read_b64_tr_b16 a[86:87], v8 offset:35336
    v_mfma_f32_16x16x32_bf16 v[88:91], a[96:99], a[8:11], v[88:91]
    s_add_u32 m0, s55, 19584
    v_mfma_f32_16x16x32_bf16 v[92:95], a[96:99], a[12:15], v[92:95]
    ds_read_b64_tr_b16 a[88:89], v8 offset:34880
    v_mfma_f32_16x16x32_bf16 a[192:195], a[96:99], a[16:19], a[192:195]
    buffer_load_dwordx4 v5, s[8:11], s60 offen lds
    v_mfma_f32_16x16x32_bf16 v[96:99], a[100:103], a[0:3], v[96:99]
    s_add_u32 s60, s60, 8192
    ds_read_b64_tr_b16 a[90:91], v8 offset:35392
    v_mfma_f32_16x16x32_bf16 v[100:103], a[100:103], a[4:7], v[100:103]
    s_add_u32 m0, s61, 41920
    ds_read_b64_tr_b16 a[92:93], v8 offset:34888
    v_mfma_f32_16x16x32_bf16 v[104:107], a[100:103], a[8:11], v[104:107]
    buffer_load_dwordx4 v4, s[4:7], s54 offen offset:64 lds
    v_mfma_f32_16x16x32_bf16 v[108:111], a[100:103], a[12:15], v[108:111]
    ds_read_b64_tr_b16 a[94:95], v8 offset:35400
    v_mfma_f32_16x16x32_bf16 a[196:199], a[100:103], a[16:19], a[196:199]
    v_mfma_f32_16x16x32_bf16 v[112:115], a[104:107], a[0:3], v[112:115]
    ds_read_b64_tr_b16 a[96:97], v8 offset:34944
    v_mfma_f32_16x16x32_bf16 v[116:119], a[104:107], a[4:7], v[116:119]
    v_mfma_f32_16x16x32_bf16 v[120:123], a[104:107], a[8:11], v[120:123]
    ds_read_b64_tr_b16 a[98:99], v8 offset:35456
    v_mfma_f32_16x16x32_bf16 v[124:127], a[104:107], a[12:15], v[124:127]
    v_mfma_f32_16x16x32_bf16 a[200:203], a[104:107], a[16:19], a[200:203]
    s_waitcnt lgkmcnt(10)
    ds_read_b64_tr_b16 a[100:101], v8 offset:34952
    v_mfma_f32_16x16x32_bf16 v[128:131], a[108:111], a[0:3], v[128:131]
    ds_read_b64_tr_b16 a[102:103], v8 offset:35464
    v_mfma_f32_16x16x32_bf16 v[132:135], a[108:111], a[4:7], v[132:135]
    s_waitcnt vmcnt(18)
    ds_read_b128 a[44:47], v6 offset:43008
    v_mfma_f32_16x16x32_bf16 v[136:139], a[108:111], a[8:11], v[136:139]
    ds_read_b64_tr_b16 a[104:105], v8 offset:35008
    v_mfma_f32_16x16x32_bf16 v[140:143], a[108:111], a[12:15], v[140:143]
    s_waitcnt vmcnt(17)
    s_add_u32 m0, s55, 20672
    ds_read_b128 a[64:67], v6 offset:44032
    v_mfma_f32_16x16x32_bf16 a[204:207], a[108:111], a[16:19], a[204:207]
    s_waitcnt lgkmcnt(13)
    ds_read_b64_tr_b16 a[106:107], v8 offset:35520
    v_mfma_f32_16x16x32_bf16 v[144:147], a[80:83], a[0:3], v[144:147]
    buffer_load_dwordx4 v5, s[8:11], s60 offen lds
    v_mfma_f32_16x16x32_bf16 v[148:151], a[80:83], a[4:7], v[148:151]
    s_add_u32 s60, s60, 237568
    ds_read_b64_tr_b16 a[108:109], v8 offset:35016
    v_mfma_f32_16x16x32_bf16 v[152:155], a[80:83], a[8:11], v[152:155]
    v_mfma_f32_16x16x32_bf16 v[156:159], a[80:83], a[12:15], v[156:159]
    s_waitcnt lgkmcnt(13)
    ds_read_b64_tr_b16 a[110:111], v8 offset:35528
    v_mfma_f32_16x16x32_bf16 v[160:163], a[84:87], a[0:3], v[160:163]
    s_add_u32 m0, s61, 43008
    v_mfma_f32_16x16x32_bf16 v[164:167], a[84:87], a[4:7], v[164:167]
    s_add_u32 s54, s43, s59
    v_mfma_f32_16x16x32_bf16 v[168:171], a[84:87], a[8:11], v[168:171]
    s_waitcnt lgkmcnt(3)
    buffer_load_dwordx4 v4, s[4:7], s54 offen lds
    v_mfma_f32_16x16x32_bf16 v[172:175], a[84:87], a[12:15], v[172:175]
    s_add_u32 m0, s61, 43968
    v_mfma_f32_16x16x32_bf16 v[176:179], a[88:91], a[0:3], v[176:179]
    v_mfma_f32_16x16x32_bf16 v[180:183], a[88:91], a[4:7], v[180:183]
    buffer_load_dwordx4 v4, s[4:7], s54 offen offset:64 lds
    v_mfma_f32_16x16x32_bf16 v[184:187], a[88:91], a[8:11], v[184:187]
    v_mfma_f32_16x16x32_bf16 v[188:191], a[88:91], a[12:15], v[188:191]
    v_mfma_f32_16x16x32_bf16 v[192:195], a[92:95], a[0:3], v[192:195]
    v_mfma_f32_16x16x32_bf16 v[196:199], a[92:95], a[4:7], v[196:199]
    v_mfma_f32_16x16x32_bf16 v[200:203], a[92:95], a[8:11], v[200:203]
    v_mfma_f32_16x16x32_bf16 v[204:207], a[92:95], a[12:15], v[204:207]
    v_mfma_f32_16x16x32_bf16 v[208:211], a[96:99], a[0:3], v[208:211]
    s_waitcnt lgkmcnt(0)
    v_mfma_f32_16x16x32_bf16 v[212:215], a[96:99], a[4:7], v[212:215]
    s_barrier
    v_mfma_f32_16x16x32_bf16 v[216:219], a[96:99], a[8:11], v[216:219]
    v_mfma_f32_16x16x32_bf16 v[220:223], a[96:99], a[12:15], v[220:223]
    ds_read_b64_tr_b16 a[80:81], v7 offset:52224
    v_mfma_f32_16x16x32_bf16 v[224:227], a[100:103], a[0:3], v[224:227]
    ds_read_b64_tr_b16 a[82:83], v7 offset:52736
    v_mfma_f32_16x16x32_bf16 v[228:231], a[100:103], a[4:7], v[228:231]
    s_waitcnt vmcnt(17)
    ds_read_b128 a[48:51], v6 offset:45056
    v_mfma_f32_16x16x32_bf16 v[232:235], a[100:103], a[8:11], v[232:235]
    ds_read_b64_tr_b16 a[84:85], v7 offset:52232
    v_mfma_f32_16x16x32_bf16 v[236:239], a[100:103], a[12:15], v[236:239]
    s_waitcnt vmcnt(16)
    ds_read_b128 a[68:71], v6 offset:46080
    v_mfma_f32_16x16x32_bf16 v[240:243], a[104:107], a[0:3], v[240:243]
    s_add_u32 m0, s55, 34816
    ds_read_b64_tr_b16 a[86:87], v7 offset:52744
    v_mfma_f32_16x16x32_bf16 v[244:247], a[104:107], a[4:7], v[244:247]
    buffer_load_dwordx4 v5, s[8:11], s60 offen lds
    v_mfma_f32_16x16x32_bf16 v[248:251], a[104:107], a[8:11], v[248:251]
    s_add_u32 s60, s60, 8192
    ds_read_b64_tr_b16 a[88:89], v7 offset:52288
    v_mfma_f32_16x16x32_bf16 v[252:255], a[104:107], a[12:15], v[252:255]
    v_mfma_f32_16x16x32_bf16 a[160:163], a[108:111], a[0:3], a[160:163]
    ds_read_b64_tr_b16 a[90:91], v7 offset:52800
    v_mfma_f32_16x16x32_bf16 a[164:167], a[108:111], a[4:7], a[164:167]
    ds_read_b64_tr_b16 a[92:93], v7 offset:52296
    v_mfma_f32_16x16x32_bf16 a[168:171], a[108:111], a[8:11], a[168:171]
    s_waitcnt lgkmcnt(7)
    ds_read_b64_tr_b16 a[94:95], v7 offset:52808
    v_mfma_f32_16x16x32_bf16 a[172:175], a[108:111], a[12:15], a[172:175]
    s_add_u32 m0, s51, 64
    v_mfma_f32_16x16x32_bf16 v[16:19], a[80:83], a[20:23], v[16:19]
    buffer_load_dwordx4 v1, s[16:19], s52 offen offset:2048 nt lds
    v_mfma_f32_16x16x32_bf16 v[20:23], a[80:83], a[24:27], v[20:23]
    ds_read_b64_tr_b16 a[96:97], v7 offset:52352
    v_mfma_f32_16x16x32_bf16 v[24:27], a[80:83], a[28:31], v[24:27]
    s_add_u32 m0, s61, 45056
    v_mfma_f32_16x16x32_bf16 v[28:31], a[80:83], a[32:35], v[28:31]
    s_add_u32 s54, s44, s59
    ds_read_b64_tr_b16 a[98:99], v7 offset:52864
    v_mfma_f32_16x16x32_bf16 a[176:179], a[80:83], a[36:39], a[176:179]
    s_waitcnt lgkmcnt(6)
    buffer_load_dwordx4 v4, s[4:7], s54 offen lds
    v_mfma_f32_16x16x32_bf16 v[32:35], a[84:87], a[20:23], v[32:35]
    s_add_u32 m0, s61, 46016
    ds_read_b64_tr_b16 a[100:101], v7 offset:52360
    v_mfma_f32_16x16x32_bf16 v[36:39], a[84:87], a[24:27], v[36:39]
    ds_read_b64_tr_b16 a[102:103], v7 offset:52872
    v_mfma_f32_16x16x32_bf16 v[40:43], a[84:87], a[28:31], v[40:43]
    buffer_load_dwordx4 v4, s[4:7], s54 offen offset:64 lds
    v_mfma_f32_16x16x32_bf16 v[44:47], a[84:87], a[32:35], v[44:47]
    ds_read_b64_tr_b16 a[104:105], v7 offset:52416
    v_mfma_f32_16x16x32_bf16 a[180:183], a[84:87], a[36:39], a[180:183]
    s_waitcnt lgkmcnt(7)
    v_mfma_f32_16x16x32_bf16 v[48:51], a[88:91], a[20:23], v[48:51]
    s_add_u32 m0, s55, 35904
    ds_read_b64_tr_b16 a[106:107], v7 offset:52928
    v_mfma_f32_16x16x32_bf16 v[52:55], a[88:91], a[24:27], v[52:55]
    buffer_load_dwordx4 v5, s[8:11], s60 offen lds
    v_mfma_f32_16x16x32_bf16 v[56:59], a[88:91], a[28:31], v[56:59]
    s_add_u32 s60, s60, 8192
    ds_read_b64_tr_b16 a[108:109], v7 offset:52424
    v_mfma_f32_16x16x32_bf16 v[60:63], a[88:91], a[32:35], v[60:63]
    v_mfma_f32_16x16x32_bf16 a[184:187], a[88:91], a[36:39], a[184:187]
    s_waitcnt lgkmcnt(7)
    ds_read_b64_tr_b16 a[110:111], v7 offset:52936
    v_mfma_f32_16x16x32_bf16 v[64:67], a[92:95], a[20:23], v[64:67]
    s_waitcnt vmcnt(18)
    ds_read_b128 a[52:55], v6 offset:47104
    v_mfma_f32_16x16x32_bf16 v[68:71], a[92:95], a[24:27], v[68:71]
    ds_read_b64_tr_b16 a[80:81], v8 offset:52224
    v_mfma_f32_16x16x32_bf16 v[72:75], a[92:95], a[28:31], v[72:75]
    ds_read_b64_tr_b16 a[82:83], v8 offset:52736
    v_mfma_f32_16x16x32_bf16 v[76:79], a[92:95], a[32:35], v[76:79]
    s_waitcnt vmcnt(17)
    s_add_u32 m0, s55, 36992
    ds_read_b128 a[72:75], v6 offset:48128
    v_mfma_f32_16x16x32_bf16 a[188:191], a[92:95], a[36:39], a[188:191]
    s_waitcnt lgkmcnt(10)
    ds_read_b64_tr_b16 a[84:85], v8 offset:52232
    v_mfma_f32_16x16x32_bf16 v[80:83], a[96:99], a[20:23], v[80:83]
    buffer_load_dwordx4 v5, s[8:11], s60 offen lds
    v_mfma_f32_16x16x32_bf16 v[84:87], a[96:99], a[24:27], v[84:87]
    s_add_u32 s60, s60, 8192
    ds_read_b64_tr_b16 a[86:87], v8 offset:52744
    v_mfma_f32_16x16x32_bf16 v[88:91], a[96:99], a[28:31], v[88:91]
    v_mfma_f32_16x16x32_bf16 v[92:95], a[96:99], a[32:35], v[92:95]
    ds_read_b64_tr_b16 a[88:89], v8 offset:52288
    v_mfma_f32_16x16x32_bf16 a[192:195], a[96:99], a[36:39], a[192:195]
    s_waitcnt lgkmcnt(11)
    v_mfma_f32_16x16x32_bf16 v[96:99], a[100:103], a[20:23], v[96:99]
    s_add_u32 m0, s61, 47104
    ds_read_b64_tr_b16 a[90:91], v8 offset:52800
    v_mfma_f32_16x16x32_bf16 v[100:103], a[100:103], a[24:27], v[100:103]
    s_add_u32 s54, s45, s59
    ds_read_b64_tr_b16 a[92:93], v8 offset:52296
    v_mfma_f32_16x16x32_bf16 v[104:107], a[100:103], a[28:31], v[104:107]
    s_waitcnt lgkmcnt(5)
    buffer_load_dwordx4 v4, s[4:7], s54 offen lds
    v_mfma_f32_16x16x32_bf16 v[108:111], a[100:103], a[32:35], v[108:111]
    ds_read_b64_tr_b16 a[94:95], v8 offset:52808
    v_mfma_f32_16x16x32_bf16 a[196:199], a[100:103], a[36:39], a[196:199]
    s_add_u32 m0, s61, 48064
    v_mfma_f32_16x16x32_bf16 v[112:115], a[104:107], a[20:23], v[112:115]
    ds_read_b64_tr_b16 a[96:97], v8 offset:52352
    v_mfma_f32_16x16x32_bf16 v[116:119], a[104:107], a[24:27], v[116:119]
    buffer_load_dwordx4 v4, s[4:7], s54 offen offset:64 lds
    v_mfma_f32_16x16x32_bf16 v[120:123], a[104:107], a[28:31], v[120:123]
    ds_read_b64_tr_b16 a[98:99], v8 offset:52864
    v_mfma_f32_16x16x32_bf16 v[124:127], a[104:107], a[32:35], v[124:127]
    v_mfma_f32_16x16x32_bf16 a[200:203], a[104:107], a[36:39], a[200:203]
    s_add_u32 m0, s55, 38080
    ds_read_b64_tr_b16 a[100:101], v8 offset:52360
    v_mfma_f32_16x16x32_bf16 v[128:131], a[108:111], a[20:23], v[128:131]
    ds_read_b64_tr_b16 a[102:103], v8 offset:52872
    v_mfma_f32_16x16x32_bf16 v[132:135], a[108:111], a[24:27], v[132:135]
    buffer_load_dwordx4 v5, s[8:11], s60 offen lds
    v_mfma_f32_16x16x32_bf16 v[136:139], a[108:111], a[28:31], v[136:139]
    s_add_u32 s60, s60, 237568
    ds_read_b64_tr_b16 a[104:105], v8 offset:52416
    v_mfma_f32_16x16x32_bf16 v[140:143], a[108:111], a[32:35], v[140:143]
    v_mfma_f32_16x16x32_bf16 a[204:207], a[108:111], a[36:39], a[204:207]
    ds_read_b64_tr_b16 a[106:107], v8 offset:52928
    v_mfma_f32_16x16x32_bf16 v[144:147], a[80:83], a[20:23], v[144:147]
    s_waitcnt vmcnt(19)
    ds_read_b128 a[56:59], v6 offset:49152
    v_mfma_f32_16x16x32_bf16 v[148:151], a[80:83], a[24:27], v[148:151]
    ds_read_b64_tr_b16 a[108:109], v8 offset:52424
    v_mfma_f32_16x16x32_bf16 v[152:155], a[80:83], a[28:31], v[152:155]
    s_waitcnt vmcnt(18)
    ds_read_b128 a[76:79], v6 offset:50176
    v_mfma_f32_16x16x32_bf16 v[156:159], a[80:83], a[32:35], v[156:159]
    s_waitcnt lgkmcnt(13)
    ds_read_b64_tr_b16 a[110:111], v8 offset:52936
    v_mfma_f32_16x16x32_bf16 v[160:163], a[84:87], a[20:23], v[160:163]
    v_mfma_f32_16x16x32_bf16 v[164:167], a[84:87], a[24:27], v[164:167]
    v_mfma_f32_16x16x32_bf16 v[168:171], a[84:87], a[28:31], v[168:171]
    v_mfma_f32_16x16x32_bf16 v[172:175], a[84:87], a[32:35], v[172:175]
    s_waitcnt lgkmcnt(12)
    v_mfma_f32_16x16x32_bf16 v[176:179], a[88:91], a[20:23], v[176:179]
    s_add_u32 m0, s61, 49152
    v_mfma_f32_16x16x32_bf16 v[180:183], a[88:91], a[24:27], v[180:183]
    s_add_u32 s54, s46, s59
    v_mfma_f32_16x16x32_bf16 v[184:187], a[88:91], a[28:31], v[184:187]
    s_waitcnt lgkmcnt(1)
    buffer_load_dwordx4 v4, s[4:7], s54 offen lds
    v_mfma_f32_16x16x32_bf16 v[188:191], a[88:91], a[32:35], v[188:191]
    s_add_u32 m0, s61, 50112
    v_mfma_f32_16x16x32_bf16 v[192:195], a[92:95], a[20:23], v[192:195]
    v_mfma_f32_16x16x32_bf16 v[196:199], a[92:95], a[24:27], v[196:199]
    buffer_load_dwordx4 v4, s[4:7], s54 offen offset:64 lds
    v_mfma_f32_16x16x32_bf16 v[200:203], a[92:95], a[28:31], v[200:203]
    s_add_u32 s59, s59, 128
    v_mfma_f32_16x16x32_bf16 v[204:207], a[92:95], a[32:35], v[204:207]
    v_mfma_f32_16x16x32_bf16 v[208:211], a[96:99], a[20:23], v[208:211]
    s_waitcnt lgkmcnt(0)
    v_mfma_f32_16x16x32_bf16 v[212:215], a[96:99], a[24:27], v[212:215]
    s_barrier
    v_mfma_f32_16x16x32_bf16 v[216:219], a[96:99], a[28:31], v[216:219]
    v_mfma_f32_16x16x32_bf16 v[220:223], a[96:99], a[32:35], v[220:223]
    s_add_u32 m0, s55, 52224
    ds_read_b64_tr_b16 a[80:81], v7 offset:0
    v_mfma_f32_16x16x32_bf16 v[224:227], a[100:103], a[20:23], v[224:227]
    ds_read_b64_tr_b16 a[82:83], v7 offset:512
    v_mfma_f32_16x16x32_bf16 v[228:231], a[100:103], a[24:27], v[228:231]
    buffer_load_dwordx4 v5, s[8:11], s60 offen lds
    v_mfma_f32_16x16x32_bf16 v[232:235], a[100:103], a[28:31], v[232:235]
    s_add_u32 s60, s60, 8192
    ds_read_b64_tr_b16 a[84:85], v7 offset:8
    v_mfma_f32_16x16x32_bf16 v[236:239], a[100:103], a[32:35], v[236:239]
    s_add_u32 m0, s51, 96
    v_mfma_f32_16x16x32_bf16 v[240:243], a[104:107], a[20:23], v[240:243]
    ds_read_b64_tr_b16 a[86:87], v7 offset:520
    v_mfma_f32_16x16x32_bf16 v[244:247], a[104:107], a[24:27], v[244:247]
    buffer_load_dwordx4 v1, s[16:19], s52 offen offset:3072 nt lds
    v_mfma_f32_16x16x32_bf16 v[248:251], a[104:107], a[28:31], v[248:251]
    s_add_u32 s51, s51, 17408
    ds_read_b64_tr_b16 a[88:89], v7 offset:64
    v_mfma_f32_16x16x32_bf16 v[252:255], a[104:107], a[32:35], v[252:255]
    s_add_u32 s52, s52, 16384
    v_mfma_f32_16x16x32_bf16 a[160:163], a[108:111], a[20:23], a[160:163]
    s_cmp_lg_u32 s59, 1152
    ds_read_b64_tr_b16 a[90:91], v7 offset:576
    v_mfma_f32_16x16x32_bf16 a[164:167], a[108:111], a[24:27], a[164:167]
    ds_read_b64_tr_b16 a[92:93], v7 offset:72
    v_mfma_f32_16x16x32_bf16 a[168:171], a[108:111], a[28:31], a[168:171]
    s_waitcnt lgkmcnt(5)
    ds_read_b64_tr_b16 a[94:95], v7 offset:584
    v_mfma_f32_16x16x32_bf16 a[172:175], a[108:111], a[32:35], a[172:175]
    s_cbranch_scc1 L_qloop
    v_mfma_f32_16x16x32_bf16 v[16:19], a[80:83], a[40:43], v[16:19]
    v_mfma_f32_16x16x32_bf16 v[20:23], a[80:83], a[44:47], v[20:23]
    ds_read_b64_tr_b16 a[96:97], v7 offset:128
    v_mfma_f32_16x16x32_bf16 v[24:27], a[80:83], a[48:51], v[24:27]
    s_add_u32 m0, s55, 53312
    v_mfma_f32_16x16x32_bf16 v[28:31], a[80:83], a[52:55], v[28:31]
    ds_read_b64_tr_b16 a[98:99], v7 offset:640
    v_mfma_f32_16x16x32_bf16 a[176:179], a[80:83], a[56:59], a[176:179]
    s_waitcnt lgkmcnt(6)
    buffer_load_dwordx4 v5, s[8:11], s60 offen lds
    v_mfma_f32_16x16x32_bf16 v[32:35], a[84:87], a[40:43], v[32:35]
    s_add_u32 s60, s60, 8192
    ds_read_b64_tr_b16 a[100:101], v7 offset:136
    v_mfma_f32_16x16x32_bf16 v[36:39], a[84:87], a[44:47], v[36:39]
    ds_read_b64_tr_b16 a[102:103], v7 offset:648
    v_mfma_f32_16x16x32_bf16 v[40:43], a[84:87], a[48:51], v[40:43]
    v_mfma_f32_16x16x32_bf16 v[44:47], a[84:87], a[52:55], v[44:47]
    ds_read_b64_tr_b16 a[104:105], v7 offset:192
    v_mfma_f32_16x16x32_bf16 a[180:183], a[84:87], a[56:59], a[180:183]
    s_waitcnt vmcnt(19) lgkmcnt(7)
    ds_read_b128 a[0:3], v6 offset:40960
    v_mfma_f32_16x16x32_bf16 v[48:51], a[88:91], a[40:43], v[48:51]
    ds_read_b64_tr_b16 a[106:107], v7 offset:704
    v_mfma_f32_16x16x32_bf16 v[52:55], a[88:91], a[44:47], v[52:55]
    s_waitcnt vmcnt(17)
    ds_read_b128 a[20:23], v6 offset:41984
    v_mfma_f32_16x16x32_bf16 v[56:59], a[88:91], a[48:51], v[56:59]
    ds_read_b64_tr_b16 a[108:109], v7 offset:200
    v_mfma_f32_16x16x32_bf16 v[60:63], a[88:91], a[52:55], v[60:63]
    v_mfma_f32_16x16x32_bf16 a[184:187], a[88:91], a[56:59], a[184:187]
    s_waitcnt lgkmcnt(9)
    ds_read_b64_tr_b16 a[110:111], v7 offset:712
    v_mfma_f32_16x16x32_bf16 v[64:67], a[92:95], a[40:43], v[64:67]
    v_mfma_f32_16x16x32_bf16 v[68:71], a[92:95], a[44:47], v[68:71]
    ds_read_b64_tr_b16 a[80:81], v8 offset:0
    v_mfma_f32_16x16x32_bf16 v[72:75], a[92:95], a[48:51], v[72:75]
    ds_read_b64_tr_b16 a[82:83], v8 offset:512
    v_mfma_f32_16x16x32_bf16 v[76:79], a[92:95], a[52:55], v[76:79]
    s_add_u32 m0, s55, 54400
    v_mfma_f32_16x16x32_bf16 a[188:191], a[92:95], a[56:59], a[188:191]
    s_waitcnt lgkmcnt(10)
    ds_read_b64_tr_b16 a[84:85], v8 offset:8
    v_mfma_f32_16x16x32_bf16 v[80:83], a[96:99], a[40:43], v[80:83]
    buffer_load_dwordx4 v5, s[8:11], s60 offen lds
    v_mfma_f32_16x16x32_bf16 v[84:87], a[96:99], a[44:47], v[84:87]
    s_add_u32 s60, s60, 8192
    ds_read_b64_tr_b16 a[86:87], v8 offset:520
    v_mfma_f32_16x16x32_bf16 v[88:91], a[96:99], a[48:51], v[88:91]
    v_mfma_f32_16x16x32_bf16 v[92:95], a[96:99], a[52:55], v[92:95]
    ds_read_b64_tr_b16 a[88:89], v8 offset:64
    v_mfma_f32_16x16x32_bf16 a[192:195], a[96:99], a[56:59], a[192:195]
    s_waitcnt lgkmcnt(11)
    v_mfma_f32_16x16x32_bf16 v[96:99], a[100:103], a[40:43], v[96:99]
    ds_read_b64_tr_b16 a[90:91], v8 offset:576
    v_mfma_f32_16x16x32_bf16 v[100:103], a[100:103], a[44:47], v[100:103]
    ds_read_b64_tr_b16 a[92:93], v8 offset:72
    v_mfma_f32_16x16x32_bf16 v[104:107], a[100:103], a[48:51], v[104:107]
    v_mfma_f32_16x16x32_bf16 v[108:111], a[100:103], a[52:55], v[108:111]
    ds_read_b64_tr_b16 a[94:95], v8 offset:584
    v_mfma_f32_16x16x32_bf16 a[196:199], a[100:103], a[56:59], a[196:199]
    s_waitcnt lgkmcnt(11)
    v_mfma_f32_16x16x32_bf16 v[112:115], a[104:107], a[40:43], v[112:115]
    ds_read_b64_tr_b16 a[96:97], v8 offset:128
    v_mfma_f32_16x16x32_bf16 v[116:119], a[104:107], a[44:47], v[116:119]
    v_mfma_f32_16x16x32_bf16 v[120:123], a[104:107], a[48:51], v[120:123]
    ds_read_b64_tr_b16 a[98:99], v8 offset:640
    v_mfma_f32_16x16x32_bf16 v[124:127], a[104:107], a[52:55], v[124:127]
    v_mfma_f32_16x16x32_bf16 a[200:203], a[104:107], a[56:59], a[200:203]
    s_waitcnt lgkmcnt(10)
    ds_read_b64_tr_b16 a[100:101], v8 offset:136
    v_mfma_f32_16x16x32_bf16 v[128:131], a[108:111], a[40:43], v[128:131]
    ds_read_b64_tr_b16 a[102:103], v8 offset:648
    v_mfma_f32_16x16x32_bf16 v[132:135], a[108:111], a[44:47], v[132:135]
    s_waitcnt vmcnt(16)
    ds_read_b128 a[4:7], v6 offset:43008
    v_mfma_f32_16x16x32_bf16 v[136:139], a[108:111], a[48:51], v[136:139]
    ds_read_b64_tr_b16 a[104:105], v8 offset:192
    v_mfma_f32_16x16x32_bf16 v[140:143], a[108:111], a[52:55], v[140:143]
    s_waitcnt vmcnt(15)
    s_add_u32 m0, s55, 55488
    ds_read_b128 a[24:27], v6 offset:44032
    v_mfma_f32_16x16x32_bf16 a[204:207], a[108:111], a[56:59], a[204:207]
    s_waitcnt lgkmcnt(13)
    ds_read_b64_tr_b16 a[106:107], v8 offset:704
    v_mfma_f32_16x16x32_bf16 v[144:147], a[80:83], a[40:43], v[144:147]
    buffer_load_dwordx4 v5, s[8:11], s60 offen lds
    v_mfma_f32_16x16x32_bf16 v[148:151], a[80:83], a[44:47], v[148:151]
    s_add_u32 s60, s60, 237568
    ds_read_b64_tr_b16 a[108:109], v8 offset:200
    v_mfma_f32_16x16x32_bf16 v[152:155], a[80:83], a[48:51], v[152:155]
    v_mfma_f32_16x16x32_bf16 v[156:159], a[80:83], a[52:55], v[156:159]
    s_waitcnt lgkmcnt(13)
    ds_read_b64_tr_b16 a[110:111], v8 offset:712
    v_mfma_f32_16x16x32_bf16 v[160:163], a[84:87], a[40:43], v[160:163]
    s_mov_b32 s4, s100
    s_mov_b32 s5, s101
    v_mfma_f32_16x16x32_bf16 v[164:167], a[84:87], a[44:47], v[164:167]
    s_mov_b32 s6, L_end-L_pc
    v_mfma_f32_16x16x32_bf16 v[168:171], a[84:87], a[48:51], v[168:171]
    v_lshrrev_b32 v10, 3, v0
    v_mfma_f32_16x16x32_bf16 v[172:175], a[84:87], a[52:55], v[172:175]
    s_waitcnt lgkmcnt(12)
    v_lshlrev_b32 v10, 24, v10
    v_mfma_f32_16x16x32_bf16 v[176:179], a[88:91], a[40:43], v[176:179]
    v_lshl_add_u32 v10, v0, 7, v10
    v_mfma_f32_16x16x32_bf16 v[180:183], a[88:91], a[44:47], v[180:183]
    v_mov_b32 v11, s66
    v_mfma_f32_16x16x32_bf16 v[184:187], a[88:91], a[48:51], v[184:187]
    v_lshl_add_u32 v10, v11, 10, v10
    s_mov_b32 s60, L_qepi-L_pc
    v_mfma_f32_16x16x32_bf16 v[188:191], a[88:91], a[52:55], v[188:191]
    s_waitcnt lgkmcnt(10)
    v_mfma_f32_16x16x32_bf16 v[192:195], a[92:95], a[40:43], v[192:195]
    buffer_load_dword v11, v10, s[4:7], s60 offen
    v_mfma_f32_16x16x32_bf16 v[196:199], a[92:95], a[44:47], v[196:199]
    v_mfma_f32_16x16x32_bf16 v[200:203], a[92:95], a[48:51], v[200:203]
    v_mfma_f32_16x16x32_bf16 v[204:207], a[92:95], a[52:55], v[204:207]
    s_waitcnt lgkmcnt(8)
    v_mfma_f32_16x16x32_bf16 v[208:211], a[96:99], a[40:43], v[208:211]
    s_waitcnt lgkmcnt(0)
    v_mfma_f32_16x16x32_bf16 v[212:215], a[96:99], a[44:47], v[212:215]
    s_barrier
    v_mfma_f32_16x16x32_bf16 v[216:219], a[96:99], a[48:51], v[216:219]
    v_mfma_f32_16x16x32_bf16 v[220:223], a[96:99], a[52:55], v[220:223]
    ds_read_b64_tr_b16 a[80:81], v7 offset:17408
    v_mfma_f32_16x16x32_bf16 v[224:227], a[100:103], a[40:43], v[224:227]
    ds_read_b64_tr_b16 a[82:83], v7 offset:17920
    v_mfma_f32_16x16x32_bf16 v[228:231], a[100:103], a[44:47], v[228:231]
    s_waitcnt vmcnt(14)
    ds_read_b128 a[8:11], v6 offset:45056
    v_mfma_f32_16x16x32_bf16 v[232:235], a[100:103], a[48:51], v[232:235]
    ds_read_b64_tr_b16 a[84:85], v7 offset:17416
    v_mfma_f32_16x16x32_bf16 v[236:239], a[100:103], a[52:55], v[236:239]
    s_waitcnt vmcnt(13)
    ds_read_b128 a[28:31], v6 offset:46080
    v_mfma_f32_16x16x32_bf16 v[240:243], a[104:107], a[40:43], v[240:243]
    s_add_u32 m0, s63, 0
    ds_read_b64_tr_b16 a[86:87], v7 offset:17928
    v_mfma_f32_16x16x32_bf16 v[244:247], a[104:107], a[44:47], v[244:247]
    s_mov_b32 s67, 0
    buffer_load_dwordx4 v1, s[12:15], s67 offen offset:0 nt lds
    v_mfma_f32_16x16x32_bf16 v[248:251], a[104:107], a[48:51], v[248:251]
    ds_read_b64_tr_b16 a[88:89], v7 offset:17472
    v_mfma_f32_16x16x32_bf16 v[252:255], a[104:107], a[52:55], v[252:255]
    v_mfma_f32_16x16x32_bf16 a[160:163], a[108:111], a[40:43], a[160:163]
    ds_read_b64_tr_b16 a[90:91], v7 offset:17984
    v_mfma_f32_16x16x32_bf16 a[164:167], a[108:111], a[44:47], a[164:167]
    ds_read_b64_tr_b16 a[92:93], v7 offset:17480
    v_mfma_f32_16x16x32_bf16 a[168:171], a[108:111], a[48:51], a[168:171]
    s_waitcnt lgkmcnt(7)
    ds_read_b64_tr_b16 a[94:95], v7 offset:17992
    v_mfma_f32_16x16x32_bf16 a[172:175], a[108:111], a[52:55], a[172:175]
    v_mfma_f32_16x16x32_bf16 v[16:19], a[80:83], a[60:63], v[16:19]
    v_mfma_f32_16x16x32_bf16 v[20:23], a[80:83], a[64:67], v[20:23]
    ds_read_b64_tr_b16 a[96:97], v7 offset:17536
    v_mfma_f32_16x16x32_bf16 v[24:27], a[80:83], a[68:71], v[24:27]
    s_add_u32 m0, s63, 32
    v_mfma_f32_16x16x32_bf16 v[28:31], a[80:83], a[72:75], v[28:31]
    ds_read_b64_tr_b16 a[98:99], v7 offset:18048
    v_mfma_f32_16x16x32_bf16 a[176:179], a[80:83], a[76:79], a[176:179]
    s_waitcnt lgkmcnt(6)
    buffer_load_dwordx4 v1, s[12:15], s67 offen offset:1024 nt lds
    v_mfma_f32_16x16x32_bf16 v[32:35], a[84:87], a[60:63], v[32:35]
    ds_read_b64_tr_b16 a[100:101], v7 offset:17544
    v_mfma_f32_16x16x32_bf16 v[36:39], a[84:87], a[64:67], v[36:39]
    ds_read_b64_tr_b16 a[102:103], v7 offset:18056
    v_mfma_f32_16x16x32_bf16 v[40:43], a[84:87], a[68:71], v[40:43]
    v_mfma_f32_16x16x32_bf16 v[44:47], a[84:87], a[72:75], v[44:47]
    ds_read_b64_tr_b16 a[104:105], v7 offset:17600
    v_mfma_f32_16x16x32_bf16 a[180:183], a[84:87], a[76:79], a[180:183]
    s_waitcnt lgkmcnt(7)
    v_mfma_f32_16x16x32_bf16 v[48:51], a[88:91], a[60:63], v[48:51]
    ds_read_b64_tr_b16 a[106:107], v7 offset:18112
    v_mfma_f32_16x16x32_bf16 v[52:55], a[88:91], a[64:67], v[52:55]
    v_mfma_f32_16x16x32_bf16 v[56:59], a[88:91], a[68:71], v[56:59]
    ds_read_b64_tr_b16 a[108:109], v7 offset:17608
    v_mfma_f32_16x16x32_bf16 v[60:63], a[88:91], a[72:75], v[60:63]
    v_mfma_f32_16x16x32_bf16 a[184:187], a[88:91], a[76:79], a[184:187]
    s_waitcnt lgkmcnt(7)
    ds_read_b64_tr_b16 a[110:111], v7 offset:18120
    v_mfma_f32_16x16x32_bf16 v[64:67], a[92:95], a[60:63], v[64:67]
    s_waitcnt vmcnt(12)
    ds_read_b128 a[12:15], v6 offset:47104
    v_mfma_f32_16x16x32_bf16 v[68:71], a[92:95], a[64:67], v[68:71]
    ds_read_b64_tr_b16 a[80:81], v8 offset:17408
    v_mfma_f32_16x16x32_bf16 v[72:75], a[92:95], a[68:71], v[72:75]
    ds_read_b64_tr_b16 a[82:83], v8 offset:17920
    v_mfma_f32_16x16x32_bf16 v[76:79], a[92:95], a[72:75], v[76:79]
    s_waitcnt vmcnt(11)
    s_add_u32 m0, s63, 64
    ds_read_b128 a[32:35], v6 offset:48128
    v_mfma_f32_16x16x32_bf16 a[188:191], a[92:95], a[76:79], a[188:191]
    s_waitcnt lgkmcnt(10)
    ds_read_b64_tr_b16 a[84:85], v8 offset:17416
    v_mfma_f32_16x16x32_bf16 v[80:83], a[96:99], a[60:63], v[80:83]
    buffer_load_dwordx4 v1, s[12:15], s67 offen offset:2048 nt lds
    v_mfma_f32_16x16x32_bf16 v[84:87], a[96:99], a[64:67], v[84:87]
    ds_read_b64_tr_b16 a[86:87], v8 offset:17928
    v_mfma_f32_16x16x32_bf16 v[88:91], a[96:99], a[68:71], v[88:91]
    v_mfma_f32_16x16x32_bf16 v[92:95], a[96:99], a[72:75], v[92:95]
    ds_read_b64_tr_b16 a[88:89], v8 offset:17472
    v_mfma_f32_16x16x32_bf16 a[192:195], a[96:99], a[76:79], a[192:195]
    s_waitcnt lgkmcnt(11)
    v_mfma_f32_16x16x32_bf16 v[96:99], a[100:103], a[60:63], v[96:99]
    ds_read_b64_tr_b16 a[90:91], v8 offset:17984
    v_mfma_f32_16x16x32_bf16 v[100:103], a[100:103], a[64:67], v[100:103]
    ds_read_b64_tr_b16 a[92:93], v8 offset:17480
    v_mfma_f32_16x16x32_bf16 v[104:107], a[100:103], a[68:71], v[104:107]
    v_mfma_f32_16x16x32_bf16 v[108:111], a[100:103], a[72:75], v[108:111]
    ds_read_b64_tr_b16 a[94:95], v8 offset:17992
    v_mfma_f32_16x16x32_bf16 a[196:199], a[100:103], a[76:79], a[196:199]
    s_waitcnt lgkmcnt(12)
    v_mfma_f32_16x16x32_bf16 v[112:115], a[104:107], a[60:63], v[112:115]
    ds_read_b64_tr_b16 a[96:97], v8 offset:17536
    v_mfma_f32_16x16x32_bf16 v[116:119], a[104:107], a[64:67], v[116:119]
    v_mfma_f32_16x16x32_bf16 v[120:123], a[104:107], a[68:71], v[120:123]
    ds_read_b64_tr_b16 a[98:99], v8 offset:18048
    v_mfma_f32_16x16x32_bf16 v[124:127], a[104:107], a[72:75], v[124:127]
    v_mfma_f32_16x16x32_bf16 a[200:203], a[104:107], a[76:79], a[200:203]
    s_waitcnt lgkmcnt(12)
    ds_read_b64_tr_b16 a[100:101], v8 offset:17544
    v_mfma_f32_16x16x32_bf16 v[128:131], a[108:111], a[60:63], v[128:131]
    s_add_u32 m0, s63, 96
    ds_read_b64_tr_b16 a[102:103], v8 offset:18056
    v_mfma_f32_16x16x32_bf16 v[132:135], a[108:111], a[64:67], v[132:135]
    buffer_load_dwordx4 v1, s[12:15], s67 offen offset:3072 nt lds
    v_mfma_f32_16x16x32_bf16 v[136:139], a[108:111], a[68:71], v[136:139]
    ds_read_b64_tr_b16 a[104:105], v8 offset:17600
    v_mfma_f32_16x16x32_bf16 v[140:143], a[108:111], a[72:75], v[140:143]
    v_mfma_f32_16x16x32_bf16 a[204:207], a[108:111], a[76:79], a[204:207]
    s_waitcnt lgkmcnt(12)
    ds_read_b64_tr_b16 a[106:107], v8 offset:18112
    v_mfma_f32_16x16x32_bf16 v[144:147], a[80:83], a[60:63], v[144:147]
    s_waitcnt vmcnt(11)
    ds_read_b128 a[16:19], v6 offset:49152
    v_mfma_f32_16x16x32_bf16 v[148:151], a[80:83], a[64:67], v[148:151]
    ds_read_b64_tr_b16 a[108:109], v8 offset:17608
    v_mfma_f32_16x16x32_bf16 v[152:155], a[80:83], a[68:71], v[152:155]
    s_waitcnt vmcnt(10)
    ds_read_b128 a[36:39], v6 offset:50176
    v_mfma_f32_16x16x32_bf16 v[156:159], a[80:83], a[72:75], v[156:159]
    s_waitcnt lgkmcnt(13)
    ds_read_b64_tr_b16 a[110:111], v8 offset:18120
    v_mfma_f32_16x16x32_bf16 v[160:163], a[84:87], a[60:63], v[160:163]
    v_mfma_f32_16x16x32_bf16 v[164:167], a[84:87], a[64:67], v[164:167]
    v_mfma_f32_16x16x32_bf16 v[168:171], a[84:87], a[68:71], v[168:171]
    v_mfma_f32_16x16x32_bf16 v[172:175], a[84:87], a[72:75], v[172:175]
    s_waitcnt lgkmcnt(12)
    v_mfma_f32_16x16x32_bf16 v[176:179], a[88:91], a[60:63], v[176:179]
    v_mfma_f32_16x16x32_bf16 v[180:183], a[88:91], a[64:67], v[180:183]
    v_mfma_f32_16x16x32_bf16 v[184:187], a[88:91], a[68:71], v[184:187]
    v_mfma_f32_16x16x32_bf16 v[188:191], a[88:91], a[72:75], v[188:191]
    s_waitcnt lgkmcnt(10)
    v_mfma_f32_16x16x32_bf16 v[192:195], a[92:95], a[60:63], v[192:195]
    v_mfma_f32_16x16x32_bf16 v[196:199], a[92:95], a[64:67], v[196:199]
    v_mfma_f32_16x16x32_bf16 v[200:203], a[92:95], a[68:71], v[200:203]
    v_mfma_f32_16x16x32_bf16 v[204:207], a[92:95], a[72:75], v[204:207]
    s_waitcnt lgkmcnt(8)
    v_mfma_f32_16x16x32_bf16 v[208:211], a[96:99], a[60:63], v[208:211]
    s_waitcnt lgkmcnt(0)
    v_mfma_f32_16x16x32_bf16 v[212:215], a[96:99], a[64:67], v[212:215]
    s_barrier
    v_mfma_f32_16x16x32_bf16 v[216:219], a[96:99], a[68:71], v[216:219]
    v_mfma_f32_16x16x32_bf16 v[220:223], a[96:99], a[72:75], v[220:223]
    s_add_u32 m0, s63, 17408
    ds_read_b64_tr_b16 a[80:81], v7 offset:34816
    v_mfma_f32_16x16x32_bf16 v[224:227], a[100:103], a[60:63], v[224:227]
    s_mov_b32 s67, 16384
    ds_read_b64_tr_b16 a[82:83], v7 offset:35328
    v_mfma_f32_16x16x32_bf16 v[228:231], a[100:103], a[64:67], v[228:231]
    buffer_load_dwordx4 v1, s[12:15], s67 offen offset:0 nt lds
    v_mfma_f32_16x16x32_bf16 v[232:235], a[100:103], a[68:71], v[232:235]
    ds_read_b64_tr_b16 a[84:85], v7 offset:34824
    v_mfma_f32_16x16x32_bf16 v[236:239], a[100:103], a[72:75], v[236:239]
    v_mfma_f32_16x16x32_bf16 v[240:243], a[104:107], a[60:63], v[240:243]
    ds_read_b64_tr_b16 a[86:87], v7 offset:35336
    v_mfma_f32_16x16x32_bf16 v[244:247], a[104:107], a[64:67], v[244:247]
    v_mfma_f32_16x16x32_bf16 v[248:251], a[104:107], a[68:71], v[248:251]
    ds_read_b64_tr_b16 a[88:89], v7 offset:34880
    v_mfma_f32_16x16x32_bf16 v[252:255], a[104:107], a[72:75], v[252:255]
    v_mfma_f32_16x16x32_bf16 a[160:163], a[108:111], a[60:63], a[160:163]
    ds_read_b64_tr_b16 a[90:91], v7 offset:35392
    v_mfma_f32_16x16x32_bf16 a[164:167], a[108:111], a[64:67], a[164:167]
    ds_read_b64_tr_b16 a[92:93], v7 offset:34888
    v_mfma_f32_16x16x32_bf16 a[168:171], a[108:111], a[68:71], a[168:171]
    s_waitcnt lgkmcnt(5)
    ds_read_b64_tr_b16 a[94:95], v7 offset:35400
    v_mfma_f32_16x16x32_bf16 a[172:175], a[108:111], a[72:75], a[172:175]
    v_mfma_f32_16x16x32_bf16 v[16:19], a[80:83], a[0:3], v[16:19]
    v_mfma_f32_16x16x32_bf16 v[20:23], a[80:83], a[4:7], v[20:23]
    ds_read_b64_tr_b16 a[96:97], v7 offset:34944
    v_mfma_f32_16x16x32_bf16 v[24:27], a[80:83], a[8:11], v[24:27]
    s_add_u32 m0, s63, 17440
    v_mfma_f32_16x16x32_bf16 v[28:31], a[80:83], a[12:15], v[28:31]
    ds_read_b64_tr_b16 a[98:99], v7 offset:35456
    v_mfma_f32_16x16x32_bf16 a[176:179], a[80:83], a[16:19], a[176:179]
    s_waitcnt lgkmcnt(6)
    buffer_load_dwordx4 v1, s[12:15], s67 offen offset:1024 nt lds
    v_mfma_f32_16x16x32_bf16 v[32:35], a[84:87], a[0:3], v[32:35]
    ds_read_b64_tr_b16 a[100:101], v7 offset:34952
    v_mfma_f32_16x16x32_bf16 v[36:39], a[84:87], a[4:7], v[36:39]
    ds_read_b64_tr_b16 a[102:103], v7 offset:35464
    v_mfma_f32_16x16x32_bf16 v[40:43], a[84:87], a[8:11], v[40:43]
    v_mfma_f32_16x16x32_bf16 v[44:47], a[84:87], a[12:15], v[44:47]
    ds_read_b64_tr_b16 a[104:105], v7 offset:35008
    v_mfma_f32_16x16x32_bf16 a[180:183], a[84:87], a[16:19], a[180:183]
    s_waitcnt lgkmcnt(7)
    v_mfma_f32_16x16x32_bf16 v[48:51], a[88:91], a[0:3], v[48:51]
    ds_read_b64_tr_b16 a[106:107], v7 offset:35520
    v_mfma_f32_16x16x32_bf16 v[52:55], a[88:91], a[4:7], v[52:55]
    v_mfma_f32_16x16x32_bf16 v[56:59], a[88:91], a[8:11], v[56:59]
    ds_read_b64_tr_b16 a[108:109], v7 offset:35016
    v_mfma_f32_16x16x32_bf16 v[60:63], a[88:91], a[12:15], v[60:63]
    v_mfma_f32_16x16x32_bf16 a[184:187], a[88:91], a[16:19], a[184:187]
    s_waitcnt lgkmcnt(7)
    ds_read_b64_tr_b16 a[110:111], v7 offset:35528
    v_mfma_f32_16x16x32_bf16 v[64:67], a[92:95], a[0:3], v[64:67]
    v_mfma_f32_16x16x32_bf16 v[68:71], a[92:95], a[4:7], v[68:71]
    ds_read_b64_tr_b16 a[80:81], v8 offset:34816
    v_mfma_f32_16x16x32_bf16 v[72:75], a[92:95], a[8:11], v[72:75]
    ds_read_b64_tr_b16 a[82:83], v8 offset:35328
    v_mfma_f32_16x16x32_bf16 v[76:79], a[92:95], a[12:15], v[76:79]
    s_add_u32 m0, s63, 17472
    v_mfma_f32_16x16x32_bf16 a[188:191], a[92:95], a[16:19], a[188:191]
    s_waitcnt lgkmcnt(8)
    ds_read_b64_tr_b16 a[84:85], v8 offset:34824
    v_mfma_f32_16x16x32_bf16 v[80:83], a[96:99], a[0:3], v[80:83]
    buffer_load_dwordx4 v1, s[12:15], s67 offen offset:2048 nt lds
    v_mfma_f32_16x16x32_bf16 v[84:87], a[96:99], a[4:7], v[84:87]
    ds_read_b64_tr_b16 a[86:87], v8 offset:35336
    v_mfma_f32_16x16x32_bf16 v[88:91], a[96:99], a[8:11], v[88:91]
    v_mfma_f32_16x16x32_bf16 v[92:95], a[96:99], a[12:15], v[92:95]
    ds_read_b64_tr_b16 a[88:89], v8 offset:34880
    v_mfma_f32_16x16x32_bf16 a[192:195], a[96:99], a[16:19], a[192:195]
    s_waitcnt lgkmcnt(9)
    v_mfma_f32_16x16x32_bf16 v[96:99], a[100:103], a[0:3], v[96:99]
    ds_read_b64_tr_b16 a[90:91], v8 offset:35392
    v_mfma_f32_16x16x32_bf16 v[100:103], a[100:103], a[4:7], v[100:103]
    ds_read_b64_tr_b16 a[92:93], v8 offset:34888
    v_mfma_f32_16x16x32_bf16 v[104:107], a[100:103], a[8:11], v[104:107]
    v_mfma_f32_16x16x32_bf16 v[108:111], a[100:103], a[12:15], v[108:111]
    ds_read_b64_tr_b16 a[94:95], v8 offset:35400
    v_mfma_f32_16x16x32_bf16 a[196:199], a[100:103], a[16:19], a[196:199]
    s_waitcnt lgkmcnt(10)
    v_mfma_f32_16x16x32_bf16 v[112:115], a[104:107], a[0:3], v[112:115]
    ds_read_b64_tr_b16 a[96:97], v8 offset:34944
    v_mfma_f32_16x16x32_bf16 v[116:119], a[104:107], a[4:7], v[116:119]
    v_mfma_f32_16x16x32_bf16 v[120:123], a[104:107], a[8:11], v[120:123]
    ds_read_b64_tr_b16 a[98:99], v8 offset:35456
    v_mfma_f32_16x16x32_bf16 v[124:127], a[104:107], a[12:15], v[124:127]
    v_mfma_f32_16x16x32_bf16 a[200:203], a[104:107], a[16:19], a[200:203]
    s_waitcnt lgkmcnt(10)
    ds_read_b64_tr_b16 a[100:101], v8 offset:34952
    v_mfma_f32_16x16x32_bf16 v[128:131], a[108:111], a[0:3], v[128:131]
    s_add_u32 m0, s63, 17504
    ds_read_b64_tr_b16 a[102:103], v8 offset:35464
    v_mfma_f32_16x16x32_bf16 v[132:135], a[108:111], a[4:7], v[132:135]
    buffer_load_dwordx4 v1, s[12:15], s67 offen offset:3072 nt lds
    v_mfma_f32_16x16x32_bf16 v[136:139], a[108:111], a[8:11], v[136:139]
    ds_read_b64_tr_b16 a[104:105], v8 offset:35008
    v_mfma_f32_16x16x32_bf16 v[140:143], a[108:111], a[12:15], v[140:143]
    v_mfma_f32_16x16x32_bf16 a[204:207], a[108:111], a[16:19], a[204:207]
    s_waitcnt lgkmcnt(11)
    ds_read_b64_tr_b16 a[106:107], v8 offset:35520
    v_mfma_f32_16x16x32_bf16 v[144:147], a[80:83], a[0:3], v[144:147]
    v_mfma_f32_16x16x32_bf16 v[148:151], a[80:83], a[4:7], v[148:151]
    ds_read_b64_tr_b16 a[108:109], v8 offset:35016
    v_mfma_f32_16x16x32_bf16 v[152:155], a[80:83], a[8:11], v[152:155]
    v_mfma_f32_16x16x32_bf16 v[156:159], a[80:83], a[12:15], v[156:159]
    s_waitcnt lgkmcnt(11)
    ds_read_b64_tr_b16 a[110:111], v8 offset:35528
    v_mfma_f32_16x16x32_bf16 v[160:163], a[84:87], a[0:3], v[160:163]
    v_mfma_f32_16x16x32_bf16 v[164:167], a[84:87], a[4:7], v[164:167]
    v_mfma_f32_16x16x32_bf16 v[168:171], a[84:87], a[8:11], v[168:171]
    v_mfma_f32_16x16x32_bf16 v[172:175], a[84:87], a[12:15], v[172:175]
    s_waitcnt lgkmcnt(10)
    v_mfma_f32_16x16x32_bf16 v[176:179], a[88:91], a[0:3], v[176:179]
    v_mfma_f32_16x16x32_bf16 v[180:183], a[88:91], a[4:7], v[180:183]
    v_mfma_f32_16x16x32_bf16 v[184:187], a[88:91], a[8:11], v[184:187]
    v_mfma_f32_16x16x32_bf16 v[188:191], a[88:91], a[12:15], v[188:191]
    s_waitcnt lgkmcnt(8)
    v_mfma_f32_16x16x32_bf16 v[192:195], a[92:95], a[0:3], v[192:195]
    v_mfma_f32_16x16x32_bf16 v[196:199], a[92:95], a[4:7], v[196:199]
    v_mfma_f32_16x16x32_bf16 v[200:203], a[92:95], a[8:11], v[200:203]
    v_mfma_f32_16x16x32_bf16 v[204:207], a[92:95], a[12:15], v[204:207]
    s_waitcnt lgkmcnt(6)
    v_mfma_f32_16x16x32_bf16 v[208:211], a[96:99], a[0:3], v[208:211]
    s_waitcnt vmcnt(9) lgkmcnt(0)
    v_mfma_f32_16x16x32_bf16 v[212:215], a[96:99], a[4:7], v[212:215]
    s_barrier
    v_mfma_f32_16x16x32_bf16 v[216:219], a[96:99], a[8:11], v[216:219]
    v_mfma_f32_16x16x32_bf16 v[220:223], a[96:99], a[12:15], v[220:223]
    s_add_u32 m0, s63, 34816
    ds_read_b64_tr_b16 a[80:81], v7 offset:52224
    v_mfma_f32_16x16x32_bf16 v[224:227], a[100:103], a[0:3], v[224:227]
    s_mov_b32 s67, 32768
    ds_read_b64_tr_b16 a[82:83], v7 offset:52736
    v_mfma_f32_16x16x32_bf16 v[228:231], a[100:103], a[4:7], v[228:231]
    buffer_load_dwordx4 v1, s[12:15], s67 offen offset:0 nt lds
    v_mfma_f32_16x16x32_bf16 v[232:235], a[100:103], a[8:11], v[232:235]
    ds_read_b64_tr_b16 a[84:85], v7 offset:52232
    v_mfma_f32_16x16x32_bf16 v[236:239], a[100:103], a[12:15], v[236:239]
    v_mfma_f32_16x16x32_bf16 v[240:243], a[104:107], a[0:3], v[240:243]
    ds_read_b64_tr_b16 a[86:87], v7 offset:52744
    v_mfma_f32_16x16x32_bf16 v[244:247], a[104:107], a[4:7], v[244:247]
    v_mfma_f32_16x16x32_bf16 v[248:251], a[104:107], a[8:11], v[248:251]
    ds_read_b64_tr_b16 a[88:89], v7 offset:52288
    v_mfma_f32_16x16x32_bf16 v[252:255], a[104:107], a[12:15], v[252:255]
    v_mfma_f32_16x16x32_bf16 a[160:163], a[108:111], a[0:3], a[160:163]
    ds_read_b64_tr_b16 a[90:91], v7 offset:52800
    v_mfma_f32_16x16x32_bf16 a[164:167], a[108:111], a[4:7], a[164:167]
    ds_read_b64_tr_b16 a[92:93], v7 offset:52296
    v_mfma_f32_16x16x32_bf16 a[168:171], a[108:111], a[8:11], a[168:171]
    s_waitcnt lgkmcnt(5)
    ds_read_b64_tr_b16 a[94:95], v7 offset:52808
    v_mfma_f32_16x16x32_bf16 a[172:175], a[108:111], a[12:15], a[172:175]
    s_add_u32 m0, s63, 34848
    v_mfma_f32_16x16x32_bf16 v[16:19], a[80:83], a[20:23], v[16:19]
    buffer_load_dwordx4 v1, s[12:15], s67 offen offset:1024 nt lds
    v_mfma_f32_16x16x32_bf16 v[20:23], a[80:83], a[24:27], v[20:23]
    ds_read_b64_tr_b16 a[96:97], v7 offset:52352
    v_mfma_f32_16x16x32_bf16 v[24:27], a[80:83], a[28:31], v[24:27]
    s_add_u32 m0, s63, 34880
    v_mfma_f32_16x16x32_bf16 v[28:31], a[80:83], a[32:35], v[28:31]
    ds_read_b64_tr_b16 a[98:99], v7 offset:52864
    v_mfma_f32_16x16x32_bf16 a[176:179], a[80:83], a[36:39], a[176:179]
    s_waitcnt lgkmcnt(6)
    buffer_load_dwordx4 v1, s[12:15], s67 offen offset:2048 nt lds
    v_mfma_f32_16x16x32_bf16 v[32:35], a[84:87], a[20:23], v[32:35]
    ds_read_b64_tr_b16 a[100:101], v7 offset:52360
    v_mfma_f32_16x16x32_bf16 v[36:39], a[84:87], a[24:27], v[36:39]
    ds_read_b64_tr_b16 a[102:103], v7 offset:52872
    v_mfma_f32_16x16x32_bf16 v[40:43], a[84:87], a[28:31], v[40:43]
    v_mfma_f32_16x16x32_bf16 v[44:47], a[84:87], a[32:35], v[44:47]
    ds_read_b64_tr_b16 a[104:105], v7 offset:52416
    v_mfma_f32_16x16x32_bf16 a[180:183], a[84:87], a[36:39], a[180:183]
    s_waitcnt lgkmcnt(7)
    v_mfma_f32_16x16x32_bf16 v[48:51], a[88:91], a[20:23], v[48:51]
    ds_read_b64_tr_b16 a[106:107], v7 offset:52928
    v_mfma_f32_16x16x32_bf16 v[52:55], a[88:91], a[24:27], v[52:55]
    s_add_u32 m0, s63, 34912
    v_mfma_f32_16x16x32_bf16 v[56:59], a[88:91], a[28:31], v[56:59]
    ds_read_b64_tr_b16 a[108:109], v7 offset:52424
    v_mfma_f32_16x16x32_bf16 v[60:63], a[88:91], a[32:35], v[60:63]
    buffer_load_dwordx4 v1, s[12:15], s67 offen offset:3072 nt lds
    v_mfma_f32_16x16x32_bf16 a[184:187], a[88:91], a[36:39], a[184:187]
    s_waitcnt lgkmcnt(7)
    ds_read_b64_tr_b16 a[110:111], v7 offset:52936
    v_mfma_f32_16x16x32_bf16 v[64:67], a[92:95], a[20:23], v[64:67]
    v_mfma_f32_16x16x32_bf16 v[68:71], a[92:95], a[24:27], v[68:71]
    ds_read_b64_tr_b16 a[80:81], v8 offset:52224
    v_mfma_f32_16x16x32_bf16 v[72:75], a[92:95], a[28:31], v[72:75]
    ds_read_b64_tr_b16 a[82:83], v8 offset:52736
    v_mfma_f32_16x16x32_bf16 v[76:79], a[92:95], a[32:35], v[76:79]
    s_add_u32 m0, s63, 121856
    v_mfma_f32_16x16x32_bf16 a[188:191], a[92:95], a[36:39], a[188:191]
    s_waitcnt lgkmcnt(8)
    ds_read_b64_tr_b16 a[84:85], v8 offset:52232
    v_mfma_f32_16x16x32_bf16 v[80:83], a[96:99], a[20:23], v[80:83]
    s_mov_b32 s67, 49152
    buffer_load_dwordx4 v1, s[16:19], s67 offen offset:0 nt lds
    v_mfma_f32_16x16x32_bf16 v[84:87], a[96:99], a[24:27], v[84:87]
    ds_read_b64_tr_b16 a[86:87], v8 offset:52744
    v_mfma_f32_16x16x32_bf16 v[88:91], a[96:99], a[28:31], v[88:91]
    v_mfma_f32_16x16x32_bf16 v[92:95], a[96:99], a[32:35], v[92:95]
    ds_read_b64_tr_b16 a[88:89], v8 offset:52288
    v_mfma_f32_16x16x32_bf16 a[192:195], a[96:99], a[36:39], a[192:195]
    s_waitcnt lgkmcnt(9)
    v_mfma_f32_16x16x32_bf16 v[96:99], a[100:103], a[20:23], v[96:99]
    ds_read_b64_tr_b16 a[90:91], v8 offset:52800
    v_mfma_f32_16x16x32_bf16 v[100:103], a[100:103], a[24:27], v[100:103]
    ds_read_b64_tr_b16 a[92:93], v8 offset:52296
    v_mfma_f32_16x16x32_bf16 v[104:107], a[100:103], a[28:31], v[104:107]
    s_add_u32 m0, s63, 121888
    v_mfma_f32_16x16x32_bf16 v[108:111], a[100:103], a[32:35], v[108:111]
    ds_read_b64_tr_b16 a[94:95], v8 offset:52808
    v_mfma_f32_16x16x32_bf16 a[196:199], a[100:103], a[36:39], a[196:199]
    s_waitcnt lgkmcnt(10)
    buffer_load_dwordx4 v1, s[16:19], s67 offen offset:1024 nt lds
    v_mfma_f32_16x16x32_bf16 v[112:115], a[104:107], a[20:23], v[112:115]
    ds_read_b64_tr_b16 a[96:97], v8 offset:52352
    v_mfma_f32_16x16x32_bf16 v[116:119], a[104:107], a[24:27], v[116:119]
    v_mfma_f32_16x16x32_bf16 v[120:123], a[104:107], a[28:31], v[120:123]
    ds_read_b64_tr_b16 a[98:99], v8 offset:52864
    v_mfma_f32_16x16x32_bf16 v[124:127], a[104:107], a[32:35], v[124:127]
    v_mfma_f32_16x16x32_bf16 a[200:203], a[104:107], a[36:39], a[200:203]
    s_waitcnt lgkmcnt(10)
    ds_read_b64_tr_b16 a[100:101], v8 offset:52360
    v_mfma_f32_16x16x32_bf16 v[128:131], a[108:111], a[20:23], v[128:131]
    s_add_u32 m0, s63, 121920
    ds_read_b64_tr_b16 a[102:103], v8 offset:52872
    v_mfma_f32_16x16x32_bf16 v[132:135], a[108:111], a[24:27], v[132:135]
    buffer_load_dwordx4 v1, s[16:19], s67 offen offset:2048 nt lds
    v_mfma_f32_16x16x32_bf16 v[136:139], a[108:111], a[28:31], v[136:139]
    ds_read_b64_tr_b16 a[104:105], v8 offset:52416
    v_mfma_f32_16x16x32_bf16 v[140:143], a[108:111], a[32:35], v[140:143]
    v_mfma_f32_16x16x32_bf16 a[204:207], a[108:111], a[36:39], a[204:207]
    s_waitcnt lgkmcnt(11)
    ds_read_b64_tr_b16 a[106:107], v8 offset:52928
    v_mfma_f32_16x16x32_bf16 v[144:147], a[80:83], a[20:23], v[144:147]
    v_mfma_f32_16x16x32_bf16 v[148:151], a[80:83], a[24:27], v[148:151]
    ds_read_b64_tr_b16 a[108:109], v8 offset:52424
    v_mfma_f32_16x16x32_bf16 v[152:155], a[80:83], a[28:31], v[152:155]
    s_add_u32 m0, s63, 121952
    v_mfma_f32_16x16x32_bf16 v[156:159], a[80:83], a[32:35], v[156:159]
    s_waitcnt lgkmcnt(11)
    ds_read_b64_tr_b16 a[110:111], v8 offset:52936
    v_mfma_f32_16x16x32_bf16 v[160:163], a[84:87], a[20:23], v[160:163]
    buffer_load_dwordx4 v1, s[16:19], s67 offen offset:3072 nt lds
    v_mfma_f32_16x16x32_bf16 v[164:167], a[84:87], a[24:27], v[164:167]
    v_mfma_f32_16x16x32_bf16 v[168:171], a[84:87], a[28:31], v[168:171]
    v_mfma_f32_16x16x32_bf16 v[172:175], a[84:87], a[32:35], v[172:175]
    s_waitcnt lgkmcnt(10)
    v_mfma_f32_16x16x32_bf16 v[176:179], a[88:91], a[20:23], v[176:179]
    v_mfma_f32_16x16x32_bf16 v[180:183], a[88:91], a[24:27], v[180:183]
    v_mfma_f32_16x16x32_bf16 v[184:187], a[88:91], a[28:31], v[184:187]
    v_mfma_f32_16x16x32_bf16 v[188:191], a[88:91], a[32:35], v[188:191]
    s_waitcnt lgkmcnt(8)
    v_mfma_f32_16x16x32_bf16 v[192:195], a[92:95], a[20:23], v[192:195]
    v_mfma_f32_16x16x32_bf16 v[196:199], a[92:95], a[24:27], v[196:199]
    v_mfma_f32_16x16x32_bf16 v[200:203], a[92:95], a[28:31], v[200:203]
    v_mfma_f32_16x16x32_bf16 v[204:207], a[92:95], a[32:35], v[204:207]
    s_waitcnt lgkmcnt(6)
    v_mfma_f32_16x16x32_bf16 v[208:211], a[96:99], a[20:23], v[208:211]
    s_waitcnt lgkmcnt(0)
    v_mfma_f32_16x16x32_bf16 v[212:215], a[96:99], a[24:27], v[212:215]
    s_barrier
    v_mfma_f32_16x16x32_bf16 v[216:219], a[96:99], a[28:31], v[216:219]
    v_mfma_f32_16x16x32_bf16 v[220:223], a[96:99], a[32:35], v[220:223]
    v_mfma_f32_16x16x32_bf16 v[224:227], a[100:103], a[20:23], v[224:227]
    v_mfma_f32_16x16x32_bf16 v[228:231], a[100:103], a[24:27], v[228:231]
    v_mfma_f32_16x16x32_bf16 v[232:235], a[100:103], a[28:31], v[232:235]
    v_mfma_f32_16x16x32_bf16 v[236:239], a[100:103], a[32:35], v[236:239]
    v_mfma_f32_16x16x32_bf16 v[240:243], a[104:107], a[20:23], v[240:243]
    v_mfma_f32_16x16x32_bf16 v[244:247], a[104:107], a[24:27], v[244:247]
    v_mfma_f32_16x16x32_bf16 v[248:251], a[104:107], a[28:31], v[248:251]
    v_mfma_f32_16x16x32_bf16 v[252:255], a[104:107], a[32:35], v[252:255]
    v_mfma_f32_16x16x32_bf16 a[160:163], a[108:111], a[20:23], a[160:163]
    v_mfma_f32_16x16x32_bf16 a[164:167], a[108:111], a[24:27], a[164:167]
    v_mfma_f32_16x16x32_bf16 a[168:171], a[108:111], a[28:31], a[168:171]
    v_mfma_f32_16x16x32_bf16 a[172:175], a[108:111], a[32:35], a[172:175]
L_qepi:
    v_add_u32 v9, 139264, v1
    v_accvgpr_read_b32 v12, a176
    v_accvgpr_read_b32 v13, a177
    v_accvgpr_read_b32 v14, a178
    v_accvgpr_read_b32 v15, a179
    v_pk_mul_f32 v[12:13], v[12:13], s[56:57]
    v_pk_mul_f32 v[14:15], v[14:15], s[56:57]
    v_cvt_pk_bf16_f32 v4, v12, v13
    v_cvt_pk_bf16_f32 v5, v14, v15
    v_accvgpr_read_b32 v12, a180
    v_accvgpr_read_b32 v13, a181
    v_accvgpr_read_b32 v14, a182
    v_accvgpr_read_b32 v15, a183
    v_pk_mul_f32 v[12:13], v[12:13], s[56:57]
    v_pk_mul_f32 v[14:15], v[14:15], s[56:57]
    v_cvt_pk_bf16_f32 v6, v12, v13
    v_cvt_pk_bf16_f32 v7, v14, v15
    ds_write_b128 v9, v[4:7] offset:0
    v_accvgpr_read_b32 v12, a184
    v_accvgpr_read_b32 v13, a185
    v_accvgpr_read_b32 v14, a186
    v_accvgpr_read_b32 v15, a187
    v_pk_mul_f32 v[12:13], v[12:13], s[56:57]
    v_pk_mul_f32 v[14:15], v[14:15], s[56:57]
    v_cvt_pk_bf16_f32 v4, v12, v13
    v_cvt_pk_bf16_f32 v5, v14, v15
    v_accvgpr_read_b32 v12, a188
    v_accvgpr_read_b32 v13, a189
    v_accvgpr_read_b32 v14, a190
    v_accvgpr_read_b32 v15, a191
    v_pk_mul_f32 v[12:13], v[12:13], s[56:57]
    v_pk_mul_f32 v[14:15], v[14:15], s[56:57]
    v_cvt_pk_bf16_f32 v6, v12, v13
    v_cvt_pk_bf16_f32 v7, v14, v15
    ds_write_b128 v9, v[4:7] offset:1024
    v_accvgpr_read_b32 v12, a192
    v_accvgpr_read_b32 v13, a193
    v_accvgpr_read_b32 v14, a194
    v_accvgpr_read_b32 v15, a195
    v_pk_mul_f32 v[12:13], v[12:13], s[56:57]
    v_pk_mul_f32 v[14:15], v[14:15], s[56:57]
    v_cvt_pk_bf16_f32 v4, v12, v13
    v_cvt_pk_bf16_f32 v5, v14, v15
    v_accvgpr_read_b32 v12, a196
    v_accvgpr_read_b32 v13, a197
    v_accvgpr_read_b32 v14, a198
    v_accvgpr_read_b32 v15, a199
    v_pk_mul_f32 v[12:13], v[12:13], s[56:57]
    v_pk_mul_f32 v[14:15], v[14:15], s[56:57]
    v_cvt_pk_bf16_f32 v6, v12, v13
    v_cvt_pk_bf16_f32 v7, v14, v15
    ds_write_b128 v9, v[4:7] offset:2048
    v_accvgpr_read_b32 v12, a200
    v_accvgpr_read_b32 v13, a201
    v_accvgpr_read_b32 v14, a202
    v_accvgpr_read_b32 v15, a203
    v_pk_mul_f32 v[12:13], v[12:13], s[56:57]
    v_pk_mul_f32 v[14:15], v[14:15], s[56:57]
    v_cvt_pk_bf16_f32 v4, v12, v13
    v_cvt_pk_bf16_f32 v5, v14, v15
    v_accvgpr_read_b32 v12, a204
    v_accvgpr_read_b32 v13, a205
    v_accvgpr_read_b32 v14, a206
    v_accvgpr_read_b32 v15, a207
    v_pk_mul_f32 v[12:13], v[12:13], s[56:57]
    v_pk_mul_f32 v[14:15], v[14:15], s[56:57]
    v_cvt_pk_bf16_f32 v6, v12, v13
    v_cvt_pk_bf16_f32 v7, v14, v15
    ds_write_b128 v9, v[4:7] offset:3072
    s_cmp_eq_u32 s37, 1
    s_cbranch_scc1 L_qe1
    v_pk_mul_f32 v[16:17], v[16:17], s[56:57]
    v_pk_mul_f32 v[18:19], v[18:19], s[56:57]
    v_cvt_pk_bf16_f32 v16, v16, v17
    v_cvt_pk_bf16_f32 v17, v18, v19
    v_pk_mul_f32 v[32:33], v[32:33], s[56:57]
    v_pk_mul_f32 v[34:35], v[34:35], s[56:57]
    v_cvt_pk_bf16_f32 v18, v32, v33
    v_cvt_pk_bf16_f32 v19, v34, v35
    s_add_u32 m0, s63, 52224
    s_mov_b32 s67, 49152
    v_accvgpr_write_b32 a0, v16
    v_accvgpr_write_b32 a1, v17
    v_accvgpr_write_b32 a2, v18
    v_accvgpr_write_b32 a3, v19
    buffer_load_dwordx4 v1, s[12:15], s67 offen offset:0 nt lds
    v_pk_mul_f32 v[48:49], v[48:49], s[56:57]
    v_pk_mul_f32 v[50:51], v[50:51], s[56:57]
    v_cvt_pk_bf16_f32 v48, v48, v49
    v_cvt_pk_bf16_f32 v49, v50, v51
    v_pk_mul_f32 v[64:65], v[64:65], s[56:57]
    v_pk_mul_f32 v[66:67], v[66:67], s[56:57]
    v_cvt_pk_bf16_f32 v50, v64, v65
    v_cvt_pk_bf16_f32 v51, v66, v67
    v_accvgpr_write_b32 a4, v48
    v_accvgpr_write_b32 a5, v49
    v_accvgpr_write_b32 a6, v50
    v_accvgpr_write_b32 a7, v51
    v_pk_mul_f32 v[80:81], v[80:81], s[56:57]
    v_pk_mul_f32 v[82:83], v[82:83], s[56:57]
    v_cvt_pk_bf16_f32 v80, v80, v81
    v_cvt_pk_bf16_f32 v81, v82, v83
    v_pk_mul_f32 v[96:97], v[96:97], s[56:57]
    v_pk_mul_f32 v[98:99], v[98:99], s[56:57]
    v_cvt_pk_bf16_f32 v82, v96, v97
    v_cvt_pk_bf16_f32 v83, v98, v99
    v_accvgpr_write_b32 a8, v80
    v_accvgpr_write_b32 a9, v81
    v_accvgpr_write_b32 a10, v82
    v_accvgpr_write_b32 a11, v83
    v_pk_mul_f32 v[112:113], v[112:113], s[56:57]
    v_pk_mul_f32 v[114:115], v[114:115], s[56:57]
    v_cvt_pk_bf16_f32 v112, v112, v113
    v_cvt_pk_bf16_f32 v113, v114, v115
    v_pk_mul_f32 v[128:129], v[128:129], s[56:57]
    v_pk_mul_f32 v[130:131], v[130:131], s[56:57]
    v_cvt_pk_bf16_f32 v114, v128, v129
    v_cvt_pk_bf16_f32 v115, v130, v131
    v_accvgpr_write_b32 a12, v112
    v_accvgpr_write_b32 a13, v113
    v_accvgpr_write_b32 a14, v114
    v_accvgpr_write_b32 a15, v115
    v_pk_mul_f32 v[20:21], v[20:21], s[56:57]
    v_pk_mul_f32 v[22:23], v[22:23], s[56:57]
    v_cvt_pk_bf16_f32 v20, v20, v21
    v_cvt_pk_bf16_f32 v21, v22, v23
    v_pk_mul_f32 v[36:37], v[36:37], s[56:57]
    v_pk_mul_f32 v[38:39], v[38:39], s[56:57]
    v_cvt_pk_bf16_f32 v22, v36, v37
    v_cvt_pk_bf16_f32 v23, v38, v39
    v_accvgpr_write_b32 a16, v20
    v_accvgpr_write_b32 a17, v21
    v_accvgpr_write_b32 a18, v22
    v_accvgpr_write_b32 a19, v23
    v_pk_mul_f32 v[52:53], v[52:53], s[56:57]
    v_pk_mul_f32 v[54:55], v[54:55], s[56:57]
    v_cvt_pk_bf16_f32 v52, v52, v53
    v_cvt_pk_bf16_f32 v53, v54, v55
    v_pk_mul_f32 v[68:69], v[68:69], s[56:57]
    v_pk_mul_f32 v[70:71], v[70:71], s[56:57]
    v_cvt_pk_bf16_f32 v54, v68, v69
    v_cvt_pk_bf16_f32 v55, v70, v71
    v_accvgpr_write_b32 a20, v52
    v_accvgpr_write_b32 a21, v53
    v_accvgpr_write_b32 a22, v54
    v_accvgpr_write_b32 a23, v55
    v_pk_mul_f32 v[84:85], v[84:85], s[56:57]
    v_pk_mul_f32 v[86:87], v[86:87], s[56:57]
    v_cvt_pk_bf16_f32 v84, v84, v85
    v_cvt_pk_bf16_f32 v85, v86, v87
    v_pk_mul_f32 v[100:101], v[100:101], s[56:57]
    v_pk_mul_f32 v[102:103], v[102:103], s[56:57]
    v_cvt_pk_bf16_f32 v86, v100, v101
    v_cvt_pk_bf16_f32 v87, v102, v103
    v_accvgpr_write_b32 a24, v84
    v_accvgpr_write_b32 a25, v85
    v_accvgpr_write_b32 a26, v86
    v_accvgpr_write_b32 a27, v87
    v_pk_mul_f32 v[116:117], v[116:117], s[56:57]
    v_pk_mul_f32 v[118:119], v[118:119], s[56:57]
    v_cvt_pk_bf16_f32 v116, v116, v117
    v_cvt_pk_bf16_f32 v117, v118, v119
    v_pk_mul_f32 v[132:133], v[132:133], s[56:57]
    v_pk_mul_f32 v[134:135], v[134:135], s[56:57]
    v_cvt_pk_bf16_f32 v118, v132, v133
    v_cvt_pk_bf16_f32 v119, v134, v135
    v_accvgpr_write_b32 a28, v116
    v_accvgpr_write_b32 a29, v117
    v_accvgpr_write_b32 a30, v118
    v_accvgpr_write_b32 a31, v119
    v_pk_mul_f32 v[24:25], v[24:25], s[56:57]
    v_pk_mul_f32 v[26:27], v[26:27], s[56:57]
    v_cvt_pk_bf16_f32 v24, v24, v25
    v_cvt_pk_bf16_f32 v25, v26, v27
    v_pk_mul_f32 v[40:41], v[40:41], s[56:57]
    v_pk_mul_f32 v[42:43], v[42:43], s[56:57]
    v_cvt_pk_bf16_f32 v26, v40, v41
    v_cvt_pk_bf16_f32 v27, v42, v43
    s_add_u32 m0, s63, 52256
    v_accvgpr_write_b32 a32, v24
    v_accvgpr_write_b32 a33, v25
    v_accvgpr_write_b32 a34, v26
    v_accvgpr_write_b32 a35, v27
    buffer_load_dwordx4 v1, s[12:15], s67 offen offset:1024 nt lds
    v_pk_mul_f32 v[56:57], v[56:57], s[56:57]
    v_pk_mul_f32 v[58:59], v[58:59], s[56:57]
    v_cvt_pk_bf16_f32 v56, v56, v57
    v_cvt_pk_bf16_f32 v57, v58, v59
    v_pk_mul_f32 v[72:73], v[72:73], s[56:57]
    v_pk_mul_f32 v[74:75], v[74:75], s[56:57]
    v_cvt_pk_bf16_f32 v58, v72, v73
    v_cvt_pk_bf16_f32 v59, v74, v75
    v_accvgpr_write_b32 a36, v56
    v_accvgpr_write_b32 a37, v57
    v_accvgpr_write_b32 a38, v58
    v_accvgpr_write_b32 a39, v59
    v_pk_mul_f32 v[88:89], v[88:89], s[56:57]
    v_pk_mul_f32 v[90:91], v[90:91], s[56:57]
    v_cvt_pk_bf16_f32 v88, v88, v89
    v_cvt_pk_bf16_f32 v89, v90, v91
    v_pk_mul_f32 v[104:105], v[104:105], s[56:57]
    v_pk_mul_f32 v[106:107], v[106:107], s[56:57]
    v_cvt_pk_bf16_f32 v90, v104, v105
    v_cvt_pk_bf16_f32 v91, v106, v107
    v_accvgpr_write_b32 a40, v88
    v_accvgpr_write_b32 a41, v89
    v_accvgpr_write_b32 a42, v90
    v_accvgpr_write_b32 a43, v91
    v_pk_mul_f32 v[120:121], v[120:121], s[56:57]
    v_pk_mul_f32 v[122:123], v[122:123], s[56:57]
    v_cvt_pk_bf16_f32 v120, v120, v121
    v_cvt_pk_bf16_f32 v121, v122, v123
    v_pk_mul_f32 v[136:137], v[136:137], s[56:57]
    v_pk_mul_f32 v[138:139], v[138:139], s[56:57]
    v_cvt_pk_bf16_f32 v122, v136, v137
    v_cvt_pk_bf16_f32 v123, v138, v139
    v_accvgpr_write_b32 a44, v120
    v_accvgpr_write_b32 a45, v121
    v_accvgpr_write_b32 a46, v122
    v_accvgpr_write_b32 a47, v123
    v_pk_mul_f32 v[28:29], v[28:29], s[56:57]
    v_pk_mul_f32 v[30:31], v[30:31], s[56:57]
    v_cvt_pk_bf16_f32 v28, v28, v29
    v_cvt_pk_bf16_f32 v29, v30, v31
    v_pk_mul_f32 v[44:45], v[44:45], s[56:57]
    v_pk_mul_f32 v[46:47], v[46:47], s[56:57]
    v_cvt_pk_bf16_f32 v30, v44, v45
    v_cvt_pk_bf16_f32 v31, v46, v47
    v_accvgpr_write_b32 a48, v28
    v_accvgpr_write_b32 a49, v29
    v_accvgpr_write_b32 a50, v30
    v_accvgpr_write_b32 a51, v31
    v_pk_mul_f32 v[60:61], v[60:61], s[56:57]
    v_pk_mul_f32 v[62:63], v[62:63], s[56:57]
    v_cvt_pk_bf16_f32 v60, v60, v61
    v_cvt_pk_bf16_f32 v61, v62, v63
    v_pk_mul_f32 v[76:77], v[76:77], s[56:57]
    v_pk_mul_f32 v[78:79], v[78:79], s[56:57]
    v_cvt_pk_bf16_f32 v62, v76, v77
    v_cvt_pk_bf16_f32 v63, v78, v79
    v_accvgpr_write_b32 a52, v60
    v_accvgpr_write_b32 a53, v61
    v_accvgpr_write_b32 a54, v62
    v_accvgpr_write_b32 a55, v63
    v_pk_mul_f32 v[92:93], v[92:93], s[56:57]
    v_pk_mul_f32 v[94:95], v[94:95], s[56:57]
    v_cvt_pk_bf16_f32 v92, v92, v93
    v_cvt_pk_bf16_f32 v93, v94, v95
    v_pk_mul_f32 v[108:109], v[108:109], s[56:57]
    v_pk_mul_f32 v[110:111], v[110:111], s[56:57]
    v_cvt_pk_bf16_f32 v94, v108, v109
    v_cvt_pk_bf16_f32 v95, v110, v111
    v_accvgpr_write_b32 a56, v92
    v_accvgpr_write_b32 a57, v93
    v_accvgpr_write_b32 a58, v94
    v_accvgpr_write_b32 a59, v95
    v_pk_mul_f32 v[124:125], v[124:125], s[56:57]
    v_pk_mul_f32 v[126:127], v[126:127], s[56:57]
    v_cvt_pk_bf16_f32 v124, v124, v125
    v_cvt_pk_bf16_f32 v125, v126, v127
    v_pk_mul_f32 v[140:141], v[140:141], s[56:57]
    v_pk_mul_f32 v[142:143], v[142:143], s[56:57]
    v_cvt_pk_bf16_f32 v126, v140, v141
    v_cvt_pk_bf16_f32 v127, v142, v143
    v_accvgpr_write_b32 a60, v124
    v_accvgpr_write_b32 a61, v125
    v_accvgpr_write_b32 a62, v126
    v_accvgpr_write_b32 a63, v127
    v_pk_mul_f32 v[144:145], v[144:145], s[56:57]
    v_pk_mul_f32 v[146:147], v[146:147], s[56:57]
    v_cvt_pk_bf16_f32 v144, v144, v145
    v_cvt_pk_bf16_f32 v145, v146, v147
    v_pk_mul_f32 v[160:161], v[160:161], s[56:57]
    v_pk_mul_f32 v[162:163], v[162:163], s[56:57]
    v_cvt_pk_bf16_f32 v146, v160, v161
    v_cvt_pk_bf16_f32 v147, v162, v163
    s_add_u32 m0, s63, 52288
    v_accvgpr_write_b32 a80, v144
    v_accvgpr_write_b32 a81, v145
    v_accvgpr_write_b32 a82, v146
    v_accvgpr_write_b32 a83, v147
    buffer_load_dwordx4 v1, s[12:15], s67 offen offset:2048 nt lds
    v_pk_mul_f32 v[176:177], v[176:177], s[56:57]
    v_pk_mul_f32 v[178:179], v[178:179], s[56:57]
    v_cvt_pk_bf16_f32 v176, v176, v177
    v_cvt_pk_bf16_f32 v177, v178, v179
    v_pk_mul_f32 v[192:193], v[192:193], s[56:57]
    v_pk_mul_f32 v[194:195], v[194:195], s[56:57]
    v_cvt_pk_bf16_f32 v178, v192, v193
    v_cvt_pk_bf16_f32 v179, v194, v195
    v_accvgpr_write_b32 a84, v176
    v_accvgpr_write_b32 a85, v177
    v_accvgpr_write_b32 a86, v178
    v_accvgpr_write_b32 a87, v179
    v_pk_mul_f32 v[208:209], v[208:209], s[56:57]
    v_pk_mul_f32 v[210:211], v[210:211], s[56:57]
    v_cvt_pk_bf16_f32 v208, v208, v209
    v_cvt_pk_bf16_f32 v209, v210, v211
    v_pk_mul_f32 v[224:225], v[224:225], s[56:57]
    v_pk_mul_f32 v[226:227], v[226:227], s[56:57]
    v_cvt_pk_bf16_f32 v210, v224, v225
    v_cvt_pk_bf16_f32 v211, v226, v227
    v_accvgpr_write_b32 a88, v208
    v_accvgpr_write_b32 a89, v209
    v_accvgpr_write_b32 a90, v210
    v_accvgpr_write_b32 a91, v211
    v_pk_mul_f32 v[240:241], v[240:241], s[56:57]
    v_pk_mul_f32 v[242:243], v[242:243], s[56:57]
    v_cvt_pk_bf16_f32 v240, v240, v241
    v_cvt_pk_bf16_f32 v241, v242, v243
    v_accvgpr_read_b32 v12, a160
    v_accvgpr_read_b32 v13, a161
    v_accvgpr_read_b32 v14, a162
    v_accvgpr_read_b32 v15, a163
    v_pk_mul_f32 v[12:13], v[12:13], s[56:57]
    v_pk_mul_f32 v[14:15], v[14:15], s[56:57]
    v_cvt_pk_bf16_f32 v242, v12, v13
    v_cvt_pk_bf16_f32 v243, v14, v15
    v_accvgpr_write_b32 a92, v240
    v_accvgpr_write_b32 a93, v241
    v_accvgpr_write_b32 a94, v242
    v_accvgpr_write_b32 a95, v243
    v_pk_mul_f32 v[148:149], v[148:149], s[56:57]
    v_pk_mul_f32 v[150:151], v[150:151], s[56:57]
    v_cvt_pk_bf16_f32 v148, v148, v149
    v_cvt_pk_bf16_f32 v149, v150, v151
    v_pk_mul_f32 v[164:165], v[164:165], s[56:57]
    v_pk_mul_f32 v[166:167], v[166:167], s[56:57]
    v_cvt_pk_bf16_f32 v150, v164, v165
    v_cvt_pk_bf16_f32 v151, v166, v167
    v_accvgpr_write_b32 a96, v148
    v_accvgpr_write_b32 a97, v149
    v_accvgpr_write_b32 a98, v150
    v_accvgpr_write_b32 a99, v151
    v_pk_mul_f32 v[180:181], v[180:181], s[56:57]
    v_pk_mul_f32 v[182:183], v[182:183], s[56:57]
    v_cvt_pk_bf16_f32 v180, v180, v181
    v_cvt_pk_bf16_f32 v181, v182, v183
    v_pk_mul_f32 v[196:197], v[196:197], s[56:57]
    v_pk_mul_f32 v[198:199], v[198:199], s[56:57]
    v_cvt_pk_bf16_f32 v182, v196, v197
    v_cvt_pk_bf16_f32 v183, v198, v199
    v_accvgpr_write_b32 a100, v180
    v_accvgpr_write_b32 a101, v181
    v_accvgpr_write_b32 a102, v182
    v_accvgpr_write_b32 a103, v183
    v_pk_mul_f32 v[212:213], v[212:213], s[56:57]
    v_pk_mul_f32 v[214:215], v[214:215], s[56:57]
    v_cvt_pk_bf16_f32 v212, v212, v213
    v_cvt_pk_bf16_f32 v213, v214, v215
    v_pk_mul_f32 v[228:229], v[228:229], s[56:57]
    v_pk_mul_f32 v[230:231], v[230:231], s[56:57]
    v_cvt_pk_bf16_f32 v214, v228, v229
    v_cvt_pk_bf16_f32 v215, v230, v231
    v_accvgpr_write_b32 a104, v212
    v_accvgpr_write_b32 a105, v213
    v_accvgpr_write_b32 a106, v214
    v_accvgpr_write_b32 a107, v215
    v_pk_mul_f32 v[244:245], v[244:245], s[56:57]
    v_pk_mul_f32 v[246:247], v[246:247], s[56:57]
    v_cvt_pk_bf16_f32 v244, v244, v245
    v_cvt_pk_bf16_f32 v245, v246, v247
    v_accvgpr_read_b32 v12, a164
    v_accvgpr_read_b32 v13, a165
    v_accvgpr_read_b32 v14, a166
    v_accvgpr_read_b32 v15, a167
    v_pk_mul_f32 v[12:13], v[12:13], s[56:57]
    v_pk_mul_f32 v[14:15], v[14:15], s[56:57]
    v_cvt_pk_bf16_f32 v246, v12, v13
    v_cvt_pk_bf16_f32 v247, v14, v15
    v_accvgpr_write_b32 a108, v244
    v_accvgpr_write_b32 a109, v245
    v_accvgpr_write_b32 a110, v246
    v_accvgpr_write_b32 a111, v247
    v_pk_mul_f32 v[152:153], v[152:153], s[56:57]
    v_pk_mul_f32 v[154:155], v[154:155], s[56:57]
    v_cvt_pk_bf16_f32 v152, v152, v153
    v_cvt_pk_bf16_f32 v153, v154, v155
    v_pk_mul_f32 v[168:169], v[168:169], s[56:57]
    v_pk_mul_f32 v[170:171], v[170:171], s[56:57]
    v_cvt_pk_bf16_f32 v154, v168, v169
    v_cvt_pk_bf16_f32 v155, v170, v171
    s_add_u32 m0, s63, 52320
    v_accvgpr_write_b32 a112, v152
    v_accvgpr_write_b32 a113, v153
    v_accvgpr_write_b32 a114, v154
    v_accvgpr_write_b32 a115, v155
    buffer_load_dwordx4 v1, s[12:15], s67 offen offset:3072 nt lds
    v_pk_mul_f32 v[184:185], v[184:185], s[56:57]
    v_pk_mul_f32 v[186:187], v[186:187], s[56:57]
    v_cvt_pk_bf16_f32 v184, v184, v185
    v_cvt_pk_bf16_f32 v185, v186, v187
    v_pk_mul_f32 v[200:201], v[200:201], s[56:57]
    v_pk_mul_f32 v[202:203], v[202:203], s[56:57]
    v_cvt_pk_bf16_f32 v186, v200, v201
    v_cvt_pk_bf16_f32 v187, v202, v203
    v_accvgpr_write_b32 a116, v184
    v_accvgpr_write_b32 a117, v185
    v_accvgpr_write_b32 a118, v186
    v_accvgpr_write_b32 a119, v187
    v_pk_mul_f32 v[216:217], v[216:217], s[56:57]
    v_pk_mul_f32 v[218:219], v[218:219], s[56:57]
    v_cvt_pk_bf16_f32 v216, v216, v217
    v_cvt_pk_bf16_f32 v217, v218, v219
    v_pk_mul_f32 v[232:233], v[232:233], s[56:57]
    v_pk_mul_f32 v[234:235], v[234:235], s[56:57]
    v_cvt_pk_bf16_f32 v218, v232, v233
    v_cvt_pk_bf16_f32 v219, v234, v235
    v_accvgpr_write_b32 a120, v216
    v_accvgpr_write_b32 a121, v217
    v_accvgpr_write_b32 a122, v218
    v_accvgpr_write_b32 a123, v219
    v_pk_mul_f32 v[248:249], v[248:249], s[56:57]
    v_pk_mul_f32 v[250:251], v[250:251], s[56:57]
    v_cvt_pk_bf16_f32 v248, v248, v249
    v_cvt_pk_bf16_f32 v249, v250, v251
    v_accvgpr_read_b32 v12, a168
    v_accvgpr_read_b32 v13, a169
    v_accvgpr_read_b32 v14, a170
    v_accvgpr_read_b32 v15, a171
    v_pk_mul_f32 v[12:13], v[12:13], s[56:57]
    v_pk_mul_f32 v[14:15], v[14:15], s[56:57]
    v_cvt_pk_bf16_f32 v250, v12, v13
    v_cvt_pk_bf16_f32 v251, v14, v15
    v_accvgpr_write_b32 a124, v248
    v_accvgpr_write_b32 a125, v249
    v_accvgpr_write_b32 a126, v250
    v_accvgpr_write_b32 a127, v251
    v_pk_mul_f32 v[156:157], v[156:157], s[56:57]
    v_pk_mul_f32 v[158:159], v[158:159], s[56:57]
    v_cvt_pk_bf16_f32 v156, v156, v157
    v_cvt_pk_bf16_f32 v157, v158, v159
    v_pk_mul_f32 v[172:173], v[172:173], s[56:57]
    v_pk_mul_f32 v[174:175], v[174:175], s[56:57]
    v_cvt_pk_bf16_f32 v158, v172, v173
    v_cvt_pk_bf16_f32 v159, v174, v175
    v_accvgpr_write_b32 a128, v156
    v_accvgpr_write_b32 a129, v157
    v_accvgpr_write_b32 a130, v158
    v_accvgpr_write_b32 a131, v159
    v_pk_mul_f32 v[188:189], v[188:189], s[56:57]
    v_pk_mul_f32 v[190:191], v[190:191], s[56:57]
    v_cvt_pk_bf16_f32 v188, v188, v189
    v_cvt_pk_bf16_f32 v189, v190, v191
    v_pk_mul_f32 v[204:205], v[204:205], s[56:57]
    v_pk_mul_f32 v[206:207], v[206:207], s[56:57]
    v_cvt_pk_bf16_f32 v190, v204, v205
    v_cvt_pk_bf16_f32 v191, v206, v207
    v_accvgpr_write_b32 a132, v188
    v_accvgpr_write_b32 a133, v189
    v_accvgpr_write_b32 a134, v190
    v_accvgpr_write_b32 a135, v191
    v_pk_mul_f32 v[220:221], v[220:221], s[56:57]
    v_pk_mul_f32 v[222:223], v[222:223], s[56:57]
    v_cvt_pk_bf16_f32 v220, v220, v221
    v_cvt_pk_bf16_f32 v221, v222, v223
    v_pk_mul_f32 v[236:237], v[236:237], s[56:57]
    v_pk_mul_f32 v[238:239], v[238:239], s[56:57]
    v_cvt_pk_bf16_f32 v222, v236, v237
    v_cvt_pk_bf16_f32 v223, v238, v239
    v_accvgpr_write_b32 a136, v220
    v_accvgpr_write_b32 a137, v221
    v_accvgpr_write_b32 a138, v222
    v_accvgpr_write_b32 a139, v223
    v_pk_mul_f32 v[252:253], v[252:253], s[56:57]
    v_pk_mul_f32 v[254:255], v[254:255], s[56:57]
    v_cvt_pk_bf16_f32 v252, v252, v253
    v_cvt_pk_bf16_f32 v253, v254, v255
    v_accvgpr_read_b32 v12, a172
    v_accvgpr_read_b32 v13, a173
    v_accvgpr_read_b32 v14, a174
    v_accvgpr_read_b32 v15, a175
    v_pk_mul_f32 v[12:13], v[12:13], s[56:57]
    v_pk_mul_f32 v[14:15], v[14:15], s[56:57]
    v_cvt_pk_bf16_f32 v254, v12, v13
    v_cvt_pk_bf16_f32 v255, v14, v15
    v_accvgpr_write_b32 a140, v252
    v_accvgpr_write_b32 a141, v253
    v_accvgpr_write_b32 a142, v254
    v_accvgpr_write_b32 a143, v255
    s_branch L_qe2
L_qe1:
    v_pk_mul_f32 v[16:17], v[16:17], s[56:57]
    v_pk_mul_f32 v[18:19], v[18:19], s[56:57]
    v_cvt_pk_bf16_f32 v16, v16, v17
    v_cvt_pk_bf16_f32 v17, v18, v19
    v_pk_mul_f32 v[32:33], v[32:33], s[56:57]
    v_pk_mul_f32 v[34:35], v[34:35], s[56:57]
    v_cvt_pk_bf16_f32 v18, v32, v33
    v_cvt_pk_bf16_f32 v19, v34, v35
    s_add_u32 m0, s63, 52224
    s_mov_b32 s67, 49152
    v_accvgpr_write_b32 a80, v16
    v_accvgpr_write_b32 a81, v17
    v_accvgpr_write_b32 a82, v18
    v_accvgpr_write_b32 a83, v19
    buffer_load_dwordx4 v1, s[12:15], s67 offen offset:0 nt lds
    v_pk_mul_f32 v[48:49], v[48:49], s[56:57]
    v_pk_mul_f32 v[50:51], v[50:51], s[56:57]
    v_cvt_pk_bf16_f32 v48, v48, v49
    v_cvt_pk_bf16_f32 v49, v50, v51
    v_pk_mul_f32 v[64:65], v[64:65], s[56:57]
    v_pk_mul_f32 v[66:67], v[66:67], s[56:57]
    v_cvt_pk_bf16_f32 v50, v64, v65
    v_cvt_pk_bf16_f32 v51, v66, v67
    v_accvgpr_write_b32 a84, v48
    v_accvgpr_write_b32 a85, v49
    v_accvgpr_write_b32 a86, v50
    v_accvgpr_write_b32 a87, v51
    v_pk_mul_f32 v[80:81], v[80:81], s[56:57]
    v_pk_mul_f32 v[82:83], v[82:83], s[56:57]
    v_cvt_pk_bf16_f32 v80, v80, v81
    v_cvt_pk_bf16_f32 v81, v82, v83
    v_pk_mul_f32 v[96:97], v[96:97], s[56:57]
    v_pk_mul_f32 v[98:99], v[98:99], s[56:57]
    v_cvt_pk_bf16_f32 v82, v96, v97
    v_cvt_pk_bf16_f32 v83, v98, v99
    v_accvgpr_write_b32 a88, v80
    v_accvgpr_write_b32 a89, v81
    v_accvgpr_write_b32 a90, v82
    v_accvgpr_write_b32 a91, v83
    v_pk_mul_f32 v[112:113], v[112:113], s[56:57]
    v_pk_mul_f32 v[114:115], v[114:115], s[56:57]
    v_cvt_pk_bf16_f32 v112, v112, v113
    v_cvt_pk_bf16_f32 v113, v114, v115
    v_pk_mul_f32 v[128:129], v[128:129], s[56:57]
    v_pk_mul_f32 v[130:131], v[130:131], s[56:57]
    v_cvt_pk_bf16_f32 v114, v128, v129
    v_cvt_pk_bf16_f32 v115, v130, v131
    v_accvgpr_write_b32 a92, v112
    v_accvgpr_write_b32 a93, v113
    v_accvgpr_write_b32 a94, v114
    v_accvgpr_write_b32 a95, v115
    v_pk_mul_f32 v[20:21], v[20:21], s[56:57]
    v_pk_mul_f32 v[22:23], v[22:23], s[56:57]
    v_cvt_pk_bf16_f32 v20, v20, v21
    v_cvt_pk_bf16_f32 v21, v22, v23
    v_pk_mul_f32 v[36:37], v[36:37], s[56:57]
    v_pk_mul_f32 v[38:39], v[38:39], s[56:57]
    v_cvt_pk_bf16_f32 v22, v36, v37
    v_cvt_pk_bf16_f32 v23, v38, v39
    v_accvgpr_write_b32 a96, v20
    v_accvgpr_write_b32 a97, v21
    v_accvgpr_write_b32 a98, v22
    v_accvgpr_write_b32 a99, v23
    v_pk_mul_f32 v[52:53], v[52:53], s[56:57]
    v_pk_mul_f32 v[54:55], v[54:55], s[56:57]
    v_cvt_pk_bf16_f32 v52, v52, v53
    v_cvt_pk_bf16_f32 v53, v54, v55
    v_pk_mul_f32 v[68:69], v[68:69], s[56:57]
    v_pk_mul_f32 v[70:71], v[70:71], s[56:57]
    v_cvt_pk_bf16_f32 v54, v68, v69
    v_cvt_pk_bf16_f32 v55, v70, v71
    v_accvgpr_write_b32 a100, v52
    v_accvgpr_write_b32 a101, v53
    v_accvgpr_write_b32 a102, v54
    v_accvgpr_write_b32 a103, v55
    v_pk_mul_f32 v[84:85], v[84:85], s[56:57]
    v_pk_mul_f32 v[86:87], v[86:87], s[56:57]
    v_cvt_pk_bf16_f32 v84, v84, v85
    v_cvt_pk_bf16_f32 v85, v86, v87
    v_pk_mul_f32 v[100:101], v[100:101], s[56:57]
    v_pk_mul_f32 v[102:103], v[102:103], s[56:57]
    v_cvt_pk_bf16_f32 v86, v100, v101
    v_cvt_pk_bf16_f32 v87, v102, v103
    v_accvgpr_write_b32 a104, v84
    v_accvgpr_write_b32 a105, v85
    v_accvgpr_write_b32 a106, v86
    v_accvgpr_write_b32 a107, v87
    v_pk_mul_f32 v[116:117], v[116:117], s[56:57]
    v_pk_mul_f32 v[118:119], v[118:119], s[56:57]
    v_cvt_pk_bf16_f32 v116, v116, v117
    v_cvt_pk_bf16_f32 v117, v118, v119
    v_pk_mul_f32 v[132:133], v[132:133], s[56:57]
    v_pk_mul_f32 v[134:135], v[134:135], s[56:57]
    v_cvt_pk_bf16_f32 v118, v132, v133
    v_cvt_pk_bf16_f32 v119, v134, v135
    v_accvgpr_write_b32 a108, v116
    v_accvgpr_write_b32 a109, v117
    v_accvgpr_write_b32 a110, v118
    v_accvgpr_write_b32 a111, v119
    v_pk_mul_f32 v[24:25], v[24:25], s[56:57]
    v_pk_mul_f32 v[26:27], v[26:27], s[56:57]
    v_cvt_pk_bf16_f32 v24, v24, v25
    v_cvt_pk_bf16_f32 v25, v26, v27
    v_pk_mul_f32 v[40:41], v[40:41], s[56:57]
    v_pk_mul_f32 v[42:43], v[42:43], s[56:57]
    v_cvt_pk_bf16_f32 v26, v40, v41
    v_cvt_pk_bf16_f32 v27, v42, v43
    s_add_u32 m0, s63, 52256
    v_accvgpr_write_b32 a112, v24
    v_accvgpr_write_b32 a113, v25
    v_accvgpr_write_b32 a114, v26
    v_accvgpr_write_b32 a115, v27
    buffer_load_dwordx4 v1, s[12:15], s67 offen offset:1024 nt lds
    v_pk_mul_f32 v[56:57], v[56:57], s[56:57]
    v_pk_mul_f32 v[58:59], v[58:59], s[56:57]
    v_cvt_pk_bf16_f32 v56, v56, v57
    v_cvt_pk_bf16_f32 v57, v58, v59
    v_pk_mul_f32 v[72:73], v[72:73], s[56:57]
    v_pk_mul_f32 v[74:75], v[74:75], s[56:57]
    v_cvt_pk_bf16_f32 v58, v72, v73
    v_cvt_pk_bf16_f32 v59, v74, v75
    v_accvgpr_write_b32 a116, v56
    v_accvgpr_write_b32 a117, v57
    v_accvgpr_write_b32 a118, v58
    v_accvgpr_write_b32 a119, v59
    v_pk_mul_f32 v[88:89], v[88:89], s[56:57]
    v_pk_mul_f32 v[90:91], v[90:91], s[56:57]
    v_cvt_pk_bf16_f32 v88, v88, v89
    v_cvt_pk_bf16_f32 v89, v90, v91
    v_pk_mul_f32 v[104:105], v[104:105], s[56:57]
    v_pk_mul_f32 v[106:107], v[106:107], s[56:57]
    v_cvt_pk_bf16_f32 v90, v104, v105
    v_cvt_pk_bf16_f32 v91, v106, v107
    v_accvgpr_write_b32 a120, v88
    v_accvgpr_write_b32 a121, v89
    v_accvgpr_write_b32 a122, v90
    v_accvgpr_write_b32 a123, v91
    v_pk_mul_f32 v[120:121], v[120:121], s[56:57]
    v_pk_mul_f32 v[122:123], v[122:123], s[56:57]
    v_cvt_pk_bf16_f32 v120, v120, v121
    v_cvt_pk_bf16_f32 v121, v122, v123
    v_pk_mul_f32 v[136:137], v[136:137], s[56:57]
    v_pk_mul_f32 v[138:139], v[138:139], s[56:57]
    v_cvt_pk_bf16_f32 v122, v136, v137
    v_cvt_pk_bf16_f32 v123, v138, v139
    v_accvgpr_write_b32 a124, v120
    v_accvgpr_write_b32 a125, v121
    v_accvgpr_write_b32 a126, v122
    v_accvgpr_write_b32 a127, v123
    v_pk_mul_f32 v[28:29], v[28:29], s[56:57]
    v_pk_mul_f32 v[30:31], v[30:31], s[56:57]
    v_cvt_pk_bf16_f32 v28, v28, v29
    v_cvt_pk_bf16_f32 v29, v30, v31
    v_pk_mul_f32 v[44:45], v[44:45], s[56:57]
    v_pk_mul_f32 v[46:47], v[46:47], s[56:57]
    v_cvt_pk_bf16_f32 v30, v44, v45
    v_cvt_pk_bf16_f32 v31, v46, v47
    v_accvgpr_write_b32 a128, v28
    v_accvgpr_write_b32 a129, v29
    v_accvgpr_write_b32 a130, v30
    v_accvgpr_write_b32 a131, v31
    v_pk_mul_f32 v[60:61], v[60:61], s[56:57]
    v_pk_mul_f32 v[62:63], v[62:63], s[56:57]
    v_cvt_pk_bf16_f32 v60, v60, v61
    v_cvt_pk_bf16_f32 v61, v62, v63
    v_pk_mul_f32 v[76:77], v[76:77], s[56:57]
    v_pk_mul_f32 v[78:79], v[78:79], s[56:57]
    v_cvt_pk_bf16_f32 v62, v76, v77
    v_cvt_pk_bf16_f32 v63, v78, v79
    v_accvgpr_write_b32 a132, v60
    v_accvgpr_write_b32 a133, v61
    v_accvgpr_write_b32 a134, v62
    v_accvgpr_write_b32 a135, v63
    v_pk_mul_f32 v[92:93], v[92:93], s[56:57]
    v_pk_mul_f32 v[94:95], v[94:95], s[56:57]
    v_cvt_pk_bf16_f32 v92, v92, v93
    v_cvt_pk_bf16_f32 v93, v94, v95
    v_pk_mul_f32 v[108:109], v[108:109], s[56:57]
    v_pk_mul_f32 v[110:111], v[110:111], s[56:57]
    v_cvt_pk_bf16_f32 v94, v108, v109
    v_cvt_pk_bf16_f32 v95, v110, v111
    v_accvgpr_write_b32 a136, v92
    v_accvgpr_write_b32 a137, v93
    v_accvgpr_write_b32 a138, v94
    v_accvgpr_write_b32 a139, v95
    v_pk_mul_f32 v[124:125], v[124:125], s[56:57]
    v_pk_mul_f32 v[126:127], v[126:127], s[56:57]
    v_cvt_pk_bf16_f32 v124, v124, v125
    v_cvt_pk_bf16_f32 v125, v126, v127
    v_pk_mul_f32 v[140:141], v[140:141], s[56:57]
    v_pk_mul_f32 v[142:143], v[142:143], s[56:57]
    v_cvt_pk_bf16_f32 v126, v140, v141
    v_cvt_pk_bf16_f32 v127, v142, v143
    v_accvgpr_write_b32 a140, v124
    v_accvgpr_write_b32 a141, v125
    v_accvgpr_write_b32 a142, v126
    v_accvgpr_write_b32 a143, v127
    v_pk_mul_f32 v[144:145], v[144:145], s[56:57]
    v_pk_mul_f32 v[146:147], v[146:147], s[56:57]
    v_cvt_pk_bf16_f32 v144, v144, v145
    v_cvt_pk_bf16_f32 v145, v146, v147
    v_pk_mul_f32 v[160:161], v[160:161], s[56:57]
    v_pk_mul_f32 v[162:163], v[162:163], s[56:57]
    v_cvt_pk_bf16_f32 v146, v160, v161
    v_cvt_pk_bf16_f32 v147, v162, v163
    s_add_u32 m0, s63, 52288
    v_accvgpr_write_b32 a0, v144
    v_accvgpr_write_b32 a1, v145
    v_accvgpr_write_b32 a2, v146
    v_accvgpr_write_b32 a3, v147
    buffer_load_dwordx4 v1, s[12:15], s67 offen offset:2048 nt lds
    v_pk_mul_f32 v[176:177], v[176:177], s[56:57]
    v_pk_mul_f32 v[178:179], v[178:179], s[56:57]
    v_cvt_pk_bf16_f32 v176, v176, v177
    v_cvt_pk_bf16_f32 v177, v178, v179
    v_pk_mul_f32 v[192:193], v[192:193], s[56:57]
    v_pk_mul_f32 v[194:195], v[194:195], s[56:57]
    v_cvt_pk_bf16_f32 v178, v192, v193
    v_cvt_pk_bf16_f32 v179, v194, v195
    v_accvgpr_write_b32 a4, v176
    v_accvgpr_write_b32 a5, v177
    v_accvgpr_write_b32 a6, v178
    v_accvgpr_write_b32 a7, v179
    v_pk_mul_f32 v[208:209], v[208:209], s[56:57]
    v_pk_mul_f32 v[210:211], v[210:211], s[56:57]
    v_cvt_pk_bf16_f32 v208, v208, v209
    v_cvt_pk_bf16_f32 v209, v210, v211
    v_pk_mul_f32 v[224:225], v[224:225], s[56:57]
    v_pk_mul_f32 v[226:227], v[226:227], s[56:57]
    v_cvt_pk_bf16_f32 v210, v224, v225
    v_cvt_pk_bf16_f32 v211, v226, v227
    v_accvgpr_write_b32 a8, v208
    v_accvgpr_write_b32 a9, v209
    v_accvgpr_write_b32 a10, v210
    v_accvgpr_write_b32 a11, v211
    v_pk_mul_f32 v[240:241], v[240:241], s[56:57]
    v_pk_mul_f32 v[242:243], v[242:243], s[56:57]
    v_cvt_pk_bf16_f32 v240, v240, v241
    v_cvt_pk_bf16_f32 v241, v242, v243
    v_accvgpr_read_b32 v12, a160
    v_accvgpr_read_b32 v13, a161
    v_accvgpr_read_b32 v14, a162
    v_accvgpr_read_b32 v15, a163
    v_pk_mul_f32 v[12:13], v[12:13], s[56:57]
    v_pk_mul_f32 v[14:15], v[14:15], s[56:57]
    v_cvt_pk_bf16_f32 v242, v12, v13
    v_cvt_pk_bf16_f32 v243, v14, v15
    v_accvgpr_write_b32 a12, v240
    v_accvgpr_write_b32 a13, v241
    v_accvgpr_write_b32 a14, v242
    v_accvgpr_write_b32 a15, v243
    v_pk_mul_f32 v[148:149], v[148:149], s[56:57]
    v_pk_mul_f32 v[150:151], v[150:151], s[56:57]
    v_cvt_pk_bf16_f32 v148, v148, v149
    v_cvt_pk_bf16_f32 v149, v150, v151
    v_pk_mul_f32 v[164:165], v[164:165], s[56:57]
    v_pk_mul_f32 v[166:167], v[166:167], s[56:57]
    v_cvt_pk_bf16_f32 v150, v164, v165
    v_cvt_pk_bf16_f32 v151, v166, v167
    v_accvgpr_write_b32 a16, v148
    v_accvgpr_write_b32 a17, v149
    v_accvgpr_write_b32 a18, v150
    v_accvgpr_write_b32 a19, v151
    v_pk_mul_f32 v[180:181], v[180:181], s[56:57]
    v_pk_mul_f32 v[182:183], v[182:183], s[56:57]
    v_cvt_pk_bf16_f32 v180, v180, v181
    v_cvt_pk_bf16_f32 v181, v182, v183
    v_pk_mul_f32 v[196:197], v[196:197], s[56:57]
    v_pk_mul_f32 v[198:199], v[198:199], s[56:57]
    v_cvt_pk_bf16_f32 v182, v196, v197
    v_cvt_pk_bf16_f32 v183, v198, v199
    v_accvgpr_write_b32 a20, v180
    v_accvgpr_write_b32 a21, v181
    v_accvgpr_write_b32 a22, v182
    v_accvgpr_write_b32 a23, v183
    v_pk_mul_f32 v[212:213], v[212:213], s[56:57]
    v_pk_mul_f32 v[214:215], v[214:215], s[56:57]
    v_cvt_pk_bf16_f32 v212, v212, v213
    v_cvt_pk_bf16_f32 v213, v214, v215
    v_pk_mul_f32 v[228:229], v[228:229], s[56:57]
    v_pk_mul_f32 v[230:231], v[230:231], s[56:57]
    v_cvt_pk_bf16_f32 v214, v228, v229
    v_cvt_pk_bf16_f32 v215, v230, v231
    v_accvgpr_write_b32 a24, v212
    v_accvgpr_write_b32 a25, v213
    v_accvgpr_write_b32 a26, v214
    v_accvgpr_write_b32 a27, v215
    v_pk_mul_f32 v[244:245], v[244:245], s[56:57]
    v_pk_mul_f32 v[246:247], v[246:247], s[56:57]
    v_cvt_pk_bf16_f32 v244, v244, v245
    v_cvt_pk_bf16_f32 v245, v246, v247
    v_accvgpr_read_b32 v12, a164
    v_accvgpr_read_b32 v13, a165
    v_accvgpr_read_b32 v14, a166
    v_accvgpr_read_b32 v15, a167
    v_pk_mul_f32 v[12:13], v[12:13], s[56:57]
    v_pk_mul_f32 v[14:15], v[14:15], s[56:57]
    v_cvt_pk_bf16_f32 v246, v12, v13
    v_cvt_pk_bf16_f32 v247, v14, v15
    v_accvgpr_write_b32 a28, v244
    v_accvgpr_write_b32 a29, v245
    v_accvgpr_write_b32 a30, v246
    v_accvgpr_write_b32 a31, v247
    v_pk_mul_f32 v[152:153], v[152:153], s[56:57]
    v_pk_mul_f32 v[154:155], v[154:155], s[56:57]
    v_cvt_pk_bf16_f32 v152, v152, v153
    v_cvt_pk_bf16_f32 v153, v154, v155
    v_pk_mul_f32 v[168:169], v[168:169], s[56:57]
    v_pk_mul_f32 v[170:171], v[170:171], s[56:57]
    v_cvt_pk_bf16_f32 v154, v168, v169
    v_cvt_pk_bf16_f32 v155, v170, v171
    s_add_u32 m0, s63, 52320
    v_accvgpr_write_b32 a32, v152
    v_accvgpr_write_b32 a33, v153
    v_accvgpr_write_b32 a34, v154
    v_accvgpr_write_b32 a35, v155
    buffer_load_dwordx4 v1, s[12:15], s67 offen offset:3072 nt lds
    v_pk_mul_f32 v[184:185], v[184:185], s[56:57]
    v_pk_mul_f32 v[186:187], v[186:187], s[56:57]
    v_cvt_pk_bf16_f32 v184, v184, v185
    v_cvt_pk_bf16_f32 v185, v186, v187
    v_pk_mul_f32 v[200:201], v[200:201], s[56:57]
    v_pk_mul_f32 v[202:203], v[202:203], s[56:57]
    v_cvt_pk_bf16_f32 v186, v200, v201
    v_cvt_pk_bf16_f32 v187, v202, v203
    v_accvgpr_write_b32 a36, v184
    v_accvgpr_write_b32 a37, v185
    v_accvgpr_write_b32 a38, v186
    v_accvgpr_write_b32 a39, v187
    v_pk_mul_f32 v[216:217], v[216:217], s[56:57]
    v_pk_mul_f32 v[218:219], v[218:219], s[56:57]
    v_cvt_pk_bf16_f32 v216, v216, v217
    v_cvt_pk_bf16_f32 v217, v218, v219
    v_pk_mul_f32 v[232:233], v[232:233], s[56:57]
    v_pk_mul_f32 v[234:235], v[234:235], s[56:57]
    v_cvt_pk_bf16_f32 v218, v232, v233
    v_cvt_pk_bf16_f32 v219, v234, v235
    v_accvgpr_write_b32 a40, v216
    v_accvgpr_write_b32 a41, v217
    v_accvgpr_write_b32 a42, v218
    v_accvgpr_write_b32 a43, v219
    v_pk_mul_f32 v[248:249], v[248:249], s[56:57]
    v_pk_mul_f32 v[250:251], v[250:251], s[56:57]
    v_cvt_pk_bf16_f32 v248, v248, v249
    v_cvt_pk_bf16_f32 v249, v250, v251
    v_accvgpr_read_b32 v12, a168
    v_accvgpr_read_b32 v13, a169
    v_accvgpr_read_b32 v14, a170
    v_accvgpr_read_b32 v15, a171
    v_pk_mul_f32 v[12:13], v[12:13], s[56:57]
    v_pk_mul_f32 v[14:15], v[14:15], s[56:57]
    v_cvt_pk_bf16_f32 v250, v12, v13
    v_cvt_pk_bf16_f32 v251, v14, v15
    v_accvgpr_write_b32 a44, v248
    v_accvgpr_write_b32 a45, v249
    v_accvgpr_write_b32 a46, v250
    v_accvgpr_write_b32 a47, v251
    v_pk_mul_f32 v[156:157], v[156:157], s[56:57]
    v_pk_mul_f32 v[158:159], v[158:159], s[56:57]
    v_cvt_pk_bf16_f32 v156, v156, v157
    v_cvt_pk_bf16_f32 v157, v158, v159
    v_pk_mul_f32 v[172:173], v[172:173], s[56:57]
    v_pk_mul_f32 v[174:175], v[174:175], s[56:57]
    v_cvt_pk_bf16_f32 v158, v172, v173
    v_cvt_pk_bf16_f32 v159, v174, v175
    v_accvgpr_write_b32 a48, v156
    v_accvgpr_write_b32 a49, v157
    v_accvgpr_write_b32 a50, v158
    v_accvgpr_write_b32 a51, v159
    v_pk_mul_f32 v[188:189], v[188:189], s[56:57]
    v_pk_mul_f32 v[190:191], v[190:191], s[56:57]
    v_cvt_pk_bf16_f32 v188, v188, v189
    v_cvt_pk_bf16_f32 v189, v190, v191
    v_pk_mul_f32 v[204:205], v[204:205], s[56:57]
    v_pk_mul_f32 v[206:207], v[206:207], s[56:57]
    v_cvt_pk_bf16_f32 v190, v204, v205
    v_cvt_pk_bf16_f32 v191, v206, v207
    v_accvgpr_write_b32 a52, v188
    v_accvgpr_write_b32 a53, v189
    v_accvgpr_write_b32 a54, v190
    v_accvgpr_write_b32 a55, v191
    v_pk_mul_f32 v[220:221], v[220:221], s[56:57]
    v_pk_mul_f32 v[222:223], v[222:223], s[56:57]
    v_cvt_pk_bf16_f32 v220, v220, v221
    v_cvt_pk_bf16_f32 v221, v222, v223
    v_pk_mul_f32 v[236:237], v[236:237], s[56:57]
    v_pk_mul_f32 v[238:239], v[238:239], s[56:57]
    v_cvt_pk_bf16_f32 v222, v236, v237
    v_cvt_pk_bf16_f32 v223, v238, v239
    v_accvgpr_write_b32 a56, v220
    v_accvgpr_write_b32 a57, v221
    v_accvgpr_write_b32 a58, v222
    v_accvgpr_write_b32 a59, v223
    v_pk_mul_f32 v[252:253], v[252:253], s[56:57]
    v_pk_mul_f32 v[254:255], v[254:255], s[56:57]
    v_cvt_pk_bf16_f32 v252, v252, v253
    v_cvt_pk_bf16_f32 v253, v254, v255
    v_accvgpr_read_b32 v12, a172
    v_accvgpr_read_b32 v13, a173
    v_accvgpr_read_b32 v14, a174
    v_accvgpr_read_b32 v15, a175
    v_pk_mul_f32 v[12:13], v[12:13], s[56:57]
    v_pk_mul_f32 v[14:15], v[14:15], s[56:57]
    v_cvt_pk_bf16_f32 v254, v12, v13
    v_cvt_pk_bf16_f32 v255, v14, v15
    v_accvgpr_write_b32 a60, v252
    v_accvgpr_write_b32 a61, v253
    v_accvgpr_write_b32 a62, v254
    v_accvgpr_write_b32 a63, v255
L_qe2:
    s_waitcnt vmcnt(16) lgkmcnt(0)
    s_barrier
    s_cmp_lg_u32 s36, 0
    s_cbranch_scc1 L_ann
    s_lshl_b32 s3, s41, 3
    s_add_u32 s3, s3, s39
    s_lshl_b32 s3, s3, 4
    v_mov_b32 v11, 1
    v_lshlrev_b32 v10, 8, v0
    buffer_atomic_add v11, v10, s[32:35], s3 offen sc1
L_ann:
    s_lshl_b32 s3, s37, 12
    v_subrev_u32 v9, s3, v9
    ds_read_b128 a[64:67], v9 offset:0
    ds_read_b128 a[68:71], v9 offset:1024
    ds_read_b128 a[72:75], v9 offset:2048
    ds_read_b128 a[76:79], v9 offset:3072
    ds_read_b128 a[144:147], v9 offset:4096
    ds_read_b128 a[148:151], v9 offset:5120
    ds_read_b128 a[152:155], v9 offset:6144
    ds_read_b128 a[156:159], v9 offset:7168
    v_mov_b32 v16, 0xff800000
    v_mov_b32 v20, 0xff800000
    v_mov_b32 v24, 0xff800000
    v_mov_b32 v28, 0xff800000
    v_mov_b32 v32, 0xff800000
L_head0:
    s_mov_b32 s52, 65536
    s_mov_b32 s89, 65536
    s_mov_b32 s94, 0
    s_mov_b32 s50, s48
    s_add_u32 s95, s63, 139264
    s_add_u32 s51, s63, 69632
    s_lshr_b32 s53, s2, 3
    s_and_b32 s3, s53, 3
    s_lshl_b32 s59, 2, s3
    s_xor_b32 s3, s53, 2
    s_and_b32 s3, s3, 3
    s_lshl_b32 s61, 2, s3
    ds_read_b128 a[160:163], v2 offset:0
    ds_read_b128 a[164:167], v2 offset:64
    ds_read_b128 a[168:171], v2 offset:128
    ds_read_b128 a[172:175], v2 offset:192
    ds_read_b128 a[176:179], v2 offset:512
    ds_read_b128 a[180:183], v2 offset:576
    ds_read_b128 a[184:187], v2 offset:640
    ds_read_b128 a[188:191], v2 offset:704
    v_add_u32 v2, s47, v2
    s_waitcnt lgkmcnt(7)
    v_mfma_f32_16x16x32_bf16 v[96:99], a[160:163], a[0:3], 0
    s_waitcnt lgkmcnt(6)
    v_mfma_f32_16x16x32_bf16 v[96:99], a[164:167], a[4:7], v[96:99]
    s_waitcnt lgkmcnt(5)
    v_mfma_f32_16x16x32_bf16 v[96:99], a[168:171], a[8:11], v[96:99]
    s_waitcnt lgkmcnt(4)
    v_mfma_f32_16x16x32_bf16 v[96:99], a[172:175], a[12:15], v[96:99]
    s_waitcnt lgkmcnt(3)
    v_mfma_f32_16x16x32_bf16 v[100:103], a[176:179], a[0:3], 0
    s_waitcnt lgkmcnt(2)
    v_mfma_f32_16x16x32_bf16 v[100:103], a[180:183], a[4:7], v[100:103]
    s_waitcnt lgkmcnt(1)
    v_mfma_f32_16x16x32_bf16 v[100:103], a[184:187], a[8:11], v[100:103]
    s_waitcnt lgkmcnt(0)
    v_mfma_f32_16x16x32_bf16 v[100:103], a[188:191], a[12:15], v[100:103]
    v_mfma_f32_16x16x32_bf16 v[104:107], a[160:163], a[16:19], 0
    v_mfma_f32_16x16x32_bf16 v[104:107], a[164:167], a[20:23], v[104:107]
    v_mfma_f32_16x16x32_bf16 v[104:107], a[168:171], a[24:27], v[104:107]
    v_mfma_f32_16x16x32_bf16 v[104:107], a[172:175], a[28:31], v[104:107]
    v_mfma_f32_16x16x32_bf16 v[108:111], a[176:179], a[16:19], 0
    v_mfma_f32_16x16x32_bf16 v[108:111], a[180:183], a[20:23], v[108:111]
    v_mfma_f32_16x16x32_bf16 v[108:111], a[184:187], a[24:27], v[108:111]
    v_mfma_f32_16x16x32_bf16 v[108:111], a[188:191], a[28:31], v[108:111]
    v_mfma_f32_16x16x32_bf16 v[112:115], a[160:163], a[32:35], 0
    v_mfma_f32_16x16x32_bf16 v[112:115], a[164:167], a[36:39], v[112:115]
    v_mfma_f32_16x16x32_bf16 v[112:115], a[168:171], a[40:43], v[112:115]
    v_mfma_f32_16x16x32_bf16 v[112:115], a[172:175], a[44:47], v[112:115]
    v_mfma_f32_16x16x32_bf16 v[116:119], a[176:179], a[32:35], 0
    v_mfma_f32_16x16x32_bf16 v[116:119], a[180:183], a[36:39], v[116:119]
    v_mfma_f32_16x16x32_bf16 v[116:119], a[184:187], a[40:43], v[116:119]
    v_mfma_f32_16x16x32_bf16 v[116:119], a[188:191], a[44:47], v[116:119]
    v_mfma_f32_16x16x32_bf16 v[120:123], a[160:163], a[48:51], 0
    v_mfma_f32_16x16x32_bf16 v[120:123], a[164:167], a[52:55], v[120:123]
    v_mfma_f32_16x16x32_bf16 v[120:123], a[168:171], a[56:59], v[120:123]
    v_mfma_f32_16x16x32_bf16 v[120:123], a[172:175], a[60:63], v[120:123]
    v_mfma_f32_16x16x32_bf16 v[124:127], a[176:179], a[48:51], 0
    v_mfma_f32_16x16x32_bf16 v[124:127], a[180:183], a[52:55], v[124:127]
    v_mfma_f32_16x16x32_bf16 v[124:127], a[184:187], a[56:59], v[124:127]
    v_mfma_f32_16x16x32_bf16 v[124:127], a[188:191], a[60:63], v[124:127]
    v_mfma_f32_16x16x32_bf16 v[128:131], a[160:163], a[64:67], 0
    v_mfma_f32_16x16x32_bf16 v[128:131], a[164:167], a[68:71], v[128:131]
    v_mfma_f32_16x16x32_bf16 v[128:131], a[168:171], a[72:75], v[128:131]
    v_mfma_f32_16x16x32_bf16 v[128:131], a[172:175], a[76:79], v[128:131]
    v_mfma_f32_16x16x32_bf16 v[132:135], a[176:179], a[64:67], 0
    v_mfma_f32_16x16x32_bf16 v[132:135], a[180:183], a[68:71], v[132:135]
    v_mfma_f32_16x16x32_bf16 v[132:135], a[184:187], a[72:75], v[132:135]
    v_mfma_f32_16x16x32_bf16 v[132:135], a[188:191], a[76:79], v[132:135]
    ds_read_b128 a[160:163], v2 offset:0
    ds_read_b128 a[164:167], v2 offset:64
    ds_read_b128 a[168:171], v2 offset:128
    ds_read_b128 a[172:175], v2 offset:192
    ds_read_b64_tr_b16 a[192:193], v3 offset:0
    ds_read_b64_tr_b16 a[194:195], v3 offset:512
    ds_read_b64_tr_b16 a[196:197], v3 offset:32
    ds_read_b64_tr_b16 a[198:199], v3 offset:544
    v_max3_f32 v36, v96, v97, v16
    v_max3_f32 v44, v98, v99, v100
    v_max3_f32 v36, v101, v102, v36
    v_max3_f32 v36, v103, v44, v36
    v_max3_f32 v37, v104, v105, v20
    v_max3_f32 v45, v106, v107, v108
    v_max3_f32 v37, v109, v110, v37
    v_max3_f32 v37, v111, v45, v37
    v_max3_f32 v38, v112, v113, v24
    v_max3_f32 v46, v114, v115, v116
    v_max3_f32 v38, v117, v118, v38
    v_max3_f32 v38, v119, v46, v38
    v_max3_f32 v39, v120, v121, v28
    v_max3_f32 v47, v122, v123, v124
    v_max3_f32 v39, v125, v126, v39
    v_max3_f32 v39, v127, v47, v39
    v_max3_f32 v40, v128, v129, v32
    v_max3_f32 v48, v130, v131, v132
    v_max3_f32 v40, v133, v134, v40
    v_max3_f32 v40, v135, v48, v40
    v_mov_b32 v44, v36
    v_mov_b32 v45, v37
    v_mov_b32 v46, v38
    v_mov_b32 v47, v39
    v_mov_b32 v48, v40
    v_permlane32_swap_b32 v44, v36
    v_permlane32_swap_b32 v45, v37
    v_permlane32_swap_b32 v46, v38
    v_permlane32_swap_b32 v47, v39
    v_permlane32_swap_b32 v48, v40
    v_max_f32 v36, v36, v44
    v_max_f32 v37, v37, v45
    v_max_f32 v38, v38, v46
    v_max_f32 v39, v39, v47
    v_max_f32 v40, v40, v48
    v_mov_b32 v44, v36
    v_mov_b32 v45, v37
    v_mov_b32 v46, v38
    v_mov_b32 v47, v39
    v_mov_b32 v48, v40
    v_permlane16_swap_b32 v44, v36
    v_permlane16_swap_b32 v45, v37
    v_permlane16_swap_b32 v46, v38
    v_permlane16_swap_b32 v47, v39
    v_permlane16_swap_b32 v48, v40
    v_max_f32 v36, v36, v44
    v_max_f32 v37, v37, v45
    v_max_f32 v38, v38, v46
    v_max_f32 v39, v39, v47
    v_max_f32 v40, v40, v48
    v_sub_f32 v16, 0, v36
    v_sub_f32 v17, 0, v36
    v_sub_f32 v18, 0, v36
    v_sub_f32 v19, 0, v36
    v_sub_f32 v20, 0, v37
    v_sub_f32 v21, 0, v37
    v_sub_f32 v22, 0, v37
    v_sub_f32 v23, 0, v37
    v_sub_f32 v24, 0, v38
    v_sub_f32 v25, 0, v38
    v_sub_f32 v26, 0, v38
    v_sub_f32 v27, 0, v38
    v_sub_f32 v28, 0, v39
    v_sub_f32 v29, 0, v39
    v_sub_f32 v30, 0, v39
    v_sub_f32 v31, 0, v39
    v_sub_f32 v32, 0, v40
    v_sub_f32 v33, 0, v40
    v_sub_f32 v34, 0, v40
    v_sub_f32 v35, 0, v40
    v_pk_add_f32 v[96:97], v[96:97], v[16:17]
    v_pk_add_f32 v[98:99], v[98:99], v[16:17]
    v_pk_add_f32 v[100:101], v[100:101], v[16:17]
    v_pk_add_f32 v[102:103], v[102:103], v[16:17]
    v_exp_f32 v96, v96
    v_exp_f32 v97, v97
    v_exp_f32 v98, v98
    v_exp_f32 v99, v99
    v_exp_f32 v100, v100
    v_exp_f32 v101, v101
    v_exp_f32 v102, v102
    v_exp_f32 v103, v103
    v_pk_add_f32 v[104:105], v[104:105], v[20:21]
    v_pk_add_f32 v[106:107], v[106:107], v[20:21]
    v_pk_add_f32 v[108:109], v[108:109], v[20:21]
    v_pk_add_f32 v[110:111], v[110:111], v[20:21]
    v_exp_f32 v104, v104
    v_exp_f32 v105, v105
    v_exp_f32 v106, v106
    v_exp_f32 v107, v107
    v_exp_f32 v108, v108
    v_exp_f32 v109, v109
    v_exp_f32 v110, v110
    v_exp_f32 v111, v111
    v_pk_add_f32 v[112:113], v[112:113], v[24:25]
    v_pk_add_f32 v[114:115], v[114:115], v[24:25]
    v_pk_add_f32 v[116:117], v[116:117], v[24:25]
    v_pk_add_f32 v[118:119], v[118:119], v[24:25]
    v_exp_f32 v112, v112
    v_exp_f32 v113, v113
    v_exp_f32 v114, v114
    v_exp_f32 v115, v115
    v_exp_f32 v116, v116
    v_exp_f32 v117, v117
    v_exp_f32 v118, v118
    v_exp_f32 v119, v119
    v_pk_add_f32 v[120:121], v[120:121], v[28:29]
    v_pk_add_f32 v[122:123], v[122:123], v[28:29]
    v_pk_add_f32 v[124:125], v[124:125], v[28:29]
    v_pk_add_f32 v[126:127], v[126:127], v[28:29]
    v_exp_f32 v120, v120
    v_exp_f32 v121, v121
    v_exp_f32 v122, v122
    v_exp_f32 v123, v123
    v_exp_f32 v124, v124
    v_exp_f32 v125, v125
    v_exp_f32 v126, v126
    v_exp_f32 v127, v127
    v_pk_add_f32 v[128:129], v[128:129], v[32:33]
    v_pk_add_f32 v[130:131], v[130:131], v[32:33]
    v_pk_add_f32 v[132:133], v[132:133], v[32:33]
    v_pk_add_f32 v[134:135], v[134:135], v[32:33]
    v_exp_f32 v128, v128
    v_exp_f32 v129, v129
    v_exp_f32 v130, v130
    v_exp_f32 v131, v131
    v_exp_f32 v132, v132
    v_exp_f32 v133, v133
    v_exp_f32 v134, v134
    v_exp_f32 v135, v135
    v_cvt_pk_bf16_f32 v60, v96, v97
    v_cvt_pk_bf16_f32 v61, v98, v99
    v_cvt_pk_bf16_f32 v62, v100, v101
    v_cvt_pk_bf16_f32 v63, v102, v103
    v_cvt_pk_bf16_f32 v64, v104, v105
    v_cvt_pk_bf16_f32 v65, v106, v107
    v_cvt_pk_bf16_f32 v66, v108, v109
    v_cvt_pk_bf16_f32 v67, v110, v111
    v_cvt_pk_bf16_f32 v68, v112, v113
    v_cvt_pk_bf16_f32 v69, v114, v115
    v_cvt_pk_bf16_f32 v70, v116, v117
    v_cvt_pk_bf16_f32 v71, v118, v119
    v_cvt_pk_bf16_f32 v72, v120, v121
    v_cvt_pk_bf16_f32 v73, v122, v123
    v_cvt_pk_bf16_f32 v74, v124, v125
    v_cvt_pk_bf16_f32 v75, v126, v127
    v_cvt_pk_bf16_f32 v76, v128, v129
    v_cvt_pk_bf16_f32 v77, v130, v131
    v_cvt_pk_bf16_f32 v78, v132, v133
    v_cvt_pk_bf16_f32 v79, v134, v135
    s_waitcnt lgkmcnt(7)
    v_mfma_f32_16x16x32_bf16 v[36:39], a[160:163], a[0:3], v[16:19]
    s_waitcnt lgkmcnt(6)
    v_mfma_f32_16x16x32_bf16 v[36:39], a[164:167], a[4:7], v[36:39]
    s_waitcnt lgkmcnt(5)
    ds_read_b128 a[176:179], v2 offset:512
    v_mfma_f32_16x16x32_bf16 v[36:39], a[168:171], a[8:11], v[36:39]
    s_waitcnt lgkmcnt(5)
    v_mfma_f32_16x16x32_bf16 v[36:39], a[172:175], a[12:15], v[36:39]
    s_waitcnt lgkmcnt(3)
    v_mfma_f32_16x16x32_bf16 v[96:99], a[192:195], v[60:63], 0
    s_bfe_u32 s53, s89, 0x2000e
    v_mfma_f32_16x16x32_bf16 v[128:131], a[192:195], v[64:67], 0
    s_mul_i32 s53, s53, 17408
    ds_read_b64_tr_b16 a[200:201], v3 offset:64
    v_mfma_f32_16x16x32_bf16 v[160:163], a[192:195], v[68:71], 0
    s_add_u32 s53, s53, s63
    v_mfma_f32_16x16x32_bf16 v[192:195], a[192:195], v[72:75], 0
    s_bitcmp1_b32 s59, s94
    ds_read_b64_tr_b16 a[202:203], v3 offset:576
    v_mfma_f32_16x16x32_bf16 v[224:227], a[192:195], v[76:79], 0
    s_cselect_b32 m0, s95, s53
    ds_read_b128 a[180:183], v2 offset:576
    v_mfma_f32_16x16x32_bf16 v[40:43], a[160:163], a[16:19], v[20:23]
    s_cselect_b32 s67, s58, s89
    v_exp_f32 v36, v36
    v_mfma_f32_16x16x32_bf16 v[40:43], a[164:167], a[20:23], v[40:43]
    s_cselect_b32 s53, 0, 0x4000
    v_exp_f32 v37, v37
    v_mfma_f32_16x16x32_bf16 v[40:43], a[168:171], a[24:27], v[40:43]
    s_add_u32 s89, s89, s53
    v_exp_f32 v38, v38
    v_mfma_f32_16x16x32_bf16 v[40:43], a[172:175], a[28:31], v[40:43]
    s_waitcnt lgkmcnt(4)
    v_exp_f32 v39, v39
    v_mfma_f32_16x16x32_bf16 v[100:103], a[196:199], v[60:63], 0
    ds_read_b64_tr_b16 a[204:205], v3 offset:96
    v_cvt_pk_bf16_f32 v80, v36, v37
    v_mfma_f32_16x16x32_bf16 v[132:135], a[196:199], v[64:67], 0
    v_mfma_f32_16x16x32_bf16 v[164:167], a[196:199], v[68:71], 0
    ds_read_b64_tr_b16 a[206:207], v3 offset:608
    v_cvt_pk_bf16_f32 v81, v38, v39
    v_mfma_f32_16x16x32_bf16 v[196:199], a[196:199], v[72:75], 0
    ds_read_b128 a[184:187], v2 offset:640
    v_mfma_f32_16x16x32_bf16 v[228:231], a[196:199], v[76:79], 0
    v_exp_f32 v40, v40
    v_mfma_f32_16x16x32_bf16 v[44:47], a[160:163], a[32:35], v[24:27]
    v_exp_f32 v41, v41
    v_mfma_f32_16x16x32_bf16 v[44:47], a[164:167], a[36:39], v[44:47]
    ds_read_b128 a[188:191], v2 offset:704
    v_cvt_pk_bf16_f32 v84, v40, v41
    v_mfma_f32_16x16x32_bf16 v[44:47], a[168:171], a[40:43], v[44:47]
    v_add_u32 v2, s50, v2
    v_mfma_f32_16x16x32_bf16 v[44:47], a[172:175], a[44:47], v[44:47]
    s_waitcnt lgkmcnt(5)
    v_exp_f32 v42, v42
    v_mfma_f32_16x16x32_bf16 v[104:107], a[200:203], v[60:63], 0
    ds_read_b64_tr_b16 a[192:193], v3 offset:128
    v_mfma_f32_16x16x32_bf16 v[136:139], a[200:203], v[64:67], 0
    v_exp_f32 v43, v43
    v_mfma_f32_16x16x32_bf16 v[168:171], a[200:203], v[68:71], 0
    v_mfma_f32_16x16x32_bf16 v[200:203], a[200:203], v[72:75], 0
    ds_read_b64_tr_b16 a[194:195], v3 offset:640
    v_cvt_pk_bf16_f32 v85, v42, v43
    v_mfma_f32_16x16x32_bf16 v[232:235], a[200:203], v[76:79], 0
    v_exp_f32 v44, v44
    v_mfma_f32_16x16x32_bf16 a[208:211], a[228:231], v[60:63], 0
    v_exp_f32 v45, v45
    v_mfma_f32_16x16x32_bf16 v[48:51], a[160:163], a[48:51], v[28:31]
    v_exp_f32 v46, v46
    v_mfma_f32_16x16x32_bf16 v[48:51], a[164:167], a[52:55], v[48:51]
    v_exp_f32 v47, v47
    v_mfma_f32_16x16x32_bf16 v[48:51], a[168:171], a[56:59], v[48:51]
    v_cvt_pk_bf16_f32 v88, v44, v45
    v_cvt_pk_bf16_f32 v89, v46, v47
    v_mfma_f32_16x16x32_bf16 v[48:51], a[172:175], a[60:63], v[48:51]
    s_waitcnt lgkmcnt(4)
    v_mfma_f32_16x16x32_bf16 v[108:111], a[204:207], v[60:63], 0
    ds_read_b64_tr_b16 a[196:197], v3 offset:160
    v_mfma_f32_16x16x32_bf16 v[140:143], a[204:207], v[64:67], 0
    v_mfma_f32_16x16x32_bf16 v[172:175], a[204:207], v[68:71], 0
    v_mfma_f32_16x16x32_bf16 v[204:207], a[204:207], v[72:75], 0
    ds_read_b64_tr_b16 a[198:199], v3 offset:672
    v_mfma_f32_16x16x32_bf16 v[236:239], a[204:207], v[76:79], 0
    v_exp_f32 v48, v48
    v_mfma_f32_16x16x32_bf16 a[212:215], a[228:231], v[64:67], 0
    v_exp_f32 v49, v49
    v_mfma_f32_16x16x32_bf16 v[52:55], a[176:179], a[0:3], v[16:19]
    v_exp_f32 v50, v50
    v_mfma_f32_16x16x32_bf16 v[52:55], a[180:183], a[4:7], v[52:55]
    s_waitcnt lgkmcnt(5)
    v_exp_f32 v51, v51
    v_mfma_f32_16x16x32_bf16 v[52:55], a[184:187], a[8:11], v[52:55]
    s_waitcnt lgkmcnt(4)
    v_cvt_pk_bf16_f32 v92, v48, v49
    v_cvt_pk_bf16_f32 v93, v50, v51
    v_mfma_f32_16x16x32_bf16 v[52:55], a[188:191], a[12:15], v[52:55]
    s_waitcnt vmcnt(12) lgkmcnt(2)
    v_mfma_f32_16x16x32_bf16 v[112:115], a[192:195], v[60:63], 0
    s_barrier
    ds_read_b64_tr_b16 a[200:201], v3 offset:192
    v_mfma_f32_16x16x32_bf16 v[144:147], a[192:195], v[64:67], 0
    v_mfma_f32_16x16x32_bf16 v[176:179], a[192:195], v[68:71], 0
    ds_read_b64_tr_b16 a[202:203], v3 offset:704
    v_mfma_f32_16x16x32_bf16 v[208:211], a[192:195], v[72:75], 0
    ds_read_b128 a[160:163], v2 offset:0
    v_mfma_f32_16x16x32_bf16 v[240:243], a[192:195], v[76:79], 0
    v_exp_f32 v52, v52
    v_mfma_f32_16x16x32_bf16 a[216:219], a[228:231], v[68:71], 0
    v_exp_f32 v53, v53
    v_mfma_f32_16x16x32_bf16 v[56:59], a[176:179], a[16:19], v[20:23]
    v_exp_f32 v54, v54
    v_mfma_f32_16x16x32_bf16 v[56:59], a[180:183], a[20:23], v[56:59]
    buffer_load_dwordx4 v1, s[12:15], s67 offen offset:0 nt lds
    v_mfma_f32_16x16x32_bf16 v[56:59], a[184:187], a[24:27], v[56:59]
    s_add_u32 m0, m0, 32
    ds_read_b128 a[164:167], v2 offset:64
    v_cvt_pk_bf16_f32 v82, v52, v53
    v_mfma_f32_16x16x32_bf16 v[56:59], a[188:191], a[28:31], v[56:59]
    s_waitcnt lgkmcnt(4)
    v_exp_f32 v55, v55
    v_mfma_f32_16x16x32_bf16 v[116:119], a[196:199], v[60:63], 0
    ds_read_b64_tr_b16 a[204:205], v3 offset:224
    v_cvt_pk_bf16_f32 v83, v54, v55
    v_mfma_f32_16x16x32_bf16 v[148:151], a[196:199], v[64:67], 0
    v_mfma_f32_16x16x32_bf16 v[180:183], a[196:199], v[68:71], 0
    ds_read_b64_tr_b16 a[206:207], v3 offset:736
    v_add_u32 v3, s47, v3
    v_mfma_f32_16x16x32_bf16 v[212:215], a[196:199], v[72:75], 0
    v_mfma_f32_16x16x32_bf16 v[244:247], a[196:199], v[76:79], 0
    ds_read_b128 a[168:171], v2 offset:128
    v_mfma_f32_16x16x32_bf16 a[220:223], a[228:231], v[72:75], 0
    v_exp_f32 v56, v56
    v_mfma_f32_16x16x32_bf16 v[36:39], a[176:179], a[32:35], v[24:27]
    v_exp_f32 v57, v57
    v_mfma_f32_16x16x32_bf16 v[36:39], a[180:183], a[36:39], v[36:39]
    v_exp_f32 v58, v58
    v_mfma_f32_16x16x32_bf16 v[36:39], a[184:187], a[40:43], v[36:39]
    v_exp_f32 v59, v59
    v_mfma_f32_16x16x32_bf16 v[36:39], a[188:191], a[44:47], v[36:39]
    s_waitcnt lgkmcnt(5)
    v_cvt_pk_bf16_f32 v86, v56, v57
    v_cvt_pk_bf16_f32 v87, v58, v59
    v_mfma_f32_16x16x32_bf16 v[120:123], a[200:203], v[60:63], 0
    ds_read_b64_tr_b16 a[192:193], v3 offset:0
    v_mfma_f32_16x16x32_bf16 v[152:155], a[200:203], v[64:67], 0
    ds_read_b128 a[172:175], v2 offset:192
    v_mfma_f32_16x16x32_bf16 v[184:187], a[200:203], v[68:71], 0
    ds_read_b64_tr_b16 a[194:195], v3 offset:512
    v_mfma_f32_16x16x32_bf16 v[216:219], a[200:203], v[72:75], 0
    v_mfma_f32_16x16x32_bf16 v[248:251], a[200:203], v[76:79], 0
    v_exp_f32 v36, v36
    v_mfma_f32_16x16x32_bf16 a[224:227], a[228:231], v[76:79], 0
    buffer_load_dwordx4 v1, s[12:15], s67 offen offset:1024 nt lds
    v_mfma_f32_16x16x32_bf16 v[40:43], a[176:179], a[48:51], v[28:31]
    s_add_u32 m0, m0, 32
    v_exp_f32 v37, v37
    v_mfma_f32_16x16x32_bf16 v[40:43], a[180:183], a[52:55], v[40:43]
    v_exp_f32 v38, v38
    v_mfma_f32_16x16x32_bf16 v[40:43], a[184:187], a[56:59], v[40:43]
    v_exp_f32 v39, v39
    v_mfma_f32_16x16x32_bf16 v[40:43], a[188:191], a[60:63], v[40:43]
    s_waitcnt lgkmcnt(4)
    v_cvt_pk_bf16_f32 v90, v36, v37
    v_cvt_pk_bf16_f32 v91, v38, v39
    v_mfma_f32_16x16x32_bf16 v[124:127], a[204:207], v[60:63], 0
    ds_read_b64_tr_b16 a[196:197], v3 offset:32
    v_mfma_f32_16x16x32_bf16 v[156:159], a[204:207], v[64:67], 0
    v_mfma_f32_16x16x32_bf16 v[188:191], a[204:207], v[68:71], 0
    ds_read_b64_tr_b16 a[198:199], v3 offset:544
    v_mfma_f32_16x16x32_bf16 v[220:223], a[204:207], v[72:75], 0
    v_mfma_f32_16x16x32_bf16 v[252:255], a[204:207], v[76:79], 0
    v_exp_f32 v40, v40
    v_mfma_f32_16x16x32_bf16 v[44:47], a[160:163], a[0:3], v[16:19]
    v_exp_f32 v41, v41
    v_mfma_f32_16x16x32_bf16 v[44:47], a[164:167], a[4:7], v[44:47]
    s_waitcnt lgkmcnt(5)
    ds_read_b128 a[176:179], v2 offset:512
    v_cvt_pk_bf16_f32 v94, v40, v41
    v_mfma_f32_16x16x32_bf16 v[44:47], a[168:171], a[8:11], v[44:47]
    s_waitcnt lgkmcnt(4)
    v_exp_f32 v42, v42
    v_mfma_f32_16x16x32_bf16 v[44:47], a[172:175], a[12:15], v[44:47]
    s_waitcnt lgkmcnt(3)
    v_exp_f32 v43, v43
    v_mfma_f32_16x16x32_bf16 v[96:99], a[192:195], v[80:83], v[96:99]
    ds_read_b64_tr_b16 a[200:201], v3 offset:64
    v_cvt_pk_bf16_f32 v95, v42, v43
    v_mfma_f32_16x16x32_bf16 v[128:131], a[192:195], v[84:87], v[128:131]
    v_mfma_f32_16x16x32_bf16 v[160:163], a[192:195], v[88:91], v[160:163]
    ds_read_b64_tr_b16 a[202:203], v3 offset:576
    v_mfma_f32_16x16x32_bf16 v[48:51], a[160:163], a[16:19], v[20:23]
    ds_read_b128 a[180:183], v2 offset:576
    v_mfma_f32_16x16x32_bf16 v[48:51], a[164:167], a[20:23], v[48:51]
    buffer_load_dwordx4 v1, s[12:15], s67 offen offset:2048 nt lds
    v_mfma_f32_16x16x32_bf16 v[48:51], a[168:171], a[24:27], v[48:51]
    s_add_u32 m0, m0, 32
    v_exp_f32 v44, v44
    v_mfma_f32_16x16x32_bf16 v[48:51], a[172:175], a[28:31], v[48:51]
    v_exp_f32 v45, v45
    v_mfma_f32_16x16x32_bf16 v[192:195], a[192:195], v[92:95], v[192:195]
    s_waitcnt lgkmcnt(4)
    v_exp_f32 v46, v46
    v_mfma_f32_16x16x32_bf16 v[100:103], a[196:199], v[80:83], v[100:103]
    ds_read_b64_tr_b16 a[204:205], v3 offset:96
    v_cvt_pk_bf16_f32 v60, v44, v45
    v_mfma_f32_16x16x32_bf16 v[132:135], a[196:199], v[84:87], v[132:135]
    ds_read_b128 a[184:187], v2 offset:640
    v_mfma_f32_16x16x32_bf16 v[52:55], a[160:163], a[32:35], v[24:27]
    ds_read_b64_tr_b16 a[206:207], v3 offset:608
    v_mfma_f32_16x16x32_bf16 v[52:55], a[164:167], a[36:39], v[52:55]
    v_exp_f32 v47, v47
    v_mfma_f32_16x16x32_bf16 v[52:55], a[168:171], a[40:43], v[52:55]
    v_exp_f32 v48, v48
    v_mfma_f32_16x16x32_bf16 v[52:55], a[172:175], a[44:47], v[52:55]
    v_exp_f32 v49, v49
    v_mfma_f32_16x16x32_bf16 v[164:167], a[196:199], v[88:91], v[164:167]
    v_exp_f32 v50, v50
    v_mfma_f32_16x16x32_bf16 v[196:199], a[196:199], v[92:95], v[196:199]
    s_waitcnt lgkmcnt(4)
    ds_read_b128 a[188:191], v2 offset:704
    v_cvt_pk_bf16_f32 v61, v46, v47
    v_mfma_f32_16x16x32_bf16 v[104:107], a[200:203], v[80:83], v[104:107]
    ds_read_b64_tr_b16 a[192:193], v3 offset:128
    v_add_u32 v2, s47, v2
    v_mfma_f32_16x16x32_bf16 a[208:211], a[228:231], v[80:83], a[208:211]
    v_exp_f32 v51, v51
    v_mfma_f32_16x16x32_bf16 v[56:59], a[160:163], a[48:51], v[28:31]
    ds_read_b64_tr_b16 a[194:195], v3 offset:640
    v_cvt_pk_bf16_f32 v64, v48, v49
    v_mfma_f32_16x16x32_bf16 v[56:59], a[164:167], a[52:55], v[56:59]
    v_exp_f32 v52, v52
    v_mfma_f32_16x16x32_bf16 v[56:59], a[168:171], a[56:59], v[56:59]
    v_exp_f32 v53, v53
    v_mfma_f32_16x16x32_bf16 v[56:59], a[172:175], a[60:63], v[56:59]
    v_exp_f32 v54, v54
    v_mfma_f32_16x16x32_bf16 v[136:139], a[200:203], v[84:87], v[136:139]
    buffer_load_dwordx4 v1, s[12:15], s67 offen offset:3072 nt lds
    v_mfma_f32_16x16x32_bf16 v[168:171], a[200:203], v[88:91], v[168:171]
    s_add_u32 s94, s94, 1
    v_exp_f32 v55, v55
    v_mfma_f32_16x16x32_bf16 v[200:203], a[200:203], v[92:95], v[200:203]
    s_bfe_u32 s53, s52, 0x2000e
    v_cvt_pk_bf16_f32 v65, v50, v51
    v_cvt_pk_bf16_f32 v68, v52, v53
    v_mfma_f32_16x16x32_bf16 v[36:39], a[160:163], a[64:67], v[32:35]
    s_mul_i32 s53, s53, 17408
    v_cvt_pk_bf16_f32 v69, v54, v55
    v_mfma_f32_16x16x32_bf16 v[36:39], a[164:167], a[68:71], v[36:39]
    s_add_u32 s53, s53, s51
    v_exp_f32 v56, v56
    v_mfma_f32_16x16x32_bf16 v[36:39], a[168:171], a[72:75], v[36:39]
    s_bitcmp1_b32 s61, s94
    v_exp_f32 v57, v57
    v_mfma_f32_16x16x32_bf16 v[36:39], a[172:175], a[76:79], v[36:39]
    s_waitcnt lgkmcnt(3)
    v_exp_f32 v58, v58
    v_mfma_f32_16x16x32_bf16 v[108:111], a[204:207], v[80:83], v[108:111]
    s_cselect_b32 m0, s95, s53
    ds_read_b64_tr_b16 a[196:197], v3 offset:160
    v_cvt_pk_bf16_f32 v72, v56, v57
    v_mfma_f32_16x16x32_bf16 v[140:143], a[204:207], v[84:87], v[140:143]
    s_cselect_b32 s67, s58, s52
    v_exp_f32 v59, v59
    v_mfma_f32_16x16x32_bf16 v[172:175], a[204:207], v[88:91], v[172:175]
    s_cselect_b32 s53, 0, 0x4000
    ds_read_b64_tr_b16 a[198:199], v3 offset:672
    v_cvt_pk_bf16_f32 v73, v58, v59
    v_mfma_f32_16x16x32_bf16 v[40:43], a[176:179], a[0:3], v[16:19]
    s_add_u32 s52, s52, s53
    v_mfma_f32_16x16x32_bf16 v[40:43], a[180:183], a[4:7], v[40:43]
    s_and_b32 s53, s94, 3
    ds_read_b128 a[160:163], v2 offset:0
    v_mfma_f32_16x16x32_bf16 v[40:43], a[184:187], a[8:11], v[40:43]
    s_waitcnt lgkmcnt(5)
    v_exp_f32 v36, v36
    v_mfma_f32_16x16x32_bf16 v[40:43], a[188:191], a[12:15], v[40:43]
    s_cmp_eq_u32 s53, 3
    v_exp_f32 v37, v37
    v_mfma_f32_16x16x32_bf16 v[204:207], a[204:207], v[92:95], v[204:207]
    s_waitcnt lgkmcnt(3)
    v_exp_f32 v38, v38
    v_mfma_f32_16x16x32_bf16 v[112:115], a[192:195], v[80:83], v[112:115]
    ds_read_b64_tr_b16 a[200:201], v3 offset:192
    v_cvt_pk_bf16_f32 v76, v36, v37
    v_mfma_f32_16x16x32_bf16 v[144:147], a[192:195], v[84:87], v[144:147]
    v_exp_f32 v39, v39
    v_mfma_f32_16x16x32_bf16 a[212:215], a[228:231], v[84:87], a[212:215]
    ds_read_b64_tr_b16 a[202:203], v3 offset:704
    v_cvt_pk_bf16_f32 v77, v38, v39
    v_mfma_f32_16x16x32_bf16 v[44:47], a[176:179], a[16:19], v[20:23]
    ds_read_b128 a[164:167], v2 offset:64
    v_mfma_f32_16x16x32_bf16 v[44:47], a[180:183], a[20:23], v[44:47]
    v_exp_f32 v40, v40
    v_mfma_f32_16x16x32_bf16 v[44:47], a[184:187], a[24:27], v[44:47]
    v_exp_f32 v41, v41
    v_mfma_f32_16x16x32_bf16 v[44:47], a[188:191], a[28:31], v[44:47]
    v_exp_f32 v42, v42
    v_mfma_f32_16x16x32_bf16 v[176:179], a[192:195], v[88:91], v[176:179]
    v_exp_f32 v43, v43
    v_mfma_f32_16x16x32_bf16 v[208:211], a[192:195], v[92:95], v[208:211]
    s_waitcnt lgkmcnt(4)
    ds_read_b128 a[168:171], v2 offset:128
    v_cvt_pk_bf16_f32 v62, v40, v41
    v_mfma_f32_16x16x32_bf16 v[116:119], a[196:199], v[80:83], v[116:119]
    ds_read_b64_tr_b16 a[204:205], v3 offset:224
    v_cvt_pk_bf16_f32 v63, v42, v43
    v_mfma_f32_16x16x32_bf16 v[48:51], a[176:179], a[32:35], v[24:27]
    v_mfma_f32_16x16x32_bf16 v[48:51], a[180:183], a[36:39], v[48:51]
    ds_read_b64_tr_b16 a[206:207], v3 offset:736
    v_add_u32 v3, s50, v3
    v_mfma_f32_16x16x32_bf16 v[48:51], a[184:187], a[40:43], v[48:51]
    s_cselect_b32 s50, s49, s48
    v_exp_f32 v44, v44
    v_mfma_f32_16x16x32_bf16 v[48:51], a[188:191], a[44:47], v[48:51]
    v_exp_f32 v45, v45
    v_mfma_f32_16x16x32_bf16 v[148:151], a[196:199], v[84:87], v[148:151]
    ds_read_b128 a[172:175], v2 offset:192
    v_cvt_pk_bf16_f32 v66, v44, v45
    v_mfma_f32_16x16x32_bf16 v[180:183], a[196:199], v[88:91], v[180:183]
    v_exp_f32 v46, v46
    v_mfma_f32_16x16x32_bf16 v[212:215], a[196:199], v[92:95], v[212:215]
    v_exp_f32 v47, v47
    v_mfma_f32_16x16x32_bf16 v[52:55], a[176:179], a[48:51], v[28:31]
    v_cvt_pk_bf16_f32 v67, v46, v47
    v_mfma_f32_16x16x32_bf16 v[52:55], a[180:183], a[52:55], v[52:55]
    v_exp_f32 v48, v48
    v_mfma_f32_16x16x32_bf16 v[52:55], a[184:187], a[56:59], v[52:55]
    s_waitcnt lgkmcnt(1)
    v_exp_f32 v49, v49
    v_mfma_f32_16x16x32_bf16 v[52:55], a[188:191], a[60:63], v[52:55]
    s_barrier
    v_exp_f32 v50, v50
    v_mfma_f32_16x16x32_bf16 v[120:123], a[200:203], v[80:83], v[120:123]
    ds_read_b64_tr_b16 a[192:193], v3 offset:0
    v_cvt_pk_bf16_f32 v70, v48, v49
    v_mfma_f32_16x16x32_bf16 v[152:155], a[200:203], v[84:87], v[152:155]
    v_exp_f32 v51, v51
    v_mfma_f32_16x16x32_bf16 v[184:187], a[200:203], v[88:91], v[184:187]
    ds_read_b64_tr_b16 a[194:195], v3 offset:512
    v_cvt_pk_bf16_f32 v71, v50, v51
    v_mfma_f32_16x16x32_bf16 v[56:59], a[176:179], a[64:67], v[32:35]
    v_mfma_f32_16x16x32_bf16 v[56:59], a[180:183], a[68:71], v[56:59]
    v_exp_f32 v52, v52
    v_mfma_f32_16x16x32_bf16 v[56:59], a[184:187], a[72:75], v[56:59]
    v_exp_f32 v53, v53
    v_mfma_f32_16x16x32_bf16 v[56:59], a[188:191], a[76:79], v[56:59]
    v_exp_f32 v54, v54
    v_mfma_f32_16x16x32_bf16 v[216:219], a[200:203], v[92:95], v[216:219]
    v_exp_f32 v55, v55
    v_mfma_f32_16x16x32_bf16 v[124:127], a[204:207], v[80:83], v[124:127]
    ds_read_b64_tr_b16 a[196:197], v3 offset:32
    v_cvt_pk_bf16_f32 v74, v52, v53
    v_mfma_f32_16x16x32_bf16 v[156:159], a[204:207], v[84:87], v[156:159]
    v_cvt_pk_bf16_f32 v75, v54, v55
    v_mfma_f32_16x16x32_bf16 v[188:191], a[204:207], v[88:91], v[188:191]
    ds_read_b64_tr_b16 a[198:199], v3 offset:544
    v_mfma_f32_16x16x32_bf16 v[220:223], a[204:207], v[92:95], v[220:223]
    v_exp_f32 v56, v56
    v_mfma_f32_16x16x32_bf16 a[216:219], a[228:231], v[88:91], a[216:219]
    v_exp_f32 v57, v57
    v_mfma_f32_16x16x32_bf16 a[220:223], a[228:231], v[92:95], a[220:223]
    s_branch L_loop0
    .p2align 6
L_loop0:
    v_mfma_f32_16x16x32_bf16 v[36:39], a[160:163], a[0:3], v[16:19]
    v_exp_f32 v58, v58
    v_mfma_f32_16x16x32_bf16 v[36:39], a[164:167], a[4:7], v[36:39]
    ds_read_b128 a[176:179], v2 offset:512
    v_cvt_pk_bf16_f32 v78, v56, v57
    v_mfma_f32_16x16x32_bf16 v[36:39], a[168:171], a[8:11], v[36:39]
    s_waitcnt lgkmcnt(5)
    v_exp_f32 v59, v59
    v_mfma_f32_16x16x32_bf16 v[36:39], a[172:175], a[12:15], v[36:39]
    s_waitcnt lgkmcnt(3)
    v_cvt_pk_bf16_f32 v79, v58, v59
    v_mfma_f32_16x16x32_bf16 v[96:99], a[192:195], v[60:63], v[96:99]
    buffer_load_dwordx4 v1, s[16:19], s67 offen offset:0 nt lds
    v_mfma_f32_16x16x32_bf16 v[128:131], a[192:195], v[64:67], v[128:131]
    s_add_u32 m0, m0, 32
    ds_read_b64_tr_b16 a[200:201], v3 offset:64
    v_mfma_f32_16x16x32_bf16 v[160:163], a[192:195], v[68:71], v[160:163]
    v_mfma_f32_16x16x32_bf16 v[192:195], a[192:195], v[72:75], v[192:195]
    ds_read_b64_tr_b16 a[202:203], v3 offset:576
    v_mfma_f32_16x16x32_bf16 v[224:227], a[192:195], v[76:79], v[224:227]
    ds_read_b128 a[180:183], v2 offset:576
    v_mfma_f32_16x16x32_bf16 v[40:43], a[160:163], a[16:19], v[20:23]
    v_exp_f32 v36, v36
    v_mfma_f32_16x16x32_bf16 v[40:43], a[164:167], a[20:23], v[40:43]
    v_exp_f32 v37, v37
    v_mfma_f32_16x16x32_bf16 v[40:43], a[168:171], a[24:27], v[40:43]
    v_exp_f32 v38, v38
    v_mfma_f32_16x16x32_bf16 v[40:43], a[172:175], a[28:31], v[40:43]
    s_waitcnt lgkmcnt(4)
    v_exp_f32 v39, v39
    v_mfma_f32_16x16x32_bf16 v[100:103], a[196:199], v[60:63], v[100:103]
    ds_read_b64_tr_b16 a[204:205], v3 offset:96
    v_cvt_pk_bf16_f32 v80, v36, v37
    v_mfma_f32_16x16x32_bf16 v[132:135], a[196:199], v[64:67], v[132:135]
    buffer_load_dwordx4 v1, s[16:19], s67 offen offset:1024 nt lds
    v_mfma_f32_16x16x32_bf16 v[164:167], a[196:199], v[68:71], v[164:167]
    s_add_u32 m0, m0, 32
    ds_read_b64_tr_b16 a[206:207], v3 offset:608
    v_cvt_pk_bf16_f32 v81, v38, v39
    v_mfma_f32_16x16x32_bf16 v[196:199], a[196:199], v[72:75], v[196:199]
    ds_read_b128 a[184:187], v2 offset:640
    v_mfma_f32_16x16x32_bf16 v[228:231], a[196:199], v[76:79], v[228:231]
    v_exp_f32 v40, v40
    v_mfma_f32_16x16x32_bf16 v[44:47], a[160:163], a[32:35], v[24:27]
    v_exp_f32 v41, v41
    v_mfma_f32_16x16x32_bf16 v[44:47], a[164:167], a[36:39], v[44:47]
    ds_read_b128 a[188:191], v2 offset:704
    v_cvt_pk_bf16_f32 v84, v40, v41
    v_mfma_f32_16x16x32_bf16 v[44:47], a[168:171], a[40:43], v[44:47]
    v_add_u32 v2, s50, v2
    v_mfma_f32_16x16x32_bf16 v[44:47], a[172:175], a[44:47], v[44:47]
    s_waitcnt lgkmcnt(5)
    v_exp_f32 v42, v42
    v_mfma_f32_16x16x32_bf16 v[104:107], a[200:203], v[60:63], v[104:107]
    ds_read_b64_tr_b16 a[192:193], v3 offset:128
    v_mfma_f32_16x16x32_bf16 v[136:139], a[200:203], v[64:67], v[136:139]
    v_exp_f32 v43, v43
    v_mfma_f32_16x16x32_bf16 v[168:171], a[200:203], v[68:71], v[168:171]
    buffer_load_dwordx4 v1, s[16:19], s67 offen offset:2048 nt lds
    v_mfma_f32_16x16x32_bf16 v[200:203], a[200:203], v[72:75], v[200:203]
    s_add_u32 m0, m0, 32
    ds_read_b64_tr_b16 a[194:195], v3 offset:640
    v_cvt_pk_bf16_f32 v85, v42, v43
    v_mfma_f32_16x16x32_bf16 v[232:235], a[200:203], v[76:79], v[232:235]
    v_exp_f32 v44, v44
    v_mfma_f32_16x16x32_bf16 a[208:211], a[228:231], v[60:63], a[208:211]
    v_exp_f32 v45, v45
    v_mfma_f32_16x16x32_bf16 v[48:51], a[160:163], a[48:51], v[28:31]
    v_exp_f32 v46, v46
    v_mfma_f32_16x16x32_bf16 v[48:51], a[164:167], a[52:55], v[48:51]
    v_exp_f32 v47, v47
    v_mfma_f32_16x16x32_bf16 v[48:51], a[168:171], a[56:59], v[48:51]
    v_cvt_pk_bf16_f32 v88, v44, v45
    v_cvt_pk_bf16_f32 v89, v46, v47
    v_mfma_f32_16x16x32_bf16 v[48:51], a[172:175], a[60:63], v[48:51]
    s_waitcnt lgkmcnt(4)
    v_mfma_f32_16x16x32_bf16 v[108:111], a[204:207], v[60:63], v[108:111]
    ds_read_b64_tr_b16 a[196:197], v3 offset:160
    v_mfma_f32_16x16x32_bf16 v[140:143], a[204:207], v[64:67], v[140:143]
    v_mfma_f32_16x16x32_bf16 v[172:175], a[204:207], v[68:71], v[172:175]
    buffer_load_dwordx4 v1, s[16:19], s67 offen offset:3072 nt lds
    v_mfma_f32_16x16x32_bf16 v[204:207], a[204:207], v[72:75], v[204:207]
    s_bfe_u32 s53, s89, 0x2000e
    ds_read_b64_tr_b16 a[198:199], v3 offset:672
    v_mfma_f32_16x16x32_bf16 v[236:239], a[204:207], v[76:79], v[236:239]
    s_mul_i32 s53, s53, 17408
    v_exp_f32 v48, v48
    v_mfma_f32_16x16x32_bf16 a[212:215], a[228:231], v[64:67], a[212:215]
    s_add_u32 s53, s53, s63
    v_exp_f32 v49, v49
    v_mfma_f32_16x16x32_bf16 v[52:55], a[176:179], a[0:3], v[16:19]
    s_bitcmp1_b32 s59, s94
    v_exp_f32 v50, v50
    v_mfma_f32_16x16x32_bf16 v[52:55], a[180:183], a[4:7], v[52:55]
    s_waitcnt lgkmcnt(5)
    v_exp_f32 v51, v51
    v_mfma_f32_16x16x32_bf16 v[52:55], a[184:187], a[8:11], v[52:55]
    s_waitcnt lgkmcnt(4)
    v_cvt_pk_bf16_f32 v92, v48, v49
    v_cvt_pk_bf16_f32 v93, v50, v51
    v_mfma_f32_16x16x32_bf16 v[52:55], a[188:191], a[12:15], v[52:55]
    s_waitcnt vmcnt(12) lgkmcnt(2)
    v_mfma_f32_16x16x32_bf16 v[112:115], a[192:195], v[60:63], v[112:115]
    s_barrier
    ds_read_b64_tr_b16 a[200:201], v3 offset:192
    v_mfma_f32_16x16x32_bf16 v[144:147], a[192:195], v[64:67], v[144:147]
    s_cselect_b32 m0, s95, s53
    v_mfma_f32_16x16x32_bf16 v[176:179], a[192:195], v[68:71], v[176:179]
    s_cselect_b32 s67, s58, s89
    ds_read_b64_tr_b16 a[202:203], v3 offset:704
    v_mfma_f32_16x16x32_bf16 v[208:211], a[192:195], v[72:75], v[208:211]
    s_cselect_b32 s53, 0, 0x4000
    ds_read_b128 a[160:163], v2 offset:0
    v_mfma_f32_16x16x32_bf16 v[240:243], a[192:195], v[76:79], v[240:243]
    s_add_u32 s89, s89, s53
    v_exp_f32 v52, v52
    v_mfma_f32_16x16x32_bf16 a[216:219], a[228:231], v[68:71], a[216:219]
    v_exp_f32 v53, v53
    v_mfma_f32_16x16x32_bf16 v[56:59], a[176:179], a[16:19], v[20:23]
    v_exp_f32 v54, v54
    v_mfma_f32_16x16x32_bf16 v[56:59], a[180:183], a[20:23], v[56:59]
    buffer_load_dwordx4 v1, s[12:15], s67 offen offset:0 nt lds
    v_mfma_f32_16x16x32_bf16 v[56:59], a[184:187], a[24:27], v[56:59]
    s_add_u32 m0, m0, 32
    ds_read_b128 a[164:167], v2 offset:64
    v_cvt_pk_bf16_f32 v82, v52, v53
    v_mfma_f32_16x16x32_bf16 v[56:59], a[188:191], a[28:31], v[56:59]
    s_waitcnt lgkmcnt(4)
    v_exp_f32 v55, v55
    v_mfma_f32_16x16x32_bf16 v[116:119], a[196:199], v[60:63], v[116:119]
    ds_read_b64_tr_b16 a[204:205], v3 offset:224
    v_cvt_pk_bf16_f32 v83, v54, v55
    v_mfma_f32_16x16x32_bf16 v[148:151], a[196:199], v[64:67], v[148:151]
    v_mfma_f32_16x16x32_bf16 v[180:183], a[196:199], v[68:71], v[180:183]
    ds_read_b64_tr_b16 a[206:207], v3 offset:736
    v_add_u32 v3, s47, v3
    v_mfma_f32_16x16x32_bf16 v[212:215], a[196:199], v[72:75], v[212:215]
    v_mfma_f32_16x16x32_bf16 v[244:247], a[196:199], v[76:79], v[244:247]
    ds_read_b128 a[168:171], v2 offset:128
    v_mfma_f32_16x16x32_bf16 a[220:223], a[228:231], v[72:75], a[220:223]
    v_exp_f32 v56, v56
    v_mfma_f32_16x16x32_bf16 v[36:39], a[176:179], a[32:35], v[24:27]
    v_exp_f32 v57, v57
    v_mfma_f32_16x16x32_bf16 v[36:39], a[180:183], a[36:39], v[36:39]
    v_exp_f32 v58, v58
    v_mfma_f32_16x16x32_bf16 v[36:39], a[184:187], a[40:43], v[36:39]
    v_exp_f32 v59, v59
    v_mfma_f32_16x16x32_bf16 v[36:39], a[188:191], a[44:47], v[36:39]
    s_waitcnt lgkmcnt(5)
    v_cvt_pk_bf16_f32 v86, v56, v57
    v_cvt_pk_bf16_f32 v87, v58, v59
    v_mfma_f32_16x16x32_bf16 v[120:123], a[200:203], v[60:63], v[120:123]
    ds_read_b64_tr_b16 a[192:193], v3 offset:0
    v_mfma_f32_16x16x32_bf16 v[152:155], a[200:203], v[64:67], v[152:155]
    ds_read_b128 a[172:175], v2 offset:192
    v_mfma_f32_16x16x32_bf16 v[184:187], a[200:203], v[68:71], v[184:187]
    ds_read_b64_tr_b16 a[194:195], v3 offset:512
    v_mfma_f32_16x16x32_bf16 v[216:219], a[200:203], v[72:75], v[216:219]
    v_mfma_f32_16x16x32_bf16 v[248:251], a[200:203], v[76:79], v[248:251]
    v_exp_f32 v36, v36
    v_mfma_f32_16x16x32_bf16 a[224:227], a[228:231], v[76:79], a[224:227]
    buffer_load_dwordx4 v1, s[12:15], s67 offen offset:1024 nt lds
    v_mfma_f32_16x16x32_bf16 v[40:43], a[176:179], a[48:51], v[28:31]
    s_add_u32 m0, m0, 32
    v_exp_f32 v37, v37
    v_mfma_f32_16x16x32_bf16 v[40:43], a[180:183], a[52:55], v[40:43]
    v_exp_f32 v38, v38
    v_mfma_f32_16x16x32_bf16 v[40:43], a[184:187], a[56:59], v[40:43]
    v_exp_f32 v39, v39
    v_mfma_f32_16x16x32_bf16 v[40:43], a[188:191], a[60:63], v[40:43]
    s_waitcnt lgkmcnt(4)
    v_cvt_pk_bf16_f32 v90, v36, v37
    v_cvt_pk_bf16_f32 v91, v38, v39
    v_mfma_f32_16x16x32_bf16 v[124:127], a[204:207], v[60:63], v[124:127]
    ds_read_b64_tr_b16 a[196:197], v3 offset:32
    v_mfma_f32_16x16x32_bf16 v[156:159], a[204:207], v[64:67], v[156:159]
    v_mfma_f32_16x16x32_bf16 v[188:191], a[204:207], v[68:71], v[188:191]
    ds_read_b64_tr_b16 a[198:199], v3 offset:544
    v_mfma_f32_16x16x32_bf16 v[220:223], a[204:207], v[72:75], v[220:223]
    v_mfma_f32_16x16x32_bf16 v[252:255], a[204:207], v[76:79], v[252:255]
    v_exp_f32 v40, v40
    v_mfma_f32_16x16x32_bf16 v[44:47], a[160:163], a[0:3], v[16:19]
    v_exp_f32 v41, v41
    v_mfma_f32_16x16x32_bf16 v[44:47], a[164:167], a[4:7], v[44:47]
    s_waitcnt lgkmcnt(5)
    ds_read_b128 a[176:179], v2 offset:512
    v_cvt_pk_bf16_f32 v94, v40, v41
    v_mfma_f32_16x16x32_bf16 v[44:47], a[168:171], a[8:11], v[44:47]
    s_waitcnt lgkmcnt(4)
    v_exp_f32 v42, v42
    v_mfma_f32_16x16x32_bf16 v[44:47], a[172:175], a[12:15], v[44:47]
    s_waitcnt lgkmcnt(3)
    v_exp_f32 v43, v43
    v_mfma_f32_16x16x32_bf16 v[96:99], a[192:195], v[80:83], v[96:99]
    ds_read_b64_tr_b16 a[200:201], v3 offset:64
    v_cvt_pk_bf16_f32 v95, v42, v43
    v_mfma_f32_16x16x32_bf16 v[128:131], a[192:195], v[84:87], v[128:131]
    v_mfma_f32_16x16x32_bf16 v[160:163], a[192:195], v[88:91], v[160:163]
    ds_read_b64_tr_b16 a[202:203], v3 offset:576
    v_mfma_f32_16x16x32_bf16 v[48:51], a[160:163], a[16:19], v[20:23]
    ds_read_b128 a[180:183], v2 offset:576
    v_mfma_f32_16x16x32_bf16 v[48:51], a[164:167], a[20:23], v[48:51]
    buffer_load_dwordx4 v1, s[12:15], s67 offen offset:2048 nt lds
    v_mfma_f32_16x16x32_bf16 v[48:51], a[168:171], a[24:27], v[48:51]
    s_add_u32 m0, m0, 32
    v_exp_f32 v44, v44
    v_mfma_f32_16x16x32_bf16 v[48:51], a[172:175], a[28:31], v[48:51]
    v_exp_f32 v45, v45
    v_mfma_f32_16x16x32_bf16 v[192:195], a[192:195], v[92:95], v[192:195]
    s_waitcnt lgkmcnt(4)
    v_exp_f32 v46, v46
    v_mfma_f32_16x16x32_bf16 v[100:103], a[196:199], v[80:83], v[100:103]
    ds_read_b64_tr_b16 a[204:205], v3 offset:96
    v_cvt_pk_bf16_f32 v60, v44, v45
    v_mfma_f32_16x16x32_bf16 v[132:135], a[196:199], v[84:87], v[132:135]
    ds_read_b128 a[184:187], v2 offset:640
    v_mfma_f32_16x16x32_bf16 v[52:55], a[160:163], a[32:35], v[24:27]
    ds_read_b64_tr_b16 a[206:207], v3 offset:608
    v_mfma_f32_16x16x32_bf16 v[52:55], a[164:167], a[36:39], v[52:55]
    v_exp_f32 v47, v47
    v_mfma_f32_16x16x32_bf16 v[52:55], a[168:171], a[40:43], v[52:55]
    v_exp_f32 v48, v48
    v_mfma_f32_16x16x32_bf16 v[52:55], a[172:175], a[44:47], v[52:55]
    v_exp_f32 v49, v49
    v_mfma_f32_16x16x32_bf16 v[164:167], a[196:199], v[88:91], v[164:167]
    v_exp_f32 v50, v50
    v_mfma_f32_16x16x32_bf16 v[196:199], a[196:199], v[92:95], v[196:199]
    s_waitcnt lgkmcnt(4)
    ds_read_b128 a[188:191], v2 offset:704
    v_cvt_pk_bf16_f32 v61, v46, v47
    v_mfma_f32_16x16x32_bf16 v[104:107], a[200:203], v[80:83], v[104:107]
    ds_read_b64_tr_b16 a[192:193], v3 offset:128
    v_add_u32 v2, s47, v2
    v_mfma_f32_16x16x32_bf16 a[208:211], a[228:231], v[80:83], a[208:211]
    v_exp_f32 v51, v51
    v_mfma_f32_16x16x32_bf16 v[56:59], a[160:163], a[48:51], v[28:31]
    ds_read_b64_tr_b16 a[194:195], v3 offset:640
    v_cvt_pk_bf16_f32 v64, v48, v49
    v_mfma_f32_16x16x32_bf16 v[56:59], a[164:167], a[52:55], v[56:59]
    v_exp_f32 v52, v52
    v_mfma_f32_16x16x32_bf16 v[56:59], a[168:171], a[56:59], v[56:59]
    v_exp_f32 v53, v53
    v_mfma_f32_16x16x32_bf16 v[56:59], a[172:175], a[60:63], v[56:59]
    v_exp_f32 v54, v54
    v_mfma_f32_16x16x32_bf16 v[136:139], a[200:203], v[84:87], v[136:139]
    buffer_load_dwordx4 v1, s[12:15], s67 offen offset:3072 nt lds
    v_mfma_f32_16x16x32_bf16 v[168:171], a[200:203], v[88:91], v[168:171]
    s_add_u32 s94, s94, 1
    v_exp_f32 v55, v55
    v_mfma_f32_16x16x32_bf16 v[200:203], a[200:203], v[92:95], v[200:203]
    s_bfe_u32 s53, s52, 0x2000e
    v_cvt_pk_bf16_f32 v65, v50, v51
    v_cvt_pk_bf16_f32 v68, v52, v53
    v_mfma_f32_16x16x32_bf16 v[36:39], a[160:163], a[64:67], v[32:35]
    s_mul_i32 s53, s53, 17408
    v_cvt_pk_bf16_f32 v69, v54, v55
    v_mfma_f32_16x16x32_bf16 v[36:39], a[164:167], a[68:71], v[36:39]
    s_add_u32 s53, s53, s51
    v_exp_f32 v56, v56
    v_mfma_f32_16x16x32_bf16 v[36:39], a[168:171], a[72:75], v[36:39]
    s_bitcmp1_b32 s61, s94
    v_exp_f32 v57, v57
    v_mfma_f32_16x16x32_bf16 v[36:39], a[172:175], a[76:79], v[36:39]
    s_waitcnt lgkmcnt(3)
    v_exp_f32 v58, v58
    v_mfma_f32_16x16x32_bf16 v[108:111], a[204:207], v[80:83], v[108:111]
    s_cselect_b32 m0, s95, s53
    ds_read_b64_tr_b16 a[196:197], v3 offset:160
    v_cvt_pk_bf16_f32 v72, v56, v57
    v_mfma_f32_16x16x32_bf16 v[140:143], a[204:207], v[84:87], v[140:143]
    s_cselect_b32 s67, s58, s52
    v_exp_f32 v59, v59
    v_mfma_f32_16x16x32_bf16 v[172:175], a[204:207], v[88:91], v[172:175]
    s_cselect_b32 s53, 0, 0x4000
    ds_read_b64_tr_b16 a[198:199], v3 offset:672
    v_cvt_pk_bf16_f32 v73, v58, v59
    v_mfma_f32_16x16x32_bf16 v[40:43], a[176:179], a[0:3], v[16:19]
    s_add_u32 s52, s52, s53
    v_mfma_f32_16x16x32_bf16 v[40:43], a[180:183], a[4:7], v[40:43]
    s_and_b32 s53, s94, 3
    ds_read_b128 a[160:163], v2 offset:0
    v_mfma_f32_16x16x32_bf16 v[40:43], a[184:187], a[8:11], v[40:43]
    s_waitcnt lgkmcnt(5)
    v_exp_f32 v36, v36
    v_mfma_f32_16x16x32_bf16 v[40:43], a[188:191], a[12:15], v[40:43]
    s_cmp_eq_u32 s53, 3
    v_exp_f32 v37, v37
    v_mfma_f32_16x16x32_bf16 v[204:207], a[204:207], v[92:95], v[204:207]
    s_waitcnt lgkmcnt(3)
    v_exp_f32 v38, v38
    v_mfma_f32_16x16x32_bf16 v[112:115], a[192:195], v[80:83], v[112:115]
    ds_read_b64_tr_b16 a[200:201], v3 offset:192
    v_cvt_pk_bf16_f32 v76, v36, v37
    v_mfma_f32_16x16x32_bf16 v[144:147], a[192:195], v[84:87], v[144:147]
    v_exp_f32 v39, v39
    v_mfma_f32_16x16x32_bf16 a[212:215], a[228:231], v[84:87], a[212:215]
    ds_read_b64_tr_b16 a[202:203], v3 offset:704
    v_cvt_pk_bf16_f32 v77, v38, v39
    v_mfma_f32_16x16x32_bf16 v[44:47], a[176:179], a[16:19], v[20:23]
    ds_read_b128 a[164:167], v2 offset:64
    v_mfma_f32_16x16x32_bf16 v[44:47], a[180:183], a[20:23], v[44:47]
    v_exp_f32 v40, v40
    v_mfma_f32_16x16x32_bf16 v[44:47], a[184:187], a[24:27], v[44:47]
    v_exp_f32 v41, v41
    v_mfma_f32_16x16x32_bf16 v[44:47], a[188:191], a[28:31], v[44:47]
    v_exp_f32 v42, v42
    v_mfma_f32_16x16x32_bf16 v[176:179], a[192:195], v[88:91], v[176:179]
    v_exp_f32 v43, v43
    v_mfma_f32_16x16x32_bf16 v[208:211], a[192:195], v[92:95], v[208:211]
    s_waitcnt lgkmcnt(4)
    ds_read_b128 a[168:171], v2 offset:128
    v_cvt_pk_bf16_f32 v62, v40, v41
    v_mfma_f32_16x16x32_bf16 v[116:119], a[196:199], v[80:83], v[116:119]
    ds_read_b64_tr_b16 a[204:205], v3 offset:224
    v_cvt_pk_bf16_f32 v63, v42, v43
    v_mfma_f32_16x16x32_bf16 v[48:51], a[176:179], a[32:35], v[24:27]
    v_mfma_f32_16x16x32_bf16 v[48:51], a[180:183], a[36:39], v[48:51]
    ds_read_b64_tr_b16 a[206:207], v3 offset:736
    v_add_u32 v3, s50, v3
    v_mfma_f32_16x16x32_bf16 v[48:51], a[184:187], a[40:43], v[48:51]
    s_cselect_b32 s50, s49, s48
    v_exp_f32 v44, v44
    v_mfma_f32_16x16x32_bf16 v[48:51], a[188:191], a[44:47], v[48:51]
    s_cmp_lg_u32 s94, 15
    v_exp_f32 v45, v45
    v_mfma_f32_16x16x32_bf16 v[148:151], a[196:199], v[84:87], v[148:151]
    ds_read_b128 a[172:175], v2 offset:192
    v_cvt_pk_bf16_f32 v66, v44, v45
    v_mfma_f32_16x16x32_bf16 v[180:183], a[196:199], v[88:91], v[180:183]
    v_exp_f32 v46, v46
    v_mfma_f32_16x16x32_bf16 v[212:215], a[196:199], v[92:95], v[212:215]
    v_exp_f32 v47, v47
    v_mfma_f32_16x16x32_bf16 v[52:55], a[176:179], a[48:51], v[28:31]
    v_cvt_pk_bf16_f32 v67, v46, v47
    v_mfma_f32_16x16x32_bf16 v[52:55], a[180:183], a[52:55], v[52:55]
    v_exp_f32 v48, v48
    v_mfma_f32_16x16x32_bf16 v[52:55], a[184:187], a[56:59], v[52:55]
    s_waitcnt vmcnt(12) lgkmcnt(1)
    v_exp_f32 v49, v49
    v_mfma_f32_16x16x32_bf16 v[52:55], a[188:191], a[60:63], v[52:55]
    s_barrier
    v_exp_f32 v50, v50
    v_mfma_f32_16x16x32_bf16 v[120:123], a[200:203], v[80:83], v[120:123]
    ds_read_b64_tr_b16 a[192:193], v3 offset:0
    v_cvt_pk_bf16_f32 v70, v48, v49
    v_mfma_f32_16x16x32_bf16 v[152:155], a[200:203], v[84:87], v[152:155]
    v_exp_f32 v51, v51
    v_mfma_f32_16x16x32_bf16 v[184:187], a[200:203], v[88:91], v[184:187]
    ds_read_b64_tr_b16 a[194:195], v3 offset:512
    v_cvt_pk_bf16_f32 v71, v50, v51
    v_mfma_f32_16x16x32_bf16 v[56:59], a[176:179], a[64:67], v[32:35]
    v_mfma_f32_16x16x32_bf16 v[56:59], a[180:183], a[68:71], v[56:59]
    v_exp_f32 v52, v52
    v_mfma_f32_16x16x32_bf16 v[56:59], a[184:187], a[72:75], v[56:59]
    v_exp_f32 v53, v53
    v_mfma_f32_16x16x32_bf16 v[56:59], a[188:191], a[76:79], v[56:59]
    v_exp_f32 v54, v54
    v_mfma_f32_16x16x32_bf16 v[216:219], a[200:203], v[92:95], v[216:219]
    v_exp_f32 v55, v55
    v_mfma_f32_16x16x32_bf16 v[124:127], a[204:207], v[80:83], v[124:127]
    ds_read_b64_tr_b16 a[196:197], v3 offset:32
    v_cvt_pk_bf16_f32 v74, v52, v53
    v_mfma_f32_16x16x32_bf16 v[156:159], a[204:207], v[84:87], v[156:159]
    v_cvt_pk_bf16_f32 v75, v54, v55
    v_mfma_f32_16x16x32_bf16 v[188:191], a[204:207], v[88:91], v[188:191]
    ds_read_b64_tr_b16 a[198:199], v3 offset:544
    v_mfma_f32_16x16x32_bf16 v[220:223], a[204:207], v[92:95], v[220:223]
    v_exp_f32 v56, v56
    v_mfma_f32_16x16x32_bf16 a[216:219], a[228:231], v[88:91], a[216:219]
    v_exp_f32 v57, v57
    v_mfma_f32_16x16x32_bf16 a[220:223], a[228:231], v[92:95], a[220:223]
    s_cbranch_scc1 L_loop0
    v_mfma_f32_16x16x32_bf16 v[36:39], a[160:163], a[0:3], v[16:19]
    v_exp_f32 v58, v58
    v_mfma_f32_16x16x32_bf16 v[36:39], a[164:167], a[4:7], v[36:39]
    ds_read_b128 a[176:179], v2 offset:512
    v_lshrrev_b32 v10, 3, v0
    v_cvt_pk_bf16_f32 v78, v56, v57
    v_mfma_f32_16x16x32_bf16 v[36:39], a[168:171], a[8:11], v[36:39]
    s_waitcnt lgkmcnt(5)
    v_lshlrev_b32 v10, 24, v10
    v_exp_f32 v59, v59
    v_mfma_f32_16x16x32_bf16 v[36:39], a[172:175], a[12:15], v[36:39]
    s_waitcnt lgkmcnt(3)
    v_lshl_add_u32 v10, v0, 7, v10
    v_cvt_pk_bf16_f32 v79, v58, v59
    v_mfma_f32_16x16x32_bf16 v[96:99], a[192:195], v[60:63], v[96:99]
    buffer_load_dwordx4 v1, s[16:19], s67 offen offset:0 nt lds
    v_mov_b32 v11, s66
    v_mfma_f32_16x16x32_bf16 v[128:131], a[192:195], v[64:67], v[128:131]
    s_add_u32 m0, m0, 32
    ds_read_b64_tr_b16 a[200:201], v3 offset:64
    v_lshl_add_u32 v10, v11, 10, v10
    s_mov_b32 s60, L_hepi0-L_pc
    v_mfma_f32_16x16x32_bf16 v[160:163], a[192:195], v[68:71], v[160:163]
    v_mfma_f32_16x16x32_bf16 v[192:195], a[192:195], v[72:75], v[192:195]
    ds_read_b64_tr_b16 a[202:203], v3 offset:576
    v_mfma_f32_16x16x32_bf16 v[224:227], a[192:195], v[76:79], v[224:227]
    ds_read_b128 a[180:183], v2 offset:576
    v_mfma_f32_16x16x32_bf16 v[40:43], a[160:163], a[16:19], v[20:23]
    buffer_load_dword v11, v10, s[4:7], s60 offen
    v_exp_f32 v36, v36
    v_mfma_f32_16x16x32_bf16 v[40:43], a[164:167], a[20:23], v[40:43]
    v_exp_f32 v37, v37
    v_mfma_f32_16x16x32_bf16 v[40:43], a[168:171], a[24:27], v[40:43]
    v_exp_f32 v38, v38
    v_mfma_f32_16x16x32_bf16 v[40:43], a[172:175], a[28:31], v[40:43]
    s_waitcnt lgkmcnt(4)
    v_exp_f32 v39, v39
    v_mfma_f32_16x16x32_bf16 v[100:103], a[196:199], v[60:63], v[100:103]
    ds_read_b64_tr_b16 a[204:205], v3 offset:96
    v_cvt_pk_bf16_f32 v80, v36, v37
    v_mfma_f32_16x16x32_bf16 v[132:135], a[196:199], v[64:67], v[132:135]
    buffer_load_dwordx4 v1, s[16:19], s67 offen offset:1024 nt lds
    v_mfma_f32_16x16x32_bf16 v[164:167], a[196:199], v[68:71], v[164:167]
    s_add_u32 m0, m0, 32
    ds_read_b64_tr_b16 a[206:207], v3 offset:608
    v_cvt_pk_bf16_f32 v81, v38, v39
    v_mfma_f32_16x16x32_bf16 v[196:199], a[196:199], v[72:75], v[196:199]
    ds_read_b128 a[184:187], v2 offset:640
    v_mfma_f32_16x16x32_bf16 v[228:231], a[196:199], v[76:79], v[228:231]
    v_exp_f32 v40, v40
    v_mfma_f32_16x16x32_bf16 v[44:47], a[160:163], a[32:35], v[24:27]
    v_exp_f32 v41, v41
    v_mfma_f32_16x16x32_bf16 v[44:47], a[164:167], a[36:39], v[44:47]
    ds_read_b128 a[188:191], v2 offset:704
    v_cvt_pk_bf16_f32 v84, v40, v41
    v_mfma_f32_16x16x32_bf16 v[44:47], a[168:171], a[40:43], v[44:47]
    v_add_u32 v2, s50, v2
    v_mfma_f32_16x16x32_bf16 v[44:47], a[172:175], a[44:47], v[44:47]
    s_waitcnt lgkmcnt(5)
    v_exp_f32 v42, v42
    v_mfma_f32_16x16x32_bf16 v[104:107], a[200:203], v[60:63], v[104:107]
    ds_read_b64_tr_b16 a[192:193], v3 offset:128
    v_mfma_f32_16x16x32_bf16 v[136:139], a[200:203], v[64:67], v[136:139]
    v_exp_f32 v43, v43
    v_mfma_f32_16x16x32_bf16 v[168:171], a[200:203], v[68:71], v[168:171]
    buffer_load_dwordx4 v1, s[16:19], s67 offen offset:2048 nt lds
    v_mfma_f32_16x16x32_bf16 v[200:203], a[200:203], v[72:75], v[200:203]
    s_add_u32 m0, m0, 32
    ds_read_b64_tr_b16 a[194:195], v3 offset:640
    v_cvt_pk_bf16_f32 v85, v42, v43
    v_mfma_f32_16x16x32_bf16 v[232:235], a[200:203], v[76:79], v[232:235]
    v_exp_f32 v44, v44
    v_mfma_f32_16x16x32_bf16 a[208:211], a[228:231], v[60:63], a[208:211]
    v_exp_f32 v45, v45
    v_mfma_f32_16x16x32_bf16 v[48:51], a[160:163], a[48:51], v[28:31]
    v_exp_f32 v46, v46
    v_mfma_f32_16x16x32_bf16 v[48:51], a[164:167], a[52:55], v[48:51]
    v_exp_f32 v47, v47
    v_mfma_f32_16x16x32_bf16 v[48:51], a[168:171], a[56:59], v[48:51]
    v_cvt_pk_bf16_f32 v88, v44, v45
    v_cvt_pk_bf16_f32 v89, v46, v47
    v_mfma_f32_16x16x32_bf16 v[48:51], a[172:175], a[60:63], v[48:51]
    s_waitcnt lgkmcnt(4)
    v_mfma_f32_16x16x32_bf16 v[108:111], a[204:207], v[60:63], v[108:111]
    ds_read_b64_tr_b16 a[196:197], v3 offset:160
    v_mfma_f32_16x16x32_bf16 v[140:143], a[204:207], v[64:67], v[140:143]
    v_mfma_f32_16x16x32_bf16 v[172:175], a[204:207], v[68:71], v[172:175]
    buffer_load_dwordx4 v1, s[16:19], s67 offen offset:3072 nt lds
    v_mfma_f32_16x16x32_bf16 v[204:207], a[204:207], v[72:75], v[204:207]
    s_bfe_u32 s53, s89, 0x2000e
    ds_read_b64_tr_b16 a[198:199], v3 offset:672
    v_mfma_f32_16x16x32_bf16 v[236:239], a[204:207], v[76:79], v[236:239]
    s_mul_i32 s53, s53, 17408
    v_exp_f32 v48, v48
    v_mfma_f32_16x16x32_bf16 a[212:215], a[228:231], v[64:67], a[212:215]
    s_add_u32 s53, s53, s63
    v_exp_f32 v49, v49
    v_mfma_f32_16x16x32_bf16 v[52:55], a[176:179], a[0:3], v[16:19]
    s_bitcmp1_b32 s59, s94
    v_exp_f32 v50, v50
    v_mfma_f32_16x16x32_bf16 v[52:55], a[180:183], a[4:7], v[52:55]
    s_waitcnt lgkmcnt(5)
    v_exp_f32 v51, v51
    v_mfma_f32_16x16x32_bf16 v[52:55], a[184:187], a[8:11], v[52:55]
    s_waitcnt lgkmcnt(4)
    v_cvt_pk_bf16_f32 v92, v48, v49
    v_cvt_pk_bf16_f32 v93, v50, v51
    v_mfma_f32_16x16x32_bf16 v[52:55], a[188:191], a[12:15], v[52:55]
    s_waitcnt vmcnt(13) lgkmcnt(2)
    v_mfma_f32_16x16x32_bf16 v[112:115], a[192:195], v[60:63], v[112:115]
    s_barrier
    ds_read_b64_tr_b16 a[200:201], v3 offset:192
    v_mfma_f32_16x16x32_bf16 v[144:147], a[192:195], v[64:67], v[144:147]
    s_cselect_b32 m0, s95, s53
    v_mfma_f32_16x16x32_bf16 v[176:179], a[192:195], v[68:71], v[176:179]
    s_cselect_b32 s67, s58, s89
    ds_read_b64_tr_b16 a[202:203], v3 offset:704
    v_mfma_f32_16x16x32_bf16 v[208:211], a[192:195], v[72:75], v[208:211]
    s_cselect_b32 s53, 0, 0x4000
    v_mfma_f32_16x16x32_bf16 v[240:243], a[192:195], v[76:79], v[240:243]
    s_add_u32 s89, s89, s53
    v_exp_f32 v52, v52
    v_mfma_f32_16x16x32_bf16 a[216:219], a[228:231], v[68:71], a[216:219]
    v_exp_f32 v53, v53
    v_mfma_f32_16x16x32_bf16 v[56:59], a[176:179], a[16:19], v[20:23]
    v_exp_f32 v54, v54
    v_mfma_f32_16x16x32_bf16 v[56:59], a[180:183], a[20:23], v[56:59]
    buffer_load_dwordx4 v1, s[12:15], s67 offen offset:0 nt lds
    v_mfma_f32_16x16x32_bf16 v[56:59], a[184:187], a[24:27], v[56:59]
    s_add_u32 m0, m0, 32
    v_cvt_pk_bf16_f32 v82, v52, v53
    v_mfma_f32_16x16x32_bf16 v[56:59], a[188:191], a[28:31], v[56:59]
    s_waitcnt lgkmcnt(2)
    v_exp_f32 v55, v55
    v_mfma_f32_16x16x32_bf16 v[116:119], a[196:199], v[60:63], v[116:119]
    ds_read_b64_tr_b16 a[204:205], v3 offset:224
    v_cvt_pk_bf16_f32 v83, v54, v55
    v_mfma_f32_16x16x32_bf16 v[148:151], a[196:199], v[64:67], v[148:151]
    v_mfma_f32_16x16x32_bf16 v[180:183], a[196:199], v[68:71], v[180:183]
    ds_read_b64_tr_b16 a[206:207], v3 offset:736
    v_add_u32 v3, s47, v3
    v_mfma_f32_16x16x32_bf16 v[212:215], a[196:199], v[72:75], v[212:215]
    v_mfma_f32_16x16x32_bf16 v[244:247], a[196:199], v[76:79], v[244:247]
    v_mfma_f32_16x16x32_bf16 a[220:223], a[228:231], v[72:75], a[220:223]
    v_exp_f32 v56, v56
    v_mfma_f32_16x16x32_bf16 v[36:39], a[176:179], a[32:35], v[24:27]
    v_exp_f32 v57, v57
    v_mfma_f32_16x16x32_bf16 v[36:39], a[180:183], a[36:39], v[36:39]
    v_exp_f32 v58, v58
    v_mfma_f32_16x16x32_bf16 v[36:39], a[184:187], a[40:43], v[36:39]
    v_exp_f32 v59, v59
    v_mfma_f32_16x16x32_bf16 v[36:39], a[188:191], a[44:47], v[36:39]
    s_waitcnt lgkmcnt(2)
    v_cvt_pk_bf16_f32 v86, v56, v57
    v_cvt_pk_bf16_f32 v87, v58, v59
    v_mfma_f32_16x16x32_bf16 v[120:123], a[200:203], v[60:63], v[120:123]
    ds_read_b64_tr_b16 a[192:193], v3 offset:0
    v_mfma_f32_16x16x32_bf16 v[152:155], a[200:203], v[64:67], v[152:155]
    v_mfma_f32_16x16x32_bf16 v[184:187], a[200:203], v[68:71], v[184:187]
    ds_read_b64_tr_b16 a[194:195], v3 offset:512
    v_mfma_f32_16x16x32_bf16 v[216:219], a[200:203], v[72:75], v[216:219]
    v_mfma_f32_16x16x32_bf16 v[248:251], a[200:203], v[76:79], v[248:251]
    v_exp_f32 v36, v36
    v_mfma_f32_16x16x32_bf16 a[224:227], a[228:231], v[76:79], a[224:227]
    buffer_load_dwordx4 v1, s[12:15], s67 offen offset:1024 nt lds
    v_mfma_f32_16x16x32_bf16 v[40:43], a[176:179], a[48:51], v[28:31]
    s_add_u32 m0, m0, 32
    v_exp_f32 v37, v37
    v_mfma_f32_16x16x32_bf16 v[40:43], a[180:183], a[52:55], v[40:43]
    v_exp_f32 v38, v38
    v_mfma_f32_16x16x32_bf16 v[40:43], a[184:187], a[56:59], v[40:43]
    v_exp_f32 v39, v39
    v_mfma_f32_16x16x32_bf16 v[40:43], a[188:191], a[60:63], v[40:43]
    s_waitcnt lgkmcnt(2)
    v_cvt_pk_bf16_f32 v90, v36, v37
    v_cvt_pk_bf16_f32 v91, v38, v39
    v_mfma_f32_16x16x32_bf16 v[124:127], a[204:207], v[60:63], v[124:127]
    ds_read_b64_tr_b16 a[196:197], v3 offset:32
    v_mfma_f32_16x16x32_bf16 v[156:159], a[204:207], v[64:67], v[156:159]
    v_mfma_f32_16x16x32_bf16 v[188:191], a[204:207], v[68:71], v[188:191]
    ds_read_b64_tr_b16 a[198:199], v3 offset:544
    v_mfma_f32_16x16x32_bf16 v[220:223], a[204:207], v[72:75], v[220:223]
    v_mfma_f32_16x16x32_bf16 v[252:255], a[204:207], v[76:79], v[252:255]
    s_waitcnt lgkmcnt(2)
    v_exp_f32 v40, v40
    v_exp_f32 v41, v41
    s_nop 0
    v_cvt_pk_bf16_f32 v94, v40, v41
    v_exp_f32 v42, v42
    v_exp_f32 v43, v43
    v_mfma_f32_16x16x32_bf16 v[96:99], a[192:195], v[80:83], v[96:99]
    ds_read_b64_tr_b16 a[200:201], v3 offset:64
    v_cvt_pk_bf16_f32 v95, v42, v43
    v_mfma_f32_16x16x32_bf16 v[128:131], a[192:195], v[84:87], v[128:131]
    v_mfma_f32_16x16x32_bf16 v[160:163], a[192:195], v[88:91], v[160:163]
    ds_read_b64_tr_b16 a[202:203], v3 offset:576
    buffer_load_dwordx4 v1, s[12:15], s67 offen offset:2048 nt lds
    v_mfma_f32_16x16x32_bf16 v[192:195], a[192:195], v[92:95], v[192:195]
    s_waitcnt lgkmcnt(2)
    v_mfma_f32_16x16x32_bf16 v[100:103], a[196:199], v[80:83], v[100:103]
    s_add_u32 m0, m0, 32
    ds_read_b64_tr_b16 a[204:205], v3 offset:96
    v_mfma_f32_16x16x32_bf16 v[132:135], a[196:199], v[84:87], v[132:135]
    ds_read_b64_tr_b16 a[206:207], v3 offset:608
    v_mfma_f32_16x16x32_bf16 v[164:167], a[196:199], v[88:91], v[164:167]
    v_mfma_f32_16x16x32_bf16 v[196:199], a[196:199], v[92:95], v[196:199]
    s_waitcnt lgkmcnt(2)
    v_mfma_f32_16x16x32_bf16 v[104:107], a[200:203], v[80:83], v[104:107]
    ds_read_b64_tr_b16 a[192:193], v3 offset:128
    v_mfma_f32_16x16x32_bf16 a[208:211], a[228:231], v[80:83], a[208:211]
    ds_read_b64_tr_b16 a[194:195], v3 offset:640
    v_mfma_f32_16x16x32_bf16 v[136:139], a[200:203], v[84:87], v[136:139]
    buffer_load_dwordx4 v1, s[12:15], s67 offen offset:3072 nt lds
    v_mfma_f32_16x16x32_bf16 v[168:171], a[200:203], v[88:91], v[168:171]
    v_mfma_f32_16x16x32_bf16 v[200:203], a[200:203], v[92:95], v[200:203]
    s_waitcnt lgkmcnt(2)
    v_mfma_f32_16x16x32_bf16 v[108:111], a[204:207], v[80:83], v[108:111]
    ds_read_b64_tr_b16 a[196:197], v3 offset:160
    v_mfma_f32_16x16x32_bf16 v[140:143], a[204:207], v[84:87], v[140:143]
    v_mfma_f32_16x16x32_bf16 v[172:175], a[204:207], v[88:91], v[172:175]
    ds_read_b64_tr_b16 a[198:199], v3 offset:672
    v_mfma_f32_16x16x32_bf16 v[204:207], a[204:207], v[92:95], v[204:207]
    s_waitcnt lgkmcnt(2)
    v_mfma_f32_16x16x32_bf16 v[112:115], a[192:195], v[80:83], v[112:115]
    ds_read_b64_tr_b16 a[200:201], v3 offset:192
    v_mfma_f32_16x16x32_bf16 v[144:147], a[192:195], v[84:87], v[144:147]
    v_mfma_f32_16x16x32_bf16 a[212:215], a[228:231], v[84:87], a[212:215]
    ds_read_b64_tr_b16 a[202:203], v3 offset:704
    v_mfma_f32_16x16x32_bf16 v[176:179], a[192:195], v[88:91], v[176:179]
    v_mfma_f32_16x16x32_bf16 v[208:211], a[192:195], v[92:95], v[208:211]
    s_waitcnt lgkmcnt(2)
    v_mfma_f32_16x16x32_bf16 v[116:119], a[196:199], v[80:83], v[116:119]
    ds_read_b64_tr_b16 a[204:205], v3 offset:224
    ds_read_b64_tr_b16 a[206:207], v3 offset:736
    v_add_u32 v3, s50, v3
    v_mfma_f32_16x16x32_bf16 v[148:151], a[196:199], v[84:87], v[148:151]
    v_mfma_f32_16x16x32_bf16 v[180:183], a[196:199], v[88:91], v[180:183]
    v_mfma_f32_16x16x32_bf16 v[212:215], a[196:199], v[92:95], v[212:215]
    s_waitcnt lgkmcnt(2)
    v_mfma_f32_16x16x32_bf16 v[120:123], a[200:203], v[80:83], v[120:123]
    v_mfma_f32_16x16x32_bf16 v[152:155], a[200:203], v[84:87], v[152:155]
    v_mfma_f32_16x16x32_bf16 v[184:187], a[200:203], v[88:91], v[184:187]
    v_mfma_f32_16x16x32_bf16 v[216:219], a[200:203], v[92:95], v[216:219]
    s_waitcnt lgkmcnt(0)
    v_mfma_f32_16x16x32_bf16 v[124:127], a[204:207], v[80:83], v[124:127]
    v_mfma_f32_16x16x32_bf16 v[156:159], a[204:207], v[84:87], v[156:159]
    v_mfma_f32_16x16x32_bf16 v[188:191], a[204:207], v[88:91], v[188:191]
    v_mfma_f32_16x16x32_bf16 v[220:223], a[204:207], v[92:95], v[220:223]
    v_mfma_f32_16x16x32_bf16 a[216:219], a[228:231], v[88:91], a[216:219]
    v_mfma_f32_16x16x32_bf16 a[220:223], a[228:231], v[92:95], a[220:223]
L_hepi0:
    s_nop 7
    v_accvgpr_read_b32 v8, a224
    v_accvgpr_read_b32 v4, a208
    v_accvgpr_read_b32 v5, a212
    v_accvgpr_read_b32 v6, a216
    v_accvgpr_read_b32 v7, a220
    v_mov_b32 v36, v4
    v_mov_b32 v37, v5
    v_mov_b32 v38, v6
    v_mov_b32 v39, v7
    v_mov_b32 v40, v8
    v_permlane32_swap_b32 v36, v4
    v_permlane32_swap_b32 v37, v5
    v_permlane32_swap_b32 v38, v6
    v_permlane32_swap_b32 v39, v7
    v_permlane32_swap_b32 v40, v8
    v_add_f32 v4, v4, v36
    v_add_f32 v5, v5, v37
    v_add_f32 v6, v6, v38
    v_add_f32 v7, v7, v39
    v_add_f32 v8, v8, v40
    v_mov_b32 v36, v4
    v_mov_b32 v37, v5
    v_mov_b32 v38, v6
    v_mov_b32 v39, v7
    v_mov_b32 v40, v8
    v_permlane16_swap_b32 v36, v4
    v_permlane16_swap_b32 v37, v5
    v_permlane16_swap_b32 v38, v6
    v_permlane16_swap_b32 v39, v7
    v_permlane16_swap_b32 v40, v8
    v_add_f32 v4, v4, v36
    v_add_f32 v5, v5, v37
    v_add_f32 v6, v6, v38
    v_add_f32 v7, v7, v39
    v_add_f32 v8, v8, v40
    v_add_f32 v10, v4, v5
    s_waitcnt vmcnt(7)
    v_add_f32 v11, v6, v7
    v_add_f32 v10, v10, v8
    v_add_f32 v10, v10, v11
    v_cmp_nge_f32 vcc, s58, v10
    s_cmp_lg_u64 vcc, 0
    s_cselect_b32 s3, 1, 0
    v_mov_b32 v12, s3
    s_lshl_b32 s3, s36, 2
    s_add_u32 s3, s3, 158720
    v_mov_b32 v13, s3
    ds_write_b32 v13, v12
    v_add_u32 v9, 139264, v1
    v_xor_b32 v10, 4096, v1
    v_add_u32 v10, 139264, v10
    v_lshrrev_b32 v11, 1, v1
    v_and_b32 v11, 0x1f8, v11
    s_lshl_b32 s3, s36, 9
    s_add_u32 s3, s3, 156672
    v_add_u32 v11, s3, v11
    v_mov_b32 v12, v8
    v_mov_b32 v13, v32
    ds_write_b64 v11, v[12:13]
    v_xor_b32 v11, 512, v11
    s_cmp_eq_u32 s37, 1
    s_cbranch_scc1 L_he1_0
    ds_write_b128 v10, v[240:243] offset:0
    ds_write_b128 v10, v[244:247] offset:1024
    ds_write_b128 v10, v[248:251] offset:2048
    ds_write_b128 v10, v[252:255] offset:3072
    s_branch L_he2_0
L_he1_0:
    ds_write_b128 v10, v[224:227] offset:0
    ds_write_b128 v10, v[228:231] offset:1024
    ds_write_b128 v10, v[232:235] offset:2048
    ds_write_b128 v10, v[236:239] offset:3072
    s_nop 1
    v_mov_b32 v224, v240
    v_mov_b32 v225, v241
    v_mov_b32 v226, v242
    v_mov_b32 v227, v243
    v_mov_b32 v228, v244
    v_mov_b32 v229, v245
    v_mov_b32 v230, v246
    v_mov_b32 v231, v247
    v_mov_b32 v232, v248
    v_mov_b32 v233, v249
    v_mov_b32 v234, v250
    v_mov_b32 v235, v251
    v_mov_b32 v236, v252
    v_mov_b32 v237, v253
    v_mov_b32 v238, v254
    v_mov_b32 v239, v255
L_he2_0:
    v_rcp_f32 v4, v4
    v_rcp_f32 v5, v5
    v_rcp_f32 v6, v6
    v_rcp_f32 v7, v7
    s_waitcnt lgkmcnt(0)
    s_barrier
    v_mov_b32 v14, 158720
    ds_read_b128 v[36:39], v14
    ds_read_b64 v[14:15], v11
    ds_read_b128 v[240:243], v9 offset:0
    ds_read_b128 v[244:247], v9 offset:1024
    ds_read_b128 v[248:251], v9 offset:2048
    ds_read_b128 v[252:255], v9 offset:3072
    s_waitcnt lgkmcnt(5)
    v_or3_b32 v36, v36, v37, v38
    v_or_b32 v36, v36, v39
    s_nop 0
    v_readfirstlane_b32 s3, v36
    s_andn2_b32 s3, s3, s62
    s_cbranch_scc1 L_redo0
    s_mov_b32 s62, 0
    s_waitcnt lgkmcnt(4)
    v_min_f32 v11, v13, v15
    v_sub_f32 v13, v11, v13
    v_sub_f32 v15, v11, v15
    v_exp_f32 v13, v13
    v_exp_f32 v15, v15
    s_nop 0
    v_mul_f32 v12, v12, v13
    v_fmac_f32 v12, v14, v15
    v_rcp_f32 v12, v12
    s_nop 0
    v_mul_f32 v14, v12, v15
    v_mul_f32 v12, v12, v13
    v_pk_mul_f32 v[224:225], v[224:225], v[12:13] op_sel_hi:[1,0]
    v_pk_mul_f32 v[226:227], v[226:227], v[12:13] op_sel_hi:[1,0]
    v_pk_mul_f32 v[228:229], v[228:229], v[12:13] op_sel_hi:[1,0]
    v_pk_mul_f32 v[230:231], v[230:231], v[12:13] op_sel_hi:[1,0]
    v_pk_mul_f32 v[232:233], v[232:233], v[12:13] op_sel_hi:[1,0]
    v_pk_mul_f32 v[234:235], v[234:235], v[12:13] op_sel_hi:[1,0]
    v_pk_mul_f32 v[236:237], v[236:237], v[12:13] op_sel_hi:[1,0]
    v_pk_mul_f32 v[238:239], v[238:239], v[12:13] op_sel_hi:[1,0]
    s_waitcnt lgkmcnt(3)
    v_pk_fma_f32 v[224:225], v[240:241], v[14:15], v[224:225] op_sel_hi:[1,0,1]
    v_pk_fma_f32 v[226:227], v[242:243], v[14:15], v[226:227] op_sel_hi:[1,0,1]
    s_waitcnt lgkmcnt(2)
    v_pk_fma_f32 v[228:229], v[244:245], v[14:15], v[228:229] op_sel_hi:[1,0,1]
    v_pk_fma_f32 v[230:231], v[246:247], v[14:15], v[230:231] op_sel_hi:[1,0,1]
    s_waitcnt lgkmcnt(1)
    v_pk_fma_f32 v[232:233], v[248:249], v[14:15], v[232:233] op_sel_hi:[1,0,1]
    v_pk_fma_f32 v[234:235], v[250:251], v[14:15], v[234:235] op_sel_hi:[1,0,1]
    s_waitcnt lgkmcnt(0)
    v_pk_fma_f32 v[236:237], v[252:253], v[14:15], v[236:237] op_sel_hi:[1,0,1]
    v_pk_fma_f32 v[238:239], v[254:255], v[14:15], v[238:239] op_sel_hi:[1,0,1]
    v_cvt_pk_bf16_f32 v224, v224, v225
    v_cvt_pk_bf16_f32 v225, v226, v227
    v_cvt_pk_bf16_f32 v226, v228, v229
    v_cvt_pk_bf16_f32 v227, v230, v231
    v_cvt_pk_bf16_f32 v228, v232, v233
    v_cvt_pk_bf16_f32 v229, v234, v235
    v_cvt_pk_bf16_f32 v230, v236, v237
    v_cvt_pk_bf16_f32 v231, v238, v239
    v_and_b32 v13, 0x3ff, v1
    s_lshl_b32 s3, s37, 11
    s_add_u32 s3, s3, s65
    ds_write_b128 v9, v[224:227] offset:0
    buffer_store_dwordx4 v[224:227], v13, s[24:27], s3 offen offset:0 sc1
    ds_write_b128 v9, v[228:231] offset:1024
    buffer_store_dwordx4 v[228:231], v13, s[24:27], s3 offen offset:1024 sc1
    s_add_u32 s3, s64, 0
    v_pk_mul_f32 v[96:97], v[96:97], v[4:5] op_sel_hi:[1,0]
    v_pk_mul_f32 v[98:99], v[98:99], v[4:5] op_sel_hi:[1,0]
    v_pk_mul_f32 v[100:101], v[100:101], v[4:5] op_sel_hi:[1,0]
    v_pk_mul_f32 v[102:103], v[102:103], v[4:5] op_sel_hi:[1,0]
    v_cvt_pk_bf16_f32 v16, v96, v97
    v_cvt_pk_bf16_f32 v17, v98, v99
    v_cvt_pk_bf16_f32 v18, v100, v101
    v_cvt_pk_bf16_f32 v19, v102, v103
    s_add_u32 m0, s63, 104448
    s_mov_b32 s67, 294912
    v_accvgpr_write_b32 a0, v16
    v_accvgpr_write_b32 a1, v17
    v_accvgpr_write_b32 a2, v18
    v_accvgpr_write_b32 a3, v19
    buffer_load_dwordx4 v1, s[16:19], s67 offen offset:0 nt lds
    v_pk_mul_f32 v[104:105], v[104:105], v[4:5] op_sel_hi:[1,0]
    v_pk_mul_f32 v[106:107], v[106:107], v[4:5] op_sel_hi:[1,0]
    v_pk_mul_f32 v[108:109], v[108:109], v[4:5] op_sel_hi:[1,0]
    v_pk_mul_f32 v[110:111], v[110:111], v[4:5] op_sel_hi:[1,0]
    v_cvt_pk_bf16_f32 v20, v104, v105
    v_cvt_pk_bf16_f32 v21, v106, v107
    v_cvt_pk_bf16_f32 v22, v108, v109
    v_cvt_pk_bf16_f32 v23, v110, v111
    v_accvgpr_write_b32 a4, v20
    v_accvgpr_write_b32 a5, v21
    v_accvgpr_write_b32 a6, v22
    v_accvgpr_write_b32 a7, v23
    v_pk_mul_f32 v[112:113], v[112:113], v[4:5] op_sel_hi:[1,0]
    v_pk_mul_f32 v[114:115], v[114:115], v[4:5] op_sel_hi:[1,0]
    v_pk_mul_f32 v[116:117], v[116:117], v[4:5] op_sel_hi:[1,0]
    v_pk_mul_f32 v[118:119], v[118:119], v[4:5] op_sel_hi:[1,0]
    v_cvt_pk_bf16_f32 v24, v112, v113
    v_cvt_pk_bf16_f32 v25, v114, v115
    v_cvt_pk_bf16_f32 v26, v116, v117
    v_cvt_pk_bf16_f32 v27, v118, v119
    s_add_u32 m0, s63, 104480
    v_accvgpr_write_b32 a8, v24
    v_accvgpr_write_b32 a9, v25
    v_accvgpr_write_b32 a10, v26
    v_accvgpr_write_b32 a11, v27
    buffer_load_dwordx4 v1, s[16:19], s67 offen offset:1024 nt lds
    v_pk_mul_f32 v[120:121], v[120:121], v[4:5] op_sel_hi:[1,0]
    v_pk_mul_f32 v[122:123], v[122:123], v[4:5] op_sel_hi:[1,0]
    v_pk_mul_f32 v[124:125], v[124:125], v[4:5] op_sel_hi:[1,0]
    v_pk_mul_f32 v[126:127], v[126:127], v[4:5] op_sel_hi:[1,0]
    v_cvt_pk_bf16_f32 v28, v120, v121
    v_cvt_pk_bf16_f32 v29, v122, v123
    v_cvt_pk_bf16_f32 v30, v124, v125
    v_cvt_pk_bf16_f32 v31, v126, v127
    v_accvgpr_write_b32 a12, v28
    v_accvgpr_write_b32 a13, v29
    v_accvgpr_write_b32 a14, v30
    v_accvgpr_write_b32 a15, v31
    s_add_u32 s3, s64, 4096
    v_pk_mul_f32 v[128:129], v[128:129], v[4:5] op_sel:[0,1] op_sel_hi:[1,1]
    v_pk_mul_f32 v[130:131], v[130:131], v[4:5] op_sel:[0,1] op_sel_hi:[1,1]
    v_pk_mul_f32 v[132:133], v[132:133], v[4:5] op_sel:[0,1] op_sel_hi:[1,1]
    v_pk_mul_f32 v[134:135], v[134:135], v[4:5] op_sel:[0,1] op_sel_hi:[1,1]
    v_cvt_pk_bf16_f32 v32, v128, v129
    v_cvt_pk_bf16_f32 v33, v130, v131
    v_cvt_pk_bf16_f32 v34, v132, v133
    v_cvt_pk_bf16_f32 v35, v134, v135
    s_add_u32 m0, s63, 104512
    v_accvgpr_write_b32 a16, v32
    v_accvgpr_write_b32 a17, v33
    v_accvgpr_write_b32 a18, v34
    v_accvgpr_write_b32 a19, v35
    buffer_load_dwordx4 v1, s[16:19], s67 offen offset:2048 nt lds
    v_pk_mul_f32 v[136:137], v[136:137], v[4:5] op_sel:[0,1] op_sel_hi:[1,1]
    v_pk_mul_f32 v[138:139], v[138:139], v[4:5] op_sel:[0,1] op_sel_hi:[1,1]
    v_pk_mul_f32 v[140:141], v[140:141], v[4:5] op_sel:[0,1] op_sel_hi:[1,1]
    v_pk_mul_f32 v[142:143], v[142:143], v[4:5] op_sel:[0,1] op_sel_hi:[1,1]
    v_cvt_pk_bf16_f32 v36, v136, v137
    v_cvt_pk_bf16_f32 v37, v138, v139
    v_cvt_pk_bf16_f32 v38, v140, v141
    v_cvt_pk_bf16_f32 v39, v142, v143
    v_accvgpr_write_b32 a20, v36
    v_accvgpr_write_b32 a21, v37
    v_accvgpr_write_b32 a22, v38
    v_accvgpr_write_b32 a23, v39
    v_pk_mul_f32 v[144:145], v[144:145], v[4:5] op_sel:[0,1] op_sel_hi:[1,1]
    v_pk_mul_f32 v[146:147], v[146:147], v[4:5] op_sel:[0,1] op_sel_hi:[1,1]
    v_pk_mul_f32 v[148:149], v[148:149], v[4:5] op_sel:[0,1] op_sel_hi:[1,1]
    v_pk_mul_f32 v[150:151], v[150:151], v[4:5] op_sel:[0,1] op_sel_hi:[1,1]
    v_cvt_pk_bf16_f32 v40, v144, v145
    v_cvt_pk_bf16_f32 v41, v146, v147
    v_cvt_pk_bf16_f32 v42, v148, v149
    v_cvt_pk_bf16_f32 v43, v150, v151
    s_add_u32 m0, s63, 104544
    v_accvgpr_write_b32 a24, v40
    v_accvgpr_write_b32 a25, v41
    v_accvgpr_write_b32 a26, v42
    v_accvgpr_write_b32 a27, v43
    buffer_load_dwordx4 v1, s[16:19], s67 offen offset:3072 nt lds
    v_pk_mul_f32 v[152:153], v[152:153], v[4:5] op_sel:[0,1] op_sel_hi:[1,1]
    v_pk_mul_f32 v[154:155], v[154:155], v[4:5] op_sel:[0,1] op_sel_hi:[1,1]
    v_pk_mul_f32 v[156:157], v[156:157], v[4:5] op_sel:[0,1] op_sel_hi:[1,1]
    v_pk_mul_f32 v[158:159], v[158:159], v[4:5] op_sel:[0,1] op_sel_hi:[1,1]
    v_cvt_pk_bf16_f32 v44, v152, v153
    v_cvt_pk_bf16_f32 v45, v154, v155
    v_cvt_pk_bf16_f32 v46, v156, v157
    v_cvt_pk_bf16_f32 v47, v158, v159
    v_accvgpr_write_b32 a28, v44
    v_accvgpr_write_b32 a29, v45
    v_accvgpr_write_b32 a30, v46
    v_accvgpr_write_b32 a31, v47
    s_add_u32 s3, s64, 8192
    v_pk_mul_f32 v[160:161], v[160:161], v[6:7] op_sel_hi:[1,0]
    v_pk_mul_f32 v[162:163], v[162:163], v[6:7] op_sel_hi:[1,0]
    v_pk_mul_f32 v[164:165], v[164:165], v[6:7] op_sel_hi:[1,0]
    v_pk_mul_f32 v[166:167], v[166:167], v[6:7] op_sel_hi:[1,0]
    v_cvt_pk_bf16_f32 v48, v160, v161
    v_cvt_pk_bf16_f32 v49, v162, v163
    v_cvt_pk_bf16_f32 v50, v164, v165
    v_cvt_pk_bf16_f32 v51, v166, v167
    s_add_u32 m0, s63, 52224
    s_mov_b32 s67, 311296
    v_accvgpr_write_b32 a32, v48
    v_accvgpr_write_b32 a33, v49
    v_accvgpr_write_b32 a34, v50
    v_accvgpr_write_b32 a35, v51
    buffer_load_dwordx4 v1, s[12:15], s67 offen offset:0 nt lds
    v_pk_mul_f32 v[168:169], v[168:169], v[6:7] op_sel_hi:[1,0]
    v_pk_mul_f32 v[170:171], v[170:171], v[6:7] op_sel_hi:[1,0]
    v_pk_mul_f32 v[172:173], v[172:173], v[6:7] op_sel_hi:[1,0]
    v_pk_mul_f32 v[174:175], v[174:175], v[6:7] op_sel_hi:[1,0]
    v_cvt_pk_bf16_f32 v52, v168, v169
    v_cvt_pk_bf16_f32 v53, v170, v171
    v_cvt_pk_bf16_f32 v54, v172, v173
    v_cvt_pk_bf16_f32 v55, v174, v175
    v_accvgpr_write_b32 a36, v52
    v_accvgpr_write_b32 a37, v53
    v_accvgpr_write_b32 a38, v54
    v_accvgpr_write_b32 a39, v55
    v_pk_mul_f32 v[176:177], v[176:177], v[6:7] op_sel_hi:[1,0]
    v_pk_mul_f32 v[178:179], v[178:179], v[6:7] op_sel_hi:[1,0]
    v_pk_mul_f32 v[180:181], v[180:181], v[6:7] op_sel_hi:[1,0]
    v_pk_mul_f32 v[182:183], v[182:183], v[6:7] op_sel_hi:[1,0]
    v_cvt_pk_bf16_f32 v56, v176, v177
    v_cvt_pk_bf16_f32 v57, v178, v179
    v_cvt_pk_bf16_f32 v58, v180, v181
    v_cvt_pk_bf16_f32 v59, v182, v183
    s_add_u32 m0, s63, 52256
    v_accvgpr_write_b32 a40, v56
    v_accvgpr_write_b32 a41, v57
    v_accvgpr_write_b32 a42, v58
    v_accvgpr_write_b32 a43, v59
    buffer_load_dwordx4 v1, s[12:15], s67 offen offset:1024 nt lds
    v_pk_mul_f32 v[184:185], v[184:185], v[6:7] op_sel_hi:[1,0]
    v_pk_mul_f32 v[186:187], v[186:187], v[6:7] op_sel_hi:[1,0]
    v_pk_mul_f32 v[188:189], v[188:189], v[6:7] op_sel_hi:[1,0]
    v_pk_mul_f32 v[190:191], v[190:191], v[6:7] op_sel_hi:[1,0]
    v_cvt_pk_bf16_f32 v60, v184, v185
    v_cvt_pk_bf16_f32 v61, v186, v187
    v_cvt_pk_bf16_f32 v62, v188, v189
    v_cvt_pk_bf16_f32 v63, v190, v191
    v_accvgpr_write_b32 a44, v60
    v_accvgpr_write_b32 a45, v61
    v_accvgpr_write_b32 a46, v62
    v_accvgpr_write_b32 a47, v63
    s_add_u32 s3, s64, 12288
    v_pk_mul_f32 v[192:193], v[192:193], v[6:7] op_sel:[0,1] op_sel_hi:[1,1]
    v_pk_mul_f32 v[194:195], v[194:195], v[6:7] op_sel:[0,1] op_sel_hi:[1,1]
    v_pk_mul_f32 v[196:197], v[196:197], v[6:7] op_sel:[0,1] op_sel_hi:[1,1]
    v_pk_mul_f32 v[198:199], v[198:199], v[6:7] op_sel:[0,1] op_sel_hi:[1,1]
    v_cvt_pk_bf16_f32 v64, v192, v193
    v_cvt_pk_bf16_f32 v65, v194, v195
    v_cvt_pk_bf16_f32 v66, v196, v197
    v_cvt_pk_bf16_f32 v67, v198, v199
    s_add_u32 m0, s63, 52288
    v_accvgpr_write_b32 a48, v64
    v_accvgpr_write_b32 a49, v65
    v_accvgpr_write_b32 a50, v66
    v_accvgpr_write_b32 a51, v67
    buffer_load_dwordx4 v1, s[12:15], s67 offen offset:2048 nt lds
    v_pk_mul_f32 v[200:201], v[200:201], v[6:7] op_sel:[0,1] op_sel_hi:[1,1]
    v_pk_mul_f32 v[202:203], v[202:203], v[6:7] op_sel:[0,1] op_sel_hi:[1,1]
    v_pk_mul_f32 v[204:205], v[204:205], v[6:7] op_sel:[0,1] op_sel_hi:[1,1]
    v_pk_mul_f32 v[206:207], v[206:207], v[6:7] op_sel:[0,1] op_sel_hi:[1,1]
    v_cvt_pk_bf16_f32 v68, v200, v201
    v_cvt_pk_bf16_f32 v69, v202, v203
    v_cvt_pk_bf16_f32 v70, v204, v205
    v_cvt_pk_bf16_f32 v71, v206, v207
    v_accvgpr_write_b32 a52, v68
    v_accvgpr_write_b32 a53, v69
    v_accvgpr_write_b32 a54, v70
    v_accvgpr_write_b32 a55, v71
    v_pk_mul_f32 v[208:209], v[208:209], v[6:7] op_sel:[0,1] op_sel_hi:[1,1]
    v_pk_mul_f32 v[210:211], v[210:211], v[6:7] op_sel:[0,1] op_sel_hi:[1,1]
    v_pk_mul_f32 v[212:213], v[212:213], v[6:7] op_sel:[0,1] op_sel_hi:[1,1]
    v_pk_mul_f32 v[214:215], v[214:215], v[6:7] op_sel:[0,1] op_sel_hi:[1,1]
    v_cvt_pk_bf16_f32 v72, v208, v209
    v_cvt_pk_bf16_f32 v73, v210, v211
    v_cvt_pk_bf16_f32 v74, v212, v213
    v_cvt_pk_bf16_f32 v75, v214, v215
    s_add_u32 m0, s63, 52320
    v_accvgpr_write_b32 a56, v72
    v_accvgpr_write_b32 a57, v73
    v_accvgpr_write_b32 a58, v74
    v_accvgpr_write_b32 a59, v75
    buffer_load_dwordx4 v1, s[12:15], s67 offen offset:3072 nt lds
    v_pk_mul_f32 v[216:217], v[216:217], v[6:7] op_sel:[0,1] op_sel_hi:[1,1]
    v_pk_mul_f32 v[218:219], v[218:219], v[6:7] op_sel:[0,1] op_sel_hi:[1,1]
    v_pk_mul_f32 v[220:221], v[220:221], v[6:7] op_sel:[0,1] op_sel_hi:[1,1]
    v_pk_mul_f32 v[222:223], v[222:223], v[6:7] op_sel:[0,1] op_sel_hi:[1,1]
    v_cvt_pk_bf16_f32 v76, v216, v217
    v_cvt_pk_bf16_f32 v77, v218, v219
    v_cvt_pk_bf16_f32 v78, v220, v221
    v_cvt_pk_bf16_f32 v79, v222, v223
    v_accvgpr_write_b32 a60, v76
    v_accvgpr_write_b32 a61, v77
    v_accvgpr_write_b32 a62, v78
    v_accvgpr_write_b32 a63, v79
    s_waitcnt lgkmcnt(0)
    s_barrier
    s_lshl_b32 s3, s37, 12
    v_subrev_u32 v9, s3, v9
    ds_read_b128 a[64:67], v9 offset:0
    ds_read_b128 a[68:71], v9 offset:1024
    ds_read_b128 a[72:75], v9 offset:4096
    ds_read_b128 a[76:79], v9 offset:5120
    s_nop 1
    v_mov_b32 v16, 0xff800000
    v_mov_b32 v20, 0xff800000
    v_mov_b32 v24, 0xff800000
    v_mov_b32 v28, 0xff800000
    v_mov_b32 v32, 0xff800000
L_head1:
    s_mov_b32 s52, 327680
    s_mov_b32 s89, 327680
    s_mov_b32 s94, 0
    s_mov_b32 s50, s48
    s_add_u32 s95, s63, 139264
    s_add_u32 s51, s63, 69632
    s_lshr_b32 s53, s2, 3
    s_and_b32 s3, s53, 3
    s_lshl_b32 s59, 2, s3
    s_xor_b32 s3, s53, 2
    s_and_b32 s3, s3, 3
    s_lshl_b32 s61, 2, s3
    ds_read_b128 a[160:163], v2 offset:0
    ds_read_b128 a[164:167], v2 offset:64
    ds_read_b128 a[168:171], v2 offset:128
    ds_read_b128 a[172:175], v2 offset:192
    ds_read_b128 a[176:179], v2 offset:512
    ds_read_b128 a[180:183], v2 offset:576
    ds_read_b128 a[184:187], v2 offset:640
    ds_read_b128 a[188:191], v2 offset:704
    v_add_u32 v2, s47, v2
    s_waitcnt lgkmcnt(7)
    v_mfma_f32_16x16x32_bf16 v[96:99], a[160:163], a[80:83], 0
    s_waitcnt lgkmcnt(6)
    v_mfma_f32_16x16x32_bf16 v[96:99], a[164:167], a[84:87], v[96:99]
    s_waitcnt lgkmcnt(5)
    v_mfma_f32_16x16x32_bf16 v[96:99], a[168:171], a[88:91], v[96:99]
    s_waitcnt lgkmcnt(4)
    v_mfma_f32_16x16x32_bf16 v[96:99], a[172:175], a[92:95], v[96:99]
    s_waitcnt lgkmcnt(3)
    v_mfma_f32_16x16x32_bf16 v[100:103], a[176:179], a[80:83], 0
    s_waitcnt lgkmcnt(2)
    v_mfma_f32_16x16x32_bf16 v[100:103], a[180:183], a[84:87], v[100:103]
    s_waitcnt lgkmcnt(1)
    v_mfma_f32_16x16x32_bf16 v[100:103], a[184:187], a[88:91], v[100:103]
    s_waitcnt lgkmcnt(0)
    v_mfma_f32_16x16x32_bf16 v[100:103], a[188:191], a[92:95], v[100:103]
    v_mfma_f32_16x16x32_bf16 v[104:107], a[160:163], a[96:99], 0
    s_add_u32 m0, s63, 121856
    v_mfma_f32_16x16x32_bf16 v[104:107], a[164:167], a[100:103], v[104:107]
    s_mov_b32 s67, 311296
    buffer_load_dwordx4 v1, s[16:19], s67 offen offset:0 nt lds
    v_mfma_f32_16x16x32_bf16 v[104:107], a[168:171], a[104:107], v[104:107]
    v_mfma_f32_16x16x32_bf16 v[104:107], a[172:175], a[108:111], v[104:107]
    v_mfma_f32_16x16x32_bf16 v[108:111], a[176:179], a[96:99], 0
    v_mfma_f32_16x16x32_bf16 v[108:111], a[180:183], a[100:103], v[108:111]
    v_mfma_f32_16x16x32_bf16 v[108:111], a[184:187], a[104:107], v[108:111]
    v_mfma_f32_16x16x32_bf16 v[108:111], a[188:191], a[108:111], v[108:111]
    v_mfma_f32_16x16x32_bf16 v[112:115], a[160:163], a[112:115], 0
    v_mfma_f32_16x16x32_bf16 v[112:115], a[164:167], a[116:119], v[112:115]
    v_mfma_f32_16x16x32_bf16 v[112:115], a[168:171], a[120:123], v[112:115]
    v_mfma_f32_16x16x32_bf16 v[112:115], a[172:175], a[124:127], v[112:115]
    v_mfma_f32_16x16x32_bf16 v[116:119], a[176:179], a[112:115], 0
    v_mfma_f32_16x16x32_bf16 v[116:119], a[180:183], a[116:119], v[116:119]
    v_mfma_f32_16x16x32_bf16 v[116:119], a[184:187], a[120:123], v[116:119]
    v_mfma_f32_16x16x32_bf16 v[116:119], a[188:191], a[124:127], v[116:119]
    v_mfma_f32_16x16x32_bf16 v[120:123], a[160:163], a[128:131], 0
    v_mfma_f32_16x16x32_bf16 v[120:123], a[164:167], a[132:135], v[120:123]
    v_mfma_f32_16x16x32_bf16 v[120:123], a[168:171], a[136:139], v[120:123]
    v_mfma_f32_16x16x32_bf16 v[120:123], a[172:175], a[140:143], v[120:123]
    v_mfma_f32_16x16x32_bf16 v[124:127], a[176:179], a[128:131], 0
    v_mfma_f32_16x16x32_bf16 v[124:127], a[180:183], a[132:135], v[124:127]
    v_mfma_f32_16x16x32_bf16 v[124:127], a[184:187], a[136:139], v[124:127]
    v_mfma_f32_16x16x32_bf16 v[124:127], a[188:191], a[140:143], v[124:127]
    v_mfma_f32_16x16x32_bf16 v[128:131], a[160:163], a[144:147], 0
    s_add_u32 m0, s63, 121888
    v_mfma_f32_16x16x32_bf16 v[128:131], a[164:167], a[148:151], v[128:131]
    buffer_load_dwordx4 v1, s[16:19], s67 offen offset:1024 nt lds
    v_mfma_f32_16x16x32_bf16 v[128:131], a[168:171], a[152:155], v[128:131]
    v_mfma_f32_16x16x32_bf16 v[128:131], a[172:175], a[156:159], v[128:131]
    v_mfma_f32_16x16x32_bf16 v[132:135], a[176:179], a[144:147], 0
    v_mfma_f32_16x16x32_bf16 v[132:135], a[180:183], a[148:151], v[132:135]
    v_mfma_f32_16x16x32_bf16 v[132:135], a[184:187], a[152:155], v[132:135]
    v_mfma_f32_16x16x32_bf16 v[132:135], a[188:191], a[156:159], v[132:135]
    ds_read_b128 a[160:163], v2 offset:0
    ds_read_b128 a[164:167], v2 offset:64
    ds_read_b128 a[168:171], v2 offset:128
    ds_read_b128 a[172:175], v2 offset:192
    ds_read_b64_tr_b16 a[192:193], v3 offset:0
    ds_read_b64_tr_b16 a[194:195], v3 offset:512
    ds_read_b64_tr_b16 a[196:197], v3 offset:32
    ds_read_b64_tr_b16 a[198:199], v3 offset:544
    v_max3_f32 v36, v96, v97, v16
    v_max3_f32 v44, v98, v99, v100
    v_max3_f32 v36, v101, v102, v36
    v_max3_f32 v36, v103, v44, v36
    v_max3_f32 v37, v104, v105, v20
    v_max3_f32 v45, v106, v107, v108
    v_max3_f32 v37, v109, v110, v37
    v_max3_f32 v37, v111, v45, v37
    v_max3_f32 v38, v112, v113, v24
    v_max3_f32 v46, v114, v115, v116
    v_max3_f32 v38, v117, v118, v38
    v_max3_f32 v38, v119, v46, v38
    v_max3_f32 v39, v120, v121, v28
    v_max3_f32 v47, v122, v123, v124
    v_max3_f32 v39, v125, v126, v39
    v_max3_f32 v39, v127, v47, v39
    v_max3_f32 v40, v128, v129, v32
    v_max3_f32 v48, v130, v131, v132
    v_max3_f32 v40, v133, v134, v40
    v_max3_f32 v40, v135, v48, v40
    v_mov_b32 v44, v36
    v_mov_b32 v45, v37
    v_mov_b32 v46, v38
    v_mov_b32 v47, v39
    v_mov_b32 v48, v40
    v_permlane32_swap_b32 v44, v36
    v_permlane32_swap_b32 v45, v37
    v_permlane32_swap_b32 v46, v38
    v_permlane32_swap_b32 v47, v39
    v_permlane32_swap_b32 v48, v40
    v_max_f32 v36, v36, v44
    v_max_f32 v37, v37, v45
    v_max_f32 v38, v38, v46
    v_max_f32 v39, v39, v47
    v_max_f32 v40, v40, v48
    v_mov_b32 v44, v36
    v_mov_b32 v45, v37
    v_mov_b32 v46, v38
    v_mov_b32 v47, v39
    v_mov_b32 v48, v40
    v_permlane16_swap_b32 v44, v36
    v_permlane16_swap_b32 v45, v37
    v_permlane16_swap_b32 v46, v38
    v_permlane16_swap_b32 v47, v39
    v_permlane16_swap_b32 v48, v40
    v_max_f32 v36, v36, v44
    v_max_f32 v37, v37, v45
    v_max_f32 v38, v38, v46
    v_max_f32 v39, v39, v47
    v_max_f32 v40, v40, v48
    v_sub_f32 v16, 0, v36
    v_sub_f32 v17, 0, v36
    v_sub_f32 v18, 0, v36
    v_sub_f32 v19, 0, v36
    v_sub_f32 v20, 0, v37
    v_sub_f32 v21, 0, v37
    v_sub_f32 v22, 0, v37
    v_sub_f32 v23, 0, v37
    v_sub_f32 v24, 0, v38
    v_sub_f32 v25, 0, v38
    v_sub_f32 v26, 0, v38
    v_sub_f32 v27, 0, v38
    v_sub_f32 v28, 0, v39
    v_sub_f32 v29, 0, v39
    v_sub_f32 v30, 0, v39
    v_sub_f32 v31, 0, v39
    v_sub_f32 v32, 0, v40
    v_sub_f32 v33, 0, v40
    v_sub_f32 v34, 0, v40
    v_sub_f32 v35, 0, v40
    v_pk_add_f32 v[96:97], v[96:97], v[16:17]
    v_pk_add_f32 v[98:99], v[98:99], v[16:17]
    v_pk_add_f32 v[100:101], v[100:101], v[16:17]
    v_pk_add_f32 v[102:103], v[102:103], v[16:17]
    s_add_u32 m0, s63, 121920
    v_exp_f32 v96, v96
    v_exp_f32 v97, v97
    v_exp_f32 v98, v98
    v_exp_f32 v99, v99
    v_exp_f32 v100, v100
    v_exp_f32 v101, v101
    v_exp_f32 v102, v102
    v_exp_f32 v103, v103
    buffer_load_dwordx4 v1, s[16:19], s67 offen offset:2048 nt lds
    v_pk_add_f32 v[104:105], v[104:105], v[20:21]
    v_pk_add_f32 v[106:107], v[106:107], v[20:21]
    v_pk_add_f32 v[108:109], v[108:109], v[20:21]
    v_pk_add_f32 v[110:111], v[110:111], v[20:21]
    v_exp_f32 v104, v104
    v_exp_f32 v105, v105
    v_exp_f32 v106, v106
    v_exp_f32 v107, v107
    v_exp_f32 v108, v108
    v_exp_f32 v109, v109
    v_exp_f32 v110, v110
    v_exp_f32 v111, v111
    v_pk_add_f32 v[112:113], v[112:113], v[24:25]
    v_pk_add_f32 v[114:115], v[114:115], v[24:25]
    v_pk_add_f32 v[116:117], v[116:117], v[24:25]
    v_pk_add_f32 v[118:119], v[118:119], v[24:25]
    v_exp_f32 v112, v112
    v_exp_f32 v113, v113
    v_exp_f32 v114, v114
    v_exp_f32 v115, v115
    v_exp_f32 v116, v116
    v_exp_f32 v117, v117
    v_exp_f32 v118, v118
    v_exp_f32 v119, v119
    v_pk_add_f32 v[120:121], v[120:121], v[28:29]
    v_pk_add_f32 v[122:123], v[122:123], v[28:29]
    v_pk_add_f32 v[124:125], v[124:125], v[28:29]
    v_pk_add_f32 v[126:127], v[126:127], v[28:29]
    v_exp_f32 v120, v120
    v_exp_f32 v121, v121
    v_exp_f32 v122, v122
    v_exp_f32 v123, v123
    v_exp_f32 v124, v124
    v_exp_f32 v125, v125
    v_exp_f32 v126, v126
    v_exp_f32 v127, v127
    v_pk_add_f32 v[128:129], v[128:129], v[32:33]
    v_pk_add_f32 v[130:131], v[130:131], v[32:33]
    v_pk_add_f32 v[132:133], v[132:133], v[32:33]
    v_pk_add_f32 v[134:135], v[134:135], v[32:33]
    s_add_u32 m0, s63, 121952
    v_exp_f32 v128, v128
    v_exp_f32 v129, v129
    v_exp_f32 v130, v130
    v_exp_f32 v131, v131
    v_exp_f32 v132, v132
    v_exp_f32 v133, v133
    v_exp_f32 v134, v134
    v_exp_f32 v135, v135
    buffer_load_dwordx4 v1, s[16:19], s67 offen offset:3072 nt lds
    v_cvt_pk_bf16_f32 v60, v96, v97
    v_cvt_pk_bf16_f32 v61, v98, v99
    v_cvt_pk_bf16_f32 v62, v100, v101
    v_cvt_pk_bf16_f32 v63, v102, v103
    v_cvt_pk_bf16_f32 v64, v104, v105
    v_cvt_pk_bf16_f32 v65, v106, v107
    v_cvt_pk_bf16_f32 v66, v108, v109
    v_cvt_pk_bf16_f32 v67, v110, v111
    v_cvt_pk_bf16_f32 v68, v112, v113
    v_cvt_pk_bf16_f32 v69, v114, v115
    v_cvt_pk_bf16_f32 v70, v116, v117
    v_cvt_pk_bf16_f32 v71, v118, v119
    v_cvt_pk_bf16_f32 v72, v120, v121
    v_cvt_pk_bf16_f32 v73, v122, v123
    v_cvt_pk_bf16_f32 v74, v124, v125
    v_cvt_pk_bf16_f32 v75, v126, v127
    v_cvt_pk_bf16_f32 v76, v128, v129
    v_cvt_pk_bf16_f32 v77, v130, v131
    v_cvt_pk_bf16_f32 v78, v132, v133
    v_cvt_pk_bf16_f32 v79, v134, v135
    v_lshlrev_b32 v13, 4, v0
    s_add_u32 s90, s64, 0
    s_add_u32 s91, s64, 4096
    s_add_u32 s92, s64, 8192
    s_add_u32 s93, s64, 12288
    s_mul_i32 s3, s40, 288
    s_sub_u32 s8, s20, s3
    s_subb_u32 s9, s21, 0
    s_add_u32 s10, s22, s3
    s_lshr_b32 s3, s2, 3
    s_lshl_b32 s53, s38, 5
    s_add_u32 s3, s3, s53
    s_mul_i32 s3, s3, 36864
    s_mul_i32 s53, s36, 9216
    s_add_u32 s87, s3, s53
    s_lshl_b32 s3, s41, 3
    s_add_u32 s3, s3, s39
    s_lshl_b32 s55, s3, 4
    buffer_load_dword v11, off, s[32:35], s55 sc1
    s_waitcnt lgkmcnt(7)
    v_mfma_f32_16x16x32_bf16 v[36:39], a[160:163], a[80:83], v[16:19]
    s_waitcnt lgkmcnt(6)
    v_mfma_f32_16x16x32_bf16 v[36:39], a[164:167], a[84:87], v[36:39]
    s_waitcnt lgkmcnt(5)
    ds_read_b128 a[176:179], v2 offset:512
    v_mfma_f32_16x16x32_bf16 v[36:39], a[168:171], a[88:91], v[36:39]
    s_waitcnt lgkmcnt(5)
    v_mfma_f32_16x16x32_bf16 v[36:39], a[172:175], a[92:95], v[36:39]
    s_waitcnt lgkmcnt(3)
    v_mfma_f32_16x16x32_bf16 v[96:99], a[192:195], v[60:63], 0
    s_bfe_u32 s53, s89, 0x2000e
    v_mfma_f32_16x16x32_bf16 v[128:131], a[192:195], v[64:67], 0
    s_mul_i32 s53, s53, 17408
    ds_read_b64_tr_b16 a[200:201], v3 offset:64
    v_mfma_f32_16x16x32_bf16 v[160:163], a[192:195], v[68:71], 0
    s_add_u32 s53, s53, s63
    v_mfma_f32_16x16x32_bf16 v[192:195], a[192:195], v[72:75], 0
    s_bitcmp1_b32 s59, s94
    ds_read_b64_tr_b16 a[202:203], v3 offset:576
    v_mfma_f32_16x16x32_bf16 v[224:227], a[192:195], v[76:79], 0
    s_cselect_b32 m0, s95, s53
    ds_read_b128 a[180:183], v2 offset:576
    v_mfma_f32_16x16x32_bf16 v[40:43], a[160:163], a[96:99], v[20:23]
    s_cselect_b32 s67, s58, s89
    v_exp_f32 v36, v36
    v_mfma_f32_16x16x32_bf16 v[40:43], a[164:167], a[100:103], v[40:43]
    s_cselect_b32 s53, 0, 0x4000
    v_exp_f32 v37, v37
    v_mfma_f32_16x16x32_bf16 v[40:43], a[168:171], a[104:107], v[40:43]
    s_add_u32 s89, s89, s53
    v_exp_f32 v38, v38
    v_mfma_f32_16x16x32_bf16 v[40:43], a[172:175], a[108:111], v[40:43]
    s_waitcnt lgkmcnt(4)
    v_exp_f32 v39, v39
    v_mfma_f32_16x16x32_bf16 v[100:103], a[196:199], v[60:63], 0
    ds_read_b64_tr_b16 a[204:205], v3 offset:96
    v_cvt_pk_bf16_f32 v80, v36, v37
    v_mfma_f32_16x16x32_bf16 v[132:135], a[196:199], v[64:67], 0
    v_mfma_f32_16x16x32_bf16 v[164:167], a[196:199], v[68:71], 0
    ds_read_b64_tr_b16 a[206:207], v3 offset:608
    v_cvt_pk_bf16_f32 v81, v38, v39
    v_mfma_f32_16x16x32_bf16 v[196:199], a[196:199], v[72:75], 0
    ds_read_b128 a[184:187], v2 offset:640
    v_mfma_f32_16x16x32_bf16 v[228:231], a[196:199], v[76:79], 0
    v_exp_f32 v40, v40
    v_mfma_f32_16x16x32_bf16 v[44:47], a[160:163], a[112:115], v[24:27]
    v_exp_f32 v41, v41
    v_mfma_f32_16x16x32_bf16 v[44:47], a[164:167], a[116:119], v[44:47]
    ds_read_b128 a[188:191], v2 offset:704
    v_cvt_pk_bf16_f32 v84, v40, v41
    v_mfma_f32_16x16x32_bf16 v[44:47], a[168:171], a[120:123], v[44:47]
    v_add_u32 v2, s50, v2
    v_mfma_f32_16x16x32_bf16 v[44:47], a[172:175], a[124:127], v[44:47]
    s_waitcnt lgkmcnt(5)
    v_exp_f32 v42, v42
    v_mfma_f32_16x16x32_bf16 v[104:107], a[200:203], v[60:63], 0
    ds_read_b64_tr_b16 a[192:193], v3 offset:128
    v_mfma_f32_16x16x32_bf16 v[136:139], a[200:203], v[64:67], 0
    v_exp_f32 v43, v43
    v_mfma_f32_16x16x32_bf16 v[168:171], a[200:203], v[68:71], 0
    v_mfma_f32_16x16x32_bf16 v[200:203], a[200:203], v[72:75], 0
    ds_read_b64_tr_b16 a[194:195], v3 offset:640
    v_cvt_pk_bf16_f32 v85, v42, v43
    v_mfma_f32_16x16x32_bf16 v[232:235], a[200:203], v[76:79], 0
    v_exp_f32 v44, v44
    v_mfma_f32_16x16x32_bf16 a[208:211], a[228:231], v[60:63], 0
    v_exp_f32 v45, v45
    v_mfma_f32_16x16x32_bf16 v[48:51], a[160:163], a[128:131], v[28:31]
    v_exp_f32 v46, v46
    v_mfma_f32_16x16x32_bf16 v[48:51], a[164:167], a[132:135], v[48:51]
    v_exp_f32 v47, v47
    v_mfma_f32_16x16x32_bf16 v[48:51], a[168:171], a[136:139], v[48:51]
    v_cvt_pk_bf16_f32 v88, v44, v45
    v_cvt_pk_bf16_f32 v89, v46, v47
    v_mfma_f32_16x16x32_bf16 v[48:51], a[172:175], a[140:143], v[48:51]
    s_waitcnt lgkmcnt(4)
    v_mfma_f32_16x16x32_bf16 v[108:111], a[204:207], v[60:63], 0
    ds_read_b64_tr_b16 a[196:197], v3 offset:160
    v_mfma_f32_16x16x32_bf16 v[140:143], a[204:207], v[64:67], 0
    v_mfma_f32_16x16x32_bf16 v[172:175], a[204:207], v[68:71], 0
    v_mfma_f32_16x16x32_bf16 v[204:207], a[204:207], v[72:75], 0
    ds_read_b64_tr_b16 a[198:199], v3 offset:672
    v_mfma_f32_16x16x32_bf16 v[236:239], a[204:207], v[76:79], 0
    v_exp_f32 v48, v48
    v_mfma_f32_16x16x32_bf16 a[212:215], a[228:231], v[64:67], 0
    v_exp_f32 v49, v49
    v_mfma_f32_16x16x32_bf16 v[52:55], a[176:179], a[80:83], v[16:19]
    v_exp_f32 v50, v50
    v_mfma_f32_16x16x32_bf16 v[52:55], a[180:183], a[84:87], v[52:55]
    s_waitcnt lgkmcnt(5)
    v_exp_f32 v51, v51
    v_mfma_f32_16x16x32_bf16 v[52:55], a[184:187], a[88:91], v[52:55]
    s_waitcnt lgkmcnt(4)
    v_cvt_pk_bf16_f32 v92, v48, v49
    v_cvt_pk_bf16_f32 v93, v50, v51
    v_mfma_f32_16x16x32_bf16 v[52:55], a[188:191], a[92:95], v[52:55]
    s_waitcnt lgkmcnt(2)
    v_mfma_f32_16x16x32_bf16 v[112:115], a[192:195], v[60:63], 0
    s_barrier
    ds_read_b64_tr_b16 a[200:201], v3 offset:192
    v_mfma_f32_16x16x32_bf16 v[144:147], a[192:195], v[64:67], 0
    v_mfma_f32_16x16x32_bf16 v[176:179], a[192:195], v[68:71], 0
    ds_read_b64_tr_b16 a[202:203], v3 offset:704
    v_mfma_f32_16x16x32_bf16 v[208:211], a[192:195], v[72:75], 0
    ds_read_b128 a[160:163], v2 offset:0
    v_mfma_f32_16x16x32_bf16 v[240:243], a[192:195], v[76:79], 0
    v_exp_f32 v52, v52
    v_mfma_f32_16x16x32_bf16 a[216:219], a[228:231], v[68:71], 0
    v_exp_f32 v53, v53
    v_mfma_f32_16x16x32_bf16 v[56:59], a[176:179], a[96:99], v[20:23]
    v_exp_f32 v54, v54
    v_mfma_f32_16x16x32_bf16 v[56:59], a[180:183], a[100:103], v[56:59]
    buffer_load_dwordx4 v1, s[12:15], s67 offen offset:0 nt lds
    v_mfma_f32_16x16x32_bf16 v[56:59], a[184:187], a[104:107], v[56:59]
    s_add_u32 m0, m0, 32
    ds_read_b128 a[164:167], v2 offset:64
    v_cvt_pk_bf16_f32 v82, v52, v53
    v_mfma_f32_16x16x32_bf16 v[56:59], a[188:191], a[108:111], v[56:59]
    s_waitcnt lgkmcnt(4)
    v_exp_f32 v55, v55
    v_mfma_f32_16x16x32_bf16 v[116:119], a[196:199], v[60:63], 0
    ds_read_b64_tr_b16 a[204:205], v3 offset:224
    v_cvt_pk_bf16_f32 v83, v54, v55
    v_mfma_f32_16x16x32_bf16 v[148:151], a[196:199], v[64:67], 0
    v_mfma_f32_16x16x32_bf16 v[180:183], a[196:199], v[68:71], 0
    ds_read_b64_tr_b16 a[206:207], v3 offset:736
    v_add_u32 v3, s47, v3
    v_mfma_f32_16x16x32_bf16 v[212:215], a[196:199], v[72:75], 0
    v_mfma_f32_16x16x32_bf16 v[244:247], a[196:199], v[76:79], 0
    ds_read_b128 a[168:171], v2 offset:128
    v_mfma_f32_16x16x32_bf16 a[220:223], a[228:231], v[72:75], 0
    v_exp_f32 v56, v56
    v_mfma_f32_16x16x32_bf16 v[36:39], a[176:179], a[112:115], v[24:27]
    v_exp_f32 v57, v57
    v_mfma_f32_16x16x32_bf16 v[36:39], a[180:183], a[116:119], v[36:39]
    v_exp_f32 v58, v58
    v_mfma_f32_16x16x32_bf16 v[36:39], a[184:187], a[120:123], v[36:39]
    v_exp_f32 v59, v59
    v_mfma_f32_16x16x32_bf16 v[36:39], a[188:191], a[124:127], v[36:39]
    s_waitcnt lgkmcnt(5)
    v_cvt_pk_bf16_f32 v86, v56, v57
    v_cvt_pk_bf16_f32 v87, v58, v59
    v_mfma_f32_16x16x32_bf16 v[120:123], a[200:203], v[60:63], 0
    ds_read_b64_tr_b16 a[192:193], v3 offset:0
    v_mfma_f32_16x16x32_bf16 v[152:155], a[200:203], v[64:67], 0
    ds_read_b128 a[172:175], v2 offset:192
    v_mfma_f32_16x16x32_bf16 v[184:187], a[200:203], v[68:71], 0
    ds_read_b64_tr_b16 a[194:195], v3 offset:512
    v_mfma_f32_16x16x32_bf16 v[216:219], a[200:203], v[72:75], 0
    v_mfma_f32_16x16x32_bf16 v[248:251], a[200:203], v[76:79], 0
    v_exp_f32 v36, v36
    v_mfma_f32_16x16x32_bf16 a[224:227], a[228:231], v[76:79], 0
    buffer_load_dwordx4 v1, s[12:15], s67 offen offset:1024 nt lds
    v_mfma_f32_16x16x32_bf16 v[40:43], a[176:179], a[128:131], v[28:31]
    s_add_u32 m0, m0, 32
    v_exp_f32 v37, v37
    v_mfma_f32_16x16x32_bf16 v[40:43], a[180:183], a[132:135], v[40:43]
    v_exp_f32 v38, v38
    v_mfma_f32_16x16x32_bf16 v[40:43], a[184:187], a[136:139], v[40:43]
    v_exp_f32 v39, v39
    v_mfma_f32_16x16x32_bf16 v[40:43], a[188:191], a[140:143], v[40:43]
    s_waitcnt lgkmcnt(4)
    v_cvt_pk_bf16_f32 v90, v36, v37
    v_cvt_pk_bf16_f32 v91, v38, v39
    v_mfma_f32_16x16x32_bf16 v[124:127], a[204:207], v[60:63], 0
    ds_read_b64_tr_b16 a[196:197], v3 offset:32
    v_mfma_f32_16x16x32_bf16 v[156:159], a[204:207], v[64:67], 0
    v_mfma_f32_16x16x32_bf16 v[188:191], a[204:207], v[68:71], 0
    ds_read_b64_tr_b16 a[198:199], v3 offset:544
    v_mfma_f32_16x16x32_bf16 v[220:223], a[204:207], v[72:75], 0
    v_mfma_f32_16x16x32_bf16 v[252:255], a[204:207], v[76:79], 0
    v_exp_f32 v40, v40
    v_mfma_f32_16x16x32_bf16 v[44:47], a[160:163], a[80:83], v[16:19]
    v_exp_f32 v41, v41
    v_mfma_f32_16x16x32_bf16 v[44:47], a[164:167], a[84:87], v[44:47]
    s_waitcnt lgkmcnt(5)
    ds_read_b128 a[176:179], v2 offset:512
    v_cvt_pk_bf16_f32 v94, v40, v41
    v_mfma_f32_16x16x32_bf16 v[44:47], a[168:171], a[88:91], v[44:47]
    s_waitcnt lgkmcnt(4)
    v_exp_f32 v42, v42
    v_mfma_f32_16x16x32_bf16 v[44:47], a[172:175], a[92:95], v[44:47]
    s_waitcnt lgkmcnt(3)
    v_exp_f32 v43, v43
    v_mfma_f32_16x16x32_bf16 v[96:99], a[192:195], v[80:83], v[96:99]
    ds_read_b64_tr_b16 a[200:201], v3 offset:64
    v_cvt_pk_bf16_f32 v95, v42, v43
    v_mfma_f32_16x16x32_bf16 v[128:131], a[192:195], v[84:87], v[128:131]
    v_mfma_f32_16x16x32_bf16 v[160:163], a[192:195], v[88:91], v[160:163]
    ds_read_b64_tr_b16 a[202:203], v3 offset:576
    v_mfma_f32_16x16x32_bf16 v[48:51], a[160:163], a[96:99], v[20:23]
    ds_read_b128 a[180:183], v2 offset:576
    v_mfma_f32_16x16x32_bf16 v[48:51], a[164:167], a[100:103], v[48:51]
    buffer_load_dwordx4 v1, s[12:15], s67 offen offset:2048 nt lds
    v_mfma_f32_16x16x32_bf16 v[48:51], a[168:171], a[104:107], v[48:51]
    s_add_u32 m0, m0, 32
    v_exp_f32 v44, v44
    v_mfma_f32_16x16x32_bf16 v[48:51], a[172:175], a[108:111], v[48:51]
    v_exp_f32 v45, v45
    v_mfma_f32_16x16x32_bf16 v[192:195], a[192:195], v[92:95], v[192:195]
    s_waitcnt lgkmcnt(4)
    v_exp_f32 v46, v46
    v_mfma_f32_16x16x32_bf16 v[100:103], a[196:199], v[80:83], v[100:103]
    ds_read_b64_tr_b16 a[204:205], v3 offset:96
    v_cvt_pk_bf16_f32 v60, v44, v45
    v_mfma_f32_16x16x32_bf16 v[132:135], a[196:199], v[84:87], v[132:135]
    ds_read_b128 a[184:187], v2 offset:640
    v_mfma_f32_16x16x32_bf16 v[52:55], a[160:163], a[112:115], v[24:27]
    ds_read_b64_tr_b16 a[206:207], v3 offset:608
    v_mfma_f32_16x16x32_bf16 v[52:55], a[164:167], a[116:119], v[52:55]
    v_exp_f32 v47, v47
    v_mfma_f32_16x16x32_bf16 v[52:55], a[168:171], a[120:123], v[52:55]
    v_exp_f32 v48, v48
    v_mfma_f32_16x16x32_bf16 v[52:55], a[172:175], a[124:127], v[52:55]
    v_exp_f32 v49, v49
    v_mfma_f32_16x16x32_bf16 v[164:167], a[196:199], v[88:91], v[164:167]
    v_exp_f32 v50, v50
    v_mfma_f32_16x16x32_bf16 v[196:199], a[196:199], v[92:95], v[196:199]
    s_waitcnt lgkmcnt(4)
    ds_read_b128 a[188:191], v2 offset:704
    v_cvt_pk_bf16_f32 v61, v46, v47
    v_mfma_f32_16x16x32_bf16 v[104:107], a[200:203], v[80:83], v[104:107]
    ds_read_b64_tr_b16 a[192:193], v3 offset:128
    v_add_u32 v2, s47, v2
    v_mfma_f32_16x16x32_bf16 a[208:211], a[228:231], v[80:83], a[208:211]
    v_exp_f32 v51, v51
    v_mfma_f32_16x16x32_bf16 v[56:59], a[160:163], a[128:131], v[28:31]
    ds_read_b64_tr_b16 a[194:195], v3 offset:640
    v_cvt_pk_bf16_f32 v64, v48, v49
    v_mfma_f32_16x16x32_bf16 v[56:59], a[164:167], a[132:135], v[56:59]
    v_exp_f32 v52, v52
    v_mfma_f32_16x16x32_bf16 v[56:59], a[168:171], a[136:139], v[56:59]
    v_exp_f32 v53, v53
    v_mfma_f32_16x16x32_bf16 v[56:59], a[172:175], a[140:143], v[56:59]
    v_exp_f32 v54, v54
    v_mfma_f32_16x16x32_bf16 v[136:139], a[200:203], v[84:87], v[136:139]
    buffer_load_dwordx4 v1, s[12:15], s67 offen offset:3072 nt lds
    v_mfma_f32_16x16x32_bf16 v[168:171], a[200:203], v[88:91], v[168:171]
    s_add_u32 s94, s94, 1
    v_exp_f32 v55, v55
    v_mfma_f32_16x16x32_bf16 v[200:203], a[200:203], v[92:95], v[200:203]
    s_bfe_u32 s53, s52, 0x2000e
    v_cvt_pk_bf16_f32 v65, v50, v51
    v_cvt_pk_bf16_f32 v68, v52, v53
    v_mfma_f32_16x16x32_bf16 v[36:39], a[160:163], a[144:147], v[32:35]
    s_mul_i32 s53, s53, 17408
    v_cvt_pk_bf16_f32 v69, v54, v55
    v_mfma_f32_16x16x32_bf16 v[36:39], a[164:167], a[148:151], v[36:39]
    s_add_u32 s53, s53, s51
    v_exp_f32 v56, v56
    v_mfma_f32_16x16x32_bf16 v[36:39], a[168:171], a[152:155], v[36:39]
    s_bitcmp1_b32 s61, s94
    v_exp_f32 v57, v57
    v_mfma_f32_16x16x32_bf16 v[36:39], a[172:175], a[156:159], v[36:39]
    s_waitcnt lgkmcnt(3)
    v_exp_f32 v58, v58
    v_mfma_f32_16x16x32_bf16 v[108:111], a[204:207], v[80:83], v[108:111]
    s_cselect_b32 m0, s95, s53
    ds_read_b64_tr_b16 a[196:197], v3 offset:160
    v_cvt_pk_bf16_f32 v72, v56, v57
    v_mfma_f32_16x16x32_bf16 v[140:143], a[204:207], v[84:87], v[140:143]
    s_cselect_b32 s67, s58, s52
    v_exp_f32 v59, v59
    v_mfma_f32_16x16x32_bf16 v[172:175], a[204:207], v[88:91], v[172:175]
    s_cselect_b32 s53, 0, 0x4000
    ds_read_b64_tr_b16 a[198:199], v3 offset:672
    v_cvt_pk_bf16_f32 v73, v58, v59
    v_mfma_f32_16x16x32_bf16 v[40:43], a[176:179], a[80:83], v[16:19]
    s_add_u32 s52, s52, s53
    v_mfma_f32_16x16x32_bf16 v[40:43], a[180:183], a[84:87], v[40:43]
    s_and_b32 s53, s94, 3
    ds_read_b128 a[160:163], v2 offset:0
    v_mfma_f32_16x16x32_bf16 v[40:43], a[184:187], a[88:91], v[40:43]
    s_waitcnt lgkmcnt(5)
    v_exp_f32 v36, v36
    v_mfma_f32_16x16x32_bf16 v[40:43], a[188:191], a[92:95], v[40:43]
    s_cmp_eq_u32 s53, 3
    v_exp_f32 v37, v37
    v_mfma_f32_16x16x32_bf16 v[204:207], a[204:207], v[92:95], v[204:207]
    s_waitcnt lgkmcnt(3)
    v_exp_f32 v38, v38
    v_mfma_f32_16x16x32_bf16 v[112:115], a[192:195], v[80:83], v[112:115]
    ds_read_b64_tr_b16 a[200:201], v3 offset:192
    v_cvt_pk_bf16_f32 v76, v36, v37
    v_mfma_f32_16x16x32_bf16 v[144:147], a[192:195], v[84:87], v[144:147]
    v_exp_f32 v39, v39
    v_mfma_f32_16x16x32_bf16 a[212:215], a[228:231], v[84:87], a[212:215]
    ds_read_b64_tr_b16 a[202:203], v3 offset:704
    v_cvt_pk_bf16_f32 v77, v38, v39
    v_mfma_f32_16x16x32_bf16 v[44:47], a[176:179], a[96:99], v[20:23]
    ds_read_b128 a[164:167], v2 offset:64
    v_mfma_f32_16x16x32_bf16 v[44:47], a[180:183], a[100:103], v[44:47]
    v_exp_f32 v40, v40
    v_mfma_f32_16x16x32_bf16 v[44:47], a[184:187], a[104:107], v[44:47]
    v_exp_f32 v41, v41
    v_mfma_f32_16x16x32_bf16 v[44:47], a[188:191], a[108:111], v[44:47]
    v_exp_f32 v42, v42
    v_mfma_f32_16x16x32_bf16 v[176:179], a[192:195], v[88:91], v[176:179]
    v_exp_f32 v43, v43
    v_mfma_f32_16x16x32_bf16 v[208:211], a[192:195], v[92:95], v[208:211]
    s_waitcnt lgkmcnt(4)
    ds_read_b128 a[168:171], v2 offset:128
    v_cvt_pk_bf16_f32 v62, v40, v41
    v_mfma_f32_16x16x32_bf16 v[116:119], a[196:199], v[80:83], v[116:119]
    ds_read_b64_tr_b16 a[204:205], v3 offset:224
    v_cvt_pk_bf16_f32 v63, v42, v43
    v_mfma_f32_16x16x32_bf16 v[48:51], a[176:179], a[112:115], v[24:27]
    v_mfma_f32_16x16x32_bf16 v[48:51], a[180:183], a[116:119], v[48:51]
    ds_read_b64_tr_b16 a[206:207], v3 offset:736
    v_add_u32 v3, s50, v3
    v_mfma_f32_16x16x32_bf16 v[48:51], a[184:187], a[120:123], v[48:51]
    s_cselect_b32 s50, s49, s48
    v_exp_f32 v44, v44
    v_mfma_f32_16x16x32_bf16 v[48:51], a[188:191], a[124:127], v[48:51]
    v_exp_f32 v45, v45
    v_mfma_f32_16x16x32_bf16 v[148:151], a[196:199], v[84:87], v[148:151]
    ds_read_b128 a[172:175], v2 offset:192
    v_cvt_pk_bf16_f32 v66, v44, v45
    v_mfma_f32_16x16x32_bf16 v[180:183], a[196:199], v[88:91], v[180:183]
    v_exp_f32 v46, v46
    v_mfma_f32_16x16x32_bf16 v[212:215], a[196:199], v[92:95], v[212:215]
    v_exp_f32 v47, v47
    v_mfma_f32_16x16x32_bf16 v[52:55], a[176:179], a[128:131], v[28:31]
    v_cvt_pk_bf16_f32 v67, v46, v47
    v_mfma_f32_16x16x32_bf16 v[52:55], a[180:183], a[132:135], v[52:55]
    v_exp_f32 v48, v48
    v_mfma_f32_16x16x32_bf16 v[52:55], a[184:187], a[136:139], v[52:55]
    s_waitcnt vmcnt(23) lgkmcnt(1)
    v_exp_f32 v49, v49
    v_mfma_f32_16x16x32_bf16 v[52:55], a[188:191], a[140:143], v[52:55]
    s_barrier
    v_exp_f32 v50, v50
    v_mfma_f32_16x16x32_bf16 v[120:123], a[200:203], v[80:83], v[120:123]
    ds_read_b64_tr_b16 a[192:193], v3 offset:0
    v_cvt_pk_bf16_f32 v70, v48, v49
    v_mfma_f32_16x16x32_bf16 v[152:155], a[200:203], v[84:87], v[152:155]
    v_exp_f32 v51, v51
    v_mfma_f32_16x16x32_bf16 v[184:187], a[200:203], v[88:91], v[184:187]
    ds_read_b64_tr_b16 a[194:195], v3 offset:512
    v_cvt_pk_bf16_f32 v71, v50, v51
    v_mfma_f32_16x16x32_bf16 v[56:59], a[176:179], a[144:147], v[32:35]
    v_mfma_f32_16x16x32_bf16 v[56:59], a[180:183], a[148:151], v[56:59]
    v_exp_f32 v52, v52
    v_mfma_f32_16x16x32_bf16 v[56:59], a[184:187], a[152:155], v[56:59]
    v_exp_f32 v53, v53
    v_mfma_f32_16x16x32_bf16 v[56:59], a[188:191], a[156:159], v[56:59]
    v_exp_f32 v54, v54
    v_mfma_f32_16x16x32_bf16 v[216:219], a[200:203], v[92:95], v[216:219]
    v_exp_f32 v55, v55
    v_mfma_f32_16x16x32_bf16 v[124:127], a[204:207], v[80:83], v[124:127]
    ds_read_b64_tr_b16 a[196:197], v3 offset:32
    v_cvt_pk_bf16_f32 v74, v52, v53
    v_mfma_f32_16x16x32_bf16 v[156:159], a[204:207], v[84:87], v[156:159]
    v_cvt_pk_bf16_f32 v75, v54, v55
    v_mfma_f32_16x16x32_bf16 v[188:191], a[204:207], v[88:91], v[188:191]
    ds_read_b64_tr_b16 a[198:199], v3 offset:544
    v_mfma_f32_16x16x32_bf16 v[220:223], a[204:207], v[92:95], v[220:223]
    v_exp_f32 v56, v56
    v_mfma_f32_16x16x32_bf16 a[216:219], a[228:231], v[88:91], a[216:219]
    v_exp_f32 v57, v57
    v_mfma_f32_16x16x32_bf16 a[220:223], a[228:231], v[92:95], a[220:223]
    s_branch L_loop1
    .p2align 6
L_loop1:
    v_mfma_f32_16x16x32_bf16 v[36:39], a[160:163], a[80:83], v[16:19]
    v_exp_f32 v58, v58
    v_mfma_f32_16x16x32_bf16 v[36:39], a[164:167], a[84:87], v[36:39]
    ds_read_b128 a[176:179], v2 offset:512
    v_cvt_pk_bf16_f32 v78, v56, v57
    v_mfma_f32_16x16x32_bf16 v[36:39], a[168:171], a[88:91], v[36:39]
    s_waitcnt lgkmcnt(5)
    v_exp_f32 v59, v59
    v_mfma_f32_16x16x32_bf16 v[36:39], a[172:175], a[92:95], v[36:39]
    s_waitcnt lgkmcnt(3)
    v_cvt_pk_bf16_f32 v79, v58, v59
    v_mfma_f32_16x16x32_bf16 v[96:99], a[192:195], v[60:63], v[96:99]
    buffer_load_dwordx4 v1, s[16:19], s67 offen offset:0 nt lds
    v_mfma_f32_16x16x32_bf16 v[128:131], a[192:195], v[64:67], v[128:131]
    s_add_u32 m0, m0, 32
    ds_read_b64_tr_b16 a[200:201], v3 offset:64
    v_mfma_f32_16x16x32_bf16 v[160:163], a[192:195], v[68:71], v[160:163]
    v_mfma_f32_16x16x32_bf16 v[192:195], a[192:195], v[72:75], v[192:195]
    ds_read_b64_tr_b16 a[202:203], v3 offset:576
    v_mfma_f32_16x16x32_bf16 v[224:227], a[192:195], v[76:79], v[224:227]
    ds_read_b128 a[180:183], v2 offset:576
    v_mfma_f32_16x16x32_bf16 v[40:43], a[160:163], a[96:99], v[20:23]
    v_exp_f32 v36, v36
    v_mfma_f32_16x16x32_bf16 v[40:43], a[164:167], a[100:103], v[40:43]
    v_exp_f32 v37, v37
    v_mfma_f32_16x16x32_bf16 v[40:43], a[168:171], a[104:107], v[40:43]
    v_exp_f32 v38, v38
    v_mfma_f32_16x16x32_bf16 v[40:43], a[172:175], a[108:111], v[40:43]
    s_waitcnt lgkmcnt(4)
    v_exp_f32 v39, v39
    v_mfma_f32_16x16x32_bf16 v[100:103], a[196:199], v[60:63], v[100:103]
    ds_read_b64_tr_b16 a[204:205], v3 offset:96
    v_cvt_pk_bf16_f32 v80, v36, v37
    v_mfma_f32_16x16x32_bf16 v[132:135], a[196:199], v[64:67], v[132:135]
    buffer_load_dwordx4 v1, s[16:19], s67 offen offset:1024 nt lds
    v_mfma_f32_16x16x32_bf16 v[164:167], a[196:199], v[68:71], v[164:167]
    s_add_u32 m0, m0, 32
    ds_read_b64_tr_b16 a[206:207], v3 offset:608
    v_cvt_pk_bf16_f32 v81, v38, v39
    v_mfma_f32_16x16x32_bf16 v[196:199], a[196:199], v[72:75], v[196:199]
    ds_read_b128 a[184:187], v2 offset:640
    v_mfma_f32_16x16x32_bf16 v[228:231], a[196:199], v[76:79], v[228:231]
    v_exp_f32 v40, v40
    v_mfma_f32_16x16x32_bf16 v[44:47], a[160:163], a[112:115], v[24:27]
    v_exp_f32 v41, v41
    v_mfma_f32_16x16x32_bf16 v[44:47], a[164:167], a[116:119], v[44:47]
    ds_read_b128 a[188:191], v2 offset:704
    v_cvt_pk_bf16_f32 v84, v40, v41
    v_mfma_f32_16x16x32_bf16 v[44:47], a[168:171], a[120:123], v[44:47]
    v_add_u32 v2, s50, v2
    v_mfma_f32_16x16x32_bf16 v[44:47], a[172:175], a[124:127], v[44:47]
    s_waitcnt lgkmcnt(5)
    v_exp_f32 v42, v42
    v_mfma_f32_16x16x32_bf16 v[104:107], a[200:203], v[60:63], v[104:107]
    ds_read_b64_tr_b16 a[192:193], v3 offset:128
    v_mfma_f32_16x16x32_bf16 v[136:139], a[200:203], v[64:67], v[136:139]
    v_exp_f32 v43, v43
    v_mfma_f32_16x16x32_bf16 v[168:171], a[200:203], v[68:71], v[168:171]
    buffer_load_dwordx4 v1, s[16:19], s67 offen offset:2048 nt lds
    v_mfma_f32_16x16x32_bf16 v[200:203], a[200:203], v[72:75], v[200:203]
    s_add_u32 m0, m0, 32
    ds_read_b64_tr_b16 a[194:195], v3 offset:640
    v_cvt_pk_bf16_f32 v85, v42, v43
    v_mfma_f32_16x16x32_bf16 v[232:235], a[200:203], v[76:79], v[232:235]
    v_exp_f32 v44, v44
    v_mfma_f32_16x16x32_bf16 a[208:211], a[228:231], v[60:63], a[208:211]
    v_exp_f32 v45, v45
    v_mfma_f32_16x16x32_bf16 v[48:51], a[160:163], a[128:131], v[28:31]
    v_exp_f32 v46, v46
    v_mfma_f32_16x16x32_bf16 v[48:51], a[164:167], a[132:135], v[48:51]
    v_exp_f32 v47, v47
    v_mfma_f32_16x16x32_bf16 v[48:51], a[168:171], a[136:139], v[48:51]
    v_cvt_pk_bf16_f32 v88, v44, v45
    v_cvt_pk_bf16_f32 v89, v46, v47
    v_mfma_f32_16x16x32_bf16 v[48:51], a[172:175], a[140:143], v[48:51]
    s_waitcnt lgkmcnt(4)
    v_mfma_f32_16x16x32_bf16 v[108:111], a[204:207], v[60:63], v[108:111]
    ds_read_b64_tr_b16 a[196:197], v3 offset:160
    v_mfma_f32_16x16x32_bf16 v[140:143], a[204:207], v[64:67], v[140:143]
    v_mfma_f32_16x16x32_bf16 v[172:175], a[204:207], v[68:71], v[172:175]
    buffer_load_dwordx4 v1, s[16:19], s67 offen offset:3072 nt lds
    v_mfma_f32_16x16x32_bf16 v[204:207], a[204:207], v[72:75], v[204:207]
    s_bfe_u32 s53, s89, 0x2000e
    ds_read_b64_tr_b16 a[198:199], v3 offset:672
    v_mfma_f32_16x16x32_bf16 v[236:239], a[204:207], v[76:79], v[236:239]
    s_mul_i32 s53, s53, 17408
    v_exp_f32 v48, v48
    v_mfma_f32_16x16x32_bf16 a[212:215], a[228:231], v[64:67], a[212:215]
    s_add_u32 s53, s53, s63
    v_exp_f32 v49, v49
    v_mfma_f32_16x16x32_bf16 v[52:55], a[176:179], a[80:83], v[16:19]
    s_bitcmp1_b32 s59, s94
    v_exp_f32 v50, v50
    v_mfma_f32_16x16x32_bf16 v[52:55], a[180:183], a[84:87], v[52:55]
    s_waitcnt lgkmcnt(5)
    v_exp_f32 v51, v51
    v_mfma_f32_16x16x32_bf16 v[52:55], a[184:187], a[88:91], v[52:55]
    s_waitcnt lgkmcnt(4)
    v_cvt_pk_bf16_f32 v92, v48, v49
    v_cvt_pk_bf16_f32 v93, v50, v51
    v_mfma_f32_16x16x32_bf16 v[52:55], a[188:191], a[92:95], v[52:55]
    s_waitcnt vmcnt(12) lgkmcnt(2)
    v_mfma_f32_16x16x32_bf16 v[112:115], a[192:195], v[60:63], v[112:115]
    s_barrier
    ds_read_b64_tr_b16 a[200:201], v3 offset:192
    v_mfma_f32_16x16x32_bf16 v[144:147], a[192:195], v[64:67], v[144:147]
    s_cselect_b32 m0, s95, s53
    v_mfma_f32_16x16x32_bf16 v[176:179], a[192:195], v[68:71], v[176:179]
    s_cselect_b32 s67, s58, s89
    ds_read_b64_tr_b16 a[202:203], v3 offset:704
    v_mfma_f32_16x16x32_bf16 v[208:211], a[192:195], v[72:75], v[208:211]
    s_cselect_b32 s53, 0, 0x4000
    ds_read_b128 a[160:163], v2 offset:0
    v_mfma_f32_16x16x32_bf16 v[240:243], a[192:195], v[76:79], v[240:243]
    s_add_u32 s89, s89, s53
    v_exp_f32 v52, v52
    v_mfma_f32_16x16x32_bf16 a[216:219], a[228:231], v[68:71], a[216:219]
    v_exp_f32 v53, v53
    v_mfma_f32_16x16x32_bf16 v[56:59], a[176:179], a[96:99], v[20:23]
    v_exp_f32 v54, v54
    v_mfma_f32_16x16x32_bf16 v[56:59], a[180:183], a[100:103], v[56:59]
    buffer_load_dwordx4 v1, s[12:15], s67 offen offset:0 nt lds
    v_mfma_f32_16x16x32_bf16 v[56:59], a[184:187], a[104:107], v[56:59]
    s_add_u32 m0, m0, 32
    ds_read_b128 a[164:167], v2 offset:64
    v_cvt_pk_bf16_f32 v82, v52, v53
    v_mfma_f32_16x16x32_bf16 v[56:59], a[188:191], a[108:111], v[56:59]
    s_waitcnt lgkmcnt(4)
    v_exp_f32 v55, v55
    v_mfma_f32_16x16x32_bf16 v[116:119], a[196:199], v[60:63], v[116:119]
    ds_read_b64_tr_b16 a[204:205], v3 offset:224
    v_cvt_pk_bf16_f32 v83, v54, v55
    v_mfma_f32_16x16x32_bf16 v[148:151], a[196:199], v[64:67], v[148:151]
    v_mfma_f32_16x16x32_bf16 v[180:183], a[196:199], v[68:71], v[180:183]
    ds_read_b64_tr_b16 a[206:207], v3 offset:736
    v_add_u32 v3, s47, v3
    v_mfma_f32_16x16x32_bf16 v[212:215], a[196:199], v[72:75], v[212:215]
    v_mfma_f32_16x16x32_bf16 v[244:247], a[196:199], v[76:79], v[244:247]
    ds_read_b128 a[168:171], v2 offset:128
    v_mfma_f32_16x16x32_bf16 a[220:223], a[228:231], v[72:75], a[220:223]
    v_exp_f32 v56, v56
    v_mfma_f32_16x16x32_bf16 v[36:39], a[176:179], a[112:115], v[24:27]
    v_exp_f32 v57, v57
    v_mfma_f32_16x16x32_bf16 v[36:39], a[180:183], a[116:119], v[36:39]
    v_exp_f32 v58, v58
    v_mfma_f32_16x16x32_bf16 v[36:39], a[184:187], a[120:123], v[36:39]
    v_exp_f32 v59, v59
    v_mfma_f32_16x16x32_bf16 v[36:39], a[188:191], a[124:127], v[36:39]
    s_waitcnt lgkmcnt(5)
    v_cvt_pk_bf16_f32 v86, v56, v57
    v_cvt_pk_bf16_f32 v87, v58, v59
    v_mfma_f32_16x16x32_bf16 v[120:123], a[200:203], v[60:63], v[120:123]
    ds_read_b64_tr_b16 a[192:193], v3 offset:0
    v_mfma_f32_16x16x32_bf16 v[152:155], a[200:203], v[64:67], v[152:155]
    ds_read_b128 a[172:175], v2 offset:192
    v_mfma_f32_16x16x32_bf16 v[184:187], a[200:203], v[68:71], v[184:187]
    ds_read_b64_tr_b16 a[194:195], v3 offset:512
    v_mfma_f32_16x16x32_bf16 v[216:219], a[200:203], v[72:75], v[216:219]
    v_mfma_f32_16x16x32_bf16 v[248:251], a[200:203], v[76:79], v[248:251]
    v_exp_f32 v36, v36
    v_mfma_f32_16x16x32_bf16 a[224:227], a[228:231], v[76:79], a[224:227]
    buffer_load_dwordx4 v1, s[12:15], s67 offen offset:1024 nt lds
    v_mfma_f32_16x16x32_bf16 v[40:43], a[176:179], a[128:131], v[28:31]
    s_add_u32 m0, m0, 32
    v_exp_f32 v37, v37
    v_mfma_f32_16x16x32_bf16 v[40:43], a[180:183], a[132:135], v[40:43]
    v_exp_f32 v38, v38
    v_mfma_f32_16x16x32_bf16 v[40:43], a[184:187], a[136:139], v[40:43]
    v_exp_f32 v39, v39
    v_mfma_f32_16x16x32_bf16 v[40:43], a[188:191], a[140:143], v[40:43]
    s_waitcnt lgkmcnt(4)
    v_cvt_pk_bf16_f32 v90, v36, v37
    v_cvt_pk_bf16_f32 v91, v38, v39
    v_mfma_f32_16x16x32_bf16 v[124:127], a[204:207], v[60:63], v[124:127]
    ds_read_b64_tr_b16 a[196:197], v3 offset:32
    v_mfma_f32_16x16x32_bf16 v[156:159], a[204:207], v[64:67], v[156:159]
    v_mfma_f32_16x16x32_bf16 v[188:191], a[204:207], v[68:71], v[188:191]
    ds_read_b64_tr_b16 a[198:199], v3 offset:544
    v_mfma_f32_16x16x32_bf16 v[220:223], a[204:207], v[72:75], v[220:223]
    v_mfma_f32_16x16x32_bf16 v[252:255], a[204:207], v[76:79], v[252:255]
    v_exp_f32 v40, v40
    v_mfma_f32_16x16x32_bf16 v[44:47], a[160:163], a[80:83], v[16:19]
    v_exp_f32 v41, v41
    v_mfma_f32_16x16x32_bf16 v[44:47], a[164:167], a[84:87], v[44:47]
    s_waitcnt lgkmcnt(5)
    ds_read_b128 a[176:179], v2 offset:512
    v_cvt_pk_bf16_f32 v94, v40, v41
    v_mfma_f32_16x16x32_bf16 v[44:47], a[168:171], a[88:91], v[44:47]
    s_waitcnt lgkmcnt(4)
    v_exp_f32 v42, v42
    v_mfma_f32_16x16x32_bf16 v[44:47], a[172:175], a[92:95], v[44:47]
    s_waitcnt lgkmcnt(3)
    v_exp_f32 v43, v43
    v_mfma_f32_16x16x32_bf16 v[96:99], a[192:195], v[80:83], v[96:99]
    ds_read_b64_tr_b16 a[200:201], v3 offset:64
    v_cvt_pk_bf16_f32 v95, v42, v43
    v_mfma_f32_16x16x32_bf16 v[128:131], a[192:195], v[84:87], v[128:131]
    v_mfma_f32_16x16x32_bf16 v[160:163], a[192:195], v[88:91], v[160:163]
    ds_read_b64_tr_b16 a[202:203], v3 offset:576
    v_mfma_f32_16x16x32_bf16 v[48:51], a[160:163], a[96:99], v[20:23]
    ds_read_b128 a[180:183], v2 offset:576
    v_mfma_f32_16x16x32_bf16 v[48:51], a[164:167], a[100:103], v[48:51]
    buffer_load_dwordx4 v1, s[12:15], s67 offen offset:2048 nt lds
    v_mfma_f32_16x16x32_bf16 v[48:51], a[168:171], a[104:107], v[48:51]
    s_add_u32 m0, m0, 32
    v_exp_f32 v44, v44
    v_mfma_f32_16x16x32_bf16 v[48:51], a[172:175], a[108:111], v[48:51]
    v_exp_f32 v45, v45
    v_mfma_f32_16x16x32_bf16 v[192:195], a[192:195], v[92:95], v[192:195]
    s_waitcnt lgkmcnt(4)
    v_exp_f32 v46, v46
    v_mfma_f32_16x16x32_bf16 v[100:103], a[196:199], v[80:83], v[100:103]
    ds_read_b64_tr_b16 a[204:205], v3 offset:96
    v_cvt_pk_bf16_f32 v60, v44, v45
    v_mfma_f32_16x16x32_bf16 v[132:135], a[196:199], v[84:87], v[132:135]
    ds_read_b128 a[184:187], v2 offset:640
    v_mfma_f32_16x16x32_bf16 v[52:55], a[160:163], a[112:115], v[24:27]
    ds_read_b64_tr_b16 a[206:207], v3 offset:608
    v_mfma_f32_16x16x32_bf16 v[52:55], a[164:167], a[116:119], v[52:55]
    v_exp_f32 v47, v47
    v_mfma_f32_16x16x32_bf16 v[52:55], a[168:171], a[120:123], v[52:55]
    v_exp_f32 v48, v48
    v_mfma_f32_16x16x32_bf16 v[52:55], a[172:175], a[124:127], v[52:55]
    v_exp_f32 v49, v49
    v_mfma_f32_16x16x32_bf16 v[164:167], a[196:199], v[88:91], v[164:167]
    v_exp_f32 v50, v50
    v_mfma_f32_16x16x32_bf16 v[196:199], a[196:199], v[92:95], v[196:199]
    s_waitcnt lgkmcnt(4)
    ds_read_b128 a[188:191], v2 offset:704
    v_cvt_pk_bf16_f32 v61, v46, v47
    v_mfma_f32_16x16x32_bf16 v[104:107], a[200:203], v[80:83], v[104:107]
    ds_read_b64_tr_b16 a[192:193], v3 offset:128
    v_add_u32 v2, s47, v2
    v_mfma_f32_16x16x32_bf16 a[208:211], a[228:231], v[80:83], a[208:211]
    v_exp_f32 v51, v51
    v_mfma_f32_16x16x32_bf16 v[56:59], a[160:163], a[128:131], v[28:31]
    ds_read_b64_tr_b16 a[194:195], v3 offset:640
    v_cvt_pk_bf16_f32 v64, v48, v49
    v_mfma_f32_16x16x32_bf16 v[56:59], a[164:167], a[132:135], v[56:59]
    v_exp_f32 v52, v52
    v_mfma_f32_16x16x32_bf16 v[56:59], a[168:171], a[136:139], v[56:59]
    v_exp_f32 v53, v53
    v_mfma_f32_16x16x32_bf16 v[56:59], a[172:175], a[140:143], v[56:59]
    v_exp_f32 v54, v54
    v_mfma_f32_16x16x32_bf16 v[136:139], a[200:203], v[84:87], v[136:139]
    buffer_load_dwordx4 v1, s[12:15], s67 offen offset:3072 nt lds
    v_mfma_f32_16x16x32_bf16 v[168:171], a[200:203], v[88:91], v[168:171]
    s_add_u32 s94, s94, 1
    v_exp_f32 v55, v55
    v_mfma_f32_16x16x32_bf16 v[200:203], a[200:203], v[92:95], v[200:203]
    s_bfe_u32 s53, s52, 0x2000e
    v_cvt_pk_bf16_f32 v65, v50, v51
    v_cvt_pk_bf16_f32 v68, v52, v53
    v_mfma_f32_16x16x32_bf16 v[36:39], a[160:163], a[144:147], v[32:35]
    s_mul_i32 s53, s53, 17408
    v_cvt_pk_bf16_f32 v69, v54, v55
    v_mfma_f32_16x16x32_bf16 v[36:39], a[164:167], a[148:151], v[36:39]
    s_add_u32 s53, s53, s51
    v_exp_f32 v56, v56
    v_mfma_f32_16x16x32_bf16 v[36:39], a[168:171], a[152:155], v[36:39]
    s_bitcmp1_b32 s61, s94
    v_exp_f32 v57, v57
    v_mfma_f32_16x16x32_bf16 v[36:39], a[172:175], a[156:159], v[36:39]
    s_waitcnt lgkmcnt(3)
    v_exp_f32 v58, v58
    v_mfma_f32_16x16x32_bf16 v[108:111], a[204:207], v[80:83], v[108:111]
    s_cselect_b32 m0, s95, s53
    ds_read_b64_tr_b16 a[196:197], v3 offset:160
    v_cvt_pk_bf16_f32 v72, v56, v57
    v_mfma_f32_16x16x32_bf16 v[140:143], a[204:207], v[84:87], v[140:143]
    s_cselect_b32 s67, s58, s52
    v_exp_f32 v59, v59
    v_mfma_f32_16x16x32_bf16 v[172:175], a[204:207], v[88:91], v[172:175]
    s_cselect_b32 s53, 0, 0x4000
    ds_read_b64_tr_b16 a[198:199], v3 offset:672
    v_cvt_pk_bf16_f32 v73, v58, v59
    v_mfma_f32_16x16x32_bf16 v[40:43], a[176:179], a[80:83], v[16:19]
    s_add_u32 s52, s52, s53
    v_mfma_f32_16x16x32_bf16 v[40:43], a[180:183], a[84:87], v[40:43]
    s_and_b32 s53, s94, 3
    ds_read_b128 a[160:163], v2 offset:0
    v_mfma_f32_16x16x32_bf16 v[40:43], a[184:187], a[88:91], v[40:43]
    s_waitcnt lgkmcnt(5)
    v_exp_f32 v36, v36
    v_mfma_f32_16x16x32_bf16 v[40:43], a[188:191], a[92:95], v[40:43]
    s_cmp_eq_u32 s53, 3
    v_exp_f32 v37, v37
    v_mfma_f32_16x16x32_bf16 v[204:207], a[204:207], v[92:95], v[204:207]
    s_waitcnt lgkmcnt(3)
    v_exp_f32 v38, v38
    v_mfma_f32_16x16x32_bf16 v[112:115], a[192:195], v[80:83], v[112:115]
    ds_read_b64_tr_b16 a[200:201], v3 offset:192
    v_cvt_pk_bf16_f32 v76, v36, v37
    v_mfma_f32_16x16x32_bf16 v[144:147], a[192:195], v[84:87], v[144:147]
    v_exp_f32 v39, v39
    v_mfma_f32_16x16x32_bf16 a[212:215], a[228:231], v[84:87], a[212:215]
    ds_read_b64_tr_b16 a[202:203], v3 offset:704
    v_cvt_pk_bf16_f32 v77, v38, v39
    v_mfma_f32_16x16x32_bf16 v[44:47], a[176:179], a[96:99], v[20:23]
    ds_read_b128 a[164:167], v2 offset:64
    v_mfma_f32_16x16x32_bf16 v[44:47], a[180:183], a[100:103], v[44:47]
    v_exp_f32 v40, v40
    v_mfma_f32_16x16x32_bf16 v[44:47], a[184:187], a[104:107], v[44:47]
    v_exp_f32 v41, v41
    v_mfma_f32_16x16x32_bf16 v[44:47], a[188:191], a[108:111], v[44:47]
    v_exp_f32 v42, v42
    v_mfma_f32_16x16x32_bf16 v[176:179], a[192:195], v[88:91], v[176:179]
    v_exp_f32 v43, v43
    v_mfma_f32_16x16x32_bf16 v[208:211], a[192:195], v[92:95], v[208:211]
    s_waitcnt lgkmcnt(4)
    ds_read_b128 a[168:171], v2 offset:128
    v_cvt_pk_bf16_f32 v62, v40, v41
    v_mfma_f32_16x16x32_bf16 v[116:119], a[196:199], v[80:83], v[116:119]
    ds_read_b64_tr_b16 a[204:205], v3 offset:224
    v_cvt_pk_bf16_f32 v63, v42, v43
    v_mfma_f32_16x16x32_bf16 v[48:51], a[176:179], a[112:115], v[24:27]
    v_mfma_f32_16x16x32_bf16 v[48:51], a[180:183], a[116:119], v[48:51]
    ds_read_b64_tr_b16 a[206:207], v3 offset:736
    v_add_u32 v3, s50, v3
    v_mfma_f32_16x16x32_bf16 v[48:51], a[184:187], a[120:123], v[48:51]
    s_cselect_b32 s50, s49, s48
    v_exp_f32 v44, v44
    v_mfma_f32_16x16x32_bf16 v[48:51], a[188:191], a[124:127], v[48:51]
    s_cmp_lg_u32 s94, 13
    v_exp_f32 v45, v45
    v_mfma_f32_16x16x32_bf16 v[148:151], a[196:199], v[84:87], v[148:151]
    ds_read_b128 a[172:175], v2 offset:192
    v_cvt_pk_bf16_f32 v66, v44, v45
    v_mfma_f32_16x16x32_bf16 v[180:183], a[196:199], v[88:91], v[180:183]
    v_exp_f32 v46, v46
    v_mfma_f32_16x16x32_bf16 v[212:215], a[196:199], v[92:95], v[212:215]
    v_exp_f32 v47, v47
    v_mfma_f32_16x16x32_bf16 v[52:55], a[176:179], a[128:131], v[28:31]
    v_cvt_pk_bf16_f32 v67, v46, v47
    v_mfma_f32_16x16x32_bf16 v[52:55], a[180:183], a[132:135], v[52:55]
    v_exp_f32 v48, v48
    v_mfma_f32_16x16x32_bf16 v[52:55], a[184:187], a[136:139], v[52:55]
    s_waitcnt vmcnt(12) lgkmcnt(1)
    v_exp_f32 v49, v49
    v_mfma_f32_16x16x32_bf16 v[52:55], a[188:191], a[140:143], v[52:55]
    s_barrier
    v_exp_f32 v50, v50
    v_mfma_f32_16x16x32_bf16 v[120:123], a[200:203], v[80:83], v[120:123]
    ds_read_b64_tr_b16 a[192:193], v3 offset:0
    v_cvt_pk_bf16_f32 v70, v48, v49
    v_mfma_f32_16x16x32_bf16 v[152:155], a[200:203], v[84:87], v[152:155]
    v_exp_f32 v51, v51
    v_mfma_f32_16x16x32_bf16 v[184:187], a[200:203], v[88:91], v[184:187]
    ds_read_b64_tr_b16 a[194:195], v3 offset:512
    v_cvt_pk_bf16_f32 v71, v50, v51
    v_mfma_f32_16x16x32_bf16 v[56:59], a[176:179], a[144:147], v[32:35]
    v_mfma_f32_16x16x32_bf16 v[56:59], a[180:183], a[148:151], v[56:59]
    v_exp_f32 v52, v52
    v_mfma_f32_16x16x32_bf16 v[56:59], a[184:187], a[152:155], v[56:59]
    v_exp_f32 v53, v53
    v_mfma_f32_16x16x32_bf16 v[56:59], a[188:191], a[156:159], v[56:59]
    v_exp_f32 v54, v54
    v_mfma_f32_16x16x32_bf16 v[216:219], a[200:203], v[92:95], v[216:219]
    v_exp_f32 v55, v55
    v_mfma_f32_16x16x32_bf16 v[124:127], a[204:207], v[80:83], v[124:127]
    ds_read_b64_tr_b16 a[196:197], v3 offset:32
    v_cvt_pk_bf16_f32 v74, v52, v53
    v_mfma_f32_16x16x32_bf16 v[156:159], a[204:207], v[84:87], v[156:159]
    v_cvt_pk_bf16_f32 v75, v54, v55
    v_mfma_f32_16x16x32_bf16 v[188:191], a[204:207], v[88:91], v[188:191]
    ds_read_b64_tr_b16 a[198:199], v3 offset:544
    v_mfma_f32_16x16x32_bf16 v[220:223], a[204:207], v[92:95], v[220:223]
    v_exp_f32 v56, v56
    v_mfma_f32_16x16x32_bf16 a[216:219], a[228:231], v[88:91], a[216:219]
    v_exp_f32 v57, v57
    v_mfma_f32_16x16x32_bf16 a[220:223], a[228:231], v[92:95], a[220:223]
    s_cbranch_scc1 L_loop1
    v_mfma_f32_16x16x32_bf16 v[36:39], a[160:163], a[80:83], v[16:19]
    v_exp_f32 v58, v58
    v_mfma_f32_16x16x32_bf16 v[36:39], a[164:167], a[84:87], v[36:39]
    ds_read_b128 a[176:179], v2 offset:512
    v_lshrrev_b32 v4, 3, v0
    v_cvt_pk_bf16_f32 v78, v56, v57
    v_mfma_f32_16x16x32_bf16 v[36:39], a[168:171], a[88:91], v[36:39]
    s_waitcnt lgkmcnt(5)
    v_lshlrev_b32 v12, 7, v0
    v_lshlrev_b32 v4, 24, v4
    v_exp_f32 v59, v59
    v_mfma_f32_16x16x32_bf16 v[36:39], a[172:175], a[92:95], v[36:39]
    s_waitcnt lgkmcnt(3)
    v_and_b32 v14, 0x380, v12
    v_lshl_add_u32 v4, v0, 7, v4
    v_cvt_pk_bf16_f32 v79, v58, v59
    v_mfma_f32_16x16x32_bf16 v[96:99], a[192:195], v[60:63], v[96:99]
    buffer_load_dwordx4 v1, s[16:19], s67 offen offset:0 nt lds
    v_mov_b32 v5, s66
    v_mfma_f32_16x16x32_bf16 v[128:131], a[192:195], v[64:67], v[128:131]
    s_add_u32 m0, m0, 32
    ds_read_b64_tr_b16 a[200:201], v3 offset:64
    v_add_u32 v14, 0x2000, v14
    v_lshl_add_u32 v4, v5, 10, v4
    s_mov_b32 s60, L_hepi1-L_pc
    v_mfma_f32_16x16x32_bf16 v[160:163], a[192:195], v[68:71], v[160:163]
    v_mfma_f32_16x16x32_bf16 v[192:195], a[192:195], v[72:75], v[192:195]
    ds_read_b64_tr_b16 a[202:203], v3 offset:576
    v_mfma_f32_16x16x32_bf16 v[224:227], a[192:195], v[76:79], v[224:227]
    ds_read_b128 a[180:183], v2 offset:576
    v_mfma_f32_16x16x32_bf16 v[40:43], a[160:163], a[96:99], v[20:23]
    buffer_load_dword v5, v4, s[4:7], s60 offen
    v_exp_f32 v36, v36
    v_mfma_f32_16x16x32_bf16 v[40:43], a[164:167], a[100:103], v[40:43]
    v_exp_f32 v37, v37
    v_mfma_f32_16x16x32_bf16 v[40:43], a[168:171], a[104:107], v[40:43]
    v_exp_f32 v38, v38
    v_mfma_f32_16x16x32_bf16 v[40:43], a[172:175], a[108:111], v[40:43]
    s_waitcnt lgkmcnt(4)
    v_exp_f32 v39, v39
    v_mfma_f32_16x16x32_bf16 v[100:103], a[196:199], v[60:63], v[100:103]
    ds_read_b64_tr_b16 a[204:205], v3 offset:96
    v_cvt_pk_bf16_f32 v80, v36, v37
    v_mfma_f32_16x16x32_bf16 v[132:135], a[196:199], v[64:67], v[132:135]
    buffer_load_dwordx4 v1, s[16:19], s67 offen offset:1024 nt lds
    v_mfma_f32_16x16x32_bf16 v[164:167], a[196:199], v[68:71], v[164:167]
    s_add_u32 m0, m0, 32
    ds_read_b64_tr_b16 a[206:207], v3 offset:608
    v_cvt_pk_bf16_f32 v81, v38, v39
    v_mfma_f32_16x16x32_bf16 v[196:199], a[196:199], v[72:75], v[196:199]
    ds_read_b128 a[184:187], v2 offset:640
    v_mfma_f32_16x16x32_bf16 v[228:231], a[196:199], v[76:79], v[228:231]
    v_exp_f32 v40, v40
    v_mfma_f32_16x16x32_bf16 v[44:47], a[160:163], a[112:115], v[24:27]
    v_exp_f32 v41, v41
    v_mfma_f32_16x16x32_bf16 v[44:47], a[164:167], a[116:119], v[44:47]
    ds_read_b128 a[188:191], v2 offset:704
    v_cvt_pk_bf16_f32 v84, v40, v41
    v_mfma_f32_16x16x32_bf16 v[44:47], a[168:171], a[120:123], v[44:47]
    v_add_u32 v2, s50, v2
    v_mfma_f32_16x16x32_bf16 v[44:47], a[172:175], a[124:127], v[44:47]
    s_waitcnt lgkmcnt(5)
    v_exp_f32 v42, v42
    v_mfma_f32_16x16x32_bf16 v[104:107], a[200:203], v[60:63], v[104:107]
    ds_read_b64_tr_b16 a[192:193], v3 offset:128
    v_mfma_f32_16x16x32_bf16 v[136:139], a[200:203], v[64:67], v[136:139]
    v_exp_f32 v43, v43
    v_mfma_f32_16x16x32_bf16 v[168:171], a[200:203], v[68:71], v[168:171]
    buffer_load_dwordx4 v1, s[16:19], s67 offen offset:2048 nt lds
    v_mfma_f32_16x16x32_bf16 v[200:203], a[200:203], v[72:75], v[200:203]
    s_add_u32 m0, m0, 32
    ds_read_b64_tr_b16 a[194:195], v3 offset:640
    v_cvt_pk_bf16_f32 v85, v42, v43
    v_mfma_f32_16x16x32_bf16 v[232:235], a[200:203], v[76:79], v[232:235]
    v_exp_f32 v44, v44
    v_mfma_f32_16x16x32_bf16 a[208:211], a[228:231], v[60:63], a[208:211]
    v_exp_f32 v45, v45
    v_mfma_f32_16x16x32_bf16 v[48:51], a[160:163], a[128:131], v[28:31]
    v_exp_f32 v46, v46
    v_mfma_f32_16x16x32_bf16 v[48:51], a[164:167], a[132:135], v[48:51]
    v_exp_f32 v47, v47
    v_mfma_f32_16x16x32_bf16 v[48:51], a[168:171], a[136:139], v[48:51]
    v_cvt_pk_bf16_f32 v88, v44, v45
    v_cvt_pk_bf16_f32 v89, v46, v47
    v_mfma_f32_16x16x32_bf16 v[48:51], a[172:175], a[140:143], v[48:51]
    s_waitcnt lgkmcnt(4)
    v_mfma_f32_16x16x32_bf16 v[108:111], a[204:207], v[60:63], v[108:111]
    ds_read_b64_tr_b16 a[196:197], v3 offset:160
    v_mfma_f32_16x16x32_bf16 v[140:143], a[204:207], v[64:67], v[140:143]
    v_mfma_f32_16x16x32_bf16 v[172:175], a[204:207], v[68:71], v[172:175]
    buffer_load_dwordx4 v1, s[16:19], s67 offen offset:3072 nt lds
    v_mfma_f32_16x16x32_bf16 v[204:207], a[204:207], v[72:75], v[204:207]
    s_add_u32 s94, s94, 1
    ds_read_b64_tr_b16 a[198:199], v3 offset:672
    v_mfma_f32_16x16x32_bf16 v[236:239], a[204:207], v[76:79], v[236:239]
    s_and_b32 s53, s94, 3
    v_exp_f32 v48, v48
    v_mfma_f32_16x16x32_bf16 a[212:215], a[228:231], v[64:67], a[212:215]
    s_cmp_eq_u32 s53, 3
    v_exp_f32 v49, v49
    v_mfma_f32_16x16x32_bf16 v[52:55], a[176:179], a[80:83], v[16:19]
    v_exp_f32 v50, v50
    v_mfma_f32_16x16x32_bf16 v[52:55], a[180:183], a[84:87], v[52:55]
    s_waitcnt lgkmcnt(5)
    v_exp_f32 v51, v51
    v_mfma_f32_16x16x32_bf16 v[52:55], a[184:187], a[88:91], v[52:55]
    s_waitcnt lgkmcnt(4)
    buffer_load_dword v9, v12, s[8:11], s87 offen
    v_cvt_pk_bf16_f32 v92, v48, v49
    v_cvt_pk_bf16_f32 v93, v50, v51
    v_mfma_f32_16x16x32_bf16 v[52:55], a[188:191], a[92:95], v[52:55]
    s_waitcnt vmcnt(14) lgkmcnt(2)
    v_mfma_f32_16x16x32_bf16 v[112:115], a[192:195], v[60:63], v[112:115]
    s_barrier
    ds_read_b64_tr_b16 a[200:201], v3 offset:192
    v_mfma_f32_16x16x32_bf16 v[144:147], a[192:195], v[64:67], v[144:147]
    v_mfma_f32_16x16x32_bf16 v[176:179], a[192:195], v[68:71], v[176:179]
    ds_read_b64_tr_b16 a[202:203], v3 offset:704
    v_mfma_f32_16x16x32_bf16 v[208:211], a[192:195], v[72:75], v[208:211]
    ds_read_b128 a[160:163], v2 offset:0
    v_mfma_f32_16x16x32_bf16 v[240:243], a[192:195], v[76:79], v[240:243]
    buffer_load_dword v9, v14, s[8:11], s87 offen
    v_exp_f32 v52, v52
    v_mfma_f32_16x16x32_bf16 a[216:219], a[228:231], v[68:71], a[216:219]
    v_exp_f32 v53, v53
    v_mfma_f32_16x16x32_bf16 v[56:59], a[176:179], a[96:99], v[20:23]
    v_exp_f32 v54, v54
    v_mfma_f32_16x16x32_bf16 v[56:59], a[180:183], a[100:103], v[56:59]
    v_mfma_f32_16x16x32_bf16 v[56:59], a[184:187], a[104:107], v[56:59]
    ds_read_b128 a[164:167], v2 offset:64
    v_cvt_pk_bf16_f32 v82, v52, v53
    v_mfma_f32_16x16x32_bf16 v[56:59], a[188:191], a[108:111], v[56:59]
    s_waitcnt lgkmcnt(4)
    v_exp_f32 v55, v55
    v_mfma_f32_16x16x32_bf16 v[116:119], a[196:199], v[60:63], v[116:119]
    ds_read_b64_tr_b16 a[204:205], v3 offset:224
    v_cvt_pk_bf16_f32 v83, v54, v55
    v_mfma_f32_16x16x32_bf16 v[148:151], a[196:199], v[64:67], v[148:151]
    v_mfma_f32_16x16x32_bf16 v[180:183], a[196:199], v[68:71], v[180:183]
    ds_read_b64_tr_b16 a[206:207], v3 offset:736
    v_add_u32 v3, s47, v3
    v_mfma_f32_16x16x32_bf16 v[212:215], a[196:199], v[72:75], v[212:215]
    v_mfma_f32_16x16x32_bf16 v[244:247], a[196:199], v[76:79], v[244:247]
    ds_read_b128 a[168:171], v2 offset:128
    v_mfma_f32_16x16x32_bf16 a[220:223], a[228:231], v[72:75], a[220:223]
    v_exp_f32 v56, v56
    v_mfma_f32_16x16x32_bf16 v[36:39], a[176:179], a[112:115], v[24:27]
    v_exp_f32 v57, v57
    v_mfma_f32_16x16x32_bf16 v[36:39], a[180:183], a[116:119], v[36:39]
    v_exp_f32 v58, v58
    v_mfma_f32_16x16x32_bf16 v[36:39], a[184:187], a[120:123], v[36:39]
    v_exp_f32 v59, v59
    v_mfma_f32_16x16x32_bf16 v[36:39], a[188:191], a[124:127], v[36:39]
    s_waitcnt lgkmcnt(5)
    v_cvt_pk_bf16_f32 v86, v56, v57
    v_cvt_pk_bf16_f32 v87, v58, v59
    v_mfma_f32_16x16x32_bf16 v[120:123], a[200:203], v[60:63], v[120:123]
    ds_read_b64_tr_b16 a[192:193], v3 offset:0
    v_mfma_f32_16x16x32_bf16 v[152:155], a[200:203], v[64:67], v[152:155]
    ds_read_b128 a[172:175], v2 offset:192
    v_mfma_f32_16x16x32_bf16 v[184:187], a[200:203], v[68:71], v[184:187]
    ds_read_b64_tr_b16 a[194:195], v3 offset:512
    v_mfma_f32_16x16x32_bf16 v[216:219], a[200:203], v[72:75], v[216:219]
    v_mfma_f32_16x16x32_bf16 v[248:251], a[200:203], v[76:79], v[248:251]
    v_exp_f32 v36, v36
    v_mfma_f32_16x16x32_bf16 a[224:227], a[228:231], v[76:79], a[224:227]
    v_mfma_f32_16x16x32_bf16 v[40:43], a[176:179], a[128:131], v[28:31]
    v_exp_f32 v37, v37
    v_mfma_f32_16x16x32_bf16 v[40:43], a[180:183], a[132:135], v[40:43]
    v_exp_f32 v38, v38
    v_mfma_f32_16x16x32_bf16 v[40:43], a[184:187], a[136:139], v[40:43]
    v_exp_f32 v39, v39
    v_mfma_f32_16x16x32_bf16 v[40:43], a[188:191], a[140:143], v[40:43]
    s_waitcnt lgkmcnt(4)
    v_cvt_pk_bf16_f32 v90, v36, v37
    v_cvt_pk_bf16_f32 v91, v38, v39
    v_mfma_f32_16x16x32_bf16 v[124:127], a[204:207], v[60:63], v[124:127]
    ds_read_b64_tr_b16 a[196:197], v3 offset:32
    v_mfma_f32_16x16x32_bf16 v[156:159], a[204:207], v[64:67], v[156:159]
    v_mfma_f32_16x16x32_bf16 v[188:191], a[204:207], v[68:71], v[188:191]
    ds_read_b64_tr_b16 a[198:199], v3 offset:544
    v_mfma_f32_16x16x32_bf16 v[220:223], a[204:207], v[72:75], v[220:223]
    v_mfma_f32_16x16x32_bf16 v[252:255], a[204:207], v[76:79], v[252:255]
    v_exp_f32 v40, v40
    v_mfma_f32_16x16x32_bf16 v[44:47], a[160:163], a[80:83], v[16:19]
    v_exp_f32 v41, v41
    v_mfma_f32_16x16x32_bf16 v[44:47], a[164:167], a[84:87], v[44:47]
    s_waitcnt lgkmcnt(5)
    ds_read_b128 a[176:179], v2 offset:512
    v_cvt_pk_bf16_f32 v94, v40, v41
    v_mfma_f32_16x16x32_bf16 v[44:47], a[168:171], a[88:91], v[44:47]
    s_waitcnt lgkmcnt(4)
    v_exp_f32 v42, v42
    v_mfma_f32_16x16x32_bf16 v[44:47], a[172:175], a[92:95], v[44:47]
    s_waitcnt lgkmcnt(3)
    v_exp_f32 v43, v43
    v_mfma_f32_16x16x32_bf16 v[96:99], a[192:195], v[80:83], v[96:99]
    ds_read_b64_tr_b16 a[200:201], v3 offset:64
    v_cvt_pk_bf16_f32 v95, v42, v43
    v_mfma_f32_16x16x32_bf16 v[128:131], a[192:195], v[84:87], v[128:131]
    v_mfma_f32_16x16x32_bf16 v[160:163], a[192:195], v[88:91], v[160:163]
    ds_read_b64_tr_b16 a[202:203], v3 offset:576
    v_mfma_f32_16x16x32_bf16 v[48:51], a[160:163], a[96:99], v[20:23]
    ds_read_b128 a[180:183], v2 offset:576
    v_mfma_f32_16x16x32_bf16 v[48:51], a[164:167], a[100:103], v[48:51]
    v_mfma_f32_16x16x32_bf16 v[48:51], a[168:171], a[104:107], v[48:51]
    v_exp_f32 v44, v44
    v_mfma_f32_16x16x32_bf16 v[48:51], a[172:175], a[108:111], v[48:51]
    v_exp_f32 v45, v45
    v_mfma_f32_16x16x32_bf16 v[192:195], a[192:195], v[92:95], v[192:195]
    s_waitcnt lgkmcnt(4)
    v_exp_f32 v46, v46
    v_mfma_f32_16x16x32_bf16 v[100:103], a[196:199], v[80:83], v[100:103]
    ds_read_b64_tr_b16 a[204:205], v3 offset:96
    v_cvt_pk_bf16_f32 v60, v44, v45
    v_mfma_f32_16x16x32_bf16 v[132:135], a[196:199], v[84:87], v[132:135]
    ds_read_b128 a[184:187], v2 offset:640
    v_mfma_f32_16x16x32_bf16 v[52:55], a[160:163], a[112:115], v[24:27]
    ds_read_b64_tr_b16 a[206:207], v3 offset:608
    v_mfma_f32_16x16x32_bf16 v[52:55], a[164:167], a[116:119], v[52:55]
    v_exp_f32 v47, v47
    v_mfma_f32_16x16x32_bf16 v[52:55], a[168:171], a[120:123], v[52:55]
    v_exp_f32 v48, v48
    v_mfma_f32_16x16x32_bf16 v[52:55], a[172:175], a[124:127], v[52:55]
    v_exp_f32 v49, v49
    v_mfma_f32_16x16x32_bf16 v[164:167], a[196:199], v[88:91], v[164:167]
    v_exp_f32 v50, v50
    v_mfma_f32_16x16x32_bf16 v[196:199], a[196:199], v[92:95], v[196:199]
    s_waitcnt lgkmcnt(4)
    ds_read_b128 a[188:191], v2 offset:704
    v_cvt_pk_bf16_f32 v61, v46, v47
    v_mfma_f32_16x16x32_bf16 v[104:107], a[200:203], v[80:83], v[104:107]
    ds_read_b64_tr_b16 a[192:193], v3 offset:128
    v_add_u32 v2, s47, v2
    v_mfma_f32_16x16x32_bf16 a[208:211], a[228:231], v[80:83], a[208:211]
    v_exp_f32 v51, v51
    v_mfma_f32_16x16x32_bf16 v[56:59], a[160:163], a[128:131], v[28:31]
    ds_read_b64_tr_b16 a[194:195], v3 offset:640
    v_cvt_pk_bf16_f32 v64, v48, v49
    v_mfma_f32_16x16x32_bf16 v[56:59], a[164:167], a[132:135], v[56:59]
    v_exp_f32 v52, v52
    v_mfma_f32_16x16x32_bf16 v[56:59], a[168:171], a[136:139], v[56:59]
    v_exp_f32 v53, v53
    v_mfma_f32_16x16x32_bf16 v[56:59], a[172:175], a[140:143], v[56:59]
    v_exp_f32 v54, v54
    v_mfma_f32_16x16x32_bf16 v[136:139], a[200:203], v[84:87], v[136:139]
    v_mfma_f32_16x16x32_bf16 v[168:171], a[200:203], v[88:91], v[168:171]
    v_exp_f32 v55, v55
    v_mfma_f32_16x16x32_bf16 v[200:203], a[200:203], v[92:95], v[200:203]
    v_cvt_pk_bf16_f32 v65, v50, v51
    v_cvt_pk_bf16_f32 v68, v52, v53
    v_mfma_f32_16x16x32_bf16 v[36:39], a[160:163], a[144:147], v[32:35]
    v_cvt_pk_bf16_f32 v69, v54, v55
    v_mfma_f32_16x16x32_bf16 v[36:39], a[164:167], a[148:151], v[36:39]
    v_exp_f32 v56, v56
    v_mfma_f32_16x16x32_bf16 v[36:39], a[168:171], a[152:155], v[36:39]
    v_exp_f32 v57, v57
    v_mfma_f32_16x16x32_bf16 v[36:39], a[172:175], a[156:159], v[36:39]
    s_waitcnt lgkmcnt(3)
    v_exp_f32 v58, v58
    v_mfma_f32_16x16x32_bf16 v[108:111], a[204:207], v[80:83], v[108:111]
    ds_read_b64_tr_b16 a[196:197], v3 offset:160
    v_cvt_pk_bf16_f32 v72, v56, v57
    v_mfma_f32_16x16x32_bf16 v[140:143], a[204:207], v[84:87], v[140:143]
    v_exp_f32 v59, v59
    v_mfma_f32_16x16x32_bf16 v[172:175], a[204:207], v[88:91], v[172:175]
    ds_read_b64_tr_b16 a[198:199], v3 offset:672
    v_cvt_pk_bf16_f32 v73, v58, v59
    v_mfma_f32_16x16x32_bf16 v[40:43], a[176:179], a[80:83], v[16:19]
    buffer_store_dwordx4 a[0:3], v13, s[24:27], s90 offen offset:0 sc1
    v_mfma_f32_16x16x32_bf16 v[40:43], a[180:183], a[84:87], v[40:43]
    ds_read_b128 a[160:163], v2 offset:0
    v_mfma_f32_16x16x32_bf16 v[40:43], a[184:187], a[88:91], v[40:43]
    s_waitcnt lgkmcnt(5)
    v_exp_f32 v36, v36
    v_mfma_f32_16x16x32_bf16 v[40:43], a[188:191], a[92:95], v[40:43]
    v_exp_f32 v37, v37
    v_mfma_f32_16x16x32_bf16 v[204:207], a[204:207], v[92:95], v[204:207]
    s_waitcnt lgkmcnt(3)
    v_exp_f32 v38, v38
    v_mfma_f32_16x16x32_bf16 v[112:115], a[192:195], v[80:83], v[112:115]
    ds_read_b64_tr_b16 a[200:201], v3 offset:192
    v_cvt_pk_bf16_f32 v76, v36, v37
    v_mfma_f32_16x16x32_bf16 v[144:147], a[192:195], v[84:87], v[144:147]
    v_exp_f32 v39, v39
    v_mfma_f32_16x16x32_bf16 a[212:215], a[228:231], v[84:87], a[212:215]
    ds_read_b64_tr_b16 a[202:203], v3 offset:704
    v_cvt_pk_bf16_f32 v77, v38, v39
    v_mfma_f32_16x16x32_bf16 v[44:47], a[176:179], a[96:99], v[20:23]
    ds_read_b128 a[164:167], v2 offset:64
    v_mfma_f32_16x16x32_bf16 v[44:47], a[180:183], a[100:103], v[44:47]
    v_exp_f32 v40, v40
    v_mfma_f32_16x16x32_bf16 v[44:47], a[184:187], a[104:107], v[44:47]
    v_exp_f32 v41, v41
    v_mfma_f32_16x16x32_bf16 v[44:47], a[188:191], a[108:111], v[44:47]
    v_exp_f32 v42, v42
    v_mfma_f32_16x16x32_bf16 v[176:179], a[192:195], v[88:91], v[176:179]
    v_exp_f32 v43, v43
    v_mfma_f32_16x16x32_bf16 v[208:211], a[192:195], v[92:95], v[208:211]
    s_waitcnt lgkmcnt(4)
    ds_read_b128 a[168:171], v2 offset:128
    v_cvt_pk_bf16_f32 v62, v40, v41
    v_mfma_f32_16x16x32_bf16 v[116:119], a[196:199], v[80:83], v[116:119]
    ds_read_b64_tr_b16 a[204:205], v3 offset:224
    v_cvt_pk_bf16_f32 v63, v42, v43
    v_mfma_f32_16x16x32_bf16 v[48:51], a[176:179], a[112:115], v[24:27]
    buffer_store_dwordx4 a[4:7], v13, s[24:27], s90 offen offset:1024 sc1
    v_mfma_f32_16x16x32_bf16 v[48:51], a[180:183], a[116:119], v[48:51]
    ds_read_b64_tr_b16 a[206:207], v3 offset:736
    v_add_u32 v3, s50, v3
    v_mfma_f32_16x16x32_bf16 v[48:51], a[184:187], a[120:123], v[48:51]
    s_cselect_b32 s50, s49, s48
    v_exp_f32 v44, v44
    v_mfma_f32_16x16x32_bf16 v[48:51], a[188:191], a[124:127], v[48:51]
    v_exp_f32 v45, v45
    v_mfma_f32_16x16x32_bf16 v[148:151], a[196:199], v[84:87], v[148:151]
    ds_read_b128 a[172:175], v2 offset:192
    v_cvt_pk_bf16_f32 v66, v44, v45
    v_mfma_f32_16x16x32_bf16 v[180:183], a[196:199], v[88:91], v[180:183]
    v_exp_f32 v46, v46
    v_mfma_f32_16x16x32_bf16 v[212:215], a[196:199], v[92:95], v[212:215]
    v_exp_f32 v47, v47
    v_mfma_f32_16x16x32_bf16 v[52:55], a[176:179], a[128:131], v[28:31]
    buffer_store_dwordx4 a[8:11], v13, s[24:27], s90 offen offset:2048 sc1
    v_cvt_pk_bf16_f32 v67, v46, v47
    v_mfma_f32_16x16x32_bf16 v[52:55], a[180:183], a[132:135], v[52:55]
    v_exp_f32 v48, v48
    v_mfma_f32_16x16x32_bf16 v[52:55], a[184:187], a[136:139], v[52:55]
    s_waitcnt vmcnt(14) lgkmcnt(1)
    v_exp_f32 v49, v49
    v_mfma_f32_16x16x32_bf16 v[52:55], a[188:191], a[140:143], v[52:55]
    s_barrier
    v_exp_f32 v50, v50
    v_mfma_f32_16x16x32_bf16 v[120:123], a[200:203], v[80:83], v[120:123]
    ds_read_b64_tr_b16 a[192:193], v3 offset:0
    v_cvt_pk_bf16_f32 v70, v48, v49
    v_mfma_f32_16x16x32_bf16 v[152:155], a[200:203], v[84:87], v[152:155]
    v_exp_f32 v51, v51
    v_mfma_f32_16x16x32_bf16 v[184:187], a[200:203], v[88:91], v[184:187]
    ds_read_b64_tr_b16 a[194:195], v3 offset:512
    v_cvt_pk_bf16_f32 v71, v50, v51
    v_mfma_f32_16x16x32_bf16 v[56:59], a[176:179], a[144:147], v[32:35]
    v_mfma_f32_16x16x32_bf16 v[56:59], a[180:183], a[148:151], v[56:59]
    v_exp_f32 v52, v52
    v_mfma_f32_16x16x32_bf16 v[56:59], a[184:187], a[152:155], v[56:59]
    v_exp_f32 v53, v53
    v_mfma_f32_16x16x32_bf16 v[56:59], a[188:191], a[156:159], v[56:59]
    v_exp_f32 v54, v54
    v_mfma_f32_16x16x32_bf16 v[216:219], a[200:203], v[92:95], v[216:219]
    v_exp_f32 v55, v55
    v_mfma_f32_16x16x32_bf16 v[124:127], a[204:207], v[80:83], v[124:127]
    ds_read_b64_tr_b16 a[196:197], v3 offset:32
    v_cvt_pk_bf16_f32 v74, v52, v53
    v_mfma_f32_16x16x32_bf16 v[156:159], a[204:207], v[84:87], v[156:159]
    buffer_store_dwordx4 a[12:15], v13, s[24:27], s90 offen offset:3072 sc1
    v_cvt_pk_bf16_f32 v75, v54, v55
    v_mfma_f32_16x16x32_bf16 v[188:191], a[204:207], v[88:91], v[188:191]
    ds_read_b64_tr_b16 a[198:199], v3 offset:544
    v_mfma_f32_16x16x32_bf16 v[220:223], a[204:207], v[92:95], v[220:223]
    v_exp_f32 v56, v56
    v_mfma_f32_16x16x32_bf16 a[216:219], a[228:231], v[88:91], a[216:219]
    v_exp_f32 v57, v57
    v_mfma_f32_16x16x32_bf16 a[220:223], a[228:231], v[92:95], a[220:223]
    v_mfma_f32_16x16x32_bf16 v[36:39], a[160:163], a[80:83], v[16:19]
    v_exp_f32 v58, v58
    v_mfma_f32_16x16x32_bf16 v[36:39], a[164:167], a[84:87], v[36:39]
    ds_read_b128 a[176:179], v2 offset:512
    v_cvt_pk_bf16_f32 v78, v56, v57
    v_mfma_f32_16x16x32_bf16 v[36:39], a[168:171], a[88:91], v[36:39]
    s_waitcnt lgkmcnt(5)
    v_exp_f32 v59, v59
    v_mfma_f32_16x16x32_bf16 v[36:39], a[172:175], a[92:95], v[36:39]
    s_waitcnt lgkmcnt(3)
    v_cvt_pk_bf16_f32 v79, v58, v59
    v_readfirstlane_b32 s3, v11
    v_mfma_f32_16x16x32_bf16 v[96:99], a[192:195], v[60:63], v[96:99]
    v_mfma_f32_16x16x32_bf16 v[128:131], a[192:195], v[64:67], v[128:131]
    ds_read_b64_tr_b16 a[200:201], v3 offset:64
    v_mfma_f32_16x16x32_bf16 v[160:163], a[192:195], v[68:71], v[160:163]
    buffer_store_dwordx4 a[16:19], v13, s[24:27], s91 offen offset:0 sc1
    v_mfma_f32_16x16x32_bf16 v[192:195], a[192:195], v[72:75], v[192:195]
    ds_read_b64_tr_b16 a[202:203], v3 offset:576
    v_mfma_f32_16x16x32_bf16 v[224:227], a[192:195], v[76:79], v[224:227]
    ds_read_b128 a[180:183], v2 offset:576
    v_mfma_f32_16x16x32_bf16 v[40:43], a[160:163], a[96:99], v[20:23]
    v_exp_f32 v36, v36
    v_mfma_f32_16x16x32_bf16 v[40:43], a[164:167], a[100:103], v[40:43]
    v_exp_f32 v37, v37
    v_mfma_f32_16x16x32_bf16 v[40:43], a[168:171], a[104:107], v[40:43]
    v_exp_f32 v38, v38
    v_mfma_f32_16x16x32_bf16 v[40:43], a[172:175], a[108:111], v[40:43]
    s_waitcnt lgkmcnt(4)
    v_exp_f32 v39, v39
    s_cmp_ge_u32 s3, 16
    s_cbranch_scc0 L_sp_dbg
L_sb_dbg:
    v_mfma_f32_16x16x32_bf16 v[100:103], a[196:199], v[60:63], v[100:103]
    ds_read_b64_tr_b16 a[204:205], v3 offset:96
    v_cvt_pk_bf16_f32 v80, v36, v37
    v_mfma_f32_16x16x32_bf16 v[132:135], a[196:199], v[64:67], v[132:135]
    v_mfma_f32_16x16x32_bf16 v[164:167], a[196:199], v[68:71], v[164:167]
    ds_read_b64_tr_b16 a[206:207], v3 offset:608
    v_cvt_pk_bf16_f32 v81, v38, v39
    v_mfma_f32_16x16x32_bf16 v[196:199], a[196:199], v[72:75], v[196:199]
    ds_read_b128 a[184:187], v2 offset:640
    v_mfma_f32_16x16x32_bf16 v[228:231], a[196:199], v[76:79], v[228:231]
    v_exp_f32 v40, v40
    v_mfma_f32_16x16x32_bf16 v[44:47], a[160:163], a[112:115], v[24:27]
    v_exp_f32 v41, v41
    v_mfma_f32_16x16x32_bf16 v[44:47], a[164:167], a[116:119], v[44:47]
    ds_read_b128 a[188:191], v2 offset:704
    v_cvt_pk_bf16_f32 v84, v40, v41
    v_mfma_f32_16x16x32_bf16 v[44:47], a[168:171], a[120:123], v[44:47]
    buffer_store_dwordx4 a[20:23], v13, s[24:27], s91 offen offset:1024 sc1
    v_add_u32 v2, s50, v2
    v_mfma_f32_16x16x32_bf16 v[44:47], a[172:175], a[124:127], v[44:47]
    s_waitcnt lgkmcnt(5)
    v_exp_f32 v42, v42
    v_mfma_f32_16x16x32_bf16 v[104:107], a[200:203], v[60:63], v[104:107]
    ds_read_b64_tr_b16 a[192:193], v3 offset:128
    v_mfma_f32_16x16x32_bf16 v[136:139], a[200:203], v[64:67], v[136:139]
    v_exp_f32 v43, v43
    v_mfma_f32_16x16x32_bf16 v[168:171], a[200:203], v[68:71], v[168:171]
    v_mfma_f32_16x16x32_bf16 v[200:203], a[200:203], v[72:75], v[200:203]
    ds_read_b64_tr_b16 a[194:195], v3 offset:640
    v_cvt_pk_bf16_f32 v85, v42, v43
    v_mfma_f32_16x16x32_bf16 v[232:235], a[200:203], v[76:79], v[232:235]
    v_exp_f32 v44, v44
    v_mfma_f32_16x16x32_bf16 a[208:211], a[228:231], v[60:63], a[208:211]
    v_exp_f32 v45, v45
    v_mfma_f32_16x16x32_bf16 v[48:51], a[160:163], a[128:131], v[28:31]
    v_exp_f32 v46, v46
    v_mfma_f32_16x16x32_bf16 v[48:51], a[164:167], a[132:135], v[48:51]
    v_exp_f32 v47, v47
    v_mfma_f32_16x16x32_bf16 v[48:51], a[168:171], a[136:139], v[48:51]
    buffer_store_dwordx4 a[24:27], v13, s[24:27], s91 offen offset:2048 sc1
    v_cvt_pk_bf16_f32 v88, v44, v45
    v_cvt_pk_bf16_f32 v89, v46, v47
    v_mfma_f32_16x16x32_bf16 v[48:51], a[172:175], a[140:143], v[48:51]
    s_waitcnt lgkmcnt(4)
    v_mfma_f32_16x16x32_bf16 v[108:111], a[204:207], v[60:63], v[108:111]
    ds_read_b64_tr_b16 a[196:197], v3 offset:160
    v_mfma_f32_16x16x32_bf16 v[140:143], a[204:207], v[64:67], v[140:143]
    v_mfma_f32_16x16x32_bf16 v[172:175], a[204:207], v[68:71], v[172:175]
    v_mfma_f32_16x16x32_bf16 v[204:207], a[204:207], v[72:75], v[204:207]
    ds_read_b64_tr_b16 a[198:199], v3 offset:672
    v_mfma_f32_16x16x32_bf16 v[236:239], a[204:207], v[76:79], v[236:239]
    v_exp_f32 v48, v48
    v_mfma_f32_16x16x32_bf16 a[212:215], a[228:231], v[64:67], a[212:215]
    v_exp_f32 v49, v49
    v_mfma_f32_16x16x32_bf16 v[52:55], a[176:179], a[80:83], v[16:19]
    v_exp_f32 v50, v50
    v_mfma_f32_16x16x32_bf16 v[52:55], a[180:183], a[84:87], v[52:55]
    s_waitcnt lgkmcnt(5)
    v_exp_f32 v51, v51
    v_mfma_f32_16x16x32_bf16 v[52:55], a[184:187], a[88:91], v[52:55]
    s_waitcnt lgkmcnt(4)
    v_cvt_pk_bf16_f32 v92, v48, v49
    v_cvt_pk_bf16_f32 v93, v50, v51
    v_mfma_f32_16x16x32_bf16 v[52:55], a[188:191], a[92:95], v[52:55]
    s_waitcnt vmcnt(14) lgkmcnt(2)
    buffer_store_dwordx4 a[28:31], v13, s[24:27], s91 offen offset:3072 sc1
    v_mfma_f32_16x16x32_bf16 v[112:115], a[192:195], v[60:63], v[112:115]
    s_barrier
    ds_read_b64_tr_b16 a[200:201], v3 offset:192
    v_mfma_f32_16x16x32_bf16 v[144:147], a[192:195], v[64:67], v[144:147]
    s_waitcnt vmcnt(8)
    v_accvgpr_read_b32 v4, a240
    v_mfma_f32_16x16x32_bf16 v[176:179], a[192:195], v[68:71], v[176:179]
    ds_read_b64_tr_b16 a[202:203], v3 offset:704
    v_accvgpr_read_b32 v5, a241
    v_mfma_f32_16x16x32_bf16 v[208:211], a[192:195], v[72:75], v[208:211]
    ds_read_b128 a[160:163], v2 offset:0
    v_accvgpr_read_b32 v6, a242
    v_mfma_f32_16x16x32_bf16 v[240:243], a[192:195], v[76:79], v[240:243]
    v_accvgpr_read_b32 v7, a243
    v_exp_f32 v52, v52
    v_mfma_f32_16x16x32_bf16 a[216:219], a[228:231], v[68:71], a[216:219]
    v_accvgpr_read_b32 v8, a244
    v_exp_f32 v53, v53
    v_mfma_f32_16x16x32_bf16 v[56:59], a[176:179], a[96:99], v[20:23]
    v_accvgpr_read_b32 v9, a245
    v_exp_f32 v54, v54
    v_mfma_f32_16x16x32_bf16 v[56:59], a[180:183], a[100:103], v[56:59]
    v_accvgpr_read_b32 v12, a246
    v_mfma_f32_16x16x32_bf16 v[56:59], a[184:187], a[104:107], v[56:59]
    ds_read_b128 a[164:167], v2 offset:64
    v_accvgpr_read_b32 v14, a247
    v_cvt_pk_bf16_f32 v82, v52, v53
    v_mfma_f32_16x16x32_bf16 v[56:59], a[188:191], a[108:111], v[56:59]
    s_waitcnt lgkmcnt(4)
    v_accvgpr_read_b32 v15, a248
    v_exp_f32 v55, v55
    v_mfma_f32_16x16x32_bf16 v[116:119], a[196:199], v[60:63], v[116:119]
    ds_read_b64_tr_b16 a[204:205], v3 offset:224
    v_cvt_pk_bf16_f32 v83, v54, v55
    v_mfma_f32_16x16x32_bf16 v[148:151], a[196:199], v[64:67], v[148:151]
    buffer_store_dwordx4 a[32:35], v13, s[24:27], s92 offen offset:0 sc1
    v_mfma_f32_16x16x32_bf16 v[180:183], a[196:199], v[68:71], v[180:183]
    ds_read_b64_tr_b16 a[206:207], v3 offset:736
    v_add_u32 v3, s47, v3
    v_mfma_f32_16x16x32_bf16 v[212:215], a[196:199], v[72:75], v[212:215]
    v_mfma_f32_16x16x32_bf16 v[244:247], a[196:199], v[76:79], v[244:247]
    ds_read_b128 a[168:171], v2 offset:128
    v_mfma_f32_16x16x32_bf16 a[220:223], a[228:231], v[72:75], a[220:223]
    v_exp_f32 v56, v56
    v_mfma_f32_16x16x32_bf16 v[36:39], a[176:179], a[112:115], v[24:27]
    v_exp_f32 v57, v57
    v_mfma_f32_16x16x32_bf16 v[36:39], a[180:183], a[116:119], v[36:39]
    s_add_u32 m0, s86, 0
    v_exp_f32 v58, v58
    v_mfma_f32_16x16x32_bf16 v[36:39], a[184:187], a[120:123], v[36:39]
    s_add_u32 s87, s81, 0
    buffer_load_dwordx4 v4, s[20:23], s87 offen offset:0 lds
    v_exp_f32 v59, v59
    v_mfma_f32_16x16x32_bf16 v[36:39], a[188:191], a[124:127], v[36:39]
    s_waitcnt lgkmcnt(5)
    v_cvt_pk_bf16_f32 v86, v56, v57
    v_cvt_pk_bf16_f32 v87, v58, v59
    v_mfma_f32_16x16x32_bf16 v[120:123], a[200:203], v[60:63], v[120:123]
    ds_read_b64_tr_b16 a[192:193], v3 offset:0
    v_mfma_f32_16x16x32_bf16 v[152:155], a[200:203], v[64:67], v[152:155]
    ds_read_b128 a[172:175], v2 offset:192
    v_mfma_f32_16x16x32_bf16 v[184:187], a[200:203], v[68:71], v[184:187]
    ds_read_b64_tr_b16 a[194:195], v3 offset:512
    v_mfma_f32_16x16x32_bf16 v[216:219], a[200:203], v[72:75], v[216:219]
    buffer_store_dwordx4 a[36:39], v13, s[24:27], s92 offen offset:1024 sc1
    v_mfma_f32_16x16x32_bf16 v[248:251], a[200:203], v[76:79], v[248:251]
    v_exp_f32 v36, v36
    v_mfma_f32_16x16x32_bf16 a[224:227], a[228:231], v[76:79], a[224:227]
    v_mfma_f32_16x16x32_bf16 v[40:43], a[176:179], a[128:131], v[28:31]
    v_exp_f32 v37, v37
    v_mfma_f32_16x16x32_bf16 v[40:43], a[180:183], a[132:135], v[40:43]
    buffer_load_dwordx4 v5, s[20:23], s87 offen offset:1024 lds
    v_exp_f32 v38, v38
    v_mfma_f32_16x16x32_bf16 v[40:43], a[184:187], a[136:139], v[40:43]
    v_exp_f32 v39, v39
    v_mfma_f32_16x16x32_bf16 v[40:43], a[188:191], a[140:143], v[40:43]
    s_waitcnt lgkmcnt(4)
    v_cvt_pk_bf16_f32 v90, v36, v37
    v_cvt_pk_bf16_f32 v91, v38, v39
    v_mfma_f32_16x16x32_bf16 v[124:127], a[204:207], v[60:63], v[124:127]
    ds_read_b64_tr_b16 a[196:197], v3 offset:32
    v_mfma_f32_16x16x32_bf16 v[156:159], a[204:207], v[64:67], v[156:159]
    v_mfma_f32_16x16x32_bf16 v[188:191], a[204:207], v[68:71], v[188:191]
    ds_read_b64_tr_b16 a[198:199], v3 offset:544
    v_mfma_f32_16x16x32_bf16 v[220:223], a[204:207], v[72:75], v[220:223]
    v_mfma_f32_16x16x32_bf16 v[252:255], a[204:207], v[76:79], v[252:255]
    v_exp_f32 v40, v40
    v_mfma_f32_16x16x32_bf16 v[44:47], a[160:163], a[80:83], v[16:19]
    v_exp_f32 v41, v41
    v_mfma_f32_16x16x32_bf16 v[44:47], a[164:167], a[84:87], v[44:47]
    s_waitcnt lgkmcnt(5)
    ds_read_b128 a[176:179], v2 offset:512
    v_cvt_pk_bf16_f32 v94, v40, v41
    v_mfma_f32_16x16x32_bf16 v[44:47], a[168:171], a[88:91], v[44:47]
    s_waitcnt lgkmcnt(4)
    buffer_load_dwordx4 v6, s[20:23], s87 offen offset:2048 lds
    v_exp_f32 v42, v42
    v_mfma_f32_16x16x32_bf16 v[44:47], a[172:175], a[92:95], v[44:47]
    s_waitcnt lgkmcnt(3)
    v_exp_f32 v43, v43
    v_mfma_f32_16x16x32_bf16 v[96:99], a[192:195], v[80:83], v[96:99]
    ds_read_b64_tr_b16 a[200:201], v3 offset:64
    v_cvt_pk_bf16_f32 v95, v42, v43
    v_mfma_f32_16x16x32_bf16 v[128:131], a[192:195], v[84:87], v[128:131]
    buffer_store_dwordx4 a[40:43], v13, s[24:27], s92 offen offset:2048 sc1
    v_mfma_f32_16x16x32_bf16 v[160:163], a[192:195], v[88:91], v[160:163]
    ds_read_b64_tr_b16 a[202:203], v3 offset:576
    v_mfma_f32_16x16x32_bf16 v[48:51], a[160:163], a[96:99], v[20:23]
    ds_read_b128 a[180:183], v2 offset:576
    v_mfma_f32_16x16x32_bf16 v[48:51], a[164:167], a[100:103], v[48:51]
    v_mfma_f32_16x16x32_bf16 v[48:51], a[168:171], a[104:107], v[48:51]
    v_exp_f32 v44, v44
    v_mfma_f32_16x16x32_bf16 v[48:51], a[172:175], a[108:111], v[48:51]
    buffer_load_dwordx4 v7, s[20:23], s87 offen offset:3072 lds
    v_exp_f32 v45, v45
    v_mfma_f32_16x16x32_bf16 v[192:195], a[192:195], v[92:95], v[192:195]
    s_waitcnt lgkmcnt(4)
    v_exp_f32 v46, v46
    v_mfma_f32_16x16x32_bf16 v[100:103], a[196:199], v[80:83], v[100:103]
    ds_read_b64_tr_b16 a[204:205], v3 offset:96
    v_cvt_pk_bf16_f32 v60, v44, v45
    v_mfma_f32_16x16x32_bf16 v[132:135], a[196:199], v[84:87], v[132:135]
    ds_read_b128 a[184:187], v2 offset:640
    v_mfma_f32_16x16x32_bf16 v[52:55], a[160:163], a[112:115], v[24:27]
    ds_read_b64_tr_b16 a[206:207], v3 offset:608
    v_mfma_f32_16x16x32_bf16 v[52:55], a[164:167], a[116:119], v[52:55]
    v_exp_f32 v47, v47
    v_mfma_f32_16x16x32_bf16 v[52:55], a[168:171], a[120:123], v[52:55]
    v_exp_f32 v48, v48
    v_mfma_f32_16x16x32_bf16 v[52:55], a[172:175], a[124:127], v[52:55]
    v_exp_f32 v49, v49
    v_mfma_f32_16x16x32_bf16 v[164:167], a[196:199], v[88:91], v[164:167]
    v_exp_f32 v50, v50
    v_mfma_f32_16x16x32_bf16 v[196:199], a[196:199], v[92:95], v[196:199]
    s_waitcnt lgkmcnt(4)
    ds_read_b128 a[188:191], v2 offset:704
    v_cvt_pk_bf16_f32 v61, v46, v47
    v_mfma_f32_16x16x32_bf16 v[104:107], a[200:203], v[80:83], v[104:107]
    s_add_u32 m0, s86, 4096
    ds_read_b64_tr_b16 a[192:193], v3 offset:128
    v_add_u32 v2, s47, v2
    v_mfma_f32_16x16x32_bf16 a[208:211], a[228:231], v[80:83], a[208:211]
    buffer_load_dwordx4 v8, s[20:23], s87 offen offset:0 lds
    v_exp_f32 v51, v51
    v_mfma_f32_16x16x32_bf16 v[56:59], a[160:163], a[128:131], v[28:31]
    ds_read_b64_tr_b16 a[194:195], v3 offset:640
    v_cvt_pk_bf16_f32 v64, v48, v49
    v_mfma_f32_16x16x32_bf16 v[56:59], a[164:167], a[132:135], v[56:59]
    v_exp_f32 v52, v52
    v_mfma_f32_16x16x32_bf16 v[56:59], a[168:171], a[136:139], v[56:59]
    v_exp_f32 v53, v53
    v_mfma_f32_16x16x32_bf16 v[56:59], a[172:175], a[140:143], v[56:59]
    v_exp_f32 v54, v54
    v_mfma_f32_16x16x32_bf16 v[136:139], a[200:203], v[84:87], v[136:139]
    buffer_store_dwordx4 a[44:47], v13, s[24:27], s92 offen offset:3072 sc1
    v_mfma_f32_16x16x32_bf16 v[168:171], a[200:203], v[88:91], v[168:171]
    v_exp_f32 v55, v55
    v_mfma_f32_16x16x32_bf16 v[200:203], a[200:203], v[92:95], v[200:203]
    buffer_load_dwordx4 v9, s[20:23], s87 offen offset:1024 lds
    v_cvt_pk_bf16_f32 v65, v50, v51
    v_cvt_pk_bf16_f32 v68, v52, v53
    v_mfma_f32_16x16x32_bf16 v[36:39], a[160:163], a[144:147], v[32:35]
    buffer_store_dwordx4 a[48:51], v13, s[24:27], s93 offen offset:0 sc1
    v_cvt_pk_bf16_f32 v69, v54, v55
    v_mfma_f32_16x16x32_bf16 v[36:39], a[164:167], a[148:151], v[36:39]
    v_exp_f32 v56, v56
    v_mfma_f32_16x16x32_bf16 v[36:39], a[168:171], a[152:155], v[36:39]
    v_exp_f32 v57, v57
    v_mfma_f32_16x16x32_bf16 v[36:39], a[172:175], a[156:159], v[36:39]
    s_waitcnt lgkmcnt(3)
    v_exp_f32 v58, v58
    v_mfma_f32_16x16x32_bf16 v[108:111], a[204:207], v[80:83], v[108:111]
    ds_read_b64_tr_b16 a[196:197], v3 offset:160
    v_cvt_pk_bf16_f32 v72, v56, v57
    v_mfma_f32_16x16x32_bf16 v[140:143], a[204:207], v[84:87], v[140:143]
    v_exp_f32 v59, v59
    v_mfma_f32_16x16x32_bf16 v[172:175], a[204:207], v[88:91], v[172:175]
    ds_read_b64_tr_b16 a[198:199], v3 offset:672
    v_cvt_pk_bf16_f32 v73, v58, v59
    v_mfma_f32_16x16x32_bf16 v[40:43], a[176:179], a[80:83], v[16:19]
    buffer_store_dwordx4 a[52:55], v13, s[24:27], s93 offen offset:1024 sc1
    v_mfma_f32_16x16x32_bf16 v[40:43], a[180:183], a[84:87], v[40:43]
    ds_read_b128 a[160:163], v2 offset:0
    v_mfma_f32_16x16x32_bf16 v[40:43], a[184:187], a[88:91], v[40:43]
    s_waitcnt lgkmcnt(5)
    buffer_load_dwordx4 v12, s[20:23], s87 offen offset:2048 lds
    v_exp_f32 v36, v36
    v_mfma_f32_16x16x32_bf16 v[40:43], a[188:191], a[92:95], v[40:43]
    v_exp_f32 v37, v37
    v_mfma_f32_16x16x32_bf16 v[204:207], a[204:207], v[92:95], v[204:207]
    s_waitcnt lgkmcnt(3)
    v_exp_f32 v38, v38
    v_mfma_f32_16x16x32_bf16 v[112:115], a[192:195], v[80:83], v[112:115]
    ds_read_b64_tr_b16 a[200:201], v3 offset:192
    v_cvt_pk_bf16_f32 v76, v36, v37
    v_mfma_f32_16x16x32_bf16 v[144:147], a[192:195], v[84:87], v[144:147]
    v_exp_f32 v39, v39
    v_mfma_f32_16x16x32_bf16 a[212:215], a[228:231], v[84:87], a[212:215]
    ds_read_b64_tr_b16 a[202:203], v3 offset:704
    v_cvt_pk_bf16_f32 v77, v38, v39
    v_mfma_f32_16x16x32_bf16 v[44:47], a[176:179], a[96:99], v[20:23]
    ds_read_b128 a[164:167], v2 offset:64
    v_mfma_f32_16x16x32_bf16 v[44:47], a[180:183], a[100:103], v[44:47]
    v_exp_f32 v40, v40
    v_mfma_f32_16x16x32_bf16 v[44:47], a[184:187], a[104:107], v[44:47]
    buffer_load_dwordx4 v14, s[20:23], s87 offen offset:3072 lds
    v_exp_f32 v41, v41
    v_mfma_f32_16x16x32_bf16 v[44:47], a[188:191], a[108:111], v[44:47]
    v_exp_f32 v42, v42
    v_mfma_f32_16x16x32_bf16 v[176:179], a[192:195], v[88:91], v[176:179]
    v_exp_f32 v43, v43
    v_mfma_f32_16x16x32_bf16 v[208:211], a[192:195], v[92:95], v[208:211]
    s_waitcnt lgkmcnt(4)
    ds_read_b128 a[168:171], v2 offset:128
    v_cvt_pk_bf16_f32 v62, v40, v41
    v_mfma_f32_16x16x32_bf16 v[116:119], a[196:199], v[80:83], v[116:119]
    ds_read_b64_tr_b16 a[204:205], v3 offset:224
    v_cvt_pk_bf16_f32 v63, v42, v43
    v_mfma_f32_16x16x32_bf16 v[48:51], a[176:179], a[112:115], v[24:27]
    buffer_store_dwordx4 a[56:59], v13, s[24:27], s93 offen offset:2048 sc1
    v_mfma_f32_16x16x32_bf16 v[48:51], a[180:183], a[116:119], v[48:51]
    ds_read_b64_tr_b16 a[206:207], v3 offset:736
    v_add_u32 v3, s50, v3
    v_mfma_f32_16x16x32_bf16 v[48:51], a[184:187], a[120:123], v[48:51]
    v_exp_f32 v44, v44
    v_mfma_f32_16x16x32_bf16 v[48:51], a[188:191], a[124:127], v[48:51]
    v_exp_f32 v45, v45
    v_mfma_f32_16x16x32_bf16 v[148:151], a[196:199], v[84:87], v[148:151]
    s_add_u32 m0, s86, 8192
    ds_read_b128 a[172:175], v2 offset:192
    v_cvt_pk_bf16_f32 v66, v44, v45
    v_mfma_f32_16x16x32_bf16 v[180:183], a[196:199], v[88:91], v[180:183]
    buffer_load_dwordx4 v15, s[20:23], s87 offen offset:0 lds
    v_exp_f32 v46, v46
    v_mfma_f32_16x16x32_bf16 v[212:215], a[196:199], v[92:95], v[212:215]
    s_add_u32 s94, s94, 1
    v_exp_f32 v47, v47
    v_mfma_f32_16x16x32_bf16 v[52:55], a[176:179], a[128:131], v[28:31]
    s_and_b32 s53, s94, 3
    v_cvt_pk_bf16_f32 v67, v46, v47
    v_mfma_f32_16x16x32_bf16 v[52:55], a[180:183], a[132:135], v[52:55]
    s_cmp_eq_u32 s53, 3
    v_exp_f32 v48, v48
    v_mfma_f32_16x16x32_bf16 v[52:55], a[184:187], a[136:139], v[52:55]
    s_waitcnt lgkmcnt(1)
    v_exp_f32 v49, v49
    v_mfma_f32_16x16x32_bf16 v[52:55], a[188:191], a[140:143], v[52:55]
    s_barrier
    v_exp_f32 v50, v50
    v_mfma_f32_16x16x32_bf16 v[120:123], a[200:203], v[80:83], v[120:123]
    s_cselect_b32 s50, s49, s48
    ds_read_b64_tr_b16 a[192:193], v3 offset:0
    v_cvt_pk_bf16_f32 v70, v48, v49
    v_mfma_f32_16x16x32_bf16 v[152:155], a[200:203], v[84:87], v[152:155]
    v_exp_f32 v51, v51
    v_mfma_f32_16x16x32_bf16 v[184:187], a[200:203], v[88:91], v[184:187]
    ds_read_b64_tr_b16 a[194:195], v3 offset:512
    v_cvt_pk_bf16_f32 v71, v50, v51
    v_mfma_f32_16x16x32_bf16 v[56:59], a[176:179], a[144:147], v[32:35]
    buffer_store_dwordx4 a[60:63], v13, s[24:27], s93 offen offset:3072 sc1
    v_mfma_f32_16x16x32_bf16 v[56:59], a[180:183], a[148:151], v[56:59]
    v_exp_f32 v52, v52
    v_mfma_f32_16x16x32_bf16 v[56:59], a[184:187], a[152:155], v[56:59]
    v_exp_f32 v53, v53
    v_mfma_f32_16x16x32_bf16 v[56:59], a[188:191], a[156:159], v[56:59]
    v_exp_f32 v54, v54
    v_mfma_f32_16x16x32_bf16 v[216:219], a[200:203], v[92:95], v[216:219]
    v_exp_f32 v55, v55
    v_mfma_f32_16x16x32_bf16 v[124:127], a[204:207], v[80:83], v[124:127]
    ds_read_b64_tr_b16 a[196:197], v3 offset:32
    v_cvt_pk_bf16_f32 v74, v52, v53
    v_mfma_f32_16x16x32_bf16 v[156:159], a[204:207], v[84:87], v[156:159]
    v_cvt_pk_bf16_f32 v75, v54, v55
    v_mfma_f32_16x16x32_bf16 v[188:191], a[204:207], v[88:91], v[188:191]
    ds_read_b64_tr_b16 a[198:199], v3 offset:544
    v_mfma_f32_16x16x32_bf16 v[220:223], a[204:207], v[92:95], v[220:223]
    v_exp_f32 v56, v56
    v_mfma_f32_16x16x32_bf16 a[216:219], a[228:231], v[88:91], a[216:219]
    v_exp_f32 v57, v57
    v_mfma_f32_16x16x32_bf16 a[220:223], a[228:231], v[92:95], a[220:223]
    v_mfma_f32_16x16x32_bf16 v[36:39], a[160:163], a[80:83], v[16:19]
    v_exp_f32 v58, v58
    v_mfma_f32_16x16x32_bf16 v[36:39], a[164:167], a[84:87], v[36:39]
    s_add_u32 m0, s86, 73728
    s_add_u32 s87, s82, 0
    ds_read_b128 a[176:179], v2 offset:512
    v_cvt_pk_bf16_f32 v78, v56, v57
    v_mfma_f32_16x16x32_bf16 v[36:39], a[168:171], a[88:91], v[36:39]
    s_waitcnt lgkmcnt(5)
    buffer_load_dwordx4 v4, s[20:23], s87 offen offset:0 lds
    v_exp_f32 v59, v59
    v_mfma_f32_16x16x32_bf16 v[36:39], a[172:175], a[92:95], v[36:39]
    s_waitcnt lgkmcnt(3)
    v_cvt_pk_bf16_f32 v79, v58, v59
    v_mfma_f32_16x16x32_bf16 v[96:99], a[192:195], v[60:63], v[96:99]
    v_mfma_f32_16x16x32_bf16 v[128:131], a[192:195], v[64:67], v[128:131]
    ds_read_b64_tr_b16 a[200:201], v3 offset:64
    v_mfma_f32_16x16x32_bf16 v[160:163], a[192:195], v[68:71], v[160:163]
    buffer_load_dwordx4 v5, s[20:23], s87 offen offset:1024 lds
    v_mfma_f32_16x16x32_bf16 v[192:195], a[192:195], v[72:75], v[192:195]
    ds_read_b64_tr_b16 a[202:203], v3 offset:576
    v_mfma_f32_16x16x32_bf16 v[224:227], a[192:195], v[76:79], v[224:227]
    ds_read_b128 a[180:183], v2 offset:576
    v_mfma_f32_16x16x32_bf16 v[40:43], a[160:163], a[96:99], v[20:23]
    v_exp_f32 v36, v36
    v_mfma_f32_16x16x32_bf16 v[40:43], a[164:167], a[100:103], v[40:43]
    buffer_load_dwordx4 v6, s[20:23], s87 offen offset:2048 lds
    v_exp_f32 v37, v37
    v_mfma_f32_16x16x32_bf16 v[40:43], a[168:171], a[104:107], v[40:43]
    v_exp_f32 v38, v38
    v_mfma_f32_16x16x32_bf16 v[40:43], a[172:175], a[108:111], v[40:43]
    s_waitcnt lgkmcnt(4)
    v_exp_f32 v39, v39
    v_mfma_f32_16x16x32_bf16 v[100:103], a[196:199], v[60:63], v[100:103]
    ds_read_b64_tr_b16 a[204:205], v3 offset:96
    v_cvt_pk_bf16_f32 v80, v36, v37
    v_mfma_f32_16x16x32_bf16 v[132:135], a[196:199], v[64:67], v[132:135]
    buffer_load_dwordx4 v7, s[20:23], s87 offen offset:3072 lds
    v_mfma_f32_16x16x32_bf16 v[164:167], a[196:199], v[68:71], v[164:167]
    ds_read_b64_tr_b16 a[206:207], v3 offset:608
    v_cvt_pk_bf16_f32 v81, v38, v39
    v_mfma_f32_16x16x32_bf16 v[196:199], a[196:199], v[72:75], v[196:199]
    ds_read_b128 a[184:187], v2 offset:640
    v_mfma_f32_16x16x32_bf16 v[228:231], a[196:199], v[76:79], v[228:231]
    s_add_u32 m0, s86, 77824
    v_exp_f32 v40, v40
    v_mfma_f32_16x16x32_bf16 v[44:47], a[160:163], a[112:115], v[24:27]
    buffer_load_dwordx4 v8, s[20:23], s87 offen offset:0 lds
    v_exp_f32 v41, v41
    v_mfma_f32_16x16x32_bf16 v[44:47], a[164:167], a[116:119], v[44:47]
    ds_read_b128 a[188:191], v2 offset:704
    v_cvt_pk_bf16_f32 v84, v40, v41
    v_mfma_f32_16x16x32_bf16 v[44:47], a[168:171], a[120:123], v[44:47]
    v_add_u32 v2, s50, v2
    v_mfma_f32_16x16x32_bf16 v[44:47], a[172:175], a[124:127], v[44:47]
    s_waitcnt lgkmcnt(5)
    v_exp_f32 v42, v42
    v_mfma_f32_16x16x32_bf16 v[104:107], a[200:203], v[60:63], v[104:107]
    ds_read_b64_tr_b16 a[192:193], v3 offset:128
    v_mfma_f32_16x16x32_bf16 v[136:139], a[200:203], v[64:67], v[136:139]
    buffer_load_dwordx4 v9, s[20:23], s87 offen offset:1024 lds
    v_exp_f32 v43, v43
    v_mfma_f32_16x16x32_bf16 v[168:171], a[200:203], v[68:71], v[168:171]
    v_mfma_f32_16x16x32_bf16 v[200:203], a[200:203], v[72:75], v[200:203]
    ds_read_b64_tr_b16 a[194:195], v3 offset:640
    v_cvt_pk_bf16_f32 v85, v42, v43
    v_mfma_f32_16x16x32_bf16 v[232:235], a[200:203], v[76:79], v[232:235]
    buffer_load_dwordx4 v12, s[20:23], s87 offen offset:2048 lds
    v_exp_f32 v44, v44
    v_mfma_f32_16x16x32_bf16 a[208:211], a[228:231], v[60:63], a[208:211]
    v_exp_f32 v45, v45
    v_mfma_f32_16x16x32_bf16 v[48:51], a[160:163], a[128:131], v[28:31]
    v_exp_f32 v46, v46
    v_mfma_f32_16x16x32_bf16 v[48:51], a[164:167], a[132:135], v[48:51]
    v_exp_f32 v47, v47
    v_mfma_f32_16x16x32_bf16 v[48:51], a[168:171], a[136:139], v[48:51]
    buffer_load_dwordx4 v14, s[20:23], s87 offen offset:3072 lds
    v_cvt_pk_bf16_f32 v88, v44, v45
    v_cvt_pk_bf16_f32 v89, v46, v47
    v_mfma_f32_16x16x32_bf16 v[48:51], a[172:175], a[140:143], v[48:51]
    s_waitcnt lgkmcnt(4)
    v_mfma_f32_16x16x32_bf16 v[108:111], a[204:207], v[60:63], v[108:111]
    ds_read_b64_tr_b16 a[196:197], v3 offset:160
    v_mfma_f32_16x16x32_bf16 v[140:143], a[204:207], v[64:67], v[140:143]
    s_add_u32 m0, s86, 81920
    v_mfma_f32_16x16x32_bf16 v[172:175], a[204:207], v[68:71], v[172:175]
    buffer_load_dwordx4 v15, s[20:23], s87 offen offset:0 lds
    v_mfma_f32_16x16x32_bf16 v[204:207], a[204:207], v[72:75], v[204:207]
    ds_read_b64_tr_b16 a[198:199], v3 offset:672
    v_mfma_f32_16x16x32_bf16 v[236:239], a[204:207], v[76:79], v[236:239]
    v_exp_f32 v48, v48
    v_mfma_f32_16x16x32_bf16 a[212:215], a[228:231], v[64:67], a[212:215]
    v_exp_f32 v49, v49
    v_mfma_f32_16x16x32_bf16 v[52:55], a[176:179], a[80:83], v[16:19]
    v_exp_f32 v50, v50
    v_mfma_f32_16x16x32_bf16 v[52:55], a[180:183], a[84:87], v[52:55]
    s_waitcnt lgkmcnt(5)
    v_exp_f32 v51, v51
    v_mfma_f32_16x16x32_bf16 v[52:55], a[184:187], a[88:91], v[52:55]
    s_waitcnt lgkmcnt(4)
    v_cvt_pk_bf16_f32 v92, v48, v49
    v_cvt_pk_bf16_f32 v93, v50, v51
    v_mfma_f32_16x16x32_bf16 v[52:55], a[188:191], a[92:95], v[52:55]
    s_waitcnt lgkmcnt(2)
    v_mfma_f32_16x16x32_bf16 v[112:115], a[192:195], v[60:63], v[112:115]
    s_barrier
    ds_read_b64_tr_b16 a[200:201], v3 offset:192
    v_mfma_f32_16x16x32_bf16 v[144:147], a[192:195], v[64:67], v[144:147]
    v_mfma_f32_16x16x32_bf16 v[176:179], a[192:195], v[68:71], v[176:179]
    s_add_u32 m0, s86, 36864
    ds_read_b64_tr_b16 a[202:203], v3 offset:704
    v_mfma_f32_16x16x32_bf16 v[208:211], a[192:195], v[72:75], v[208:211]
    s_add_u32 s87, s81, 147456
    buffer_load_dwordx4 v4, s[20:23], s87 offen offset:0 lds
    v_mfma_f32_16x16x32_bf16 v[240:243], a[192:195], v[76:79], v[240:243]
    v_exp_f32 v52, v52
    v_mfma_f32_16x16x32_bf16 a[216:219], a[228:231], v[68:71], a[216:219]
    v_exp_f32 v53, v53
    v_mfma_f32_16x16x32_bf16 v[56:59], a[176:179], a[96:99], v[20:23]
    v_exp_f32 v54, v54
    v_mfma_f32_16x16x32_bf16 v[56:59], a[180:183], a[100:103], v[56:59]
    v_mfma_f32_16x16x32_bf16 v[56:59], a[184:187], a[104:107], v[56:59]
    v_cvt_pk_bf16_f32 v82, v52, v53
    v_mfma_f32_16x16x32_bf16 v[56:59], a[188:191], a[108:111], v[56:59]
    s_waitcnt lgkmcnt(2)
    buffer_load_dwordx4 v5, s[20:23], s87 offen offset:1024 lds
    v_exp_f32 v55, v55
    v_mfma_f32_16x16x32_bf16 v[116:119], a[196:199], v[60:63], v[116:119]
    ds_read_b64_tr_b16 a[204:205], v3 offset:224
    v_cvt_pk_bf16_f32 v83, v54, v55
    v_mfma_f32_16x16x32_bf16 v[148:151], a[196:199], v[64:67], v[148:151]
    v_mfma_f32_16x16x32_bf16 v[180:183], a[196:199], v[68:71], v[180:183]
    ds_read_b64_tr_b16 a[206:207], v3 offset:736
    v_add_u32 v3, s47, v3
    v_mfma_f32_16x16x32_bf16 v[212:215], a[196:199], v[72:75], v[212:215]
    v_mfma_f32_16x16x32_bf16 v[244:247], a[196:199], v[76:79], v[244:247]
    v_mfma_f32_16x16x32_bf16 a[220:223], a[228:231], v[72:75], a[220:223]
    buffer_load_dwordx4 v6, s[20:23], s87 offen offset:2048 lds
    v_exp_f32 v56, v56
    v_mfma_f32_16x16x32_bf16 v[36:39], a[176:179], a[112:115], v[24:27]
    v_exp_f32 v57, v57
    v_mfma_f32_16x16x32_bf16 v[36:39], a[180:183], a[116:119], v[36:39]
    v_exp_f32 v58, v58
    v_mfma_f32_16x16x32_bf16 v[36:39], a[184:187], a[120:123], v[36:39]
    v_exp_f32 v59, v59
    v_mfma_f32_16x16x32_bf16 v[36:39], a[188:191], a[124:127], v[36:39]
    s_waitcnt lgkmcnt(2)
    v_cvt_pk_bf16_f32 v86, v56, v57
    v_cvt_pk_bf16_f32 v87, v58, v59
    v_mfma_f32_16x16x32_bf16 v[120:123], a[200:203], v[60:63], v[120:123]
    ds_read_b64_tr_b16 a[192:193], v3 offset:0
    v_mfma_f32_16x16x32_bf16 v[152:155], a[200:203], v[64:67], v[152:155]
    buffer_load_dwordx4 v7, s[20:23], s87 offen offset:3072 lds
    v_mfma_f32_16x16x32_bf16 v[184:187], a[200:203], v[68:71], v[184:187]
    ds_read_b64_tr_b16 a[194:195], v3 offset:512
    v_mfma_f32_16x16x32_bf16 v[216:219], a[200:203], v[72:75], v[216:219]
    v_mfma_f32_16x16x32_bf16 v[248:251], a[200:203], v[76:79], v[248:251]
    v_exp_f32 v36, v36
    v_mfma_f32_16x16x32_bf16 a[224:227], a[228:231], v[76:79], a[224:227]
    v_mfma_f32_16x16x32_bf16 v[40:43], a[176:179], a[128:131], v[28:31]
    s_add_u32 m0, s86, 40960
    v_exp_f32 v37, v37
    v_mfma_f32_16x16x32_bf16 v[40:43], a[180:183], a[132:135], v[40:43]
    buffer_load_dwordx4 v8, s[20:23], s87 offen offset:0 lds
    v_exp_f32 v38, v38
    v_mfma_f32_16x16x32_bf16 v[40:43], a[184:187], a[136:139], v[40:43]
    v_exp_f32 v39, v39
    v_mfma_f32_16x16x32_bf16 v[40:43], a[188:191], a[140:143], v[40:43]
    s_waitcnt lgkmcnt(2)
    v_cvt_pk_bf16_f32 v90, v36, v37
    v_cvt_pk_bf16_f32 v91, v38, v39
    v_mfma_f32_16x16x32_bf16 v[124:127], a[204:207], v[60:63], v[124:127]
    ds_read_b64_tr_b16 a[196:197], v3 offset:32
    v_mfma_f32_16x16x32_bf16 v[156:159], a[204:207], v[64:67], v[156:159]
    v_mfma_f32_16x16x32_bf16 v[188:191], a[204:207], v[68:71], v[188:191]
    ds_read_b64_tr_b16 a[198:199], v3 offset:544
    v_mfma_f32_16x16x32_bf16 v[220:223], a[204:207], v[72:75], v[220:223]
    buffer_load_dwordx4 v9, s[20:23], s87 offen offset:1024 lds
    v_mfma_f32_16x16x32_bf16 v[252:255], a[204:207], v[76:79], v[252:255]
    s_waitcnt lgkmcnt(2)
    v_exp_f32 v40, v40
    v_exp_f32 v41, v41
    s_nop 0
    v_cvt_pk_bf16_f32 v94, v40, v41
    v_exp_f32 v42, v42
    v_exp_f32 v43, v43
    v_mfma_f32_16x16x32_bf16 v[96:99], a[192:195], v[80:83], v[96:99]
    ds_read_b64_tr_b16 a[200:201], v3 offset:64
    v_cvt_pk_bf16_f32 v95, v42, v43
    v_mfma_f32_16x16x32_bf16 v[128:131], a[192:195], v[84:87], v[128:131]
    v_mfma_f32_16x16x32_bf16 v[160:163], a[192:195], v[88:91], v[160:163]
    ds_read_b64_tr_b16 a[202:203], v3 offset:576
    v_mfma_f32_16x16x32_bf16 v[192:195], a[192:195], v[92:95], v[192:195]
    s_waitcnt lgkmcnt(2)
    v_mfma_f32_16x16x32_bf16 v[100:103], a[196:199], v[80:83], v[100:103]
    ds_read_b64_tr_b16 a[204:205], v3 offset:96
    v_mfma_f32_16x16x32_bf16 v[132:135], a[196:199], v[84:87], v[132:135]
    ds_read_b64_tr_b16 a[206:207], v3 offset:608
    v_mfma_f32_16x16x32_bf16 v[164:167], a[196:199], v[88:91], v[164:167]
    buffer_load_dwordx4 v12, s[20:23], s87 offen offset:2048 lds
    v_mfma_f32_16x16x32_bf16 v[196:199], a[196:199], v[92:95], v[196:199]
    s_waitcnt lgkmcnt(2)
    v_mfma_f32_16x16x32_bf16 v[104:107], a[200:203], v[80:83], v[104:107]
    ds_read_b64_tr_b16 a[192:193], v3 offset:128
    v_mfma_f32_16x16x32_bf16 a[208:211], a[228:231], v[80:83], a[208:211]
    ds_read_b64_tr_b16 a[194:195], v3 offset:640
    v_mfma_f32_16x16x32_bf16 v[136:139], a[200:203], v[84:87], v[136:139]
    buffer_load_dwordx4 v14, s[20:23], s87 offen offset:3072 lds
    v_mfma_f32_16x16x32_bf16 v[168:171], a[200:203], v[88:91], v[168:171]
    v_mfma_f32_16x16x32_bf16 v[200:203], a[200:203], v[92:95], v[200:203]
    s_waitcnt lgkmcnt(2)
    v_mfma_f32_16x16x32_bf16 v[108:111], a[204:207], v[80:83], v[108:111]
    ds_read_b64_tr_b16 a[196:197], v3 offset:160
    v_mfma_f32_16x16x32_bf16 v[140:143], a[204:207], v[84:87], v[140:143]
    v_mfma_f32_16x16x32_bf16 v[172:175], a[204:207], v[88:91], v[172:175]
    s_add_u32 m0, s86, 45056
    ds_read_b64_tr_b16 a[198:199], v3 offset:672
    v_mfma_f32_16x16x32_bf16 v[204:207], a[204:207], v[92:95], v[204:207]
    s_waitcnt lgkmcnt(2)
    buffer_load_dwordx4 v15, s[20:23], s87 offen offset:0 lds
    v_mfma_f32_16x16x32_bf16 v[112:115], a[192:195], v[80:83], v[112:115]
    ds_read_b64_tr_b16 a[200:201], v3 offset:192
    v_mfma_f32_16x16x32_bf16 v[144:147], a[192:195], v[84:87], v[144:147]
    v_mfma_f32_16x16x32_bf16 a[212:215], a[228:231], v[84:87], a[212:215]
    ds_read_b64_tr_b16 a[202:203], v3 offset:704
    v_mfma_f32_16x16x32_bf16 v[176:179], a[192:195], v[88:91], v[176:179]
    v_mfma_f32_16x16x32_bf16 v[208:211], a[192:195], v[92:95], v[208:211]
    s_waitcnt lgkmcnt(2)
    v_mfma_f32_16x16x32_bf16 v[116:119], a[196:199], v[80:83], v[116:119]
    ds_read_b64_tr_b16 a[204:205], v3 offset:224
    ds_read_b64_tr_b16 a[206:207], v3 offset:736
    v_add_u32 v3, s50, v3
    v_mfma_f32_16x16x32_bf16 v[148:151], a[196:199], v[84:87], v[148:151]
    v_mfma_f32_16x16x32_bf16 v[180:183], a[196:199], v[88:91], v[180:183]
    v_mfma_f32_16x16x32_bf16 v[212:215], a[196:199], v[92:95], v[212:215]
    s_waitcnt lgkmcnt(2)
    v_mfma_f32_16x16x32_bf16 v[120:123], a[200:203], v[80:83], v[120:123]
    v_mfma_f32_16x16x32_bf16 v[152:155], a[200:203], v[84:87], v[152:155]
    v_mfma_f32_16x16x32_bf16 v[184:187], a[200:203], v[88:91], v[184:187]
    v_mfma_f32_16x16x32_bf16 v[216:219], a[200:203], v[92:95], v[216:219]
    s_waitcnt lgkmcnt(0)
    v_mfma_f32_16x16x32_bf16 v[124:127], a[204:207], v[80:83], v[124:127]
    v_mfma_f32_16x16x32_bf16 v[156:159], a[204:207], v[84:87], v[156:159]
    v_mfma_f32_16x16x32_bf16 v[188:191], a[204:207], v[88:91], v[188:191]
    v_mfma_f32_16x16x32_bf16 v[220:223], a[204:207], v[92:95], v[220:223]
    v_mfma_f32_16x16x32_bf16 a[216:219], a[228:231], v[88:91], a[216:219]
    v_mfma_f32_16x16x32_bf16 a[220:223], a[228:231], v[92:95], a[220:223]
L_hepi1:
    s_nop 7
    v_accvgpr_read_b32 v8, a224
    v_accvgpr_read_b32 v4, a208
    v_accvgpr_read_b32 v5, a212
    v_accvgpr_read_b32 v6, a216
    v_accvgpr_read_b32 v7, a220
    v_mov_b32 v36, v4
    v_mov_b32 v37, v5
    v_mov_b32 v38, v6
    v_mov_b32 v39, v7
    v_mov_b32 v40, v8
    v_permlane32_swap_b32 v36, v4
    v_permlane32_swap_b32 v37, v5
    v_permlane32_swap_b32 v38, v6
    v_permlane32_swap_b32 v39, v7
    v_permlane32_swap_b32 v40, v8
    v_add_f32 v4, v4, v36
    v_add_f32 v5, v5, v37
    v_add_f32 v6, v6, v38
    v_add_f32 v7, v7, v39
    v_add_f32 v8, v8, v40
    v_mov_b32 v36, v4
    v_mov_b32 v37, v5
    v_mov_b32 v38, v6
    v_mov_b32 v39, v7
    v_mov_b32 v40, v8
    v_permlane16_swap_b32 v36, v4
    v_permlane16_swap_b32 v37, v5
    v_permlane16_swap_b32 v38, v6
    v_permlane16_swap_b32 v39, v7
    v_permlane16_swap_b32 v40, v8
    v_add_f32 v4, v4, v36
    v_add_f32 v5, v5, v37
    v_add_f32 v6, v6, v38
    v_add_f32 v7, v7, v39
    v_add_f32 v8, v8, v40
    v_add_f32 v10, v4, v5
    v_add_f32 v11, v6, v7
    v_add_f32 v10, v10, v8
    v_add_f32 v10, v10, v11
    v_cmp_nge_f32 vcc, s58, v10
    s_cmp_lg_u64 vcc, 0
    s_cselect_b32 s3, 1, 0
    v_mov_b32 v12, s3
    s_lshl_b32 s3, s36, 2
    s_add_u32 s3, s3, 158720
    v_mov_b32 v13, s3
    ds_write_b32 v13, v12
    v_add_u32 v9, 139264, v1
    v_xor_b32 v10, 4096, v1
    v_add_u32 v10, 139264, v10
    v_lshrrev_b32 v11, 1, v1
    v_and_b32 v11, 0x1f8, v11
    s_lshl_b32 s3, s36, 9
    s_add_u32 s3, s3, 156672
    v_add_u32 v11, s3, v11
    v_mov_b32 v12, v8
    v_mov_b32 v13, v32
    ds_write_b64 v11, v[12:13]
    v_xor_b32 v11, 512, v11
    s_cmp_eq_u32 s37, 1
    s_cbranch_scc1 L_he1_1
    ds_write_b128 v10, v[240:243] offset:0
    ds_write_b128 v10, v[244:247] offset:1024
    ds_write_b128 v10, v[248:251] offset:2048
    ds_write_b128 v10, v[252:255] offset:3072
    s_branch L_he2_1
L_he1_1:
    ds_write_b128 v10, v[224:227] offset:0
    ds_write_b128 v10, v[228:231] offset:1024
    ds_write_b128 v10, v[232:235] offset:2048
    ds_write_b128 v10, v[236:239] offset:3072
    s_nop 1
    v_mov_b32 v224, v240
    v_mov_b32 v225, v241
    v_mov_b32 v226, v242
    v_mov_b32 v227, v243
    v_mov_b32 v228, v244
    v_mov_b32 v229, v245
    v_mov_b32 v230, v246
    v_mov_b32 v231, v247
    v_mov_b32 v232, v248
    v_mov_b32 v233, v249
    v_mov_b32 v234, v250
    v_mov_b32 v235, v251
    v_mov_b32 v236, v252
    v_mov_b32 v237, v253
    v_mov_b32 v238, v254
    v_mov_b32 v239, v255
L_he2_1:
    v_rcp_f32 v4, v4
    v_rcp_f32 v5, v5
    v_rcp_f32 v6, v6
    v_rcp_f32 v7, v7
    s_waitcnt vmcnt(18) lgkmcnt(0)
    s_barrier
    s_cmp_lg_u32 s36, 0
    s_cbranch_scc1 L_pub1
    v_accvgpr_write_b32 a255, 1
    buffer_store_dword a255, off, s[24:27], s71 sc1
L_pub1:
    v_mov_b32 v14, 158720
    ds_read_b128 v[36:39], v14
    ds_read_b64 v[14:15], v11
    ds_read_b128 v[240:243], v9 offset:0
    ds_read_b128 v[244:247], v9 offset:1024
    ds_read_b128 v[248:251], v9 offset:2048
    ds_read_b128 v[252:255], v9 offset:3072
    s_waitcnt lgkmcnt(5)
    v_or3_b32 v36, v36, v37, v38
    v_or_b32 v36, v36, v39
    s_nop 0
    v_readfirstlane_b32 s3, v36
    s_andn2_b32 s3, s3, s62
    s_cbranch_scc1 L_redo1
    s_mov_b32 s62, 0
    s_waitcnt lgkmcnt(4)
    v_min_f32 v11, v13, v15
    v_sub_f32 v13, v11, v13
    v_sub_f32 v15, v11, v15
    v_exp_f32 v13, v13
    v_exp_f32 v15, v15
    s_nop 0
    v_mul_f32 v12, v12, v13
    v_fmac_f32 v12, v14, v15
    v_rcp_f32 v12, v12
    s_nop 0
    v_mul_f32 v14, v12, v15
    v_mul_f32 v12, v12, v13
    v_pk_mul_f32 v[224:225], v[224:225], v[12:13] op_sel_hi:[1,0]
    v_pk_mul_f32 v[226:227], v[226:227], v[12:13] op_sel_hi:[1,0]
    v_pk_mul_f32 v[228:229], v[228:229], v[12:13] op_sel_hi:[1,0]
    v_pk_mul_f32 v[230:231], v[230:231], v[12:13] op_sel_hi:[1,0]
    v_pk_mul_f32 v[232:233], v[232:233], v[12:13] op_sel_hi:[1,0]
    v_pk_mul_f32 v[234:235], v[234:235], v[12:13] op_sel_hi:[1,0]
    v_pk_mul_f32 v[236:237], v[236:237], v[12:13] op_sel_hi:[1,0]
    v_pk_mul_f32 v[238:239], v[238:239], v[12:13] op_sel_hi:[1,0]
    s_waitcnt lgkmcnt(3)
    v_pk_fma_f32 v[224:225], v[240:241], v[14:15], v[224:225] op_sel_hi:[1,0,1]
    v_pk_fma_f32 v[226:227], v[242:243], v[14:15], v[226:227] op_sel_hi:[1,0,1]
    s_waitcnt lgkmcnt(2)
    v_pk_fma_f32 v[228:229], v[244:245], v[14:15], v[228:229] op_sel_hi:[1,0,1]
    v_pk_fma_f32 v[230:231], v[246:247], v[14:15], v[230:231] op_sel_hi:[1,0,1]
    s_waitcnt lgkmcnt(1)
    v_pk_fma_f32 v[232:233], v[248:249], v[14:15], v[232:233] op_sel_hi:[1,0,1]
    v_pk_fma_f32 v[234:235], v[250:251], v[14:15], v[234:235] op_sel_hi:[1,0,1]
    s_waitcnt lgkmcnt(0)
    v_pk_fma_f32 v[236:237], v[252:253], v[14:15], v[236:237] op_sel_hi:[1,0,1]
    v_pk_fma_f32 v[238:239], v[254:255], v[14:15], v[238:239] op_sel_hi:[1,0,1]
    v_cvt_pk_bf16_f32 v224, v224, v225
    v_cvt_pk_bf16_f32 v225, v226, v227
    v_cvt_pk_bf16_f32 v226, v228, v229
    v_cvt_pk_bf16_f32 v227, v230, v231
    v_cvt_pk_bf16_f32 v228, v232, v233
    v_cvt_pk_bf16_f32 v229, v234, v235
    v_cvt_pk_bf16_f32 v230, v236, v237
    v_cvt_pk_bf16_f32 v231, v238, v239
    v_and_b32 v13, 0x3ff, v1
    s_lshl_b32 s3, s37, 11
    s_add_u32 s3, s3, s65
    s_add_u32 s3, s3, 73728
    ds_write_b128 v9, v[224:227] offset:0
    buffer_store_dwordx4 v[224:227], v13, s[24:27], s3 offen offset:0 sc1
    ds_write_b128 v9, v[228:231] offset:1024
    buffer_store_dwordx4 v[228:231], v13, s[24:27], s3 offen offset:1024 sc1
    s_add_u32 s90, s64, 73728
    s_add_u32 s91, s64, 77824
    s_add_u32 s92, s64, 81920
    s_add_u32 s93, s64, 86016
    s_add_u32 s3, s64, 73728
    v_pk_mul_f32 v[96:97], v[96:97], v[4:5] op_sel_hi:[1,0]
    v_pk_mul_f32 v[98:99], v[98:99], v[4:5] op_sel_hi:[1,0]
    v_pk_mul_f32 v[100:101], v[100:101], v[4:5] op_sel_hi:[1,0]
    v_pk_mul_f32 v[102:103], v[102:103], v[4:5] op_sel_hi:[1,0]
    v_cvt_pk_bf16_f32 v16, v96, v97
    v_cvt_pk_bf16_f32 v17, v98, v99
    v_cvt_pk_bf16_f32 v18, v100, v101
    v_cvt_pk_bf16_f32 v19, v102, v103
    v_pk_mul_f32 v[104:105], v[104:105], v[4:5] op_sel_hi:[1,0]
    v_pk_mul_f32 v[106:107], v[106:107], v[4:5] op_sel_hi:[1,0]
    v_pk_mul_f32 v[108:109], v[108:109], v[4:5] op_sel_hi:[1,0]
    v_pk_mul_f32 v[110:111], v[110:111], v[4:5] op_sel_hi:[1,0]
    v_cvt_pk_bf16_f32 v20, v104, v105
    v_cvt_pk_bf16_f32 v21, v106, v107
    v_cvt_pk_bf16_f32 v22, v108, v109
    v_cvt_pk_bf16_f32 v23, v110, v111
    v_pk_mul_f32 v[112:113], v[112:113], v[4:5] op_sel_hi:[1,0]
    v_pk_mul_f32 v[114:115], v[114:115], v[4:5] op_sel_hi:[1,0]
    v_pk_mul_f32 v[116:117], v[116:117], v[4:5] op_sel_hi:[1,0]
    v_pk_mul_f32 v[118:119], v[118:119], v[4:5] op_sel_hi:[1,0]
    v_cvt_pk_bf16_f32 v24, v112, v113
    v_cvt_pk_bf16_f32 v25, v114, v115
    v_cvt_pk_bf16_f32 v26, v116, v117
    v_cvt_pk_bf16_f32 v27, v118, v119
    buffer_store_dwordx4 v[16:19], v13, s[24:27], s90 offen offset:0 sc1
    v_pk_mul_f32 v[120:121], v[120:121], v[4:5] op_sel_hi:[1,0]
    v_pk_mul_f32 v[122:123], v[122:123], v[4:5] op_sel_hi:[1,0]
    v_pk_mul_f32 v[124:125], v[124:125], v[4:5] op_sel_hi:[1,0]
    v_pk_mul_f32 v[126:127], v[126:127], v[4:5] op_sel_hi:[1,0]
    v_cvt_pk_bf16_f32 v28, v120, v121
    v_cvt_pk_bf16_f32 v29, v122, v123
    v_cvt_pk_bf16_f32 v30, v124, v125
    v_cvt_pk_bf16_f32 v31, v126, v127
    s_add_u32 s3, s64, 77824
    v_pk_mul_f32 v[128:129], v[128:129], v[4:5] op_sel:[0,1] op_sel_hi:[1,1]
    v_pk_mul_f32 v[130:131], v[130:131], v[4:5] op_sel:[0,1] op_sel_hi:[1,1]
    v_pk_mul_f32 v[132:133], v[132:133], v[4:5] op_sel:[0,1] op_sel_hi:[1,1]
    v_pk_mul_f32 v[134:135], v[134:135], v[4:5] op_sel:[0,1] op_sel_hi:[1,1]
    v_cvt_pk_bf16_f32 v32, v128, v129
    v_cvt_pk_bf16_f32 v33, v130, v131
    v_cvt_pk_bf16_f32 v34, v132, v133
    v_cvt_pk_bf16_f32 v35, v134, v135
    v_pk_mul_f32 v[136:137], v[136:137], v[4:5] op_sel:[0,1] op_sel_hi:[1,1]
    v_pk_mul_f32 v[138:139], v[138:139], v[4:5] op_sel:[0,1] op_sel_hi:[1,1]
    v_pk_mul_f32 v[140:141], v[140:141], v[4:5] op_sel:[0,1] op_sel_hi:[1,1]
    v_pk_mul_f32 v[142:143], v[142:143], v[4:5] op_sel:[0,1] op_sel_hi:[1,1]
    v_cvt_pk_bf16_f32 v36, v136, v137
    v_cvt_pk_bf16_f32 v37, v138, v139
    v_cvt_pk_bf16_f32 v38, v140, v141
    v_cvt_pk_bf16_f32 v39, v142, v143
    buffer_store_dwordx4 v[20:23], v13, s[24:27], s90 offen offset:1024 sc1
    v_pk_mul_f32 v[144:145], v[144:145], v[4:5] op_sel:[0,1] op_sel_hi:[1,1]
    v_pk_mul_f32 v[146:147], v[146:147], v[4:5] op_sel:[0,1] op_sel_hi:[1,1]
    v_pk_mul_f32 v[148:149], v[148:149], v[4:5] op_sel:[0,1] op_sel_hi:[1,1]
    v_pk_mul_f32 v[150:151], v[150:151], v[4:5] op_sel:[0,1] op_sel_hi:[1,1]
    v_cvt_pk_bf16_f32 v40, v144, v145
    v_cvt_pk_bf16_f32 v41, v146, v147
    v_cvt_pk_bf16_f32 v42, v148, v149
    v_cvt_pk_bf16_f32 v43, v150, v151
    v_pk_mul_f32 v[152:153], v[152:153], v[4:5] op_sel:[0,1] op_sel_hi:[1,1]
    v_pk_mul_f32 v[154:155], v[154:155], v[4:5] op_sel:[0,1] op_sel_hi:[1,1]
    v_pk_mul_f32 v[156:157], v[156:157], v[4:5] op_sel:[0,1] op_sel_hi:[1,1]
    v_pk_mul_f32 v[158:159], v[158:159], v[4:5] op_sel:[0,1] op_sel_hi:[1,1]
    v_cvt_pk_bf16_f32 v44, v152, v153
    v_cvt_pk_bf16_f32 v45, v154, v155
    v_cvt_pk_bf16_f32 v46, v156, v157
    v_cvt_pk_bf16_f32 v47, v158, v159
    buffer_store_dwordx4 v[24:27], v13, s[24:27], s90 offen offset:2048 sc1
    s_add_u32 s3, s64, 81920
    v_pk_mul_f32 v[160:161], v[160:161], v[6:7] op_sel_hi:[1,0]
    v_pk_mul_f32 v[162:163], v[162:163], v[6:7] op_sel_hi:[1,0]
    v_pk_mul_f32 v[164:165], v[164:165], v[6:7] op_sel_hi:[1,0]
    v_pk_mul_f32 v[166:167], v[166:167], v[6:7] op_sel_hi:[1,0]
    v_cvt_pk_bf16_f32 v48, v160, v161
    v_cvt_pk_bf16_f32 v49, v162, v163
    v_cvt_pk_bf16_f32 v50, v164, v165
    v_cvt_pk_bf16_f32 v51, v166, v167
    v_pk_mul_f32 v[168:169], v[168:169], v[6:7] op_sel_hi:[1,0]
    v_pk_mul_f32 v[170:171], v[170:171], v[6:7] op_sel_hi:[1,0]
    v_pk_mul_f32 v[172:173], v[172:173], v[6:7] op_sel_hi:[1,0]
    v_pk_mul_f32 v[174:175], v[174:175], v[6:7] op_sel_hi:[1,0]
    v_cvt_pk_bf16_f32 v52, v168, v169
    v_cvt_pk_bf16_f32 v53, v170, v171
    v_cvt_pk_bf16_f32 v54, v172, v173
    v_cvt_pk_bf16_f32 v55, v174, v175
    v_pk_mul_f32 v[176:177], v[176:177], v[6:7] op_sel_hi:[1,0]
    v_pk_mul_f32 v[178:179], v[178:179], v[6:7] op_sel_hi:[1,0]
    v_pk_mul_f32 v[180:181], v[180:181], v[6:7] op_sel_hi:[1,0]
    v_pk_mul_f32 v[182:183], v[182:183], v[6:7] op_sel_hi:[1,0]
    v_cvt_pk_bf16_f32 v56, v176, v177
    v_cvt_pk_bf16_f32 v57, v178, v179
    v_cvt_pk_bf16_f32 v58, v180, v181
    v_cvt_pk_bf16_f32 v59, v182, v183
    buffer_store_dwordx4 v[28:31], v13, s[24:27], s90 offen offset:3072 sc1
    v_pk_mul_f32 v[184:185], v[184:185], v[6:7] op_sel_hi:[1,0]
    v_pk_mul_f32 v[186:187], v[186:187], v[6:7] op_sel_hi:[1,0]
    v_pk_mul_f32 v[188:189], v[188:189], v[6:7] op_sel_hi:[1,0]
    v_pk_mul_f32 v[190:191], v[190:191], v[6:7] op_sel_hi:[1,0]
    v_cvt_pk_bf16_f32 v60, v184, v185
    v_cvt_pk_bf16_f32 v61, v186, v187
    v_cvt_pk_bf16_f32 v62, v188, v189
    v_cvt_pk_bf16_f32 v63, v190, v191
    s_add_u32 s3, s64, 86016
    v_pk_mul_f32 v[192:193], v[192:193], v[6:7] op_sel:[0,1] op_sel_hi:[1,1]
    v_pk_mul_f32 v[194:195], v[194:195], v[6:7] op_sel:[0,1] op_sel_hi:[1,1]
    v_pk_mul_f32 v[196:197], v[196:197], v[6:7] op_sel:[0,1] op_sel_hi:[1,1]
    v_pk_mul_f32 v[198:199], v[198:199], v[6:7] op_sel:[0,1] op_sel_hi:[1,1]
    v_cvt_pk_bf16_f32 v64, v192, v193
    v_cvt_pk_bf16_f32 v65, v194, v195
    v_cvt_pk_bf16_f32 v66, v196, v197
    v_cvt_pk_bf16_f32 v67, v198, v199
    v_pk_mul_f32 v[200:201], v[200:201], v[6:7] op_sel:[0,1] op_sel_hi:[1,1]
    v_pk_mul_f32 v[202:203], v[202:203], v[6:7] op_sel:[0,1] op_sel_hi:[1,1]
    v_pk_mul_f32 v[204:205], v[204:205], v[6:7] op_sel:[0,1] op_sel_hi:[1,1]
    v_pk_mul_f32 v[206:207], v[206:207], v[6:7] op_sel:[0,1] op_sel_hi:[1,1]
    v_cvt_pk_bf16_f32 v68, v200, v201
    v_cvt_pk_bf16_f32 v69, v202, v203
    v_cvt_pk_bf16_f32 v70, v204, v205
    v_cvt_pk_bf16_f32 v71, v206, v207
    buffer_store_dwordx4 v[32:35], v13, s[24:27], s91 offen offset:0 sc1
    v_pk_mul_f32 v[208:209], v[208:209], v[6:7] op_sel:[0,1] op_sel_hi:[1,1]
    v_pk_mul_f32 v[210:211], v[210:211], v[6:7] op_sel:[0,1] op_sel_hi:[1,1]
    v_pk_mul_f32 v[212:213], v[212:213], v[6:7] op_sel:[0,1] op_sel_hi:[1,1]
    v_pk_mul_f32 v[214:215], v[214:215], v[6:7] op_sel:[0,1] op_sel_hi:[1,1]
    v_cvt_pk_bf16_f32 v72, v208, v209
    v_cvt_pk_bf16_f32 v73, v210, v211
    v_cvt_pk_bf16_f32 v74, v212, v213
    v_cvt_pk_bf16_f32 v75, v214, v215
    v_pk_mul_f32 v[216:217], v[216:217], v[6:7] op_sel:[0,1] op_sel_hi:[1,1]
    v_pk_mul_f32 v[218:219], v[218:219], v[6:7] op_sel:[0,1] op_sel_hi:[1,1]
    v_pk_mul_f32 v[220:221], v[220:221], v[6:7] op_sel:[0,1] op_sel_hi:[1,1]
    v_pk_mul_f32 v[222:223], v[222:223], v[6:7] op_sel:[0,1] op_sel_hi:[1,1]
    v_cvt_pk_bf16_f32 v76, v216, v217
    v_cvt_pk_bf16_f32 v77, v218, v219
    v_cvt_pk_bf16_f32 v78, v220, v221
    v_cvt_pk_bf16_f32 v79, v222, v223
    buffer_store_dwordx4 v[36:39], v13, s[24:27], s91 offen offset:1024 sc1
    s_waitcnt lgkmcnt(0)
    s_barrier
    s_lshl_b32 s3, s37, 12
    v_subrev_u32 v9, s3, v9
    ds_read_b128 v[80:83], v9 offset:0
    ds_read_b128 v[84:87], v9 offset:1024
    ds_read_b128 v[88:91], v9 offset:4096
    ds_read_b128 v[92:95], v9 offset:5120
    v_lshrrev_b32 v12, 2, v0
    v_mul_u32_u24 v12, 288, v12
    v_and_b32 v14, 3, v0
    v_lshl_add_u32 v12, v14, 3, v12
    v_lshlrev_b32 v1, 4, v0
    s_lshl_b32 s3, s37, 7
    s_xor_b32 s3, s3, 128
    v_add_u32 v2, s3, v12
    s_mul_i32 s50, s37, 160
    s_xor_b32 s3, s38, 0
    s_lshl_b32 s3, s3, 5
    s_add_u32 s3, s3, s50
    v_add_u32 v13, s3, v12
    s_xor_b32 s3, s38, 1
    s_lshl_b32 s3, s3, 5
    s_add_u32 s3, s3, s50
    v_add_u32 v14, s3, v12
    s_xor_b32 s3, s38, 2
    s_lshl_b32 s3, s3, 5
    s_add_u32 s3, s3, s50
    v_add_u32 v0, s3, v12
    s_xor_b32 s3, s38, 3
    s_lshl_b32 s3, s3, 5
    s_add_u32 s3, s3, s50
    v_add_u32 v12, s3, v12
    v_accvgpr_read_b32 v3, a240
    v_accvgpr_read_b32 v4, a241
    v_accvgpr_read_b32 v5, a242
    v_accvgpr_read_b32 v6, a243
    v_accvgpr_read_b32 v7, a244
    v_accvgpr_read_b32 v8, a245
    v_accvgpr_read_b32 v9, a246
    v_accvgpr_read_b32 v10, a247
    v_accvgpr_read_b32 v11, a248
    s_lshl_b32 s3, s38, 2
    s_add_u32 s3, s3, s40
    s_mul_i32 s3, s3, 147456
    s_sub_u32 s64, s64, s3
    s_sub_u32 s65, s65, s3
    s_mov_b32 s47, 4
    s_xor_b32 s52, s71, 1024
    s_mov_b32 s56, 0
    s_mov_b32 s59, 0
    s_mov_b32 s60, 0
    s_mov_b32 s61, 0
    s_mov_b32 s62, 0
    s_mov_b32 s94, 36864
    s_mov_b32 s95, 73728
    s_mov_b32 s74, 3
    s_lshl_b32 s3, s36, 7
    s_xor_b32 s3, s3, s71
    s_add_u32 s3, s3, 4
    s_add_u32 s12, s24, s3
    s_addc_u32 s13, s25, 0
    s_waitcnt lgkmcnt(0)
    s_barrier
    ds_read_b64_tr_b16 a[164:165], v13 offset:0
    ds_read_b64_tr_b16 a[166:167], v13 offset:4608
    ds_read_b64_tr_b16 a[168:169], v13 offset:9216
    ds_read_b64_tr_b16 a[170:171], v13 offset:13824
    ds_read_b64_tr_b16 a[172:173], v13 offset:18432
    ds_read_b64_tr_b16 a[174:175], v13 offset:23040
    ds_read_b64_tr_b16 a[176:177], v13 offset:27648
    ds_read_b64_tr_b16 a[178:179], v13 offset:32256
    ds_read_b64_tr_b16 a[180:181], v14 offset:0
    ds_read_b64_tr_b16 a[182:183], v14 offset:4608
    ds_read_b64_tr_b16 a[184:185], v14 offset:9216
    ds_read_b64_tr_b16 a[186:187], v14 offset:13824
    ds_read_b64_tr_b16 a[188:189], v14 offset:18432
    ds_read_b64_tr_b16 a[190:191], v14 offset:23040
    ds_read_b64_tr_b16 a[192:193], v14 offset:27648
    ds_read_b64_tr_b16 a[194:195], v14 offset:32256
    s_waitcnt lgkmcnt(8)
    v_mfma_f32_16x16x32_bf16 v[132:135], a[164:167], a[16:19], 0
    v_mfma_f32_16x16x32_bf16 v[132:135], a[168:171], a[20:23], v[132:135]
    v_mfma_f32_16x16x32_bf16 v[132:135], a[172:175], a[24:27], v[132:135]
    v_mfma_f32_16x16x32_bf16 v[132:135], a[176:179], a[28:31], v[132:135]
    buffer_store_dwordx4 v[40:43], v1, s[24:27], s91 offen offset:2048 sc1
    v_mfma_f32_16x16x32_bf16 v[168:171], a[164:167], a[32:35], 0
    v_mfma_f32_16x16x32_bf16 v[168:171], a[168:171], a[36:39], v[168:171]
    buffer_load_dword v15, off, s[24:27], s52 sc1
    v_mfma_f32_16x16x32_bf16 v[168:171], a[172:175], a[40:43], v[168:171]
    v_mfma_f32_16x16x32_bf16 v[168:171], a[176:179], a[44:47], v[168:171]
    v_mfma_f32_16x16x32_bf16 v[204:207], a[164:167], a[48:51], 0
    v_mfma_f32_16x16x32_bf16 v[204:207], a[168:171], a[52:55], v[204:207]
    v_mfma_f32_16x16x32_bf16 v[204:207], a[172:175], a[56:59], v[204:207]
    v_mfma_f32_16x16x32_bf16 v[204:207], a[176:179], a[60:63], v[204:207]
    v_mfma_f32_16x16x32_bf16 v[240:243], a[164:167], a[64:67], 0
    ds_read_b64_tr_b16 a[196:197], v0 offset:0
    v_mfma_f32_16x16x32_bf16 v[240:243], a[168:171], a[68:71], v[240:243]
    v_mfma_f32_16x16x32_bf16 v[240:243], a[172:175], a[72:75], v[240:243]
    ds_read_b64_tr_b16 a[198:199], v0 offset:4608
    v_mfma_f32_16x16x32_bf16 v[240:243], a[176:179], a[76:79], v[240:243]
    buffer_store_dwordx4 v[44:47], v1, s[24:27], s91 offen offset:3072 sc1
    v_mfma_f32_16x16x32_bf16 v[96:99], a[164:167], a[0:3], 0
    ds_read_b64_tr_b16 a[200:201], v0 offset:9216
    v_mfma_f32_16x16x32_bf16 v[96:99], a[168:171], a[4:7], v[96:99]
    v_mfma_f32_16x16x32_bf16 v[96:99], a[172:175], a[8:11], v[96:99]
    ds_read_b64_tr_b16 a[202:203], v0 offset:13824
    v_mfma_f32_16x16x32_bf16 v[96:99], a[176:179], a[12:15], v[96:99]
    s_waitcnt lgkmcnt(4)
    v_mfma_f32_16x16x32_bf16 v[136:139], a[180:183], a[16:19], 0
    ds_read_b64_tr_b16 a[204:205], v0 offset:18432
    v_mfma_f32_16x16x32_bf16 v[136:139], a[184:187], a[20:23], v[136:139]
    v_mfma_f32_16x16x32_bf16 v[136:139], a[188:191], a[24:27], v[136:139]
    ds_read_b64_tr_b16 a[206:207], v0 offset:23040
    v_mfma_f32_16x16x32_bf16 v[136:139], a[192:195], a[28:31], v[136:139]
    v_mfma_f32_16x16x32_bf16 v[172:175], a[180:183], a[32:35], 0
    ds_read_b64_tr_b16 a[208:209], v0 offset:27648
    v_mfma_f32_16x16x32_bf16 v[172:175], a[184:187], a[36:39], v[172:175]
    v_mfma_f32_16x16x32_bf16 v[172:175], a[188:191], a[40:43], v[172:175]
    ds_read_b64_tr_b16 a[210:211], v0 offset:32256
    v_mfma_f32_16x16x32_bf16 v[172:175], a[192:195], a[44:47], v[172:175]
    v_mfma_f32_16x16x32_bf16 v[208:211], a[180:183], a[48:51], 0
    buffer_store_dwordx4 v[48:51], v1, s[24:27], s92 offen offset:0 sc1
    v_mfma_f32_16x16x32_bf16 v[208:211], a[184:187], a[52:55], v[208:211]
    v_mfma_f32_16x16x32_bf16 v[208:211], a[188:191], a[56:59], v[208:211]
    v_mfma_f32_16x16x32_bf16 v[208:211], a[192:195], a[60:63], v[208:211]
    v_mfma_f32_16x16x32_bf16 v[244:247], a[180:183], a[64:67], 0
    ds_read_b64_tr_b16 a[164:165], v12 offset:0
    v_mfma_f32_16x16x32_bf16 v[244:247], a[184:187], a[68:71], v[244:247]
    v_mfma_f32_16x16x32_bf16 v[244:247], a[188:191], a[72:75], v[244:247]
    ds_read_b64_tr_b16 a[166:167], v12 offset:4608
    v_mfma_f32_16x16x32_bf16 v[244:247], a[192:195], a[76:79], v[244:247]
    v_mfma_f32_16x16x32_bf16 v[100:103], a[180:183], a[0:3], 0
    ds_read_b64_tr_b16 a[168:169], v12 offset:9216
    v_mfma_f32_16x16x32_bf16 v[100:103], a[184:187], a[4:7], v[100:103]
    v_mfma_f32_16x16x32_bf16 v[100:103], a[188:191], a[8:11], v[100:103]
    ds_read_b64_tr_b16 a[170:171], v12 offset:13824
    v_mfma_f32_16x16x32_bf16 v[100:103], a[192:195], a[12:15], v[100:103]
    s_waitcnt lgkmcnt(4)
    v_mfma_f32_16x16x32_bf16 v[140:143], a[196:199], a[16:19], 0
    ds_read_b64_tr_b16 a[172:173], v12 offset:18432
    v_mfma_f32_16x16x32_bf16 v[140:143], a[200:203], a[20:23], v[140:143]
    buffer_store_dwordx4 v[52:55], v1, s[24:27], s92 offen offset:1024 sc1
    v_mfma_f32_16x16x32_bf16 v[140:143], a[204:207], a[24:27], v[140:143]
    ds_read_b64_tr_b16 a[174:175], v12 offset:23040
    v_mfma_f32_16x16x32_bf16 v[140:143], a[208:211], a[28:31], v[140:143]
    v_mfma_f32_16x16x32_bf16 v[176:179], a[196:199], a[32:35], 0
    ds_read_b64_tr_b16 a[176:177], v12 offset:27648
    v_mfma_f32_16x16x32_bf16 v[176:179], a[200:203], a[36:39], v[176:179]
    v_mfma_f32_16x16x32_bf16 v[176:179], a[204:207], a[40:43], v[176:179]
    ds_read_b64_tr_b16 a[178:179], v12 offset:32256
    v_mfma_f32_16x16x32_bf16 v[176:179], a[208:211], a[44:47], v[176:179]
    v_mfma_f32_16x16x32_bf16 v[212:215], a[196:199], a[48:51], 0
    v_mfma_f32_16x16x32_bf16 v[212:215], a[200:203], a[52:55], v[212:215]
    v_mfma_f32_16x16x32_bf16 v[212:215], a[204:207], a[56:59], v[212:215]
    v_mfma_f32_16x16x32_bf16 v[212:215], a[208:211], a[60:63], v[212:215]
    v_mfma_f32_16x16x32_bf16 v[248:251], a[196:199], a[64:67], 0
    ds_read_b64_tr_b16 a[180:181], v2 offset:0
    v_mfma_f32_16x16x32_bf16 v[248:251], a[200:203], a[68:71], v[248:251]
    v_mfma_f32_16x16x32_bf16 v[248:251], a[204:207], a[72:75], v[248:251]
    ds_read_b64_tr_b16 a[182:183], v2 offset:4608
    v_mfma_f32_16x16x32_bf16 v[248:251], a[208:211], a[76:79], v[248:251]
    buffer_store_dwordx4 v[56:59], v1, s[24:27], s92 offen offset:2048 sc1
    v_mfma_f32_16x16x32_bf16 v[104:107], a[196:199], a[0:3], 0
    ds_read_b64_tr_b16 a[184:185], v2 offset:9216
    v_mfma_f32_16x16x32_bf16 v[104:107], a[200:203], a[4:7], v[104:107]
    v_mfma_f32_16x16x32_bf16 v[104:107], a[204:207], a[8:11], v[104:107]
    ds_read_b64_tr_b16 a[186:187], v2 offset:13824
    v_mfma_f32_16x16x32_bf16 v[104:107], a[208:211], a[12:15], v[104:107]
    s_waitcnt lgkmcnt(4)
    v_mfma_f32_16x16x32_bf16 v[144:147], a[164:167], a[16:19], 0
    ds_read_b64_tr_b16 a[188:189], v2 offset:18432
    v_mfma_f32_16x16x32_bf16 v[144:147], a[168:171], a[20:23], v[144:147]
    v_mfma_f32_16x16x32_bf16 v[144:147], a[172:175], a[24:27], v[144:147]
    ds_read_b64_tr_b16 a[190:191], v2 offset:23040
    v_mfma_f32_16x16x32_bf16 v[144:147], a[176:179], a[28:31], v[144:147]
    v_mfma_f32_16x16x32_bf16 v[180:183], a[164:167], a[32:35], 0
    ds_read_b64_tr_b16 a[192:193], v2 offset:27648
    v_mfma_f32_16x16x32_bf16 v[180:183], a[168:171], a[36:39], v[180:183]
    v_mfma_f32_16x16x32_bf16 v[180:183], a[172:175], a[40:43], v[180:183]
    ds_read_b64_tr_b16 a[194:195], v2 offset:32256
    v_mfma_f32_16x16x32_bf16 v[180:183], a[176:179], a[44:47], v[180:183]
    v_mfma_f32_16x16x32_bf16 v[216:219], a[164:167], a[48:51], 0
    v_mfma_f32_16x16x32_bf16 v[216:219], a[168:171], a[52:55], v[216:219]
    buffer_store_dwordx4 v[60:63], v1, s[24:27], s92 offen offset:3072 sc1
    v_mfma_f32_16x16x32_bf16 v[216:219], a[172:175], a[56:59], v[216:219]
    v_mfma_f32_16x16x32_bf16 v[216:219], a[176:179], a[60:63], v[216:219]
    v_mfma_f32_16x16x32_bf16 v[252:255], a[164:167], a[64:67], 0
    ds_read_b64_tr_b16 a[196:197], v2 offset:32
    v_mfma_f32_16x16x32_bf16 v[252:255], a[168:171], a[68:71], v[252:255]
    v_mfma_f32_16x16x32_bf16 v[252:255], a[172:175], a[72:75], v[252:255]
    ds_read_b64_tr_b16 a[198:199], v2 offset:4640
    v_mfma_f32_16x16x32_bf16 v[252:255], a[176:179], a[76:79], v[252:255]
    v_mfma_f32_16x16x32_bf16 v[108:111], a[164:167], a[0:3], 0
    ds_read_b64_tr_b16 a[200:201], v2 offset:9248
    v_mfma_f32_16x16x32_bf16 v[108:111], a[168:171], a[4:7], v[108:111]
    v_mfma_f32_16x16x32_bf16 v[108:111], a[172:175], a[8:11], v[108:111]
    ds_read_b64_tr_b16 a[202:203], v2 offset:13856
    v_mfma_f32_16x16x32_bf16 v[108:111], a[176:179], a[12:15], v[108:111]
    s_waitcnt lgkmcnt(4)
    v_mfma_f32_16x16x32_bf16 v[148:151], a[180:183], a[16:19], 0
    ds_read_b64_tr_b16 a[204:205], v2 offset:18464
    v_mfma_f32_16x16x32_bf16 v[148:151], a[184:187], a[20:23], v[148:151]
    v_mfma_f32_16x16x32_bf16 v[148:151], a[188:191], a[24:27], v[148:151]
    ds_read_b64_tr_b16 a[206:207], v2 offset:23072
    v_mfma_f32_16x16x32_bf16 v[148:151], a[192:195], a[28:31], v[148:151]
    buffer_store_dwordx4 v[64:67], v1, s[24:27], s93 offen offset:0 sc1
    v_mfma_f32_16x16x32_bf16 v[184:187], a[180:183], a[32:35], 0
    ds_read_b64_tr_b16 a[208:209], v2 offset:27680
    v_mfma_f32_16x16x32_bf16 v[184:187], a[184:187], a[36:39], v[184:187]
    v_mfma_f32_16x16x32_bf16 v[184:187], a[188:191], a[40:43], v[184:187]
    ds_read_b64_tr_b16 a[210:211], v2 offset:32288
    v_mfma_f32_16x16x32_bf16 v[184:187], a[192:195], a[44:47], v[184:187]
    v_mfma_f32_16x16x32_bf16 v[220:223], a[180:183], a[48:51], 0
    v_mfma_f32_16x16x32_bf16 v[220:223], a[184:187], a[52:55], v[220:223]
    v_mfma_f32_16x16x32_bf16 v[220:223], a[188:191], a[56:59], v[220:223]
    v_mfma_f32_16x16x32_bf16 v[220:223], a[192:195], a[60:63], v[220:223]
    v_mfma_f32_16x16x32_bf16 a[160:163], a[180:183], a[64:67], 0
    v_mfma_f32_16x16x32_bf16 a[160:163], a[184:187], a[68:71], a[160:163]
    ds_read_b64_tr_b16 a[164:165], v2 offset:64
    v_mfma_f32_16x16x32_bf16 a[160:163], a[188:191], a[72:75], a[160:163]
    ds_read_b64_tr_b16 a[166:167], v2 offset:4672
    v_mfma_f32_16x16x32_bf16 a[160:163], a[192:195], a[76:79], a[160:163]
    v_mfma_f32_16x16x32_bf16 v[112:115], a[180:183], a[0:3], 0
    ds_read_b64_tr_b16 a[168:169], v2 offset:9280
    v_mfma_f32_16x16x32_bf16 v[112:115], a[184:187], a[4:7], v[112:115]
    ds_read_b64_tr_b16 a[170:171], v2 offset:13888
    v_mfma_f32_16x16x32_bf16 v[112:115], a[188:191], a[8:11], v[112:115]
    buffer_store_dwordx4 v[68:71], v1, s[24:27], s93 offen offset:1024 sc1
    v_mfma_f32_16x16x32_bf16 v[112:115], a[192:195], a[12:15], v[112:115]
    s_waitcnt lgkmcnt(4)
    ds_read_b64_tr_b16 a[172:173], v2 offset:18496
    v_mfma_f32_16x16x32_bf16 v[152:155], a[196:199], a[16:19], 0
    ds_read_b64_tr_b16 a[174:175], v2 offset:23104
    v_mfma_f32_16x16x32_bf16 v[152:155], a[200:203], a[20:23], v[152:155]
    v_mfma_f32_16x16x32_bf16 v[152:155], a[204:207], a[24:27], v[152:155]
    ds_read_b64_tr_b16 a[176:177], v2 offset:27712
    v_mfma_f32_16x16x32_bf16 v[152:155], a[208:211], a[28:31], v[152:155]
    ds_read_b64_tr_b16 a[178:179], v2 offset:32320
    v_mfma_f32_16x16x32_bf16 v[188:191], a[196:199], a[32:35], 0
    s_cmp_eq_u32 s56, 110592
    s_cselect_b32 s57, 0xfffe5000, s94
    s_add_u32 s56, s56, s57
    v_mfma_f32_16x16x32_bf16 v[188:191], a[200:203], a[36:39], v[188:191]
    v_mfma_f32_16x16x32_bf16 v[188:191], a[204:207], a[40:43], v[188:191]
    ds_read_b64_tr_b16 a[180:181], v2 offset:96
    v_mfma_f32_16x16x32_bf16 v[188:191], a[208:211], a[44:47], v[188:191]
    ds_read_b64_tr_b16 a[182:183], v2 offset:4704
    v_mfma_f32_16x16x32_bf16 v[224:227], a[196:199], a[48:51], 0
    v_mfma_f32_16x16x32_bf16 v[224:227], a[200:203], a[52:55], v[224:227]
    s_and_b32 s66, s47, 3
    s_lshl_b32 s49, s66, 12
    ds_read_b64_tr_b16 a[184:185], v2 offset:9312
    v_mfma_f32_16x16x32_bf16 v[224:227], a[204:207], a[56:59], v[224:227]
    s_xor_b32 s66, s66, s38
    s_lshl_b32 s66, s66, 2
    ds_read_b64_tr_b16 a[186:187], v2 offset:13920
    v_mfma_f32_16x16x32_bf16 v[224:227], a[208:211], a[60:63], v[224:227]
    s_bfe_u32 s67, s47, 0x20002
    buffer_store_dwordx4 v[72:75], v1, s[24:27], s93 offen offset:2048 sc1
    v_mfma_f32_16x16x32_bf16 v[116:119], a[196:199], a[0:3], 0
    s_xor_b32 s67, s67, s40
    s_add_u32 s66, s66, s67
    ds_read_b64_tr_b16 a[188:189], v2 offset:18528
    v_mfma_f32_16x16x32_bf16 v[116:119], a[200:203], a[4:7], v[116:119]
    s_lshl_b32 s66, s66, 1
    s_bfe_u32 s51, s47, 0x10004
    ds_read_b64_tr_b16 a[190:191], v2 offset:23136
    v_mfma_f32_16x16x32_bf16 v[116:119], a[204:207], a[8:11], v[116:119]
    s_add_u32 s66, s66, s51
    s_mul_i32 s66, s66, 73728
    s_add_u32 s72, s66, s64
    v_mfma_f32_16x16x32_bf16 v[116:119], a[208:211], a[12:15], v[116:119]
    s_waitcnt lgkmcnt(6)
    s_add_u32 s73, s66, s65
    ds_read_b64_tr_b16 a[192:193], v2 offset:27744
    v_mfma_f32_16x16x32_bf16 v[156:159], a[164:167], a[16:19], 0
    s_add_u32 s51, s51, 1
    ds_read_b64_tr_b16 a[194:195], v2 offset:32352
    v_mfma_f32_16x16x32_bf16 v[156:159], a[168:171], a[20:23], v[156:159]
    v_mfma_f32_16x16x32_bf16 v[156:159], a[172:175], a[24:27], v[156:159]
    v_mfma_f32_16x16x32_bf16 v[156:159], a[176:179], a[28:31], v[156:159]
    ds_read_b64_tr_b16 a[196:197], v2 offset:128
    v_mfma_f32_16x16x32_bf16 v[192:195], a[164:167], a[32:35], 0
    ds_read_b64_tr_b16 a[198:199], v2 offset:4736
    v_mfma_f32_16x16x32_bf16 v[192:195], a[168:171], a[36:39], v[192:195]
    v_mfma_f32_16x16x32_bf16 v[192:195], a[172:175], a[40:43], v[192:195]
    ds_read_b64_tr_b16 a[200:201], v2 offset:9344
    v_mfma_f32_16x16x32_bf16 v[192:195], a[176:179], a[44:47], v[192:195]
    ds_read_b64_tr_b16 a[202:203], v2 offset:13952
    v_mfma_f32_16x16x32_bf16 v[228:231], a[164:167], a[48:51], 0
    buffer_store_dwordx4 v[76:79], v1, s[24:27], s93 offen offset:3072 sc1
    v_mfma_f32_16x16x32_bf16 v[228:231], a[168:171], a[52:55], v[228:231]
    ds_read_b64_tr_b16 a[204:205], v2 offset:18560
    v_mfma_f32_16x16x32_bf16 v[228:231], a[172:175], a[56:59], v[228:231]
    ds_read_b64_tr_b16 a[206:207], v2 offset:23168
    v_mfma_f32_16x16x32_bf16 v[228:231], a[176:179], a[60:63], v[228:231]
    v_mfma_f32_16x16x32_bf16 v[120:123], a[164:167], a[0:3], 0
    ds_read_b64_tr_b16 a[208:209], v2 offset:27776
    v_mfma_f32_16x16x32_bf16 v[120:123], a[168:171], a[4:7], v[120:123]
    ds_read_b64_tr_b16 a[210:211], v2 offset:32384
    v_mfma_f32_16x16x32_bf16 v[120:123], a[172:175], a[8:11], v[120:123]
    v_mfma_f32_16x16x32_bf16 v[120:123], a[176:179], a[12:15], v[120:123]
    s_waitcnt lgkmcnt(8)
    v_add_u32 v13, s57, v13
    v_mfma_f32_16x16x32_bf16 v[160:163], a[180:183], a[16:19], 0
    v_add_u32 v14, s57, v14
    v_mfma_f32_16x16x32_bf16 v[160:163], a[184:187], a[20:23], v[160:163]
    v_add_u32 v0, s57, v0
    v_mfma_f32_16x16x32_bf16 v[160:163], a[188:191], a[24:27], v[160:163]
    v_add_u32 v12, s57, v12
    v_mfma_f32_16x16x32_bf16 v[160:163], a[192:195], a[28:31], v[160:163]
    v_add_u32 v2, s57, v2
    v_mfma_f32_16x16x32_bf16 v[196:199], a[180:183], a[32:35], 0
    v_mfma_f32_16x16x32_bf16 v[196:199], a[184:187], a[36:39], v[196:199]
    v_mfma_f32_16x16x32_bf16 v[196:199], a[188:191], a[40:43], v[196:199]
    v_mfma_f32_16x16x32_bf16 v[196:199], a[192:195], a[44:47], v[196:199]
    v_mfma_f32_16x16x32_bf16 v[232:235], a[180:183], a[48:51], 0
    v_mfma_f32_16x16x32_bf16 v[232:235], a[184:187], a[52:55], v[232:235]
    v_mfma_f32_16x16x32_bf16 v[232:235], a[188:191], a[56:59], v[232:235]
    v_mfma_f32_16x16x32_bf16 v[232:235], a[192:195], a[60:63], v[232:235]
    v_mfma_f32_16x16x32_bf16 v[124:127], a[180:183], a[0:3], 0
    s_waitcnt vmcnt(19) lgkmcnt(0)
    v_mfma_f32_16x16x32_bf16 v[124:127], a[184:187], a[4:7], v[124:127]
    s_barrier
    v_mfma_f32_16x16x32_bf16 v[124:127], a[188:191], a[8:11], v[124:127]
    v_mfma_f32_16x16x32_bf16 v[124:127], a[192:195], a[12:15], v[124:127]
    s_cmp_ge_u32 s56, 73728
    s_cselect_b32 s55, 0xfffee000, s95
    ds_read_b64_tr_b16 a[164:165], v13 offset:0
    v_mfma_f32_16x16x32_bf16 v[164:167], a[196:199], a[16:19], 0
    s_add_u32 s55, s55, s56
    s_add_u32 s55, s55, s86
    ds_read_b64_tr_b16 a[166:167], v13 offset:4608
    v_mfma_f32_16x16x32_bf16 v[164:167], a[200:203], a[20:23], v[164:167]
    ds_read_b64_tr_b16 a[168:169], v13 offset:9216
    v_mfma_f32_16x16x32_bf16 v[164:167], a[204:207], a[24:27], v[164:167]
    ds_read_b64_tr_b16 a[170:171], v13 offset:13824
    v_mfma_f32_16x16x32_bf16 v[164:167], a[208:211], a[28:31], v[164:167]
    ds_read_b64_tr_b16 a[172:173], v13 offset:18432
    v_mfma_f32_16x16x32_bf16 v[200:203], a[196:199], a[32:35], 0
    ds_read_b64_tr_b16 a[174:175], v13 offset:23040
    v_mfma_f32_16x16x32_bf16 v[200:203], a[200:203], a[36:39], v[200:203]
    ds_read_b64_tr_b16 a[176:177], v13 offset:27648
    v_mfma_f32_16x16x32_bf16 v[200:203], a[204:207], a[40:43], v[200:203]
    ds_read_b64_tr_b16 a[178:179], v13 offset:32256
    v_mfma_f32_16x16x32_bf16 v[200:203], a[208:211], a[44:47], v[200:203]
    ds_read_b64_tr_b16 a[180:181], v14 offset:0
    v_mfma_f32_16x16x32_bf16 v[236:239], a[196:199], a[48:51], 0
    ds_read_b64_tr_b16 a[182:183], v14 offset:4608
    v_mfma_f32_16x16x32_bf16 v[236:239], a[200:203], a[52:55], v[236:239]
    ds_read_b64_tr_b16 a[184:185], v14 offset:9216
    v_mfma_f32_16x16x32_bf16 v[236:239], a[204:207], a[56:59], v[236:239]
    ds_read_b64_tr_b16 a[186:187], v14 offset:13824
    v_mfma_f32_16x16x32_bf16 v[236:239], a[208:211], a[60:63], v[236:239]
    s_mov_b32 s47, 8
    ds_read_b64_tr_b16 a[188:189], v14 offset:18432
    v_mfma_f32_16x16x32_bf16 v[128:131], a[196:199], a[0:3], 0
    ds_read_b64_tr_b16 a[190:191], v14 offset:23040
    v_mfma_f32_16x16x32_bf16 v[128:131], a[200:203], a[4:7], v[128:131]
    ds_read_b64_tr_b16 a[192:193], v14 offset:27648
    v_mfma_f32_16x16x32_bf16 v[128:131], a[204:207], a[8:11], v[128:131]
    s_waitcnt lgkmcnt(7)
    ds_read_b64_tr_b16 a[194:195], v14 offset:32256
    v_mfma_f32_16x16x32_bf16 v[128:131], a[208:211], a[12:15], v[128:131]
    v_mfma_f32_16x16x32_bf16 v[132:135], a[164:167], v[32:35], v[132:135]
    s_waitcnt vmcnt(9)
    v_readfirstlane_b32 s54, v15
    v_mfma_f32_16x16x32_bf16 v[132:135], a[168:171], v[36:39], v[132:135]
    s_cmp_ge_u32 s54, s51
    s_cbranch_scc0 L_sp_o1
L_sb_o1:
    v_mfma_f32_16x16x32_bf16 v[132:135], a[172:175], v[40:43], v[132:135]
    v_mfma_f32_16x16x32_bf16 v[132:135], a[176:179], v[44:47], v[132:135]
    s_xor_b32 s54, s49, 4096
    s_add_u32 s54, s54, s72
    v_mfma_f32_16x16x32_bf16 v[168:171], a[164:167], v[48:51], v[168:171]
    buffer_load_dwordx4 a[96:99], v1, s[24:27], s54 offen offset:0 sc1
    v_mfma_f32_16x16x32_bf16 v[168:171], a[168:171], v[52:55], v[168:171]
    v_mfma_f32_16x16x32_bf16 v[168:171], a[172:175], v[56:59], v[168:171]
    v_mfma_f32_16x16x32_bf16 v[168:171], a[176:179], v[60:63], v[168:171]
    v_mfma_f32_16x16x32_bf16 v[204:207], a[164:167], v[64:67], v[204:207]
    s_and_b32 s66, s47, 3
    s_xor_b32 s66, s66, s38
    s_lshl_b32 s66, s66, 2
    v_mfma_f32_16x16x32_bf16 v[204:207], a[168:171], v[68:71], v[204:207]
    s_bfe_u32 s67, s47, 0x20002
    s_xor_b32 s67, s67, s40
    s_add_u32 s66, s66, s67
    v_mfma_f32_16x16x32_bf16 v[204:207], a[172:175], v[72:75], v[204:207]
    s_lshl_b32 s66, s66, 1
    s_bfe_u32 s67, s47, 0x10004
    s_add_u32 s66, s66, s67
    v_mfma_f32_16x16x32_bf16 v[204:207], a[176:179], v[76:79], v[204:207]
    s_lshl_b32 s66, s66, 2
    buffer_load_dwordx4 a[100:103], v1, s[24:27], s54 offen offset:1024 sc1
    v_mfma_f32_16x16x32_bf16 v[240:243], a[164:167], v[80:83], v[240:243]
    s_add_u32 s66, s66, s36
    s_mul_i32 s66, s66, 36864
    ds_read_b64_tr_b16 a[196:197], v0 offset:0
    v_mfma_f32_16x16x32_bf16 v[240:243], a[168:171], v[84:87], v[240:243]
    s_cmp_lt_u32 s47, 32
    s_cselect_b32 s87, s66, s58
    v_mfma_f32_16x16x32_bf16 v[240:243], a[172:175], v[88:91], v[240:243]
    ds_read_b64_tr_b16 a[198:199], v0 offset:4608
    v_mfma_f32_16x16x32_bf16 v[240:243], a[176:179], v[92:95], v[240:243]
    v_mfma_f32_16x16x32_bf16 v[96:99], a[164:167], v[16:19], v[96:99]
    ds_read_b64_tr_b16 a[200:201], v0 offset:9216
    v_mfma_f32_16x16x32_bf16 v[96:99], a[168:171], v[20:23], v[96:99]
    v_mfma_f32_16x16x32_bf16 v[96:99], a[172:175], v[24:27], v[96:99]
    ds_read_b64_tr_b16 a[202:203], v0 offset:13824
    v_mfma_f32_16x16x32_bf16 v[96:99], a[176:179], v[28:31], v[96:99]
    s_waitcnt lgkmcnt(4)
    buffer_load_dwordx4 a[104:107], v1, s[24:27], s54 offen offset:2048 sc1
    v_mfma_f32_16x16x32_bf16 v[136:139], a[180:183], v[32:35], v[136:139]
    s_add_u32 m0, s55, 0
    ds_read_b64_tr_b16 a[204:205], v0 offset:18432
    v_mfma_f32_16x16x32_bf16 v[136:139], a[184:187], v[36:39], v[136:139]
    buffer_load_dwordx4 v3, s[20:23], s87 offen offset:0 lds
    v_mfma_f32_16x16x32_bf16 v[136:139], a[188:191], v[40:43], v[136:139]
    ds_read_b64_tr_b16 a[206:207], v0 offset:23040
    v_mfma_f32_16x16x32_bf16 v[136:139], a[192:195], v[44:47], v[136:139]
    v_mfma_f32_16x16x32_bf16 v[172:175], a[180:183], v[48:51], v[172:175]
    ds_read_b64_tr_b16 a[208:209], v0 offset:27648
    v_mfma_f32_16x16x32_bf16 v[172:175], a[184:187], v[52:55], v[172:175]
    buffer_load_dwordx4 a[108:111], v1, s[24:27], s54 offen offset:3072 sc1
    v_mfma_f32_16x16x32_bf16 v[172:175], a[188:191], v[56:59], v[172:175]
    ds_read_b64_tr_b16 a[210:211], v0 offset:32256
    v_mfma_f32_16x16x32_bf16 v[172:175], a[192:195], v[60:63], v[172:175]
    v_mfma_f32_16x16x32_bf16 v[208:211], a[180:183], v[64:67], v[208:211]
    v_mfma_f32_16x16x32_bf16 v[208:211], a[184:187], v[68:71], v[208:211]
    v_mfma_f32_16x16x32_bf16 v[208:211], a[188:191], v[72:75], v[208:211]
    v_mfma_f32_16x16x32_bf16 v[208:211], a[192:195], v[76:79], v[208:211]
    v_mfma_f32_16x16x32_bf16 v[244:247], a[180:183], v[80:83], v[244:247]
    s_xor_b32 s54, s49, 8192
    s_add_u32 s54, s54, s72
    ds_read_b64_tr_b16 a[164:165], v12 offset:0
    v_mfma_f32_16x16x32_bf16 v[244:247], a[184:187], v[84:87], v[244:247]
    buffer_load_dwordx4 a[112:115], v1, s[24:27], s54 offen offset:0 sc1
    v_mfma_f32_16x16x32_bf16 v[244:247], a[188:191], v[88:91], v[244:247]
    ds_read_b64_tr_b16 a[166:167], v12 offset:4608
    v_mfma_f32_16x16x32_bf16 v[244:247], a[192:195], v[92:95], v[244:247]
    buffer_load_dwordx4 v4, s[20:23], s87 offen offset:1024 lds
    v_mfma_f32_16x16x32_bf16 v[100:103], a[180:183], v[16:19], v[100:103]
    ds_read_b64_tr_b16 a[168:169], v12 offset:9216
    v_mfma_f32_16x16x32_bf16 v[100:103], a[184:187], v[20:23], v[100:103]
    v_mfma_f32_16x16x32_bf16 v[100:103], a[188:191], v[24:27], v[100:103]
    ds_read_b64_tr_b16 a[170:171], v12 offset:13824
    v_mfma_f32_16x16x32_bf16 v[100:103], a[192:195], v[28:31], v[100:103]
    s_waitcnt lgkmcnt(4)
    buffer_load_dwordx4 a[116:119], v1, s[24:27], s54 offen offset:1024 sc1
    v_mfma_f32_16x16x32_bf16 v[140:143], a[196:199], v[32:35], v[140:143]
    ds_read_b64_tr_b16 a[172:173], v12 offset:18432
    v_mfma_f32_16x16x32_bf16 v[140:143], a[200:203], v[36:39], v[140:143]
    v_mfma_f32_16x16x32_bf16 v[140:143], a[204:207], v[40:43], v[140:143]
    ds_read_b64_tr_b16 a[174:175], v12 offset:23040
    v_mfma_f32_16x16x32_bf16 v[140:143], a[208:211], v[44:47], v[140:143]
    v_mfma_f32_16x16x32_bf16 v[176:179], a[196:199], v[48:51], v[176:179]
    ds_read_b64_tr_b16 a[176:177], v12 offset:27648
    v_mfma_f32_16x16x32_bf16 v[176:179], a[200:203], v[52:55], v[176:179]
    v_mfma_f32_16x16x32_bf16 v[176:179], a[204:207], v[56:59], v[176:179]
    ds_read_b64_tr_b16 a[178:179], v12 offset:32256
    v_mfma_f32_16x16x32_bf16 v[176:179], a[208:211], v[60:63], v[176:179]
    buffer_load_dwordx4 a[120:123], v1, s[24:27], s54 offen offset:2048 sc1
    v_mfma_f32_16x16x32_bf16 v[212:215], a[196:199], v[64:67], v[212:215]
    v_mfma_f32_16x16x32_bf16 v[212:215], a[200:203], v[68:71], v[212:215]
    buffer_load_dwordx4 v5, s[20:23], s87 offen offset:2048 lds
    v_mfma_f32_16x16x32_bf16 v[212:215], a[204:207], v[72:75], v[212:215]
    v_mfma_f32_16x16x32_bf16 v[212:215], a[208:211], v[76:79], v[212:215]
    v_mfma_f32_16x16x32_bf16 v[248:251], a[196:199], v[80:83], v[248:251]
    ds_read_b64_tr_b16 a[180:181], v2 offset:0
    v_mfma_f32_16x16x32_bf16 v[248:251], a[200:203], v[84:87], v[248:251]
    buffer_load_dwordx4 a[124:127], v1, s[24:27], s54 offen offset:3072 sc1
    v_mfma_f32_16x16x32_bf16 v[248:251], a[204:207], v[88:91], v[248:251]
    ds_read_b64_tr_b16 a[182:183], v2 offset:4608
    v_mfma_f32_16x16x32_bf16 v[248:251], a[208:211], v[92:95], v[248:251]
    v_mfma_f32_16x16x32_bf16 v[104:107], a[196:199], v[16:19], v[104:107]
    ds_read_b64_tr_b16 a[184:185], v2 offset:9216
    v_mfma_f32_16x16x32_bf16 v[104:107], a[200:203], v[20:23], v[104:107]
    v_mfma_f32_16x16x32_bf16 v[104:107], a[204:207], v[24:27], v[104:107]
    ds_read_b64_tr_b16 a[186:187], v2 offset:13824
    v_mfma_f32_16x16x32_bf16 v[104:107], a[208:211], v[28:31], v[104:107]
    s_waitcnt lgkmcnt(4)
    buffer_load_dwordx4 v6, s[20:23], s87 offen offset:3072 lds
    v_mfma_f32_16x16x32_bf16 v[144:147], a[164:167], v[32:35], v[144:147]
    s_xor_b32 s54, s49, 12288
    s_add_u32 s54, s54, s72
    ds_read_b64_tr_b16 a[188:189], v2 offset:18432
    v_mfma_f32_16x16x32_bf16 v[144:147], a[168:171], v[36:39], v[144:147]
    buffer_load_dwordx4 a[128:131], v1, s[24:27], s54 offen offset:0 sc1
    v_mfma_f32_16x16x32_bf16 v[144:147], a[172:175], v[40:43], v[144:147]
    s_and_b32 s66, s47, 3
    s_lshl_b32 s66, s66, 7
    ds_read_b64_tr_b16 a[190:191], v2 offset:23040
    v_mfma_f32_16x16x32_bf16 v[144:147], a[176:179], v[44:47], v[144:147]
    s_xor_b32 s52, s71, s66
    v_mfma_f32_16x16x32_bf16 v[180:183], a[164:167], v[48:51], v[180:183]
    ds_read_b64_tr_b16 a[192:193], v2 offset:27648
    v_mfma_f32_16x16x32_bf16 v[180:183], a[168:171], v[52:55], v[180:183]
    v_mfma_f32_16x16x32_bf16 v[180:183], a[172:175], v[56:59], v[180:183]
    ds_read_b64_tr_b16 a[194:195], v2 offset:32256
    v_mfma_f32_16x16x32_bf16 v[180:183], a[176:179], v[60:63], v[180:183]
    buffer_load_dwordx4 a[132:135], v1, s[24:27], s54 offen offset:1024 sc1
    v_mfma_f32_16x16x32_bf16 v[216:219], a[164:167], v[64:67], v[216:219]
    v_mfma_f32_16x16x32_bf16 v[216:219], a[168:171], v[68:71], v[216:219]
    s_and_b32 s66, s47, 12
    s_lshl_b32 s66, s66, 8
    s_xor_b32 s52, s52, s66
    v_mfma_f32_16x16x32_bf16 v[216:219], a[172:175], v[72:75], v[216:219]
    v_mfma_f32_16x16x32_bf16 v[216:219], a[176:179], v[76:79], v[216:219]
    v_mfma_f32_16x16x32_bf16 v[252:255], a[164:167], v[80:83], v[252:255]
    s_add_u32 m0, s55, 4096
    ds_read_b64_tr_b16 a[196:197], v2 offset:32
    v_mfma_f32_16x16x32_bf16 v[252:255], a[168:171], v[84:87], v[252:255]
    buffer_load_dwordx4 v7, s[20:23], s87 offen offset:0 lds
    v_mfma_f32_16x16x32_bf16 v[252:255], a[172:175], v[88:91], v[252:255]
    ds_read_b64_tr_b16 a[198:199], v2 offset:4640
    v_mfma_f32_16x16x32_bf16 v[252:255], a[176:179], v[92:95], v[252:255]
    buffer_load_dwordx4 a[136:139], v1, s[24:27], s54 offen offset:2048 sc1
    v_mfma_f32_16x16x32_bf16 v[108:111], a[164:167], v[16:19], v[108:111]
    ds_read_b64_tr_b16 a[200:201], v2 offset:9248
    v_mfma_f32_16x16x32_bf16 v[108:111], a[168:171], v[20:23], v[108:111]
    v_mfma_f32_16x16x32_bf16 v[108:111], a[172:175], v[24:27], v[108:111]
    ds_read_b64_tr_b16 a[202:203], v2 offset:13856
    v_mfma_f32_16x16x32_bf16 v[108:111], a[176:179], v[28:31], v[108:111]
    s_waitcnt lgkmcnt(4)
    v_mfma_f32_16x16x32_bf16 v[148:151], a[180:183], v[32:35], v[148:151]
    ds_read_b64_tr_b16 a[204:205], v2 offset:18464
    v_mfma_f32_16x16x32_bf16 v[148:151], a[184:187], v[36:39], v[148:151]
    buffer_load_dwordx4 a[140:143], v1, s[24:27], s54 offen offset:3072 sc1
    v_mfma_f32_16x16x32_bf16 v[148:151], a[188:191], v[40:43], v[148:151]
    ds_read_b64_tr_b16 a[206:207], v2 offset:23072
    v_mfma_f32_16x16x32_bf16 v[148:151], a[192:195], v[44:47], v[148:151]
    v_mfma_f32_16x16x32_bf16 v[184:187], a[180:183], v[48:51], v[184:187]
    ds_read_b64_tr_b16 a[208:209], v2 offset:27680
    v_mfma_f32_16x16x32_bf16 v[184:187], a[184:187], v[52:55], v[184:187]
    buffer_load_dwordx4 v8, s[20:23], s87 offen offset:1024 lds
    v_mfma_f32_16x16x32_bf16 v[184:187], a[188:191], v[56:59], v[184:187]
    ds_read_b64_tr_b16 a[210:211], v2 offset:32288
    v_mfma_f32_16x16x32_bf16 v[184:187], a[192:195], v[60:63], v[184:187]
    s_mov_b32 s54, s73
    v_mfma_f32_16x16x32_bf16 v[220:223], a[180:183], v[64:67], v[220:223]
    buffer_load_dwordx4 a[144:147], v1, s[24:27], s54 offen offset:0 sc1
    v_mfma_f32_16x16x32_bf16 v[220:223], a[184:187], v[68:71], v[220:223]
    v_mfma_f32_16x16x32_bf16 v[220:223], a[188:191], v[72:75], v[220:223]
    buffer_load_dword v15, off, s[24:27], s52 sc1
    v_mfma_f32_16x16x32_bf16 v[220:223], a[192:195], v[76:79], v[220:223]
    v_mfma_f32_16x16x32_bf16 a[160:163], a[180:183], v[80:83], a[160:163]
    v_mfma_f32_16x16x32_bf16 a[160:163], a[184:187], v[84:87], a[160:163]
    ds_read_b64_tr_b16 a[164:165], v2 offset:64
    v_mfma_f32_16x16x32_bf16 a[160:163], a[188:191], v[88:91], a[160:163]
    ds_read_b64_tr_b16 a[166:167], v2 offset:4672
    v_mfma_f32_16x16x32_bf16 a[160:163], a[192:195], v[92:95], a[160:163]
    buffer_load_dwordx4 a[148:151], v1, s[24:27], s54 offen offset:1024 sc1
    v_mfma_f32_16x16x32_bf16 v[112:115], a[180:183], v[16:19], v[112:115]
    ds_read_b64_tr_b16 a[168:169], v2 offset:9280
    v_mfma_f32_16x16x32_bf16 v[112:115], a[184:187], v[20:23], v[112:115]
    ds_read_b64_tr_b16 a[170:171], v2 offset:13888
    v_mfma_f32_16x16x32_bf16 v[112:115], a[188:191], v[24:27], v[112:115]
    buffer_load_dwordx4 v9, s[20:23], s87 offen offset:2048 lds
    v_mfma_f32_16x16x32_bf16 v[112:115], a[192:195], v[28:31], v[112:115]
    s_waitcnt lgkmcnt(4)
    ds_read_b64_tr_b16 a[172:173], v2 offset:18496
    v_mfma_f32_16x16x32_bf16 v[152:155], a[196:199], v[32:35], v[152:155]
    ds_read_b64_tr_b16 a[174:175], v2 offset:23104
    v_mfma_f32_16x16x32_bf16 v[152:155], a[200:203], v[36:39], v[152:155]
    v_mfma_f32_16x16x32_bf16 v[152:155], a[204:207], v[40:43], v[152:155]
    ds_read_b64_tr_b16 a[176:177], v2 offset:27712
    v_mfma_f32_16x16x32_bf16 v[152:155], a[208:211], v[44:47], v[152:155]
    ds_read_b64_tr_b16 a[178:179], v2 offset:32320
    v_mfma_f32_16x16x32_bf16 v[188:191], a[196:199], v[48:51], v[188:191]
    s_cmp_eq_u32 s56, 110592
    buffer_load_dwordx4 a[152:155], v1, s[24:27], s54 offen offset:2048 sc1
    v_mfma_f32_16x16x32_bf16 v[188:191], a[200:203], v[52:55], v[188:191]
    s_cselect_b32 s57, 0xfffe5000, s94
    s_add_u32 s56, s56, s57
    v_mfma_f32_16x16x32_bf16 v[188:191], a[204:207], v[56:59], v[188:191]
    ds_read_b64_tr_b16 a[180:181], v2 offset:96
    v_mfma_f32_16x16x32_bf16 v[188:191], a[208:211], v[60:63], v[188:191]
    ds_read_b64_tr_b16 a[182:183], v2 offset:4704
    v_mfma_f32_16x16x32_bf16 v[224:227], a[196:199], v[64:67], v[224:227]
    v_mfma_f32_16x16x32_bf16 v[224:227], a[200:203], v[68:71], v[224:227]
    ds_read_b64_tr_b16 a[184:185], v2 offset:9312
    v_mfma_f32_16x16x32_bf16 v[224:227], a[204:207], v[72:75], v[224:227]
    ds_read_b64_tr_b16 a[186:187], v2 offset:13920
    v_mfma_f32_16x16x32_bf16 v[224:227], a[208:211], v[76:79], v[224:227]
    buffer_load_dwordx4 a[156:159], v1, s[24:27], s54 offen offset:3072 sc1
    v_mfma_f32_16x16x32_bf16 v[116:119], a[196:199], v[16:19], v[116:119]
    ds_read_b64_tr_b16 a[188:189], v2 offset:18528
    v_mfma_f32_16x16x32_bf16 v[116:119], a[200:203], v[20:23], v[116:119]
    ds_read_b64_tr_b16 a[190:191], v2 offset:23136
    v_mfma_f32_16x16x32_bf16 v[116:119], a[204:207], v[24:27], v[116:119]
    buffer_load_dwordx4 v10, s[20:23], s87 offen offset:3072 lds
    v_mfma_f32_16x16x32_bf16 v[116:119], a[208:211], v[28:31], v[116:119]
    s_waitcnt lgkmcnt(6)
    ds_read_b64_tr_b16 a[192:193], v2 offset:27744
    v_mfma_f32_16x16x32_bf16 v[156:159], a[164:167], v[32:35], v[156:159]
    s_xor_b32 s54, s49, 0
    s_add_u32 s54, s54, s72
    ds_read_b64_tr_b16 a[194:195], v2 offset:32352
    v_mfma_f32_16x16x32_bf16 v[156:159], a[168:171], v[36:39], v[156:159]
    buffer_load_dwordx4 a[80:83], v1, s[24:27], s54 offen offset:0 sc1
    v_mfma_f32_16x16x32_bf16 v[156:159], a[172:175], v[40:43], v[156:159]
    s_and_b32 s66, s47, 3
    s_lshl_b32 s49, s66, 12
    s_xor_b32 s66, s66, s38
    v_mfma_f32_16x16x32_bf16 v[156:159], a[176:179], v[44:47], v[156:159]
    s_lshl_b32 s66, s66, 2
    s_bfe_u32 s67, s47, 0x20002
    ds_read_b64_tr_b16 a[196:197], v2 offset:128
    v_mfma_f32_16x16x32_bf16 v[192:195], a[164:167], v[48:51], v[192:195]
    s_xor_b32 s67, s67, s40
    s_add_u32 s66, s66, s67
    ds_read_b64_tr_b16 a[198:199], v2 offset:4736
    v_mfma_f32_16x16x32_bf16 v[192:195], a[168:171], v[52:55], v[192:195]
    s_lshl_b32 s66, s66, 1
    s_bfe_u32 s51, s47, 0x10004
    s_add_u32 s66, s66, s51
    v_mfma_f32_16x16x32_bf16 v[192:195], a[172:175], v[56:59], v[192:195]
    s_mul_i32 s66, s66, 73728
    s_add_u32 s72, s66, s64
    ds_read_b64_tr_b16 a[200:201], v2 offset:9344
    v_mfma_f32_16x16x32_bf16 v[192:195], a[176:179], v[60:63], v[192:195]
    s_add_u32 s73, s66, s65
    s_add_u32 s51, s51, 1
    ds_read_b64_tr_b16 a[202:203], v2 offset:13952
    v_mfma_f32_16x16x32_bf16 v[228:231], a[164:167], v[64:67], v[228:231]
    buffer_load_dwordx4 a[84:87], v1, s[24:27], s54 offen offset:1024 sc1
    v_mfma_f32_16x16x32_bf16 v[228:231], a[168:171], v[68:71], v[228:231]
    ds_read_b64_tr_b16 a[204:205], v2 offset:18560
    v_mfma_f32_16x16x32_bf16 v[228:231], a[172:175], v[72:75], v[228:231]
    s_add_u32 m0, s55, 8192
    ds_read_b64_tr_b16 a[206:207], v2 offset:23168
    v_mfma_f32_16x16x32_bf16 v[228:231], a[176:179], v[76:79], v[228:231]
    buffer_load_dwordx4 v11, s[20:23], s87 offen offset:0 lds
    v_mfma_f32_16x16x32_bf16 v[120:123], a[164:167], v[16:19], v[120:123]
    ds_read_b64_tr_b16 a[208:209], v2 offset:27776
    v_mfma_f32_16x16x32_bf16 v[120:123], a[168:171], v[20:23], v[120:123]
    ds_read_b64_tr_b16 a[210:211], v2 offset:32384
    v_mfma_f32_16x16x32_bf16 v[120:123], a[172:175], v[24:27], v[120:123]
    buffer_load_dwordx4 a[88:91], v1, s[24:27], s54 offen offset:2048 sc1
    v_mfma_f32_16x16x32_bf16 v[120:123], a[176:179], v[28:31], v[120:123]
    s_waitcnt lgkmcnt(8)
    v_add_u32 v13, s57, v13
    v_mfma_f32_16x16x32_bf16 v[160:163], a[180:183], v[32:35], v[160:163]
    v_add_u32 v14, s57, v14
    v_mfma_f32_16x16x32_bf16 v[160:163], a[184:187], v[36:39], v[160:163]
    v_add_u32 v0, s57, v0
    v_mfma_f32_16x16x32_bf16 v[160:163], a[188:191], v[40:43], v[160:163]
    v_add_u32 v12, s57, v12
    v_mfma_f32_16x16x32_bf16 v[160:163], a[192:195], v[44:47], v[160:163]
    v_add_u32 v2, s57, v2
    v_mfma_f32_16x16x32_bf16 v[196:199], a[180:183], v[48:51], v[196:199]
    v_mfma_f32_16x16x32_bf16 v[196:199], a[184:187], v[52:55], v[196:199]
    buffer_load_dwordx4 a[92:95], v1, s[24:27], s54 offen offset:3072 sc1
    v_mfma_f32_16x16x32_bf16 v[196:199], a[188:191], v[56:59], v[196:199]
    v_mfma_f32_16x16x32_bf16 v[196:199], a[192:195], v[60:63], v[196:199]
    v_mfma_f32_16x16x32_bf16 v[232:235], a[180:183], v[64:67], v[232:235]
    v_mfma_f32_16x16x32_bf16 v[232:235], a[184:187], v[68:71], v[232:235]
    v_mfma_f32_16x16x32_bf16 v[232:235], a[188:191], v[72:75], v[232:235]
    v_mfma_f32_16x16x32_bf16 v[232:235], a[192:195], v[76:79], v[232:235]
    v_mfma_f32_16x16x32_bf16 v[124:127], a[180:183], v[16:19], v[124:127]
    s_waitcnt vmcnt(30) lgkmcnt(0)
    v_mfma_f32_16x16x32_bf16 v[124:127], a[184:187], v[20:23], v[124:127]
    s_barrier
    v_mfma_f32_16x16x32_bf16 v[124:127], a[188:191], v[24:27], v[124:127]
    s_cmp_lg_u32 s36, 0
    s_cbranch_scc1 L_pub2
    v_accvgpr_write_b32 a255, 2
    buffer_store_dword a255, off, s[24:27], s71 sc1
L_pub2:
    v_mfma_f32_16x16x32_bf16 v[124:127], a[192:195], v[28:31], v[124:127]
    s_cmp_ge_u32 s56, 73728
    s_cselect_b32 s55, 0xfffee000, s95
    ds_read_b64_tr_b16 a[164:165], v13 offset:0
    v_mfma_f32_16x16x32_bf16 v[164:167], a[196:199], v[32:35], v[164:167]
    s_add_u32 s55, s55, s56
    s_add_u32 s55, s55, s86
    ds_read_b64_tr_b16 a[166:167], v13 offset:4608
    v_mfma_f32_16x16x32_bf16 v[164:167], a[200:203], v[36:39], v[164:167]
    ds_read_b64_tr_b16 a[168:169], v13 offset:9216
    v_mfma_f32_16x16x32_bf16 v[164:167], a[204:207], v[40:43], v[164:167]
    ds_read_b64_tr_b16 a[170:171], v13 offset:13824
    v_mfma_f32_16x16x32_bf16 v[164:167], a[208:211], v[44:47], v[164:167]
    ds_read_b64_tr_b16 a[172:173], v13 offset:18432
    v_mfma_f32_16x16x32_bf16 v[200:203], a[196:199], v[48:51], v[200:203]
    ds_read_b64_tr_b16 a[174:175], v13 offset:23040
    v_mfma_f32_16x16x32_bf16 v[200:203], a[200:203], v[52:55], v[200:203]
    ds_read_b64_tr_b16 a[176:177], v13 offset:27648
    v_mfma_f32_16x16x32_bf16 v[200:203], a[204:207], v[56:59], v[200:203]
    ds_read_b64_tr_b16 a[178:179], v13 offset:32256
    v_mfma_f32_16x16x32_bf16 v[200:203], a[208:211], v[60:63], v[200:203]
    ds_read_b64_tr_b16 a[180:181], v14 offset:0
    v_mfma_f32_16x16x32_bf16 v[236:239], a[196:199], v[64:67], v[236:239]
    ds_read_b64_tr_b16 a[182:183], v14 offset:4608
    v_mfma_f32_16x16x32_bf16 v[236:239], a[200:203], v[68:71], v[236:239]
    ds_read_b64_tr_b16 a[184:185], v14 offset:9216
    v_mfma_f32_16x16x32_bf16 v[236:239], a[204:207], v[72:75], v[236:239]
    ds_read_b64_tr_b16 a[186:187], v14 offset:13824
    v_mfma_f32_16x16x32_bf16 v[236:239], a[208:211], v[76:79], v[236:239]
    s_mov_b32 s47, 12
    ds_read_b64_tr_b16 a[188:189], v14 offset:18432
    v_mfma_f32_16x16x32_bf16 v[128:131], a[196:199], v[16:19], v[128:131]
    ds_read_b64_tr_b16 a[190:191], v14 offset:23040
    v_mfma_f32_16x16x32_bf16 v[128:131], a[200:203], v[20:23], v[128:131]
    ds_read_b64_tr_b16 a[192:193], v14 offset:27648
    v_mfma_f32_16x16x32_bf16 v[128:131], a[204:207], v[24:27], v[128:131]
    s_waitcnt vmcnt(25) lgkmcnt(7)
    ds_read_b64_tr_b16 a[194:195], v14 offset:32256
    v_mfma_f32_16x16x32_bf16 v[128:131], a[208:211], v[28:31], v[128:131]
    s_branch L_gz
    .p2align 6
L_gz:
    v_mfma_f32_16x16x32_bf16 v[132:135], a[164:167], a[96:99], v[132:135]
    s_waitcnt vmcnt(10)
    v_readfirstlane_b32 s54, v15
    v_mfma_f32_16x16x32_bf16 v[132:135], a[168:171], a[100:103], v[132:135]
    s_cmp_ge_u32 s54, s51
    s_cbranch_scc0 L_sp_g0
L_sb_g0:
    v_mfma_f32_16x16x32_bf16 v[132:135], a[172:175], a[104:107], v[132:135]
    v_mfma_f32_16x16x32_bf16 v[132:135], a[176:179], a[108:111], v[132:135]
    s_xor_b32 s54, s49, 4096
    s_add_u32 s54, s54, s72
    v_mfma_f32_16x16x32_bf16 v[168:171], a[164:167], a[112:115], v[168:171]
    buffer_load_dwordx4 a[16:19], v1, s[24:27], s54 offen offset:0 sc1
    v_mfma_f32_16x16x32_bf16 v[168:171], a[168:171], a[116:119], v[168:171]
    s_cmp_lt_u32 s61, s60
    s_cselect_b32 s63, 2, 1
    s_min_u32 s66, s60, s61
    v_mfma_f32_16x16x32_bf16 v[168:171], a[172:175], a[120:123], v[168:171]
    s_cmp_lt_u32 s62, s66
    s_cselect_b32 s63, 3, s63
    s_min_u32 s66, s66, s62
    v_mfma_f32_16x16x32_bf16 v[168:171], a[176:179], a[124:127], v[168:171]
    s_cmp_lt_u32 s66, 3
    s_cselect_b32 s63, s63, 64
    s_cmp_lt_u32 s59, 3
    v_mfma_f32_16x16x32_bf16 v[204:207], a[164:167], a[128:131], v[204:207]
    s_cselect_b32 s63, 0, s63
    s_cmp_lt_u32 s47, 32
    s_cselect_b32 s63, s63, 64
    v_mfma_f32_16x16x32_bf16 v[204:207], a[168:171], a[132:135], v[204:207]
    s_cmp_eq_u32 s63, s36
    s_cselect_b32 s59, 1, 0
    s_cselect_b32 s60, 1, 0
    v_mfma_f32_16x16x32_bf16 v[204:207], a[172:175], a[136:139], v[204:207]
    s_atomic_add s59, s[12:13], 0 glc
    s_and_b32 s66, s47, 3
    s_xor_b32 s66, s66, s38
    v_mfma_f32_16x16x32_bf16 v[204:207], a[176:179], a[140:143], v[204:207]
    s_waitcnt vmcnt(7)
    buffer_load_dwordx4 a[20:23], v1, s[24:27], s54 offen offset:1024 sc1
    v_mfma_f32_16x16x32_bf16 v[240:243], a[164:167], a[144:147], v[240:243]
    s_lshl_b32 s66, s66, 2
    s_bfe_u32 s67, s47, 0x20002
    ds_read_b64_tr_b16 a[196:197], v0 offset:0
    v_mfma_f32_16x16x32_bf16 v[240:243], a[168:171], a[148:151], v[240:243]
    s_xor_b32 s67, s67, s40
    s_add_u32 s66, s66, s67
    s_lshl_b32 s66, s66, 1
    v_mfma_f32_16x16x32_bf16 v[240:243], a[172:175], a[152:155], v[240:243]
    s_bfe_u32 s67, s47, 0x10004
    s_add_u32 s66, s66, s67
    ds_read_b64_tr_b16 a[198:199], v0 offset:4608
    v_mfma_f32_16x16x32_bf16 v[240:243], a[176:179], a[156:159], v[240:243]
    s_waitcnt vmcnt(2)
    s_lshl_b32 s66, s66, 2
    s_add_u32 s66, s66, s36
    v_mfma_f32_16x16x32_bf16 v[96:99], a[164:167], a[80:83], v[96:99]
    s_mul_i32 s66, s66, 36864
    s_cmp_lt_u32 s47, 32
    ds_read_b64_tr_b16 a[200:201], v0 offset:9216
    v_mfma_f32_16x16x32_bf16 v[96:99], a[168:171], a[84:87], v[96:99]
    s_cselect_b32 s87, s66, s58
    v_mfma_f32_16x16x32_bf16 v[96:99], a[172:175], a[88:91], v[96:99]
    ds_read_b64_tr_b16 a[202:203], v0 offset:13824
    v_mfma_f32_16x16x32_bf16 v[96:99], a[176:179], a[92:95], v[96:99]
    s_waitcnt lgkmcnt(4)
    buffer_load_dwordx4 a[24:27], v1, s[24:27], s54 offen offset:2048 sc1
    v_mfma_f32_16x16x32_bf16 v[136:139], a[180:183], a[96:99], v[136:139]
    s_add_u32 m0, s55, 0
    ds_read_b64_tr_b16 a[204:205], v0 offset:18432
    v_mfma_f32_16x16x32_bf16 v[136:139], a[184:187], a[100:103], v[136:139]
    buffer_load_dwordx4 v3, s[20:23], s87 offen offset:0 lds
    v_mfma_f32_16x16x32_bf16 v[136:139], a[188:191], a[104:107], v[136:139]
    ds_read_b64_tr_b16 a[206:207], v0 offset:23040
    v_mfma_f32_16x16x32_bf16 v[136:139], a[192:195], a[108:111], v[136:139]
    v_mfma_f32_16x16x32_bf16 v[172:175], a[180:183], a[112:115], v[172:175]
    ds_read_b64_tr_b16 a[208:209], v0 offset:27648
    v_mfma_f32_16x16x32_bf16 v[172:175], a[184:187], a[116:119], v[172:175]
    buffer_load_dwordx4 a[28:31], v1, s[24:27], s54 offen offset:3072 sc1
    v_mfma_f32_16x16x32_bf16 v[172:175], a[188:191], a[120:123], v[172:175]
    ds_read_b64_tr_b16 a[210:211], v0 offset:32256
    v_mfma_f32_16x16x32_bf16 v[172:175], a[192:195], a[124:127], v[172:175]
    v_mfma_f32_16x16x32_bf16 v[208:211], a[180:183], a[128:131], v[208:211]
    v_mfma_f32_16x16x32_bf16 v[208:211], a[184:187], a[132:135], v[208:211]
    v_mfma_f32_16x16x32_bf16 v[208:211], a[188:191], a[136:139], v[208:211]
    v_mfma_f32_16x16x32_bf16 v[208:211], a[192:195], a[140:143], v[208:211]
    v_mfma_f32_16x16x32_bf16 v[244:247], a[180:183], a[144:147], v[244:247]
    s_xor_b32 s54, s49, 8192
    s_add_u32 s54, s54, s72
    ds_read_b64_tr_b16 a[164:165], v12 offset:0
    v_mfma_f32_16x16x32_bf16 v[244:247], a[184:187], a[148:151], v[244:247]
    buffer_load_dwordx4 a[32:35], v1, s[24:27], s54 offen offset:0 sc1
    v_mfma_f32_16x16x32_bf16 v[244:247], a[188:191], a[152:155], v[244:247]
    ds_read_b64_tr_b16 a[166:167], v12 offset:4608
    v_mfma_f32_16x16x32_bf16 v[244:247], a[192:195], a[156:159], v[244:247]
    buffer_load_dwordx4 v4, s[20:23], s87 offen offset:1024 lds
    v_mfma_f32_16x16x32_bf16 v[100:103], a[180:183], a[80:83], v[100:103]
    ds_read_b64_tr_b16 a[168:169], v12 offset:9216
    v_mfma_f32_16x16x32_bf16 v[100:103], a[184:187], a[84:87], v[100:103]
    v_mfma_f32_16x16x32_bf16 v[100:103], a[188:191], a[88:91], v[100:103]
    ds_read_b64_tr_b16 a[170:171], v12 offset:13824
    v_mfma_f32_16x16x32_bf16 v[100:103], a[192:195], a[92:95], v[100:103]
    s_waitcnt lgkmcnt(4)
    buffer_load_dwordx4 a[36:39], v1, s[24:27], s54 offen offset:1024 sc1
    v_mfma_f32_16x16x32_bf16 v[140:143], a[196:199], a[96:99], v[140:143]
    ds_read_b64_tr_b16 a[172:173], v12 offset:18432
    v_mfma_f32_16x16x32_bf16 v[140:143], a[200:203], a[100:103], v[140:143]
    v_mfma_f32_16x16x32_bf16 v[140:143], a[204:207], a[104:107], v[140:143]
    ds_read_b64_tr_b16 a[174:175], v12 offset:23040
    v_mfma_f32_16x16x32_bf16 v[140:143], a[208:211], a[108:111], v[140:143]
    v_mfma_f32_16x16x32_bf16 v[176:179], a[196:199], a[112:115], v[176:179]
    ds_read_b64_tr_b16 a[176:177], v12 offset:27648
    v_mfma_f32_16x16x32_bf16 v[176:179], a[200:203], a[116:119], v[176:179]
    v_mfma_f32_16x16x32_bf16 v[176:179], a[204:207], a[120:123], v[176:179]
    ds_read_b64_tr_b16 a[178:179], v12 offset:32256
    v_mfma_f32_16x16x32_bf16 v[176:179], a[208:211], a[124:127], v[176:179]
    buffer_load_dwordx4 a[40:43], v1, s[24:27], s54 offen offset:2048 sc1
    v_mfma_f32_16x16x32_bf16 v[212:215], a[196:199], a[128:131], v[212:215]
    v_mfma_f32_16x16x32_bf16 v[212:215], a[200:203], a[132:135], v[212:215]
    buffer_load_dwordx4 v5, s[20:23], s87 offen offset:2048 lds
    v_mfma_f32_16x16x32_bf16 v[212:215], a[204:207], a[136:139], v[212:215]
    v_mov_b32 v19, s36
    v_mfma_f32_16x16x32_bf16 v[212:215], a[208:211], a[140:143], v[212:215]
    v_mfma_f32_16x16x32_bf16 v[248:251], a[196:199], a[144:147], v[248:251]
    ds_read_b64_tr_b16 a[180:181], v2 offset:0
    v_lshlrev_b32 v19, 2, v19
    v_mfma_f32_16x16x32_bf16 v[248:251], a[200:203], a[148:151], v[248:251]
    buffer_load_dwordx4 a[44:47], v1, s[24:27], s54 offen offset:3072 sc1
    v_mfma_f32_16x16x32_bf16 v[248:251], a[204:207], a[152:155], v[248:251]
    ds_read_b64_tr_b16 a[182:183], v2 offset:4608
    v_add_u32 v19, 147456, v19
    v_mfma_f32_16x16x32_bf16 v[248:251], a[208:211], a[156:159], v[248:251]
    v_mfma_f32_16x16x32_bf16 v[104:107], a[196:199], a[80:83], v[104:107]
    ds_read_b64_tr_b16 a[184:185], v2 offset:9216
    v_lshrrev_b32 v20, 2, v1
    v_mfma_f32_16x16x32_bf16 v[104:107], a[200:203], a[84:87], v[104:107]
    v_mfma_f32_16x16x32_bf16 v[104:107], a[204:207], a[88:91], v[104:107]
    ds_read_b64_tr_b16 a[186:187], v2 offset:13824
    v_and_b32 v20, 12, v20
    v_mfma_f32_16x16x32_bf16 v[104:107], a[208:211], a[92:95], v[104:107]
    s_waitcnt lgkmcnt(4)
    buffer_load_dwordx4 v6, s[20:23], s87 offen offset:3072 lds
    v_mfma_f32_16x16x32_bf16 v[144:147], a[164:167], a[96:99], v[144:147]
    s_xor_b32 s54, s49, 12288
    ds_read_b64_tr_b16 a[188:189], v2 offset:18432
    v_add_u32 v20, 147456, v20
    v_mfma_f32_16x16x32_bf16 v[144:147], a[168:171], a[100:103], v[144:147]
    s_add_u32 s54, s54, s72
    buffer_load_dwordx4 a[48:51], v1, s[24:27], s54 offen offset:0 sc1
    v_mfma_f32_16x16x32_bf16 v[144:147], a[172:175], a[104:107], v[144:147]
    s_and_b32 s66, s47, 3
    s_lshl_b32 s66, s66, 7
    ds_read_b64_tr_b16 a[190:191], v2 offset:23040
    v_mfma_f32_16x16x32_bf16 v[144:147], a[176:179], a[108:111], v[144:147]
    s_xor_b32 s52, s71, s66
    v_mfma_f32_16x16x32_bf16 v[180:183], a[164:167], a[112:115], v[180:183]
    ds_read_b64_tr_b16 a[192:193], v2 offset:27648
    v_mfma_f32_16x16x32_bf16 v[180:183], a[168:171], a[116:119], v[180:183]
    v_mfma_f32_16x16x32_bf16 v[180:183], a[172:175], a[120:123], v[180:183]
    ds_read_b64_tr_b16 a[194:195], v2 offset:32256
    v_mfma_f32_16x16x32_bf16 v[180:183], a[176:179], a[124:127], v[180:183]
    buffer_load_dwordx4 a[52:55], v1, s[24:27], s54 offen offset:1024 sc1
    v_mfma_f32_16x16x32_bf16 v[216:219], a[164:167], a[128:131], v[216:219]
    v_mfma_f32_16x16x32_bf16 v[216:219], a[168:171], a[132:135], v[216:219]
    s_and_b32 s66, s47, 12
    s_lshl_b32 s66, s66, 8
    s_xor_b32 s52, s52, s66
    v_mfma_f32_16x16x32_bf16 v[216:219], a[172:175], a[136:139], v[216:219]
    v_mfma_f32_16x16x32_bf16 v[216:219], a[176:179], a[140:143], v[216:219]
    v_mfma_f32_16x16x32_bf16 v[252:255], a[164:167], a[144:147], v[252:255]
    s_add_u32 m0, s55, 4096
    ds_read_b64_tr_b16 a[196:197], v2 offset:32
    v_mfma_f32_16x16x32_bf16 v[252:255], a[168:171], a[148:151], v[252:255]
    buffer_load_dwordx4 v7, s[20:23], s87 offen offset:0 lds
    v_mfma_f32_16x16x32_bf16 v[252:255], a[172:175], a[152:155], v[252:255]
    ds_read_b64_tr_b16 a[198:199], v2 offset:4640
    v_mfma_f32_16x16x32_bf16 v[252:255], a[176:179], a[156:159], v[252:255]
    buffer_load_dwordx4 a[56:59], v1, s[24:27], s54 offen offset:2048 sc1
    v_mfma_f32_16x16x32_bf16 v[108:111], a[164:167], a[80:83], v[108:111]
    ds_read_b64_tr_b16 a[200:201], v2 offset:9248
    v_mfma_f32_16x16x32_bf16 v[108:111], a[168:171], a[84:87], v[108:111]
    v_mfma_f32_16x16x32_bf16 v[108:111], a[172:175], a[88:91], v[108:111]
    ds_read_b64_tr_b16 a[202:203], v2 offset:13856
    v_mfma_f32_16x16x32_bf16 v[108:111], a[176:179], a[92:95], v[108:111]
    s_waitcnt lgkmcnt(4)
    v_mfma_f32_16x16x32_bf16 v[148:151], a[180:183], a[96:99], v[148:151]
    ds_read_b64_tr_b16 a[204:205], v2 offset:18464
    v_mfma_f32_16x16x32_bf16 v[148:151], a[184:187], a[100:103], v[148:151]
    buffer_load_dwordx4 a[60:63], v1, s[24:27], s54 offen offset:3072 sc1
    v_mfma_f32_16x16x32_bf16 v[148:151], a[188:191], a[104:107], v[148:151]
    ds_read_b64_tr_b16 a[206:207], v2 offset:23072
    v_mfma_f32_16x16x32_bf16 v[148:151], a[192:195], a[108:111], v[148:151]
    v_mfma_f32_16x16x32_bf16 v[184:187], a[180:183], a[112:115], v[184:187]
    ds_read_b64_tr_b16 a[208:209], v2 offset:27680
    v_mfma_f32_16x16x32_bf16 v[184:187], a[184:187], a[116:119], v[184:187]
    buffer_load_dwordx4 v8, s[20:23], s87 offen offset:1024 lds
    v_mfma_f32_16x16x32_bf16 v[184:187], a[188:191], a[120:123], v[184:187]
    ds_read_b64_tr_b16 a[210:211], v2 offset:32288
    v_mfma_f32_16x16x32_bf16 v[184:187], a[192:195], a[124:127], v[184:187]
    s_mov_b32 s54, s73
    v_mfma_f32_16x16x32_bf16 v[220:223], a[180:183], a[128:131], v[220:223]
    buffer_load_dwordx4 a[64:67], v1, s[24:27], s54 offen offset:0 sc1
    v_mfma_f32_16x16x32_bf16 v[220:223], a[184:187], a[132:135], v[220:223]
    v_mfma_f32_16x16x32_bf16 v[220:223], a[188:191], a[136:139], v[220:223]
    buffer_load_dword v15, off, s[24:27], s52 sc1
    v_mfma_f32_16x16x32_bf16 v[220:223], a[192:195], a[140:143], v[220:223]
    v_mfma_f32_16x16x32_bf16 a[160:163], a[180:183], a[144:147], a[160:163]
    v_mfma_f32_16x16x32_bf16 a[160:163], a[184:187], a[148:151], a[160:163]
    ds_read_b64_tr_b16 a[164:165], v2 offset:64
    v_mfma_f32_16x16x32_bf16 a[160:163], a[188:191], a[152:155], a[160:163]
    ds_read_b64_tr_b16 a[166:167], v2 offset:4672
    v_mfma_f32_16x16x32_bf16 a[160:163], a[192:195], a[156:159], a[160:163]
    buffer_load_dwordx4 a[68:71], v1, s[24:27], s54 offen offset:1024 sc1
    v_mfma_f32_16x16x32_bf16 v[112:115], a[180:183], a[80:83], v[112:115]
    ds_read_b64_tr_b16 a[168:169], v2 offset:9280
    v_mfma_f32_16x16x32_bf16 v[112:115], a[184:187], a[84:87], v[112:115]
    ds_read_b64_tr_b16 a[170:171], v2 offset:13888
    v_mfma_f32_16x16x32_bf16 v[112:115], a[188:191], a[88:91], v[112:115]
    buffer_load_dwordx4 v9, s[20:23], s87 offen offset:2048 lds
    v_mfma_f32_16x16x32_bf16 v[112:115], a[192:195], a[92:95], v[112:115]
    s_waitcnt lgkmcnt(4)
    ds_read_b64_tr_b16 a[172:173], v2 offset:18496
    v_mfma_f32_16x16x32_bf16 v[152:155], a[196:199], a[96:99], v[152:155]
    ds_read_b64_tr_b16 a[174:175], v2 offset:23104
    v_mfma_f32_16x16x32_bf16 v[152:155], a[200:203], a[100:103], v[152:155]
    v_mfma_f32_16x16x32_bf16 v[152:155], a[204:207], a[104:107], v[152:155]
    ds_read_b64_tr_b16 a[176:177], v2 offset:27712
    v_mfma_f32_16x16x32_bf16 v[152:155], a[208:211], a[108:111], v[152:155]
    ds_read_b64_tr_b16 a[178:179], v2 offset:32320
    v_mfma_f32_16x16x32_bf16 v[188:191], a[196:199], a[112:115], v[188:191]
    s_cmp_eq_u32 s56, 110592
    buffer_load_dwordx4 a[72:75], v1, s[24:27], s54 offen offset:2048 sc1
    v_mfma_f32_16x16x32_bf16 v[188:191], a[200:203], a[116:119], v[188:191]
    s_cselect_b32 s57, 0xfffe5000, s94
    s_add_u32 s56, s56, s57
    v_mfma_f32_16x16x32_bf16 v[188:191], a[204:207], a[120:123], v[188:191]
    ds_read_b64_tr_b16 a[180:181], v2 offset:96
    v_mfma_f32_16x16x32_bf16 v[188:191], a[208:211], a[124:127], v[188:191]
    ds_read_b64_tr_b16 a[182:183], v2 offset:4704
    v_mfma_f32_16x16x32_bf16 v[224:227], a[196:199], a[128:131], v[224:227]
    v_mfma_f32_16x16x32_bf16 v[224:227], a[200:203], a[132:135], v[224:227]
    ds_read_b64_tr_b16 a[184:185], v2 offset:9312
    v_mfma_f32_16x16x32_bf16 v[224:227], a[204:207], a[136:139], v[224:227]
    ds_read_b64_tr_b16 a[186:187], v2 offset:13920
    v_mfma_f32_16x16x32_bf16 v[224:227], a[208:211], a[140:143], v[224:227]
    buffer_load_dwordx4 a[76:79], v1, s[24:27], s54 offen offset:3072 sc1
    v_mfma_f32_16x16x32_bf16 v[116:119], a[196:199], a[80:83], v[116:119]
    ds_read_b64_tr_b16 a[188:189], v2 offset:18528
    v_mfma_f32_16x16x32_bf16 v[116:119], a[200:203], a[84:87], v[116:119]
    ds_read_b64_tr_b16 a[190:191], v2 offset:23136
    v_mfma_f32_16x16x32_bf16 v[116:119], a[204:207], a[88:91], v[116:119]
    buffer_load_dwordx4 v10, s[20:23], s87 offen offset:3072 lds
    v_mfma_f32_16x16x32_bf16 v[116:119], a[208:211], a[92:95], v[116:119]
    s_waitcnt lgkmcnt(6)
    ds_read_b64_tr_b16 a[192:193], v2 offset:27744
    v_mfma_f32_16x16x32_bf16 v[156:159], a[164:167], a[96:99], v[156:159]
    s_xor_b32 s54, s49, 0
    s_add_u32 s54, s54, s72
    ds_read_b64_tr_b16 a[194:195], v2 offset:32352
    v_mfma_f32_16x16x32_bf16 v[156:159], a[168:171], a[100:103], v[156:159]
    buffer_load_dwordx4 a[0:3], v1, s[24:27], s54 offen offset:0 sc1
    v_mfma_f32_16x16x32_bf16 v[156:159], a[172:175], a[104:107], v[156:159]
    s_and_b32 s66, s47, 3
    s_lshl_b32 s49, s66, 12
    s_xor_b32 s66, s66, s38
    v_mfma_f32_16x16x32_bf16 v[156:159], a[176:179], a[108:111], v[156:159]
    s_lshl_b32 s66, s66, 2
    s_bfe_u32 s67, s47, 0x20002
    ds_read_b64_tr_b16 a[196:197], v2 offset:128
    v_mfma_f32_16x16x32_bf16 v[192:195], a[164:167], a[112:115], v[192:195]
    s_xor_b32 s67, s67, s40
    s_add_u32 s66, s66, s67
    ds_read_b64_tr_b16 a[198:199], v2 offset:4736
    v_mfma_f32_16x16x32_bf16 v[192:195], a[168:171], a[116:119], v[192:195]
    s_lshl_b32 s66, s66, 1
    s_bfe_u32 s51, s47, 0x10004
    s_add_u32 s66, s66, s51
    v_mfma_f32_16x16x32_bf16 v[192:195], a[172:175], a[120:123], v[192:195]
    s_mul_i32 s66, s66, 73728
    s_add_u32 s72, s66, s64
    ds_read_b64_tr_b16 a[200:201], v2 offset:9344
    v_mfma_f32_16x16x32_bf16 v[192:195], a[176:179], a[124:127], v[192:195]
    s_add_u32 s73, s66, s65
    s_add_u32 s51, s51, 1
    ds_read_b64_tr_b16 a[202:203], v2 offset:13952
    v_mfma_f32_16x16x32_bf16 v[228:231], a[164:167], a[128:131], v[228:231]
    buffer_load_dwordx4 a[4:7], v1, s[24:27], s54 offen offset:1024 sc1
    v_mfma_f32_16x16x32_bf16 v[228:231], a[168:171], a[132:135], v[228:231]
    ds_read_b64_tr_b16 a[204:205], v2 offset:18560
    v_mfma_f32_16x16x32_bf16 v[228:231], a[172:175], a[136:139], v[228:231]
    s_add_u32 m0, s55, 8192
    ds_read_b64_tr_b16 a[206:207], v2 offset:23168
    v_mfma_f32_16x16x32_bf16 v[228:231], a[176:179], a[140:143], v[228:231]
    buffer_load_dwordx4 v11, s[20:23], s87 offen offset:0 lds
    v_mfma_f32_16x16x32_bf16 v[120:123], a[164:167], a[80:83], v[120:123]
    ds_read_b64_tr_b16 a[208:209], v2 offset:27776
    v_mfma_f32_16x16x32_bf16 v[120:123], a[168:171], a[84:87], v[120:123]
    ds_read_b64_tr_b16 a[210:211], v2 offset:32384
    v_mfma_f32_16x16x32_bf16 v[120:123], a[172:175], a[88:91], v[120:123]
    buffer_load_dwordx4 a[8:11], v1, s[24:27], s54 offen offset:2048 sc1
    v_mfma_f32_16x16x32_bf16 v[120:123], a[176:179], a[92:95], v[120:123]
    s_waitcnt lgkmcnt(8)
    v_add_u32 v13, s57, v13
    v_mfma_f32_16x16x32_bf16 v[160:163], a[180:183], a[96:99], v[160:163]
    v_add_u32 v14, s57, v14
    v_mfma_f32_16x16x32_bf16 v[160:163], a[184:187], a[100:103], v[160:163]
    v_add_u32 v0, s57, v0
    v_mfma_f32_16x16x32_bf16 v[160:163], a[188:191], a[104:107], v[160:163]
    v_add_u32 v12, s57, v12
    v_mfma_f32_16x16x32_bf16 v[160:163], a[192:195], a[108:111], v[160:163]
    v_add_u32 v2, s57, v2
    v_mfma_f32_16x16x32_bf16 v[196:199], a[180:183], a[112:115], v[196:199]
    s_waitcnt lgkmcnt(0)
    v_mov_b32 v18, s59
    v_mfma_f32_16x16x32_bf16 v[196:199], a[184:187], a[116:119], v[196:199]
    buffer_load_dwordx4 a[12:15], v1, s[24:27], s54 offen offset:3072 sc1
    v_add_u32 v18, s60, v18
    v_mfma_f32_16x16x32_bf16 v[196:199], a[188:191], a[120:123], v[196:199]
    ds_write_b32 v19, v18 offset:0
    v_mfma_f32_16x16x32_bf16 v[196:199], a[192:195], a[124:127], v[196:199]
    v_mfma_f32_16x16x32_bf16 v[232:235], a[180:183], a[128:131], v[232:235]
    v_mfma_f32_16x16x32_bf16 v[232:235], a[184:187], a[132:135], v[232:235]
    v_mfma_f32_16x16x32_bf16 v[232:235], a[188:191], a[136:139], v[232:235]
    v_mfma_f32_16x16x32_bf16 v[232:235], a[192:195], a[140:143], v[232:235]
    v_mfma_f32_16x16x32_bf16 v[124:127], a[180:183], a[80:83], v[124:127]
    s_waitcnt lgkmcnt(0)
    v_mfma_f32_16x16x32_bf16 v[124:127], a[184:187], a[84:87], v[124:127]
    s_barrier
    v_mfma_f32_16x16x32_bf16 v[124:127], a[188:191], a[88:91], v[124:127]
    ds_read_b32 v18, v20 offset:0
    v_mfma_f32_16x16x32_bf16 v[124:127], a[192:195], a[92:95], v[124:127]
    s_cmp_ge_u32 s56, 73728
    s_cselect_b32 s55, 0xfffee000, s95
    ds_read_b64_tr_b16 a[164:165], v13 offset:0
    v_mfma_f32_16x16x32_bf16 v[164:167], a[196:199], a[96:99], v[164:167]
    s_add_u32 s55, s55, s56
    s_add_u32 s55, s55, s86
    ds_read_b64_tr_b16 a[166:167], v13 offset:4608
    v_mfma_f32_16x16x32_bf16 v[164:167], a[200:203], a[100:103], v[164:167]
    ds_read_b64_tr_b16 a[168:169], v13 offset:9216
    v_mfma_f32_16x16x32_bf16 v[164:167], a[204:207], a[104:107], v[164:167]
    ds_read_b64_tr_b16 a[170:171], v13 offset:13824
    v_mfma_f32_16x16x32_bf16 v[164:167], a[208:211], a[108:111], v[164:167]
    ds_read_b64_tr_b16 a[172:173], v13 offset:18432
    v_mfma_f32_16x16x32_bf16 v[200:203], a[196:199], a[112:115], v[200:203]
    ds_read_b64_tr_b16 a[174:175], v13 offset:23040
    v_mfma_f32_16x16x32_bf16 v[200:203], a[200:203], a[116:119], v[200:203]
    s_waitcnt lgkmcnt(6)
    ds_read_b64_tr_b16 a[176:177], v13 offset:27648
    v_readlane_b32 s67, v18, s63
    v_mfma_f32_16x16x32_bf16 v[200:203], a[204:207], a[120:123], v[200:203]
    s_lshl_b32 s66, s67, 2
    ds_read_b64_tr_b16 a[178:179], v13 offset:32256
    v_readlane_b32 s59, v18, 0
    v_mfma_f32_16x16x32_bf16 v[200:203], a[208:211], a[124:127], v[200:203]
    s_or_b32 s66, s66, s63
    ds_read_b64_tr_b16 a[180:181], v14 offset:0
    v_readlane_b32 s60, v18, 1
    v_mfma_f32_16x16x32_bf16 v[236:239], a[196:199], a[128:131], v[236:239]
    s_or_b32 s66, s66, 16
    ds_read_b64_tr_b16 a[182:183], v14 offset:4608
    v_readlane_b32 s61, v18, 2
    v_mfma_f32_16x16x32_bf16 v[236:239], a[200:203], a[132:135], v[236:239]
    s_cmp_le_u32 s67, 3
    ds_read_b64_tr_b16 a[184:185], v14 offset:9216
    v_readlane_b32 s62, v18, 3
    v_mfma_f32_16x16x32_bf16 v[236:239], a[204:207], a[136:139], v[236:239]
    s_cselect_b32 s48, s66, 64
    ds_read_b64_tr_b16 a[186:187], v14 offset:13824
    v_mfma_f32_16x16x32_bf16 v[236:239], a[208:211], a[140:143], v[236:239]
    s_cmp_lt_u32 s47, 32
    s_mov_b32 s47, s48
    ds_read_b64_tr_b16 a[188:189], v14 offset:18432
    v_mfma_f32_16x16x32_bf16 v[128:131], a[196:199], a[80:83], v[128:131]
    ds_read_b64_tr_b16 a[190:191], v14 offset:23040
    v_mfma_f32_16x16x32_bf16 v[128:131], a[200:203], a[84:87], v[128:131]
    ds_read_b64_tr_b16 a[192:193], v14 offset:27648
    v_mfma_f32_16x16x32_bf16 v[128:131], a[204:207], a[88:91], v[128:131]
    s_waitcnt vmcnt(25) lgkmcnt(7)
    ds_read_b64_tr_b16 a[194:195], v14 offset:32256
    v_mfma_f32_16x16x32_bf16 v[128:131], a[208:211], a[92:95], v[128:131]
    s_cbranch_scc0 L_lastx
    v_mfma_f32_16x16x32_bf16 v[132:135], a[164:167], a[16:19], v[132:135]
    s_waitcnt vmcnt(10)
    v_readfirstlane_b32 s54, v15
    v_mfma_f32_16x16x32_bf16 v[132:135], a[168:171], a[20:23], v[132:135]
    s_cmp_ge_u32 s54, s51
    s_cbranch_scc0 L_sp_g1
L_sb_g1:
    v_mfma_f32_16x16x32_bf16 v[132:135], a[172:175], a[24:27], v[132:135]
    v_mfma_f32_16x16x32_bf16 v[132:135], a[176:179], a[28:31], v[132:135]
    s_xor_b32 s54, s49, 4096
    s_add_u32 s54, s54, s72
    v_mfma_f32_16x16x32_bf16 v[168:171], a[164:167], a[32:35], v[168:171]
    buffer_load_dwordx4 a[96:99], v1, s[24:27], s54 offen offset:0 sc1
    v_mfma_f32_16x16x32_bf16 v[168:171], a[168:171], a[36:39], v[168:171]
    s_cmp_lt_u32 s61, s60
    s_cselect_b32 s63, 2, 1
    s_min_u32 s66, s60, s61
    v_mfma_f32_16x16x32_bf16 v[168:171], a[172:175], a[40:43], v[168:171]
    s_cmp_lt_u32 s62, s66
    s_cselect_b32 s63, 3, s63
    s_min_u32 s66, s66, s62
    v_mfma_f32_16x16x32_bf16 v[168:171], a[176:179], a[44:47], v[168:171]
    s_cmp_lt_u32 s66, 3
    s_cselect_b32 s63, s63, 64
    s_cmp_lt_u32 s59, 3
    v_mfma_f32_16x16x32_bf16 v[204:207], a[164:167], a[48:51], v[204:207]
    s_cselect_b32 s63, 0, s63
    s_cmp_lt_u32 s47, 32
    s_cselect_b32 s63, s63, 64
    v_mfma_f32_16x16x32_bf16 v[204:207], a[168:171], a[52:55], v[204:207]
    s_cmp_eq_u32 s63, s36
    s_cselect_b32 s59, 1, 0
    s_cselect_b32 s60, 1, 0
    v_mfma_f32_16x16x32_bf16 v[204:207], a[172:175], a[56:59], v[204:207]
    s_atomic_add s59, s[12:13], 0 glc
    s_and_b32 s66, s47, 3
    s_xor_b32 s66, s66, s38
    v_mfma_f32_16x16x32_bf16 v[204:207], a[176:179], a[60:63], v[204:207]
    s_waitcnt vmcnt(7)
    buffer_load_dwordx4 a[100:103], v1, s[24:27], s54 offen offset:1024 sc1
    v_mfma_f32_16x16x32_bf16 v[240:243], a[164:167], a[64:67], v[240:243]
    s_lshl_b32 s66, s66, 2
    s_bfe_u32 s67, s47, 0x20002
    ds_read_b64_tr_b16 a[196:197], v0 offset:0
    v_mfma_f32_16x16x32_bf16 v[240:243], a[168:171], a[68:71], v[240:243]
    s_xor_b32 s67, s67, s40
    s_add_u32 s66, s66, s67
    s_lshl_b32 s66, s66, 1
    v_mfma_f32_16x16x32_bf16 v[240:243], a[172:175], a[72:75], v[240:243]
    s_bfe_u32 s67, s47, 0x10004
    s_add_u32 s66, s66, s67
    ds_read_b64_tr_b16 a[198:199], v0 offset:4608
    v_mfma_f32_16x16x32_bf16 v[240:243], a[176:179], a[76:79], v[240:243]
    s_waitcnt vmcnt(2)
    s_lshl_b32 s66, s66, 2
    s_add_u32 s66, s66, s36
    v_mfma_f32_16x16x32_bf16 v[96:99], a[164:167], a[0:3], v[96:99]
    s_mul_i32 s66, s66, 36864
    s_cmp_lt_u32 s47, 32
    ds_read_b64_tr_b16 a[200:201], v0 offset:9216
    v_mfma_f32_16x16x32_bf16 v[96:99], a[168:171], a[4:7], v[96:99]
    s_cselect_b32 s87, s66, s58
    v_mfma_f32_16x16x32_bf16 v[96:99], a[172:175], a[8:11], v[96:99]
    ds_read_b64_tr_b16 a[202:203], v0 offset:13824
    v_mfma_f32_16x16x32_bf16 v[96:99], a[176:179], a[12:15], v[96:99]
    s_waitcnt lgkmcnt(4)
    buffer_load_dwordx4 a[104:107], v1, s[24:27], s54 offen offset:2048 sc1
    v_mfma_f32_16x16x32_bf16 v[136:139], a[180:183], a[16:19], v[136:139]
    s_add_u32 m0, s55, 0
    ds_read_b64_tr_b16 a[204:205], v0 offset:18432
    v_mfma_f32_16x16x32_bf16 v[136:139], a[184:187], a[20:23], v[136:139]
    buffer_load_dwordx4 v3, s[20:23], s87 offen offset:0 lds
    v_mfma_f32_16x16x32_bf16 v[136:139], a[188:191], a[24:27], v[136:139]
    ds_read_b64_tr_b16 a[206:207], v0 offset:23040
    v_mfma_f32_16x16x32_bf16 v[136:139], a[192:195], a[28:31], v[136:139]
    v_mfma_f32_16x16x32_bf16 v[172:175], a[180:183], a[32:35], v[172:175]
    ds_read_b64_tr_b16 a[208:209], v0 offset:27648
    v_mfma_f32_16x16x32_bf16 v[172:175], a[184:187], a[36:39], v[172:175]
    buffer_load_dwordx4 a[108:111], v1, s[24:27], s54 offen offset:3072 sc1
    v_mfma_f32_16x16x32_bf16 v[172:175], a[188:191], a[40:43], v[172:175]
    ds_read_b64_tr_b16 a[210:211], v0 offset:32256
    v_mfma_f32_16x16x32_bf16 v[172:175], a[192:195], a[44:47], v[172:175]
    v_mfma_f32_16x16x32_bf16 v[208:211], a[180:183], a[48:51], v[208:211]
    v_mfma_f32_16x16x32_bf16 v[208:211], a[184:187], a[52:55], v[208:211]
    v_mfma_f32_16x16x32_bf16 v[208:211], a[188:191], a[56:59], v[208:211]
    v_mfma_f32_16x16x32_bf16 v[208:211], a[192:195], a[60:63], v[208:211]
    v_mfma_f32_16x16x32_bf16 v[244:247], a[180:183], a[64:67], v[244:247]
    s_xor_b32 s54, s49, 8192
    s_add_u32 s54, s54, s72
    ds_read_b64_tr_b16 a[164:165], v12 offset:0
    v_mfma_f32_16x16x32_bf16 v[244:247], a[184:187], a[68:71], v[244:247]
    buffer_load_dwordx4 a[112:115], v1, s[24:27], s54 offen offset:0 sc1
    v_mfma_f32_16x16x32_bf16 v[244:247], a[188:191], a[72:75], v[244:247]
    ds_read_b64_tr_b16 a[166:167], v12 offset:4608
    v_mfma_f32_16x16x32_bf16 v[244:247], a[192:195], a[76:79], v[244:247]
    buffer_load_dwordx4 v4, s[20:23], s87 offen offset:1024 lds
    v_mfma_f32_16x16x32_bf16 v[100:103], a[180:183], a[0:3], v[100:103]
    ds_read_b64_tr_b16 a[168:169], v12 offset:9216
    v_mfma_f32_16x16x32_bf16 v[100:103], a[184:187], a[4:7], v[100:103]
    v_mfma_f32_16x16x32_bf16 v[100:103], a[188:191], a[8:11], v[100:103]
    ds_read_b64_tr_b16 a[170:171], v12 offset:13824
    v_mfma_f32_16x16x32_bf16 v[100:103], a[192:195], a[12:15], v[100:103]
    s_waitcnt lgkmcnt(4)
    buffer_load_dwordx4 a[116:119], v1, s[24:27], s54 offen offset:1024 sc1
    v_mfma_f32_16x16x32_bf16 v[140:143], a[196:199], a[16:19], v[140:143]
    ds_read_b64_tr_b16 a[172:173], v12 offset:18432
    v_mfma_f32_16x16x32_bf16 v[140:143], a[200:203], a[20:23], v[140:143]
    v_mfma_f32_16x16x32_bf16 v[140:143], a[204:207], a[24:27], v[140:143]
    ds_read_b64_tr_b16 a[174:175], v12 offset:23040
    v_mfma_f32_16x16x32_bf16 v[140:143], a[208:211], a[28:31], v[140:143]
    v_mfma_f32_16x16x32_bf16 v[176:179], a[196:199], a[32:35], v[176:179]
    ds_read_b64_tr_b16 a[176:177], v12 offset:27648
    v_mfma_f32_16x16x32_bf16 v[176:179], a[200:203], a[36:39], v[176:179]
    v_mfma_f32_16x16x32_bf16 v[176:179], a[204:207], a[40:43], v[176:179]
    ds_read_b64_tr_b16 a[178:179], v12 offset:32256
    v_mfma_f32_16x16x32_bf16 v[176:179], a[208:211], a[44:47], v[176:179]
    buffer_load_dwordx4 a[120:123], v1, s[24:27], s54 offen offset:2048 sc1
    v_mfma_f32_16x16x32_bf16 v[212:215], a[196:199], a[48:51], v[212:215]
    v_mfma_f32_16x16x32_bf16 v[212:215], a[200:203], a[52:55], v[212:215]
    buffer_load_dwordx4 v5, s[20:23], s87 offen offset:2048 lds
    v_mfma_f32_16x16x32_bf16 v[212:215], a[204:207], a[56:59], v[212:215]
    v_mov_b32 v19, s36
    v_mfma_f32_16x16x32_bf16 v[212:215], a[208:211], a[60:63], v[212:215]
    v_mfma_f32_16x16x32_bf16 v[248:251], a[196:199], a[64:67], v[248:251]
    ds_read_b64_tr_b16 a[180:181], v2 offset:0
    v_lshlrev_b32 v19, 2, v19
    v_mfma_f32_16x16x32_bf16 v[248:251], a[200:203], a[68:71], v[248:251]
    buffer_load_dwordx4 a[124:127], v1, s[24:27], s54 offen offset:3072 sc1
    v_mfma_f32_16x16x32_bf16 v[248:251], a[204:207], a[72:75], v[248:251]
    ds_read_b64_tr_b16 a[182:183], v2 offset:4608
    v_add_u32 v19, 147456, v19
    v_mfma_f32_16x16x32_bf16 v[248:251], a[208:211], a[76:79], v[248:251]
    v_mfma_f32_16x16x32_bf16 v[104:107], a[196:199], a[0:3], v[104:107]
    ds_read_b64_tr_b16 a[184:185], v2 offset:9216
    v_lshrrev_b32 v20, 2, v1
    v_mfma_f32_16x16x32_bf16 v[104:107], a[200:203], a[4:7], v[104:107]
    v_mfma_f32_16x16x32_bf16 v[104:107], a[204:207], a[8:11], v[104:107]
    ds_read_b64_tr_b16 a[186:187], v2 offset:13824
    v_and_b32 v20, 12, v20
    v_mfma_f32_16x16x32_bf16 v[104:107], a[208:211], a[12:15], v[104:107]
    s_waitcnt lgkmcnt(4)
    buffer_load_dwordx4 v6, s[20:23], s87 offen offset:3072 lds
    v_mfma_f32_16x16x32_bf16 v[144:147], a[164:167], a[16:19], v[144:147]
    s_xor_b32 s54, s49, 12288
    ds_read_b64_tr_b16 a[188:189], v2 offset:18432
    v_add_u32 v20, 147456, v20
    v_mfma_f32_16x16x32_bf16 v[144:147], a[168:171], a[20:23], v[144:147]
    s_add_u32 s54, s54, s72
    buffer_load_dwordx4 a[128:131], v1, s[24:27], s54 offen offset:0 sc1
    v_mfma_f32_16x16x32_bf16 v[144:147], a[172:175], a[24:27], v[144:147]
    s_and_b32 s66, s47, 3
    s_lshl_b32 s66, s66, 7
    ds_read_b64_tr_b16 a[190:191], v2 offset:23040
    v_mfma_f32_16x16x32_bf16 v[144:147], a[176:179], a[28:31], v[144:147]
    s_xor_b32 s52, s71, s66
    v_mfma_f32_16x16x32_bf16 v[180:183], a[164:167], a[32:35], v[180:183]
    ds_read_b64_tr_b16 a[192:193], v2 offset:27648
    v_mfma_f32_16x16x32_bf16 v[180:183], a[168:171], a[36:39], v[180:183]
    v_mfma_f32_16x16x32_bf16 v[180:183], a[172:175], a[40:43], v[180:183]
    ds_read_b64_tr_b16 a[194:195], v2 offset:32256
    v_mfma_f32_16x16x32_bf16 v[180:183], a[176:179], a[44:47], v[180:183]
    buffer_load_dwordx4 a[132:135], v1, s[24:27], s54 offen offset:1024 sc1
    v_mfma_f32_16x16x32_bf16 v[216:219], a[164:167], a[48:51], v[216:219]
    v_mfma_f32_16x16x32_bf16 v[216:219], a[168:171], a[52:55], v[216:219]
    s_and_b32 s66, s47, 12
    s_lshl_b32 s66, s66, 8
    s_xor_b32 s52, s52, s66
    v_mfma_f32_16x16x32_bf16 v[216:219], a[172:175], a[56:59], v[216:219]
    v_mfma_f32_16x16x32_bf16 v[216:219], a[176:179], a[60:63], v[216:219]
    v_mfma_f32_16x16x32_bf16 v[252:255], a[164:167], a[64:67], v[252:255]
    s_add_u32 m0, s55, 4096
    ds_read_b64_tr_b16 a[196:197], v2 offset:32
    v_mfma_f32_16x16x32_bf16 v[252:255], a[168:171], a[68:71], v[252:255]
    buffer_load_dwordx4 v7, s[20:23], s87 offen offset:0 lds
    v_mfma_f32_16x16x32_bf16 v[252:255], a[172:175], a[72:75], v[252:255]
    ds_read_b64_tr_b16 a[198:199], v2 offset:4640
    v_mfma_f32_16x16x32_bf16 v[252:255], a[176:179], a[76:79], v[252:255]
    buffer_load_dwordx4 a[136:139], v1, s[24:27], s54 offen offset:2048 sc1
    v_mfma_f32_16x16x32_bf16 v[108:111], a[164:167], a[0:3], v[108:111]
    ds_read_b64_tr_b16 a[200:201], v2 offset:9248
    v_mfma_f32_16x16x32_bf16 v[108:111], a[168:171], a[4:7], v[108:111]
    v_mfma_f32_16x16x32_bf16 v[108:111], a[172:175], a[8:11], v[108:111]
    ds_read_b64_tr_b16 a[202:203], v2 offset:13856
    v_mfma_f32_16x16x32_bf16 v[108:111], a[176:179], a[12:15], v[108:111]
    s_waitcnt lgkmcnt(4)
    v_mfma_f32_16x16x32_bf16 v[148:151], a[180:183], a[16:19], v[148:151]
    ds_read_b64_tr_b16 a[204:205], v2 offset:18464
    v_mfma_f32_16x16x32_bf16 v[148:151], a[184:187], a[20:23], v[148:151]
    buffer_load_dwordx4 a[140:143], v1, s[24:27], s54 offen offset:3072 sc1
    v_mfma_f32_16x16x32_bf16 v[148:151], a[188:191], a[24:27], v[148:151]
    ds_read_b64_tr_b16 a[206:207], v2 offset:23072
    v_mfma_f32_16x16x32_bf16 v[148:151], a[192:195], a[28:31], v[148:151]
    v_mfma_f32_16x16x32_bf16 v[184:187], a[180:183], a[32:35], v[184:187]
    ds_read_b64_tr_b16 a[208:209], v2 offset:27680
    v_mfma_f32_16x16x32_bf16 v[184:187], a[184:187], a[36:39], v[184:187]
    buffer_load_dwordx4 v8, s[20:23], s87 offen offset:1024 lds
    v_mfma_f32_16x16x32_bf16 v[184:187], a[188:191], a[40:43], v[184:187]
    ds_read_b64_tr_b16 a[210:211], v2 offset:32288
    v_mfma_f32_16x16x32_bf16 v[184:187], a[192:195], a[44:47], v[184:187]
    s_mov_b32 s54, s73
    v_mfma_f32_16x16x32_bf16 v[220:223], a[180:183], a[48:51], v[220:223]
    buffer_load_dwordx4 a[144:147], v1, s[24:27], s54 offen offset:0 sc1
    v_mfma_f32_16x16x32_bf16 v[220:223], a[184:187], a[52:55], v[220:223]
    v_mfma_f32_16x16x32_bf16 v[220:223], a[188:191], a[56:59], v[220:223]
    buffer_load_dword v15, off, s[24:27], s52 sc1
    v_mfma_f32_16x16x32_bf16 v[220:223], a[192:195], a[60:63], v[220:223]
    v_mfma_f32_16x16x32_bf16 a[160:163], a[180:183], a[64:67], a[160:163]
    v_mfma_f32_16x16x32_bf16 a[160:163], a[184:187], a[68:71], a[160:163]
    ds_read_b64_tr_b16 a[164:165], v2 offset:64
    v_mfma_f32_16x16x32_bf16 a[160:163], a[188:191], a[72:75], a[160:163]
    ds_read_b64_tr_b16 a[166:167], v2 offset:4672
    v_mfma_f32_16x16x32_bf16 a[160:163], a[192:195], a[76:79], a[160:163]
    buffer_load_dwordx4 a[148:151], v1, s[24:27], s54 offen offset:1024 sc1
    v_mfma_f32_16x16x32_bf16 v[112:115], a[180:183], a[0:3], v[112:115]
    ds_read_b64_tr_b16 a[168:169], v2 offset:9280
    v_mfma_f32_16x16x32_bf16 v[112:115], a[184:187], a[4:7], v[112:115]
    ds_read_b64_tr_b16 a[170:171], v2 offset:13888
    v_mfma_f32_16x16x32_bf16 v[112:115], a[188:191], a[8:11], v[112:115]
    buffer_load_dwordx4 v9, s[20:23], s87 offen offset:2048 lds
    v_mfma_f32_16x16x32_bf16 v[112:115], a[192:195], a[12:15], v[112:115]
    s_waitcnt lgkmcnt(4)
    ds_read_b64_tr_b16 a[172:173], v2 offset:18496
    v_mfma_f32_16x16x32_bf16 v[152:155], a[196:199], a[16:19], v[152:155]
    ds_read_b64_tr_b16 a[174:175], v2 offset:23104
    v_mfma_f32_16x16x32_bf16 v[152:155], a[200:203], a[20:23], v[152:155]
    v_mfma_f32_16x16x32_bf16 v[152:155], a[204:207], a[24:27], v[152:155]
    ds_read_b64_tr_b16 a[176:177], v2 offset:27712
    v_mfma_f32_16x16x32_bf16 v[152:155], a[208:211], a[28:31], v[152:155]
    ds_read_b64_tr_b16 a[178:179], v2 offset:32320
    v_mfma_f32_16x16x32_bf16 v[188:191], a[196:199], a[32:35], v[188:191]
    s_cmp_eq_u32 s56, 110592
    buffer_load_dwordx4 a[152:155], v1, s[24:27], s54 offen offset:2048 sc1
    v_mfma_f32_16x16x32_bf16 v[188:191], a[200:203], a[36:39], v[188:191]
    s_cselect_b32 s57, 0xfffe5000, s94
    s_add_u32 s56, s56, s57
    v_mfma_f32_16x16x32_bf16 v[188:191], a[204:207], a[40:43], v[188:191]
    ds_read_b64_tr_b16 a[180:181], v2 offset:96
    v_mfma_f32_16x16x32_bf16 v[188:191], a[208:211], a[44:47], v[188:191]
    ds_read_b64_tr_b16 a[182:183], v2 offset:4704
    v_mfma_f32_16x16x32_bf16 v[224:227], a[196:199], a[48:51], v[224:227]
    v_mfma_f32_16x16x32_bf16 v[224:227], a[200:203], a[52:55], v[224:227]
    ds_read_b64_tr_b16 a[184:185], v2 offset:9312
    v_mfma_f32_16x16x32_bf16 v[224:227], a[204:207], a[56:59], v[224:227]
    ds_read_b64_tr_b16 a[186:187], v2 offset:13920
    v_mfma_f32_16x16x32_bf16 v[224:227], a[208:211], a[60:63], v[224:227]
    buffer_load_dwordx4 a[156:159], v1, s[24:27], s54 offen offset:3072 sc1
    v_mfma_f32_16x16x32_bf16 v[116:119], a[196:199], a[0:3], v[116:119]
    ds_read_b64_tr_b16 a[188:189], v2 offset:18528
    v_mfma_f32_16x16x32_bf16 v[116:119], a[200:203], a[4:7], v[116:119]
    ds_read_b64_tr_b16 a[190:191], v2 offset:23136
    v_mfma_f32_16x16x32_bf16 v[116:119], a[204:207], a[8:11], v[116:119]
    buffer_load_dwordx4 v10, s[20:23], s87 offen offset:3072 lds
    v_mfma_f32_16x16x32_bf16 v[116:119], a[208:211], a[12:15], v[116:119]
    s_waitcnt lgkmcnt(6)
    ds_read_b64_tr_b16 a[192:193], v2 offset:27744
    v_mfma_f32_16x16x32_bf16 v[156:159], a[164:167], a[16:19], v[156:159]
    s_xor_b32 s54, s49, 0
    s_add_u32 s54, s54, s72
    ds_read_b64_tr_b16 a[194:195], v2 offset:32352
    v_mfma_f32_16x16x32_bf16 v[156:159], a[168:171], a[20:23], v[156:159]
    buffer_load_dwordx4 a[80:83], v1, s[24:27], s54 offen offset:0 sc1
    v_mfma_f32_16x16x32_bf16 v[156:159], a[172:175], a[24:27], v[156:159]
    s_and_b32 s66, s47, 3
    s_lshl_b32 s49, s66, 12
    s_xor_b32 s66, s66, s38
    v_mfma_f32_16x16x32_bf16 v[156:159], a[176:179], a[28:31], v[156:159]
    s_lshl_b32 s66, s66, 2
    s_bfe_u32 s67, s47, 0x20002
    ds_read_b64_tr_b16 a[196:197], v2 offset:128
    v_mfma_f32_16x16x32_bf16 v[192:195], a[164:167], a[32:35], v[192:195]
    s_xor_b32 s67, s67, s40
    s_add_u32 s66, s66, s67
    ds_read_b64_tr_b16 a[198:199], v2 offset:4736
    v_mfma_f32_16x16x32_bf16 v[192:195], a[168:171], a[36:39], v[192:195]
    s_lshl_b32 s66, s66, 1
    s_bfe_u32 s51, s47, 0x10004
    s_add_u32 s66, s66, s51
    v_mfma_f32_16x16x32_bf16 v[192:195], a[172:175], a[40:43], v[192:195]
    s_mul_i32 s66, s66, 73728
    s_add_u32 s72, s66, s64
    ds_read_b64_tr_b16 a[200:201], v2 offset:9344
    v_mfma_f32_16x16x32_bf16 v[192:195], a[176:179], a[44:47], v[192:195]
    s_add_u32 s73, s66, s65
    s_add_u32 s51, s51, 1
    ds_read_b64_tr_b16 a[202:203], v2 offset:13952
    v_mfma_f32_16x16x32_bf16 v[228:231], a[164:167], a[48:51], v[228:231]
    buffer_load_dwordx4 a[84:87], v1, s[24:27], s54 offen offset:1024 sc1
    v_mfma_f32_16x16x32_bf16 v[228:231], a[168:171], a[52:55], v[228:231]
    ds_read_b64_tr_b16 a[204:205], v2 offset:18560
    v_mfma_f32_16x16x32_bf16 v[228:231], a[172:175], a[56:59], v[228:231]
    s_add_u32 m0, s55, 8192
    ds_read_b64_tr_b16 a[206:207], v2 offset:23168
    v_mfma_f32_16x16x32_bf16 v[228:231], a[176:179], a[60:63], v[228:231]
    buffer_load_dwordx4 v11, s[20:23], s87 offen offset:0 lds
    v_mfma_f32_16x16x32_bf16 v[120:123], a[164:167], a[0:3], v[120:123]
    ds_read_b64_tr_b16 a[208:209], v2 offset:27776
    v_mfma_f32_16x16x32_bf16 v[120:123], a[168:171], a[4:7], v[120:123]
    ds_read_b64_tr_b16 a[210:211], v2 offset:32384
    v_mfma_f32_16x16x32_bf16 v[120:123], a[172:175], a[8:11], v[120:123]
    buffer_load_dwordx4 a[88:91], v1, s[24:27], s54 offen offset:2048 sc1
    v_mfma_f32_16x16x32_bf16 v[120:123], a[176:179], a[12:15], v[120:123]
    s_waitcnt lgkmcnt(8)
    v_add_u32 v13, s57, v13
    v_mfma_f32_16x16x32_bf16 v[160:163], a[180:183], a[16:19], v[160:163]
    v_add_u32 v14, s57, v14
    v_mfma_f32_16x16x32_bf16 v[160:163], a[184:187], a[20:23], v[160:163]
    v_add_u32 v0, s57, v0
    v_mfma_f32_16x16x32_bf16 v[160:163], a[188:191], a[24:27], v[160:163]
    v_add_u32 v12, s57, v12
    v_mfma_f32_16x16x32_bf16 v[160:163], a[192:195], a[28:31], v[160:163]
    v_add_u32 v2, s57, v2
    v_mfma_f32_16x16x32_bf16 v[196:199], a[180:183], a[32:35], v[196:199]
    s_waitcnt lgkmcnt(0)
    v_mov_b32 v18, s59
    v_mfma_f32_16x16x32_bf16 v[196:199], a[184:187], a[36:39], v[196:199]
    buffer_load_dwordx4 a[92:95], v1, s[24:27], s54 offen offset:3072 sc1
    v_add_u32 v18, s60, v18
    v_mfma_f32_16x16x32_bf16 v[196:199], a[188:191], a[40:43], v[196:199]
    ds_write_b32 v19, v18 offset:64
    v_mfma_f32_16x16x32_bf16 v[196:199], a[192:195], a[44:47], v[196:199]
    v_mfma_f32_16x16x32_bf16 v[232:235], a[180:183], a[48:51], v[232:235]
    v_mfma_f32_16x16x32_bf16 v[232:235], a[184:187], a[52:55], v[232:235]
    v_mfma_f32_16x16x32_bf16 v[232:235], a[188:191], a[56:59], v[232:235]
    v_mfma_f32_16x16x32_bf16 v[232:235], a[192:195], a[60:63], v[232:235]
    v_mfma_f32_16x16x32_bf16 v[124:127], a[180:183], a[0:3], v[124:127]
    s_waitcnt lgkmcnt(0)
    v_mfma_f32_16x16x32_bf16 v[124:127], a[184:187], a[4:7], v[124:127]
    s_barrier
    v_mfma_f32_16x16x32_bf16 v[124:127], a[188:191], a[8:11], v[124:127]
    ds_read_b32 v18, v20 offset:64
    v_mfma_f32_16x16x32_bf16 v[124:127], a[192:195], a[12:15], v[124:127]
    s_cmp_ge_u32 s56, 73728
    s_cselect_b32 s55, 0xfffee000, s95
    ds_read_b64_tr_b16 a[164:165], v13 offset:0
    v_mfma_f32_16x16x32_bf16 v[164:167], a[196:199], a[16:19], v[164:167]
    s_add_u32 s55, s55, s56
    s_add_u32 s55, s55, s86
    ds_read_b64_tr_b16 a[166:167], v13 offset:4608
    v_mfma_f32_16x16x32_bf16 v[164:167], a[200:203], a[20:23], v[164:167]
    ds_read_b64_tr_b16 a[168:169], v13 offset:9216
    v_mfma_f32_16x16x32_bf16 v[164:167], a[204:207], a[24:27], v[164:167]
    ds_read_b64_tr_b16 a[170:171], v13 offset:13824
    v_mfma_f32_16x16x32_bf16 v[164:167], a[208:211], a[28:31], v[164:167]
    ds_read_b64_tr_b16 a[172:173], v13 offset:18432
    v_mfma_f32_16x16x32_bf16 v[200:203], a[196:199], a[32:35], v[200:203]
    ds_read_b64_tr_b16 a[174:175], v13 offset:23040
    v_mfma_f32_16x16x32_bf16 v[200:203], a[200:203], a[36:39], v[200:203]
    s_waitcnt lgkmcnt(6)
    ds_read_b64_tr_b16 a[176:177], v13 offset:27648
    v_readlane_b32 s67, v18, s63
    v_mfma_f32_16x16x32_bf16 v[200:203], a[204:207], a[40:43], v[200:203]
    s_lshl_b32 s66, s67, 2
    ds_read_b64_tr_b16 a[178:179], v13 offset:32256
    v_readlane_b32 s59, v18, 0
    v_mfma_f32_16x16x32_bf16 v[200:203], a[208:211], a[44:47], v[200:203]
    s_or_b32 s66, s66, s63
    ds_read_b64_tr_b16 a[180:181], v14 offset:0
    v_readlane_b32 s60, v18, 1
    v_mfma_f32_16x16x32_bf16 v[236:239], a[196:199], a[48:51], v[236:239]
    s_or_b32 s66, s66, 16
    ds_read_b64_tr_b16 a[182:183], v14 offset:4608
    v_readlane_b32 s61, v18, 2
    v_mfma_f32_16x16x32_bf16 v[236:239], a[200:203], a[52:55], v[236:239]
    s_cmp_le_u32 s67, 3
    ds_read_b64_tr_b16 a[184:185], v14 offset:9216
    v_readlane_b32 s62, v18, 3
    v_mfma_f32_16x16x32_bf16 v[236:239], a[204:207], a[56:59], v[236:239]
    s_cselect_b32 s48, s66, 64
    ds_read_b64_tr_b16 a[186:187], v14 offset:13824
    v_mfma_f32_16x16x32_bf16 v[236:239], a[208:211], a[60:63], v[236:239]
    s_cmp_lt_u32 s47, 32
    s_mov_b32 s47, s48
    ds_read_b64_tr_b16 a[188:189], v14 offset:18432
    v_mfma_f32_16x16x32_bf16 v[128:131], a[196:199], a[0:3], v[128:131]
    ds_read_b64_tr_b16 a[190:191], v14 offset:23040
    v_mfma_f32_16x16x32_bf16 v[128:131], a[200:203], a[4:7], v[128:131]
    ds_read_b64_tr_b16 a[192:193], v14 offset:27648
    v_mfma_f32_16x16x32_bf16 v[128:131], a[204:207], a[8:11], v[128:131]
    s_waitcnt vmcnt(25) lgkmcnt(7)
    ds_read_b64_tr_b16 a[194:195], v14 offset:32256
    v_mfma_f32_16x16x32_bf16 v[128:131], a[208:211], a[12:15], v[128:131]
    s_cbranch_scc1 L_gz
    v_mfma_f32_16x16x32_bf16 v[132:135], a[164:167], a[96:99], v[132:135]
    s_sub_u32 s84, s56, s57
    ds_read_b64_tr_b16 a[196:197], v0 offset:0
    v_lshrrev_b32 v82, 1, v1
    v_mfma_f32_16x16x32_bf16 v[132:135], a[168:171], a[100:103], v[132:135]
    s_mul_i32 s53, s38, 20480
    ds_read_b64_tr_b16 a[198:199], v0 offset:4608
    v_lshrrev_b32 v3, 4, v1
    v_mfma_f32_16x16x32_bf16 v[132:135], a[172:175], a[104:107], v[132:135]
    s_add_u32 s53, s53, s85
    v_lshrrev_b32 v4, 4, v3
    v_bfe_u32 v5, v3, 2, 2
    v_mfma_f32_16x16x32_bf16 v[132:135], a[176:179], a[108:111], v[132:135]
    s_waitcnt vmcnt(19)
    ds_read_b64_tr_b16 a[200:201], v0 offset:9216
    v_cmp_eq_u32 vcc, v4, v5
    v_mfma_f32_16x16x32_bf16 v[168:171], a[164:167], a[112:115], v[168:171]
    s_xor_b32 s3, s38, 1
    ds_read_b64_tr_b16 a[202:203], v0 offset:13824
    v_and_b32 v6, 1, v3
    v_mfma_f32_16x16x32_bf16 v[168:171], a[168:171], a[116:119], v[168:171]
    s_mul_i32 s3, s3, 81920
    v_lshlrev_b32 v6, 4, v6
    v_mov_b32 v7, 0x3f80
    v_mfma_f32_16x16x32_bf16 v[168:171], a[172:175], a[120:123], v[168:171]
    s_add_u32 s90, s3, s53
    ds_read_b64_tr_b16 a[204:205], v0 offset:18432
    v_lshlrev_b32 v6, v6, v7
    v_mfma_f32_16x16x32_bf16 v[168:171], a[176:179], a[124:127], v[168:171]
    s_waitcnt vmcnt(13)
    ds_read_b64_tr_b16 a[206:207], v0 offset:23040
    v_cndmask_b32 v6, 0, v6, vcc
    v_mfma_f32_16x16x32_bf16 v[204:207], a[164:167], a[128:131], v[204:207]
    s_xor_b32 s3, s38, 2
    v_and_b32 v7, 2, v3
    v_cmp_eq_u32 vcc, 0, v7
    v_mfma_f32_16x16x32_bf16 v[204:207], a[168:171], a[132:135], v[204:207]
    s_mul_i32 s3, s3, 81920
    ds_read_b64_tr_b16 a[208:209], v0 offset:27648
    v_cvt_pk_bf16_f32 v16, v132, v133
    v_mfma_f32_16x16x32_bf16 v[204:207], a[172:175], a[136:139], v[204:207]
    s_add_u32 s91, s3, s53
    ds_read_b64_tr_b16 a[210:211], v0 offset:32256
    v_cvt_pk_bf16_f32 v17, v134, v135
    v_mfma_f32_16x16x32_bf16 v[204:207], a[176:179], a[140:143], v[204:207]
    s_waitcnt vmcnt(6) lgkmcnt(8)
    v_mov_b32 v84, 0
    v_mov_b32 v85, 0
    v_mfma_f32_16x16x32_bf16 v[244:247], a[180:183], a[144:147], v[244:247]
    s_xor_b32 s3, s38, 3
    ds_read_b64_tr_b16 a[0:1], v12 offset:0
    v_cndmask_b32 v86, 0, v6, vcc
    v_mfma_f32_16x16x32_bf16 v[244:247], a[184:187], a[148:151], v[244:247]
    s_mul_i32 s3, s3, 81920
    ds_read_b64_tr_b16 a[2:3], v12 offset:4608
    v_cvt_pk_bf16_f32 v36, v168, v169
    v_mfma_f32_16x16x32_bf16 v[244:247], a[188:191], a[152:155], v[244:247]
    s_add_u32 s92, s3, s53
    v_cvt_pk_bf16_f32 v37, v170, v171
    v_sub_u32 v87, v6, v86
    v_mfma_f32_16x16x32_bf16 v[244:247], a[192:195], a[156:159], v[244:247]
    s_lshr_b32 s3, s2, 3
    ds_read_b64_tr_b16 a[4:5], v12 offset:9216
    v_mov_b32 v88, 0
    v_mfma_f32_16x16x32_bf16 v[136:139], a[180:183], a[96:99], v[136:139]
    s_lshl_b32 s54, s41, 5
    ds_read_b64_tr_b16 a[6:7], v12 offset:13824
    v_mov_b32 v89, 0
    v_mfma_f32_16x16x32_bf16 v[136:139], a[184:187], a[100:103], v[136:139]
    s_add_u32 s3, s3, s54
    v_cvt_pk_bf16_f32 v56, v204, v205
    v_cvt_pk_bf16_f32 v57, v206, v207
    v_mfma_f32_16x16x32_bf16 v[136:139], a[188:191], a[104:107], v[136:139]
    s_lshl_b32 s3, s3, 13
    ds_read_b64_tr_b16 a[8:9], v12 offset:18432
    v_and_b32 v83, 15, v3
    v_mfma_f32_16x16x32_bf16 v[136:139], a[192:195], a[108:111], v[136:139]
    s_lshl_b32 s54, s36, 9
    ds_read_b64_tr_b16 a[10:11], v12 offset:23040
    v_mul_u32_u24 v83, 2304, v83
    v_mfma_f32_16x16x32_bf16 v[172:175], a[180:183], a[112:115], v[172:175]
    s_add_u32 s3, s3, s54
    v_lshl_add_u32 v83, v4, 3, v83
    v_add_u32 v7, 0, v3
    v_mfma_f32_16x16x32_bf16 v[172:175], a[184:187], a[116:119], v[172:175]
    s_add_u32 s87, s3, 65011712
    ds_read_b64_tr_b16 a[12:13], v12 offset:27648
    v_cvt_pk_bf16_f32 v24, v244, v245
    v_mfma_f32_16x16x32_bf16 v[172:175], a[188:191], a[120:123], v[172:175]
    s_lshl_b32 s3, s38, 11
    ds_read_b64_tr_b16 a[14:15], v12 offset:32256
    v_cvt_pk_bf16_f32 v25, v246, v247
    v_mfma_f32_16x16x32_bf16 v[172:175], a[192:195], a[124:127], v[172:175]
    s_add_u32 s93, s3, s87
    v_mul_u32_u24 v90, 3641, v7
    v_lshrrev_b32 v90, 16, v90
    v_mfma_f32_16x16x32_bf16 v[208:211], a[180:183], a[128:131], v[208:211]
    s_mul_i32 s53, s38, 81920
    ds_read_b64_tr_b16 a[16:17], v2 offset:0
    v_mul_u32_u24 v90, 2016, v90
    v_mfma_f32_16x16x32_bf16 v[208:211], a[184:187], a[132:135], v[208:211]
    s_add_u32 s53, s53, s85
    ds_read_b64_tr_b16 a[18:19], v2 offset:4608
    v_cvt_pk_bf16_f32 v18, v136, v137
    v_mfma_f32_16x16x32_bf16 v[208:211], a[188:191], a[136:139], v[208:211]
    s_xor_b32 s54, s38, 1
    v_cvt_pk_bf16_f32 v19, v138, v139
    v_lshl_add_u32 v90, v7, 4, v90
    v_mfma_f32_16x16x32_bf16 v[208:211], a[192:195], a[140:143], v[208:211]
    s_waitcnt lgkmcnt(10)
    ds_read_b64_tr_b16 a[20:21], v2 offset:9216
    v_add_u32 v7, 64, v3
    v_mfma_f32_16x16x32_bf16 v[248:251], a[196:199], a[144:147], v[248:251]
    s_mul_i32 s3, s54, 20480
    ds_read_b64_tr_b16 a[22:23], v2 offset:13824
    v_mul_u32_u24 v91, 3641, v7
    v_mfma_f32_16x16x32_bf16 v[248:251], a[200:203], a[148:151], v[248:251]
    s_add_u32 s72, s3, s53
    v_cvt_pk_bf16_f32 v38, v172, v173
    v_cvt_pk_bf16_f32 v39, v174, v175
    v_mfma_f32_16x16x32_bf16 v[248:251], a[204:207], a[152:155], v[248:251]
    s_lshl_b32 s3, s54, 11
    ds_read_b64_tr_b16 a[24:25], v2 offset:18432
    v_lshrrev_b32 v91, 16, v91
    v_mfma_f32_16x16x32_bf16 v[248:251], a[208:211], a[156:159], v[248:251]
    s_add_u32 s78, s3, s87
    ds_read_b64_tr_b16 a[26:27], v2 offset:23040
    v_mul_u32_u24 v91, 2016, v91
    v_mfma_f32_16x16x32_bf16 v[140:143], a[196:199], a[96:99], v[140:143]
    s_xor_b32 s54, s38, 2
    buffer_store_dwordx4 v[16:19], v1, s[24:27], s90 offen offset:0 sc1
    v_mfma_f32_16x16x32_bf16 v[140:143], a[200:203], a[100:103], v[140:143]
    s_mul_i32 s3, s54, 20480
    ds_read_b64_tr_b16 a[28:29], v2 offset:27648
    v_cvt_pk_bf16_f32 v58, v208, v209
    v_mfma_f32_16x16x32_bf16 v[140:143], a[204:207], a[104:107], v[140:143]
    s_add_u32 s73, s3, s53
    ds_read_b64_tr_b16 a[30:31], v2 offset:32256
    v_cvt_pk_bf16_f32 v59, v210, v211
    v_mfma_f32_16x16x32_bf16 v[140:143], a[208:211], a[108:111], v[140:143]
    s_lshl_b32 s3, s54, 11
    buffer_store_dwordx4 v[36:39], v1, s[24:27], s91 offen offset:0 sc1
    v_mfma_f32_16x16x32_bf16 v[176:179], a[196:199], a[112:115], v[176:179]
    s_add_u32 s79, s3, s87
    ds_read_b64_tr_b16 a[32:33], v2 offset:32
    v_lshl_add_u32 v91, v7, 4, v91
    v_mfma_f32_16x16x32_bf16 v[176:179], a[200:203], a[116:119], v[176:179]
    s_xor_b32 s54, s38, 3
    ds_read_b64_tr_b16 a[34:35], v2 offset:4640
    v_cvt_pk_bf16_f32 v44, v248, v249
    v_mfma_f32_16x16x32_bf16 v[176:179], a[204:207], a[120:123], v[176:179]
    s_mul_i32 s3, s54, 20480
    buffer_store_dwordx4 v[56:59], v1, s[24:27], s92 offen offset:0 sc1
    v_cvt_pk_bf16_f32 v45, v250, v251
    v_mfma_f32_16x16x32_bf16 v[176:179], a[208:211], a[124:127], v[176:179]
    s_add_u32 s74, s3, s53
    ds_read_b64_tr_b16 a[36:37], v2 offset:9248
    v_add_u32 v7, 128, v3
    v_mfma_f32_16x16x32_bf16 v[212:215], a[196:199], a[128:131], v[212:215]
    s_lshl_b32 s3, s54, 11
    ds_read_b64_tr_b16 a[38:39], v2 offset:13856
    v_mul_u32_u24 v92, 3641, v7
    v_mfma_f32_16x16x32_bf16 v[212:215], a[200:203], a[132:135], v[212:215]
    s_add_u32 s80, s3, s87
    v_cvt_pk_bf16_f32 v20, v140, v141
    v_cvt_pk_bf16_f32 v21, v142, v143
    v_mfma_f32_16x16x32_bf16 v[212:215], a[204:207], a[136:139], v[212:215]
    s_mul_i32 s53, s41, 1152
    ds_read_b64_tr_b16 a[40:41], v2 offset:18464
    v_lshrrev_b32 v92, 16, v92
    v_mfma_f32_16x16x32_bf16 v[212:215], a[208:211], a[140:143], v[212:215]
    s_waitcnt lgkmcnt(13)
    ds_read_b64_tr_b16 a[42:43], v2 offset:23072
    v_mul_u32_u24 v92, 2016, v92
    v_mfma_f32_16x16x32_bf16 v[252:255], a[0:3], a[144:147], v[252:255]
    s_mul_i32 s3, s40, 288
    v_lshl_add_u32 v92, v7, 4, v92
    v_add_u32 v7, 192, v3
    v_mfma_f32_16x16x32_bf16 v[252:255], a[4:7], a[148:151], v[252:255]
    s_add_u32 s53, s53, s3
    ds_read_b64_tr_b16 a[44:45], v2 offset:27680
    v_cvt_pk_bf16_f32 v40, v176, v177
    v_mfma_f32_16x16x32_bf16 v[252:255], a[8:11], a[152:155], v[252:255]
    s_mul_i32 s3, s39, 663552
    ds_read_b64_tr_b16 a[46:47], v2 offset:32288
    v_cvt_pk_bf16_f32 v41, v178, v179
    v_mfma_f32_16x16x32_bf16 v[252:255], a[12:15], a[156:159], v[252:255]
    s_add_u32 s53, s53, s3
    v_mul_u32_u24 v93, 3641, v7
    v_lshrrev_b32 v93, 16, v93
    v_mfma_f32_16x16x32_bf16 v[144:147], a[0:3], a[96:99], v[144:147]
    s_lshl_b32 s3, s46, 1
    ds_read_b64_tr_b16 a[48:49], v2 offset:64
    v_mul_u32_u24 v93, 2016, v93
    v_mfma_f32_16x16x32_bf16 v[144:147], a[4:7], a[100:103], v[144:147]
    s_add_u32 s82, s53, s3
    ds_read_b64_tr_b16 a[50:51], v2 offset:4672
    v_cvt_pk_bf16_f32 v60, v212, v213
    v_mfma_f32_16x16x32_bf16 v[144:147], a[8:11], a[104:107], v[144:147]
    s_lshl_b32 s3, s42, 1
    v_cvt_pk_bf16_f32 v61, v214, v215
    v_lshl_add_u32 v93, v7, 4, v93
    v_mfma_f32_16x16x32_bf16 v[144:147], a[12:15], a[108:111], v[144:147]
    s_add_u32 s81, s53, s3
    ds_read_b64_tr_b16 a[52:53], v2 offset:9280
    v_add_u32 v7, 256, v3
    v_mfma_f32_16x16x32_bf16 v[180:183], a[0:3], a[112:115], v[180:183]
    s_lshl_b32 s3, s38, 5
    ds_read_b64_tr_b16 a[54:55], v2 offset:13888
    v_mul_u32_u24 v94, 3641, v7
    v_mfma_f32_16x16x32_bf16 v[180:183], a[4:7], a[116:119], v[180:183]
    s_add_u32 s3, s3, s50
    v_cvt_pk_bf16_f32 v64, v252, v253
    v_cvt_pk_bf16_f32 v65, v254, v255
    v_mfma_f32_16x16x32_bf16 v[180:183], a[8:11], a[120:123], v[180:183]
    s_add_u32 s83, s3, s82
    ds_read_b64_tr_b16 a[56:57], v2 offset:18496
    v_lshrrev_b32 v94, 16, v94
    v_mfma_f32_16x16x32_bf16 v[180:183], a[12:15], a[124:127], v[180:183]
    s_lshl_b32 s3, s36, 2
    ds_read_b64_tr_b16 a[58:59], v2 offset:23104
    v_mul_u32_u24 v94, 2016, v94
    v_mfma_f32_16x16x32_bf16 v[216:219], a[0:3], a[128:131], v[216:219]
    s_sub_u32 s71, s71, 66060288
    v_lshl_add_u32 v94, v7, 4, v94
    v_lshrrev_b32 v7, 5, v3
    v_mfma_f32_16x16x32_bf16 v[216:219], a[4:7], a[132:135], v[216:219]
    s_add_u32 s84, s84, s86
    ds_read_b64_tr_b16 a[60:61], v2 offset:27712
    v_cvt_pk_bf16_f32 v22, v144, v145
    v_mfma_f32_16x16x32_bf16 v[216:219], a[8:11], a[136:139], v[216:219]
    s_mov_b32 s62, 2
    ds_read_b64_tr_b16 a[62:63], v2 offset:32320
    v_cvt_pk_bf16_f32 v23, v146, v147
    v_mfma_f32_16x16x32_bf16 v[216:219], a[12:15], a[140:143], v[216:219]
    s_waitcnt lgkmcnt(15)
    buffer_store_dwordx4 v[20:23], v1, s[24:27], s90 offen offset:1024 sc1
    v_mfma_f32_16x16x32_bf16 a[160:163], a[16:19], a[144:147], a[160:163]
    s_add_u32 s3, s3, 66060304
    ds_read_b64_tr_b16 a[64:65], v2 offset:96
    v_lshl_add_u32 v94, v7, 28, v94
    v_mfma_f32_16x16x32_bf16 a[160:163], a[20:23], a[148:151], a[160:163]
    s_add_u32 s12, s24, s3
    ds_read_b64_tr_b16 a[66:67], v2 offset:4704
    v_cvt_pk_bf16_f32 v42, v180, v181
    v_mfma_f32_16x16x32_bf16 a[160:163], a[24:27], a[152:155], a[160:163]
    s_addc_u32 s13, s25, 0
    s_sub_u32 s75, s75, 66060288
    v_cvt_pk_bf16_f32 v43, v182, v183
    v_mfma_f32_16x16x32_bf16 a[160:163], a[28:31], a[156:159], a[160:163]
    s_sub_u32 s76, s76, 66060288
    s_sub_u32 s77, s77, 66060288
    ds_read_b64_tr_b16 a[68:69], v2 offset:9312
    v_mfma_f32_16x16x32_bf16 v[148:151], a[16:19], a[96:99], v[148:151]
    ds_read_b64_tr_b16 a[70:71], v2 offset:13920
    v_mfma_f32_16x16x32_bf16 v[148:151], a[20:23], a[100:103], v[148:151]
    v_cvt_pk_bf16_f32 v62, v216, v217
    v_cvt_pk_bf16_f32 v63, v218, v219
    v_mfma_f32_16x16x32_bf16 v[148:151], a[24:27], a[104:107], v[148:151]
    ds_read_b64_tr_b16 a[72:73], v2 offset:18528
    v_mfma_f32_16x16x32_bf16 v[148:151], a[28:31], a[108:111], v[148:151]
    ds_read_b64_tr_b16 a[74:75], v2 offset:23136
    v_mfma_f32_16x16x32_bf16 v[184:187], a[16:19], a[112:115], v[184:187]
    v_accvgpr_read_b32 v76, a160
    v_accvgpr_read_b32 v77, a161
    v_mfma_f32_16x16x32_bf16 v[184:187], a[20:23], a[116:119], v[184:187]
    ds_read_b64_tr_b16 a[76:77], v2 offset:27744
    v_accvgpr_read_b32 v78, a162
    v_mfma_f32_16x16x32_bf16 v[184:187], a[24:27], a[120:123], v[184:187]
    ds_read_b64_tr_b16 a[78:79], v2 offset:32352
    v_accvgpr_read_b32 v79, a163
    v_mfma_f32_16x16x32_bf16 v[184:187], a[28:31], a[124:127], v[184:187]
    buffer_store_dwordx4 v[40:43], v1, s[24:27], s91 offen offset:1024 sc1
    v_cvt_pk_bf16_f32 v80, v76, v77
    v_mfma_f32_16x16x32_bf16 v[220:223], a[16:19], a[128:131], v[220:223]
    ds_read_b64_tr_b16 a[212:213], v2 offset:128
    v_cvt_pk_bf16_f32 v81, v78, v79
    v_mfma_f32_16x16x32_bf16 v[220:223], a[20:23], a[132:135], v[220:223]
    ds_read_b64_tr_b16 a[214:215], v2 offset:4736
    v_cvt_pk_bf16_f32 v26, v148, v149
    v_mfma_f32_16x16x32_bf16 v[220:223], a[24:27], a[136:139], v[220:223]
    buffer_store_dwordx4 v[60:63], v1, s[24:27], s92 offen offset:1024 sc1
    v_cvt_pk_bf16_f32 v27, v150, v151
    v_mfma_f32_16x16x32_bf16 v[220:223], a[28:31], a[140:143], v[220:223]
    s_waitcnt lgkmcnt(15)
    ds_read_b64_tr_b16 a[216:217], v2 offset:9344
    v_mfma_f32_16x16x32_bf16 v[152:155], a[32:35], a[96:99], v[152:155]
    ds_read_b64_tr_b16 a[218:219], v2 offset:13952
    v_mfma_f32_16x16x32_bf16 v[152:155], a[36:39], a[100:103], v[152:155]
    v_cvt_pk_bf16_f32 v46, v184, v185
    v_cvt_pk_bf16_f32 v47, v186, v187
    v_mfma_f32_16x16x32_bf16 v[152:155], a[40:43], a[104:107], v[152:155]
    ds_read_b64_tr_b16 a[220:221], v2 offset:18560
    v_mfma_f32_16x16x32_bf16 v[152:155], a[44:47], a[108:111], v[152:155]
    ds_read_b64_tr_b16 a[222:223], v2 offset:23168
    v_mfma_f32_16x16x32_bf16 v[188:191], a[32:35], a[112:115], v[188:191]
    buffer_store_dwordx2 v[80:81], v82, s[24:27], s93 offen sc1
    v_mfma_f32_16x16x32_bf16 v[188:191], a[36:39], a[116:119], v[188:191]
    ds_read_b64_tr_b16 a[224:225], v2 offset:27776
    v_cvt_pk_bf16_f32 v66, v220, v221
    v_mfma_f32_16x16x32_bf16 v[188:191], a[40:43], a[120:123], v[188:191]
    ds_read_b64_tr_b16 a[226:227], v2 offset:32384
    v_cvt_pk_bf16_f32 v67, v222, v223
    v_mfma_f32_16x16x32_bf16 v[188:191], a[44:47], a[124:127], v[188:191]
    buffer_store_dwordx4 v[24:27], v1, s[24:27], s90 offen offset:2048 sc1
    v_mfma_f32_16x16x32_bf16 v[224:227], a[32:35], a[128:131], v[224:227]
    v_mfma_f32_16x16x32_bf16 v[224:227], a[36:39], a[132:135], v[224:227]
    v_cvt_pk_bf16_f32 v28, v152, v153
    v_cvt_pk_bf16_f32 v29, v154, v155
    v_mfma_f32_16x16x32_bf16 v[224:227], a[40:43], a[136:139], v[224:227]
    buffer_store_dwordx4 v[44:47], v1, s[24:27], s91 offen offset:2048 sc1
    v_mfma_f32_16x16x32_bf16 v[224:227], a[44:47], a[140:143], v[224:227]
    s_waitcnt lgkmcnt(15)
    v_mfma_f32_16x16x32_bf16 v[156:159], a[48:51], a[96:99], v[156:159]
    buffer_store_dwordx4 v[64:67], v1, s[24:27], s92 offen offset:2048 sc1
    v_mfma_f32_16x16x32_bf16 v[156:159], a[52:55], a[100:103], v[156:159]
    v_cvt_pk_bf16_f32 v48, v188, v189
    v_cvt_pk_bf16_f32 v49, v190, v191
    v_mfma_f32_16x16x32_bf16 v[156:159], a[56:59], a[104:107], v[156:159]
    v_mfma_f32_16x16x32_bf16 v[156:159], a[60:63], a[108:111], v[156:159]
    v_mfma_f32_16x16x32_bf16 v[192:195], a[48:51], a[112:115], v[192:195]
    v_mfma_f32_16x16x32_bf16 v[192:195], a[52:55], a[116:119], v[192:195]
    v_cvt_pk_bf16_f32 v68, v224, v225
    v_cvt_pk_bf16_f32 v69, v226, v227
    v_mfma_f32_16x16x32_bf16 v[192:195], a[56:59], a[120:123], v[192:195]
    v_mfma_f32_16x16x32_bf16 v[192:195], a[60:63], a[124:127], v[192:195]
    v_mfma_f32_16x16x32_bf16 v[228:231], a[48:51], a[128:131], v[228:231]
    v_mfma_f32_16x16x32_bf16 v[228:231], a[52:55], a[132:135], v[228:231]
    v_cvt_pk_bf16_f32 v30, v156, v157
    v_cvt_pk_bf16_f32 v31, v158, v159
    v_mfma_f32_16x16x32_bf16 v[228:231], a[56:59], a[136:139], v[228:231]
    buffer_store_dwordx4 v[28:31], v1, s[24:27], s90 offen offset:3072 sc1
    v_mfma_f32_16x16x32_bf16 v[228:231], a[60:63], a[140:143], v[228:231]
    s_waitcnt lgkmcnt(8)
    v_mfma_f32_16x16x32_bf16 v[160:163], a[64:67], a[96:99], v[160:163]
    v_mfma_f32_16x16x32_bf16 v[160:163], a[68:71], a[100:103], v[160:163]
    v_cvt_pk_bf16_f32 v50, v192, v193
    v_cvt_pk_bf16_f32 v51, v194, v195
    v_mfma_f32_16x16x32_bf16 v[160:163], a[72:75], a[104:107], v[160:163]
    buffer_store_dwordx4 v[48:51], v1, s[24:27], s91 offen offset:3072 sc1
    v_mfma_f32_16x16x32_bf16 v[160:163], a[76:79], a[108:111], v[160:163]
    v_mfma_f32_16x16x32_bf16 v[196:199], a[64:67], a[112:115], v[196:199]
    v_mfma_f32_16x16x32_bf16 v[196:199], a[68:71], a[116:119], v[196:199]
    v_cvt_pk_bf16_f32 v70, v228, v229
    v_cvt_pk_bf16_f32 v71, v230, v231
    v_mfma_f32_16x16x32_bf16 v[196:199], a[72:75], a[120:123], v[196:199]
    buffer_store_dwordx4 v[68:71], v1, s[24:27], s92 offen offset:3072 sc1
    v_mfma_f32_16x16x32_bf16 v[196:199], a[76:79], a[124:127], v[196:199]
    v_mfma_f32_16x16x32_bf16 v[232:235], a[64:67], a[128:131], v[232:235]
    v_mfma_f32_16x16x32_bf16 v[232:235], a[68:71], a[132:135], v[232:235]
    v_cvt_pk_bf16_f32 v32, v160, v161
    v_cvt_pk_bf16_f32 v33, v162, v163
    v_mfma_f32_16x16x32_bf16 v[232:235], a[72:75], a[136:139], v[232:235]
    v_mfma_f32_16x16x32_bf16 v[232:235], a[76:79], a[140:143], v[232:235]
    s_waitcnt lgkmcnt(0)
    v_mfma_f32_16x16x32_bf16 v[164:167], a[212:215], a[96:99], v[164:167]
    v_mfma_f32_16x16x32_bf16 v[164:167], a[216:219], a[100:103], v[164:167]
    v_cvt_pk_bf16_f32 v52, v196, v197
    v_cvt_pk_bf16_f32 v53, v198, v199
    v_mfma_f32_16x16x32_bf16 v[164:167], a[220:223], a[104:107], v[164:167]
    v_mfma_f32_16x16x32_bf16 v[164:167], a[224:227], a[108:111], v[164:167]
    v_mfma_f32_16x16x32_bf16 v[200:203], a[212:215], a[112:115], v[200:203]
    v_mfma_f32_16x16x32_bf16 v[200:203], a[216:219], a[116:119], v[200:203]
    v_cvt_pk_bf16_f32 v72, v232, v233
    v_cvt_pk_bf16_f32 v73, v234, v235
    v_mfma_f32_16x16x32_bf16 v[200:203], a[220:223], a[120:123], v[200:203]
    v_mfma_f32_16x16x32_bf16 v[200:203], a[224:227], a[124:127], v[200:203]
    v_mfma_f32_16x16x32_bf16 v[236:239], a[212:215], a[128:131], v[236:239]
    v_mfma_f32_16x16x32_bf16 v[236:239], a[216:219], a[132:135], v[236:239]
    s_add_u32 s90, s90, 4096
    v_cvt_pk_bf16_f32 v34, v164, v165
    v_cvt_pk_bf16_f32 v35, v166, v167
    v_mfma_f32_16x16x32_bf16 v[236:239], a[220:223], a[136:139], v[236:239]
    buffer_store_dwordx4 v[32:35], v1, s[24:27], s90 offen offset:0 sc1
    v_mfma_f32_16x16x32_bf16 v[236:239], a[224:227], a[140:143], v[236:239]
    v_mfma_f32_16x16x32_bf16 v[240:243], a[164:167], a[144:147], v[240:243]
    v_mfma_f32_16x16x32_bf16 v[240:243], a[168:171], a[148:151], v[240:243]
    s_add_u32 s91, s91, 4096
    v_cvt_pk_bf16_f32 v54, v200, v201
    v_cvt_pk_bf16_f32 v55, v202, v203
    v_mfma_f32_16x16x32_bf16 v[240:243], a[172:175], a[152:155], v[240:243]
    buffer_store_dwordx4 v[52:55], v1, s[24:27], s91 offen offset:0 sc1
    v_mfma_f32_16x16x32_bf16 v[240:243], a[176:179], a[156:159], v[240:243]
    s_waitcnt vmcnt(15)
    v_mfma_f32_16x16x32_bf16 v[96:99], a[164:167], a[80:83], v[96:99]
    v_mfma_f32_16x16x32_bf16 v[96:99], a[168:171], a[84:87], v[96:99]
    s_add_u32 s92, s92, 4096
    v_cvt_pk_bf16_f32 v74, v236, v237
    v_cvt_pk_bf16_f32 v75, v238, v239
    v_mfma_f32_16x16x32_bf16 v[96:99], a[172:175], a[88:91], v[96:99]
    buffer_store_dwordx4 v[72:75], v1, s[24:27], s92 offen offset:0 sc1
    v_mfma_f32_16x16x32_bf16 v[96:99], a[176:179], a[92:95], v[96:99]
    s_mov_b32 s89, 0
    s_mov_b32 s94, 0
    s_mov_b32 s88, 0x40000
    v_mfma_f32_16x16x32_bf16 v[100:103], a[180:183], a[80:83], v[100:103]
    v_mfma_f32_16x16x32_bf16 v[100:103], a[184:187], a[84:87], v[100:103]
    v_lshrrev_b32 v9, 4, v1
    v_and_b32 v10, 15, v9
    v_mfma_f32_16x16x32_bf16 v[100:103], a[188:191], a[88:91], v[100:103]
    v_mul_u32_u24 v10, 288, v10
    v_lshrrev_b32 v9, 4, v9
    v_mfma_f32_16x16x32_bf16 v[100:103], a[192:195], a[92:95], v[100:103]
    v_lshl_add_u32 v10, v9, 3, v10
    v_add_u32 v10, s84, v10
    v_mfma_f32_16x16x32_bf16 v[104:107], a[196:199], a[80:83], v[104:107]
    v_add_u32 v8, s84, v1
    v_mov_b32 v11, s38
    v_mfma_f32_16x16x32_bf16 v[104:107], a[200:203], a[84:87], v[104:107]
    v_add_u32 v7, s50, v10
    v_xor_b32 v3, 0, v11
    v_mfma_f32_16x16x32_bf16 v[104:107], a[204:207], a[88:91], v[104:107]
    v_lshl_add_u32 v3, v3, 5, v7
    v_xor_b32 v4, 1, v11
    v_mfma_f32_16x16x32_bf16 v[104:107], a[208:211], a[92:95], v[104:107]
    v_lshl_add_u32 v4, v4, 5, v7
    v_xor_b32 v5, 2, v11
    v_mfma_f32_16x16x32_bf16 v[108:111], a[0:3], a[80:83], v[108:111]
    v_lshl_add_u32 v5, v5, 5, v7
    v_xor_b32 v6, 3, v11
    v_mfma_f32_16x16x32_bf16 v[108:111], a[4:7], a[84:87], v[108:111]
    v_lshl_add_u32 v6, v6, 5, v7
    v_mov_b32 v11, s37
    v_mfma_f32_16x16x32_bf16 v[108:111], a[8:11], a[88:91], v[108:111]
    v_xor_b32 v11, 1, v11
    v_lshl_add_u32 v7, v11, 7, v10
    v_mfma_f32_16x16x32_bf16 v[108:111], a[12:15], a[92:95], v[108:111]
    v_mov_b32 v138, 0
    v_mov_b32 v139, 0
    v_mfma_f32_16x16x32_bf16 v[112:115], a[16:19], a[80:83], v[112:115]
    v_mov_b32 v142, 0
    v_mov_b32 v143, 0
    v_mfma_f32_16x16x32_bf16 v[112:115], a[20:23], a[84:87], v[112:115]
    v_mov_b32 v146, 0
    v_mov_b32 v147, 0
    v_mfma_f32_16x16x32_bf16 v[112:115], a[24:27], a[88:91], v[112:115]
    v_mfma_f32_16x16x32_bf16 v[112:115], a[28:31], a[92:95], v[112:115]
    v_mfma_f32_16x16x32_bf16 v[116:119], a[32:35], a[80:83], v[116:119]
    v_mfma_f32_16x16x32_bf16 v[116:119], a[36:39], a[84:87], v[116:119]
    v_mfma_f32_16x16x32_bf16 v[116:119], a[40:43], a[88:91], v[116:119]
    v_mfma_f32_16x16x32_bf16 v[116:119], a[44:47], a[92:95], v[116:119]
    v_mfma_f32_16x16x32_bf16 v[120:123], a[48:51], a[80:83], v[120:123]
    s_mov_b32 s59, 0
    s_mov_b32 s60, 0
    s_mov_b32 s61, 0
    v_mfma_f32_16x16x32_bf16 v[120:123], a[52:55], a[84:87], v[120:123]
    s_atomic_add s59, s[12:13], s75 glc
    s_atomic_add s60, s[12:13], s76 glc
    s_atomic_add s61, s[12:13], s77 glc
    v_mfma_f32_16x16x32_bf16 v[120:123], a[56:59], a[88:91], v[120:123]
    v_mfma_f32_16x16x32_bf16 v[120:123], a[60:63], a[92:95], v[120:123]
    v_mfma_f32_16x16x32_bf16 v[124:127], a[64:67], a[80:83], v[124:127]
    v_mfma_f32_16x16x32_bf16 v[124:127], a[68:71], a[84:87], v[124:127]
    v_mfma_f32_16x16x32_bf16 v[124:127], a[72:75], a[88:91], v[124:127]
    v_mfma_f32_16x16x32_bf16 v[124:127], a[76:79], a[92:95], v[124:127]
    v_mfma_f32_16x16x32_bf16 v[128:131], a[212:215], a[80:83], v[128:131]
    v_mfma_f32_16x16x32_bf16 v[128:131], a[216:219], a[84:87], v[128:131]
    v_mfma_f32_16x16x32_bf16 v[128:131], a[220:223], a[88:91], v[128:131]
    v_mfma_f32_16x16x32_bf16 v[128:131], a[224:227], a[92:95], v[128:131]
    s_branch L_otail
    .p2align 6
L_lastx:
    v_mfma_f32_16x16x32_bf16 v[132:135], a[164:167], a[16:19], v[132:135]
    s_sub_u32 s84, s56, s57
    ds_read_b64_tr_b16 a[196:197], v0 offset:0
    v_lshrrev_b32 v82, 1, v1
    v_mfma_f32_16x16x32_bf16 v[132:135], a[168:171], a[20:23], v[132:135]
    s_mul_i32 s53, s38, 20480
    ds_read_b64_tr_b16 a[198:199], v0 offset:4608
    v_lshrrev_b32 v3, 4, v1
    v_mfma_f32_16x16x32_bf16 v[132:135], a[172:175], a[24:27], v[132:135]
    s_add_u32 s53, s53, s85
    v_lshrrev_b32 v4, 4, v3
    v_bfe_u32 v5, v3, 2, 2
    v_mfma_f32_16x16x32_bf16 v[132:135], a[176:179], a[28:31], v[132:135]
    s_waitcnt vmcnt(19)
    ds_read_b64_tr_b16 a[200:201], v0 offset:9216
    v_cmp_eq_u32 vcc, v4, v5
    v_mfma_f32_16x16x32_bf16 v[168:171], a[164:167], a[32:35], v[168:171]
    s_xor_b32 s3, s38, 1
    ds_read_b64_tr_b16 a[202:203], v0 offset:13824
    v_and_b32 v6, 1, v3
    v_mfma_f32_16x16x32_bf16 v[168:171], a[168:171], a[36:39], v[168:171]
    s_mul_i32 s3, s3, 81920
    v_lshlrev_b32 v6, 4, v6
    v_mov_b32 v7, 0x3f80
    v_mfma_f32_16x16x32_bf16 v[168:171], a[172:175], a[40:43], v[168:171]
    s_add_u32 s90, s3, s53
    ds_read_b64_tr_b16 a[204:205], v0 offset:18432
    v_lshlrev_b32 v6, v6, v7
    v_mfma_f32_16x16x32_bf16 v[168:171], a[176:179], a[44:47], v[168:171]
    s_waitcnt vmcnt(13)
    ds_read_b64_tr_b16 a[206:207], v0 offset:23040
    v_cndmask_b32 v6, 0, v6, vcc
    v_mfma_f32_16x16x32_bf16 v[204:207], a[164:167], a[48:51], v[204:207]
    s_xor_b32 s3, s38, 2
    v_and_b32 v7, 2, v3
    v_cmp_eq_u32 vcc, 0, v7
    v_mfma_f32_16x16x32_bf16 v[204:207], a[168:171], a[52:55], v[204:207]
    s_mul_i32 s3, s3, 81920
    ds_read_b64_tr_b16 a[208:209], v0 offset:27648
    v_cvt_pk_bf16_f32 v16, v132, v133
    v_mfma_f32_16x16x32_bf16 v[204:207], a[172:175], a[56:59], v[204:207]
    s_add_u32 s91, s3, s53
    ds_read_b64_tr_b16 a[210:211], v0 offset:32256
    v_cvt_pk_bf16_f32 v17, v134, v135
    v_mfma_f32_16x16x32_bf16 v[204:207], a[176:179], a[60:63], v[204:207]
    s_waitcnt vmcnt(6) lgkmcnt(8)
    v_mov_b32 v84, 0
    v_mov_b32 v85, 0
    v_mfma_f32_16x16x32_bf16 v[244:247], a[180:183], a[64:67], v[244:247]
    s_xor_b32 s3, s38, 3
    ds_read_b64_tr_b16 a[80:81], v12 offset:0
    v_cndmask_b32 v86, 0, v6, vcc
    v_mfma_f32_16x16x32_bf16 v[244:247], a[184:187], a[68:71], v[244:247]
    s_mul_i32 s3, s3, 81920
    ds_read_b64_tr_b16 a[82:83], v12 offset:4608
    v_cvt_pk_bf16_f32 v36, v168, v169
    v_mfma_f32_16x16x32_bf16 v[244:247], a[188:191], a[72:75], v[244:247]
    s_add_u32 s92, s3, s53
    v_cvt_pk_bf16_f32 v37, v170, v171
    v_sub_u32 v87, v6, v86
    v_mfma_f32_16x16x32_bf16 v[244:247], a[192:195], a[76:79], v[244:247]
    s_lshr_b32 s3, s2, 3
    ds_read_b64_tr_b16 a[84:85], v12 offset:9216
    v_mov_b32 v88, 0
    v_mfma_f32_16x16x32_bf16 v[136:139], a[180:183], a[16:19], v[136:139]
    s_lshl_b32 s54, s41, 5
    ds_read_b64_tr_b16 a[86:87], v12 offset:13824
    v_mov_b32 v89, 0
    v_mfma_f32_16x16x32_bf16 v[136:139], a[184:187], a[20:23], v[136:139]
    s_add_u32 s3, s3, s54
    v_cvt_pk_bf16_f32 v56, v204, v205
    v_cvt_pk_bf16_f32 v57, v206, v207
    v_mfma_f32_16x16x32_bf16 v[136:139], a[188:191], a[24:27], v[136:139]
    s_lshl_b32 s3, s3, 13
    ds_read_b64_tr_b16 a[88:89], v12 offset:18432
    v_and_b32 v83, 15, v3
    v_mfma_f32_16x16x32_bf16 v[136:139], a[192:195], a[28:31], v[136:139]
    s_lshl_b32 s54, s36, 9
    ds_read_b64_tr_b16 a[90:91], v12 offset:23040
    v_mul_u32_u24 v83, 2304, v83
    v_mfma_f32_16x16x32_bf16 v[172:175], a[180:183], a[32:35], v[172:175]
    s_add_u32 s3, s3, s54
    v_lshl_add_u32 v83, v4, 3, v83
    v_add_u32 v7, 0, v3
    v_mfma_f32_16x16x32_bf16 v[172:175], a[184:187], a[36:39], v[172:175]
    s_add_u32 s87, s3, 65011712
    ds_read_b64_tr_b16 a[92:93], v12 offset:27648
    v_cvt_pk_bf16_f32 v24, v244, v245
    v_mfma_f32_16x16x32_bf16 v[172:175], a[188:191], a[40:43], v[172:175]
    s_lshl_b32 s3, s38, 11
    ds_read_b64_tr_b16 a[94:95], v12 offset:32256
    v_cvt_pk_bf16_f32 v25, v246, v247
    v_mfma_f32_16x16x32_bf16 v[172:175], a[192:195], a[44:47], v[172:175]
    s_add_u32 s93, s3, s87
    v_mul_u32_u24 v90, 3641, v7
    v_lshrrev_b32 v90, 16, v90
    v_mfma_f32_16x16x32_bf16 v[208:211], a[180:183], a[48:51], v[208:211]
    s_mul_i32 s53, s38, 81920
    ds_read_b64_tr_b16 a[96:97], v2 offset:0
    v_mul_u32_u24 v90, 2016, v90
    v_mfma_f32_16x16x32_bf16 v[208:211], a[184:187], a[52:55], v[208:211]
    s_add_u32 s53, s53, s85
    ds_read_b64_tr_b16 a[98:99], v2 offset:4608
    v_cvt_pk_bf16_f32 v18, v136, v137
    v_mfma_f32_16x16x32_bf16 v[208:211], a[188:191], a[56:59], v[208:211]
    s_xor_b32 s54, s38, 1
    v_cvt_pk_bf16_f32 v19, v138, v139
    v_lshl_add_u32 v90, v7, 4, v90
    v_mfma_f32_16x16x32_bf16 v[208:211], a[192:195], a[60:63], v[208:211]
    s_waitcnt lgkmcnt(10)
    ds_read_b64_tr_b16 a[100:101], v2 offset:9216
    v_add_u32 v7, 64, v3
    v_mfma_f32_16x16x32_bf16 v[248:251], a[196:199], a[64:67], v[248:251]
    s_mul_i32 s3, s54, 20480
    ds_read_b64_tr_b16 a[102:103], v2 offset:13824
    v_mul_u32_u24 v91, 3641, v7
    v_mfma_f32_16x16x32_bf16 v[248:251], a[200:203], a[68:71], v[248:251]
    s_add_u32 s72, s3, s53
    v_cvt_pk_bf16_f32 v38, v172, v173
    v_cvt_pk_bf16_f32 v39, v174, v175
    v_mfma_f32_16x16x32_bf16 v[248:251], a[204:207], a[72:75], v[248:251]
    s_lshl_b32 s3, s54, 11
    ds_read_b64_tr_b16 a[104:105], v2 offset:18432
    v_lshrrev_b32 v91, 16, v91
    v_mfma_f32_16x16x32_bf16 v[248:251], a[208:211], a[76:79], v[248:251]
    s_add_u32 s78, s3, s87
    ds_read_b64_tr_b16 a[106:107], v2 offset:23040
    v_mul_u32_u24 v91, 2016, v91
    v_mfma_f32_16x16x32_bf16 v[140:143], a[196:199], a[16:19], v[140:143]
    s_xor_b32 s54, s38, 2
    buffer_store_dwordx4 v[16:19], v1, s[24:27], s90 offen offset:0 sc1
    v_mfma_f32_16x16x32_bf16 v[140:143], a[200:203], a[20:23], v[140:143]
    s_mul_i32 s3, s54, 20480
    ds_read_b64_tr_b16 a[108:109], v2 offset:27648
    v_cvt_pk_bf16_f32 v58, v208, v209
    v_mfma_f32_16x16x32_bf16 v[140:143], a[204:207], a[24:27], v[140:143]
    s_add_u32 s73, s3, s53
    ds_read_b64_tr_b16 a[110:111], v2 offset:32256
    v_cvt_pk_bf16_f32 v59, v210, v211
    v_mfma_f32_16x16x32_bf16 v[140:143], a[208:211], a[28:31], v[140:143]
    s_lshl_b32 s3, s54, 11
    buffer_store_dwordx4 v[36:39], v1, s[24:27], s91 offen offset:0 sc1
    v_mfma_f32_16x16x32_bf16 v[176:179], a[196:199], a[32:35], v[176:179]
    s_add_u32 s79, s3, s87
    ds_read_b64_tr_b16 a[112:113], v2 offset:32
    v_lshl_add_u32 v91, v7, 4, v91
    v_mfma_f32_16x16x32_bf16 v[176:179], a[200:203], a[36:39], v[176:179]
    s_xor_b32 s54, s38, 3
    ds_read_b64_tr_b16 a[114:115], v2 offset:4640
    v_cvt_pk_bf16_f32 v44, v248, v249
    v_mfma_f32_16x16x32_bf16 v[176:179], a[204:207], a[40:43], v[176:179]
    s_mul_i32 s3, s54, 20480
    buffer_store_dwordx4 v[56:59], v1, s[24:27], s92 offen offset:0 sc1
    v_cvt_pk_bf16_f32 v45, v250, v251
    v_mfma_f32_16x16x32_bf16 v[176:179], a[208:211], a[44:47], v[176:179]
    s_add_u32 s74, s3, s53
    ds_read_b64_tr_b16 a[116:117], v2 offset:9248
    v_add_u32 v7, 128, v3
    v_mfma_f32_16x16x32_bf16 v[212:215], a[196:199], a[48:51], v[212:215]
    s_lshl_b32 s3, s54, 11
    ds_read_b64_tr_b16 a[118:119], v2 offset:13856
    v_mul_u32_u24 v92, 3641, v7
    v_mfma_f32_16x16x32_bf16 v[212:215], a[200:203], a[52:55], v[212:215]
    s_add_u32 s80, s3, s87
    v_cvt_pk_bf16_f32 v20, v140, v141
    v_cvt_pk_bf16_f32 v21, v142, v143
    v_mfma_f32_16x16x32_bf16 v[212:215], a[204:207], a[56:59], v[212:215]
    s_mul_i32 s53, s41, 1152
    ds_read_b64_tr_b16 a[120:121], v2 offset:18464
    v_lshrrev_b32 v92, 16, v92
    v_mfma_f32_16x16x32_bf16 v[212:215], a[208:211], a[60:63], v[212:215]
    s_waitcnt lgkmcnt(13)
    ds_read_b64_tr_b16 a[122:123], v2 offset:23072
    v_mul_u32_u24 v92, 2016, v92
    v_mfma_f32_16x16x32_bf16 v[252:255], a[80:83], a[64:67], v[252:255]
    s_mul_i32 s3, s40, 288
    v_lshl_add_u32 v92, v7, 4, v92
    v_add_u32 v7, 192, v3
    v_mfma_f32_16x16x32_bf16 v[252:255], a[84:87], a[68:71], v[252:255]
    s_add_u32 s53, s53, s3
    ds_read_b64_tr_b16 a[124:125], v2 offset:27680
    v_cvt_pk_bf16_f32 v40, v176, v177
    v_mfma_f32_16x16x32_bf16 v[252:255], a[88:91], a[72:75], v[252:255]
    s_mul_i32 s3, s39, 663552
    ds_read_b64_tr_b16 a[126:127], v2 offset:32288
    v_cvt_pk_bf16_f32 v41, v178, v179
    v_mfma_f32_16x16x32_bf16 v[252:255], a[92:95], a[76:79], v[252:255]
    s_add_u32 s53, s53, s3
    v_mul_u32_u24 v93, 3641, v7
    v_lshrrev_b32 v93, 16, v93
    v_mfma_f32_16x16x32_bf16 v[144:147], a[80:83], a[16:19], v[144:147]
    s_lshl_b32 s3, s46, 1
    ds_read_b64_tr_b16 a[128:129], v2 offset:64
    v_mul_u32_u24 v93, 2016, v93
    v_mfma_f32_16x16x32_bf16 v[144:147], a[84:87], a[20:23], v[144:147]
    s_add_u32 s82, s53, s3
    ds_read_b64_tr_b16 a[130:131], v2 offset:4672
    v_cvt_pk_bf16_f32 v60, v212, v213
    v_mfma_f32_16x16x32_bf16 v[144:147], a[88:91], a[24:27], v[144:147]
    s_lshl_b32 s3, s42, 1
    v_cvt_pk_bf16_f32 v61, v214, v215
    v_lshl_add_u32 v93, v7, 4, v93
    v_mfma_f32_16x16x32_bf16 v[144:147], a[92:95], a[28:31], v[144:147]
    s_add_u32 s81, s53, s3
    ds_read_b64_tr_b16 a[132:133], v2 offset:9280
    v_add_u32 v7, 256, v3
    v_mfma_f32_16x16x32_bf16 v[180:183], a[80:83], a[32:35], v[180:183]
    s_lshl_b32 s3, s38, 5
    ds_read_b64_tr_b16 a[134:135], v2 offset:13888
    v_mul_u32_u24 v94, 3641, v7
    v_mfma_f32_16x16x32_bf16 v[180:183], a[84:87], a[36:39], v[180:183]
    s_add_u32 s3, s3, s50
    v_cvt_pk_bf16_f32 v64, v252, v253
    v_cvt_pk_bf16_f32 v65, v254, v255
    v_mfma_f32_16x16x32_bf16 v[180:183], a[88:91], a[40:43], v[180:183]
    s_add_u32 s83, s3, s82
    ds_read_b64_tr_b16 a[136:137], v2 offset:18496
    v_lshrrev_b32 v94, 16, v94
    v_mfma_f32_16x16x32_bf16 v[180:183], a[92:95], a[44:47], v[180:183]
    s_lshl_b32 s3, s36, 2
    ds_read_b64_tr_b16 a[138:139], v2 offset:23104
    v_mul_u32_u24 v94, 2016, v94
    v_mfma_f32_16x16x32_bf16 v[216:219], a[80:83], a[48:51], v[216:219]
    s_sub_u32 s71, s71, 66060288
    v_lshl_add_u32 v94, v7, 4, v94
    v_lshrrev_b32 v7, 5, v3
    v_mfma_f32_16x16x32_bf16 v[216:219], a[84:87], a[52:55], v[216:219]
    s_add_u32 s84, s84, s86
    ds_read_b64_tr_b16 a[140:141], v2 offset:27712
    v_cvt_pk_bf16_f32 v22, v144, v145
    v_mfma_f32_16x16x32_bf16 v[216:219], a[88:91], a[56:59], v[216:219]
    s_mov_b32 s62, 2
    ds_read_b64_tr_b16 a[142:143], v2 offset:32320
    v_cvt_pk_bf16_f32 v23, v146, v147
    v_mfma_f32_16x16x32_bf16 v[216:219], a[92:95], a[60:63], v[216:219]
    s_waitcnt lgkmcnt(15)
    buffer_store_dwordx4 v[20:23], v1, s[24:27], s90 offen offset:1024 sc1
    v_mfma_f32_16x16x32_bf16 a[160:163], a[96:99], a[64:67], a[160:163]
    s_add_u32 s3, s3, 66060304
    ds_read_b64_tr_b16 a[144:145], v2 offset:96
    v_lshl_add_u32 v94, v7, 28, v94
    v_mfma_f32_16x16x32_bf16 a[160:163], a[100:103], a[68:71], a[160:163]
    s_add_u32 s12, s24, s3
    ds_read_b64_tr_b16 a[146:147], v2 offset:4704
    v_cvt_pk_bf16_f32 v42, v180, v181
    v_mfma_f32_16x16x32_bf16 a[160:163], a[104:107], a[72:75], a[160:163]
    s_addc_u32 s13, s25, 0
    s_sub_u32 s75, s75, 66060288
    v_cvt_pk_bf16_f32 v43, v182, v183
    v_mfma_f32_16x16x32_bf16 a[160:163], a[108:111], a[76:79], a[160:163]
    s_sub_u32 s76, s76, 66060288
    s_sub_u32 s77, s77, 66060288
    ds_read_b64_tr_b16 a[148:149], v2 offset:9312
    v_mfma_f32_16x16x32_bf16 v[148:151], a[96:99], a[16:19], v[148:151]
    ds_read_b64_tr_b16 a[150:151], v2 offset:13920
    v_mfma_f32_16x16x32_bf16 v[148:151], a[100:103], a[20:23], v[148:151]
    v_cvt_pk_bf16_f32 v62, v216, v217
    v_cvt_pk_bf16_f32 v63, v218, v219
    v_mfma_f32_16x16x32_bf16 v[148:151], a[104:107], a[24:27], v[148:151]
    ds_read_b64_tr_b16 a[152:153], v2 offset:18528
    v_mfma_f32_16x16x32_bf16 v[148:151], a[108:111], a[28:31], v[148:151]
    ds_read_b64_tr_b16 a[154:155], v2 offset:23136
    v_mfma_f32_16x16x32_bf16 v[184:187], a[96:99], a[32:35], v[184:187]
    v_accvgpr_read_b32 v76, a160
    v_accvgpr_read_b32 v77, a161
    v_mfma_f32_16x16x32_bf16 v[184:187], a[100:103], a[36:39], v[184:187]
    ds_read_b64_tr_b16 a[156:157], v2 offset:27744
    v_accvgpr_read_b32 v78, a162
    v_mfma_f32_16x16x32_bf16 v[184:187], a[104:107], a[40:43], v[184:187]
    ds_read_b64_tr_b16 a[158:159], v2 offset:32352
    v_accvgpr_read_b32 v79, a163
    v_mfma_f32_16x16x32_bf16 v[184:187], a[108:111], a[44:47], v[184:187]
    buffer_store_dwordx4 v[40:43], v1, s[24:27], s91 offen offset:1024 sc1
    v_cvt_pk_bf16_f32 v80, v76, v77
    v_mfma_f32_16x16x32_bf16 v[220:223], a[96:99], a[48:51], v[220:223]
    ds_read_b64_tr_b16 a[212:213], v2 offset:128
    v_cvt_pk_bf16_f32 v81, v78, v79
    v_mfma_f32_16x16x32_bf16 v[220:223], a[100:103], a[52:55], v[220:223]
    ds_read_b64_tr_b16 a[214:215], v2 offset:4736
    v_cvt_pk_bf16_f32 v26, v148, v149
    v_mfma_f32_16x16x32_bf16 v[220:223], a[104:107], a[56:59], v[220:223]
    buffer_store_dwordx4 v[60:63], v1, s[24:27], s92 offen offset:1024 sc1
    v_cvt_pk_bf16_f32 v27, v150, v151
    v_mfma_f32_16x16x32_bf16 v[220:223], a[108:111], a[60:63], v[220:223]
    s_waitcnt lgkmcnt(15)
    ds_read_b64_tr_b16 a[216:217], v2 offset:9344
    v_mfma_f32_16x16x32_bf16 v[152:155], a[112:115], a[16:19], v[152:155]
    ds_read_b64_tr_b16 a[218:219], v2 offset:13952
    v_mfma_f32_16x16x32_bf16 v[152:155], a[116:119], a[20:23], v[152:155]
    v_cvt_pk_bf16_f32 v46, v184, v185
    v_cvt_pk_bf16_f32 v47, v186, v187
    v_mfma_f32_16x16x32_bf16 v[152:155], a[120:123], a[24:27], v[152:155]
    ds_read_b64_tr_b16 a[220:221], v2 offset:18560
    v_mfma_f32_16x16x32_bf16 v[152:155], a[124:127], a[28:31], v[152:155]
    ds_read_b64_tr_b16 a[222:223], v2 offset:23168
    v_mfma_f32_16x16x32_bf16 v[188:191], a[112:115], a[32:35], v[188:191]
    buffer_store_dwordx2 v[80:81], v82, s[24:27], s93 offen sc1
    v_mfma_f32_16x16x32_bf16 v[188:191], a[116:119], a[36:39], v[188:191]
    ds_read_b64_tr_b16 a[224:225], v2 offset:27776
    v_cvt_pk_bf16_f32 v66, v220, v221
    v_mfma_f32_16x16x32_bf16 v[188:191], a[120:123], a[40:43], v[188:191]
    ds_read_b64_tr_b16 a[226:227], v2 offset:32384
    v_cvt_pk_bf16_f32 v67, v222, v223
    v_mfma_f32_16x16x32_bf16 v[188:191], a[124:127], a[44:47], v[188:191]
    buffer_store_dwordx4 v[24:27], v1, s[24:27], s90 offen offset:2048 sc1
    v_mfma_f32_16x16x32_bf16 v[224:227], a[112:115], a[48:51], v[224:227]
    v_mfma_f32_16x16x32_bf16 v[224:227], a[116:119], a[52:55], v[224:227]
    v_cvt_pk_bf16_f32 v28, v152, v153
    v_cvt_pk_bf16_f32 v29, v154, v155
    v_mfma_f32_16x16x32_bf16 v[224:227], a[120:123], a[56:59], v[224:227]
    buffer_store_dwordx4 v[44:47], v1, s[24:27], s91 offen offset:2048 sc1
    v_mfma_f32_16x16x32_bf16 v[224:227], a[124:127], a[60:63], v[224:227]
    s_waitcnt lgkmcnt(15)
    v_mfma_f32_16x16x32_bf16 v[156:159], a[128:131], a[16:19], v[156:159]
    buffer_store_dwordx4 v[64:67], v1, s[24:27], s92 offen offset:2048 sc1
    v_mfma_f32_16x16x32_bf16 v[156:159], a[132:135], a[20:23], v[156:159]
    v_cvt_pk_bf16_f32 v48, v188, v189
    v_cvt_pk_bf16_f32 v49, v190, v191
    v_mfma_f32_16x16x32_bf16 v[156:159], a[136:139], a[24:27], v[156:159]
    v_mfma_f32_16x16x32_bf16 v[156:159], a[140:143], a[28:31], v[156:159]
    v_mfma_f32_16x16x32_bf16 v[192:195], a[128:131], a[32:35], v[192:195]
    v_mfma_f32_16x16x32_bf16 v[192:195], a[132:135], a[36:39], v[192:195]
    v_cvt_pk_bf16_f32 v68, v224, v225
    v_cvt_pk_bf16_f32 v69, v226, v227
    v_mfma_f32_16x16x32_bf16 v[192:195], a[136:139], a[40:43], v[192:195]
    v_mfma_f32_16x16x32_bf16 v[192:195], a[140:143], a[44:47], v[192:195]
    v_mfma_f32_16x16x32_bf16 v[228:231], a[128:131], a[48:51], v[228:231]
    v_mfma_f32_16x16x32_bf16 v[228:231], a[132:135], a[52:55], v[228:231]
    v_cvt_pk_bf16_f32 v30, v156, v157
    v_cvt_pk_bf16_f32 v31, v158, v159
    v_mfma_f32_16x16x32_bf16 v[228:231], a[136:139], a[56:59], v[228:231]
    buffer_store_dwordx4 v[28:31], v1, s[24:27], s90 offen offset:3072 sc1
    v_mfma_f32_16x16x32_bf16 v[228:231], a[140:143], a[60:63], v[228:231]
    s_waitcnt lgkmcnt(8)
    v_mfma_f32_16x16x32_bf16 v[160:163], a[144:147], a[16:19], v[160:163]
    v_mfma_f32_16x16x32_bf16 v[160:163], a[148:151], a[20:23], v[160:163]
    v_cvt_pk_bf16_f32 v50, v192, v193
    v_cvt_pk_bf16_f32 v51, v194, v195
    v_mfma_f32_16x16x32_bf16 v[160:163], a[152:155], a[24:27], v[160:163]
    buffer_store_dwordx4 v[48:51], v1, s[24:27], s91 offen offset:3072 sc1
    v_mfma_f32_16x16x32_bf16 v[160:163], a[156:159], a[28:31], v[160:163]
    v_mfma_f32_16x16x32_bf16 v[196:199], a[144:147], a[32:35], v[196:199]
    v_mfma_f32_16x16x32_bf16 v[196:199], a[148:151], a[36:39], v[196:199]
    v_cvt_pk_bf16_f32 v70, v228, v229
    v_cvt_pk_bf16_f32 v71, v230, v231
    v_mfma_f32_16x16x32_bf16 v[196:199], a[152:155], a[40:43], v[196:199]
    buffer_store_dwordx4 v[68:71], v1, s[24:27], s92 offen offset:3072 sc1
    v_mfma_f32_16x16x32_bf16 v[196:199], a[156:159], a[44:47], v[196:199]
    v_mfma_f32_16x16x32_bf16 v[232:235], a[144:147], a[48:51], v[232:235]
    v_mfma_f32_16x16x32_bf16 v[232:235], a[148:151], a[52:55], v[232:235]
    v_cvt_pk_bf16_f32 v32, v160, v161
    v_cvt_pk_bf16_f32 v33, v162, v163
    v_mfma_f32_16x16x32_bf16 v[232:235], a[152:155], a[56:59], v[232:235]
    v_mfma_f32_16x16x32_bf16 v[232:235], a[156:159], a[60:63], v[232:235]
    s_waitcnt lgkmcnt(0)
    v_mfma_f32_16x16x32_bf16 v[164:167], a[212:215], a[16:19], v[164:167]
    v_mfma_f32_16x16x32_bf16 v[164:167], a[216:219], a[20:23], v[164:167]
    v_cvt_pk_bf16_f32 v52, v196, v197
    v_cvt_pk_bf16_f32 v53, v198, v199
    v_mfma_f32_16x16x32_bf16 v[164:167], a[220:223], a[24:27], v[164:167]
    v_mfma_f32_16x16x32_bf16 v[164:167], a[224:227], a[28:31], v[164:167]
    v_mfma_f32_16x16x32_bf16 v[200:203], a[212:215], a[32:35], v[200:203]
    v_mfma_f32_16x16x32_bf16 v[200:203], a[216:219], a[36:39], v[200:203]
    v_cvt_pk_bf16_f32 v72, v232, v233
    v_cvt_pk_bf16_f32 v73, v234, v235
    v_mfma_f32_16x16x32_bf16 v[200:203], a[220:223], a[40:43], v[200:203]
    v_mfma_f32_16x16x32_bf16 v[200:203], a[224:227], a[44:47], v[200:203]
    v_mfma_f32_16x16x32_bf16 v[236:239], a[212:215], a[48:51], v[236:239]
    v_mfma_f32_16x16x32_bf16 v[236:239], a[216:219], a[52:55], v[236:239]
    s_add_u32 s90, s90, 4096
    v_cvt_pk_bf16_f32 v34, v164, v165
    v_cvt_pk_bf16_f32 v35, v166, v167
    v_mfma_f32_16x16x32_bf16 v[236:239], a[220:223], a[56:59], v[236:239]
    buffer_store_dwordx4 v[32:35], v1, s[24:27], s90 offen offset:0 sc1
    v_mfma_f32_16x16x32_bf16 v[236:239], a[224:227], a[60:63], v[236:239]
    v_mfma_f32_16x16x32_bf16 v[240:243], a[164:167], a[64:67], v[240:243]
    v_mfma_f32_16x16x32_bf16 v[240:243], a[168:171], a[68:71], v[240:243]
    s_add_u32 s91, s91, 4096
    v_cvt_pk_bf16_f32 v54, v200, v201
    v_cvt_pk_bf16_f32 v55, v202, v203
    v_mfma_f32_16x16x32_bf16 v[240:243], a[172:175], a[72:75], v[240:243]
    buffer_store_dwordx4 v[52:55], v1, s[24:27], s91 offen offset:0 sc1
    v_mfma_f32_16x16x32_bf16 v[240:243], a[176:179], a[76:79], v[240:243]
    s_waitcnt vmcnt(15)
    v_mfma_f32_16x16x32_bf16 v[96:99], a[164:167], a[0:3], v[96:99]
    v_mfma_f32_16x16x32_bf16 v[96:99], a[168:171], a[4:7], v[96:99]
    s_add_u32 s92, s92, 4096
    v_cvt_pk_bf16_f32 v74, v236, v237
    v_cvt_pk_bf16_f32 v75, v238, v239
    v_mfma_f32_16x16x32_bf16 v[96:99], a[172:175], a[8:11], v[96:99]
    buffer_store_dwordx4 v[72:75], v1, s[24:27], s92 offen offset:0 sc1
    v_mfma_f32_16x16x32_bf16 v[96:99], a[176:179], a[12:15], v[96:99]
    s_mov_b32 s89, 0
    s_mov_b32 s94, 0
    s_mov_b32 s88, 0x40000
    v_mfma_f32_16x16x32_bf16 v[100:103], a[180:183], a[0:3], v[100:103]
    v_mfma_f32_16x16x32_bf16 v[100:103], a[184:187], a[4:7], v[100:103]
    v_lshrrev_b32 v9, 4, v1
    v_and_b32 v10, 15, v9
    v_mfma_f32_16x16x32_bf16 v[100:103], a[188:191], a[8:11], v[100:103]
    v_mul_u32_u24 v10, 288, v10
    v_lshrrev_b32 v9, 4, v9
    v_mfma_f32_16x16x32_bf16 v[100:103], a[192:195], a[12:15], v[100:103]
    v_lshl_add_u32 v10, v9, 3, v10
    v_add_u32 v10, s84, v10
    v_mfma_f32_16x16x32_bf16 v[104:107], a[196:199], a[0:3], v[104:107]
    v_add_u32 v8, s84, v1
    v_mov_b32 v11, s38
    v_mfma_f32_16x16x32_bf16 v[104:107], a[200:203], a[4:7], v[104:107]
    v_add_u32 v7, s50, v10
    v_xor_b32 v3, 0, v11
    v_mfma_f32_16x16x32_bf16 v[104:107], a[204:207], a[8:11], v[104:107]
    v_lshl_add_u32 v3, v3, 5, v7
    v_xor_b32 v4, 1, v11
    v_mfma_f32_16x16x32_bf16 v[104:107], a[208:211], a[12:15], v[104:107]
    v_lshl_add_u32 v4, v4, 5, v7
    v_xor_b32 v5, 2, v11
    v_mfma_f32_16x16x32_bf16 v[108:111], a[80:83], a[0:3], v[108:111]
    v_lshl_add_u32 v5, v5, 5, v7
    v_xor_b32 v6, 3, v11
    v_mfma_f32_16x16x32_bf16 v[108:111], a[84:87], a[4:7], v[108:111]
    v_lshl_add_u32 v6, v6, 5, v7
    v_mov_b32 v11, s37
    v_mfma_f32_16x16x32_bf16 v[108:111], a[88:91], a[8:11], v[108:111]
    v_xor_b32 v11, 1, v11
    v_lshl_add_u32 v7, v11, 7, v10
    v_mfma_f32_16x16x32_bf16 v[108:111], a[92:95], a[12:15], v[108:111]
    v_mov_b32 v138, 0
    v_mov_b32 v139, 0
    v_mfma_f32_16x16x32_bf16 v[112:115], a[96:99], a[0:3], v[112:115]
    v_mov_b32 v142, 0
    v_mov_b32 v143, 0
    v_mfma_f32_16x16x32_bf16 v[112:115], a[100:103], a[4:7], v[112:115]
    v_mov_b32 v146, 0
    v_mov_b32 v147, 0
    v_mfma_f32_16x16x32_bf16 v[112:115], a[104:107], a[8:11], v[112:115]
    v_mfma_f32_16x16x32_bf16 v[112:115], a[108:111], a[12:15], v[112:115]
    v_mfma_f32_16x16x32_bf16 v[116:119], a[112:115], a[0:3], v[116:119]
    v_mfma_f32_16x16x32_bf16 v[116:119], a[116:119], a[4:7], v[116:119]
    v_mfma_f32_16x16x32_bf16 v[116:119], a[120:123], a[8:11], v[116:119]
    v_mfma_f32_16x16x32_bf16 v[116:119], a[124:127], a[12:15], v[116:119]
    v_mfma_f32_16x16x32_bf16 v[120:123], a[128:131], a[0:3], v[120:123]
    s_mov_b32 s59, 0
    s_mov_b32 s60, 0
    s_mov_b32 s61, 0
    v_mfma_f32_16x16x32_bf16 v[120:123], a[132:135], a[4:7], v[120:123]
    s_atomic_add s59, s[12:13], s75 glc
    s_atomic_add s60, s[12:13], s76 glc
    s_atomic_add s61, s[12:13], s77 glc
    v_mfma_f32_16x16x32_bf16 v[120:123], a[136:139], a[8:11], v[120:123]
    v_mfma_f32_16x16x32_bf16 v[120:123], a[140:143], a[12:15], v[120:123]
    v_mfma_f32_16x16x32_bf16 v[124:127], a[144:147], a[0:3], v[124:127]
    v_mfma_f32_16x16x32_bf16 v[124:127], a[148:151], a[4:7], v[124:127]
    v_mfma_f32_16x16x32_bf16 v[124:127], a[152:155], a[8:11], v[124:127]
    v_mfma_f32_16x16x32_bf16 v[124:127], a[156:159], a[12:15], v[124:127]
    v_mfma_f32_16x16x32_bf16 v[128:131], a[212:215], a[0:3], v[128:131]
    v_mfma_f32_16x16x32_bf16 v[128:131], a[216:219], a[4:7], v[128:131]
    v_mfma_f32_16x16x32_bf16 v[128:131], a[220:223], a[8:11], v[128:131]
    v_mfma_f32_16x16x32_bf16 v[128:131], a[224:227], a[12:15], v[128:131]
L_otail:
    s_waitcnt vmcnt(0) lgkmcnt(0)
    s_atomic_add s62, s[12:13], s71
    s_branch L_gfirst
L_gather:
    s_waitcnt lgkmcnt(0)
L_gfirst:
    s_bitcmp1_b32 s89, 0
    s_cbranch_scc1 L_gl0
    s_cmp_ge_u32 s59, 1
    s_cbranch_scc0 L_gl0
    s_bitset1_b32 s89, 0
    buffer_load_dwordx4 v[16:19], v1, s[24:27], s72 offen offset:0 sc1
    buffer_load_dwordx4 v[20:23], v1, s[24:27], s72 offen offset:1024 sc1
    buffer_load_dwordx4 v[24:27], v1, s[24:27], s72 offen offset:2048 sc1
    buffer_load_dwordx2 v[136:137], v82, s[24:27], s78 offen sc1
L_gl0:
    s_bitcmp1_b32 s89, 1
    s_cbranch_scc1 L_gl1
    s_cmp_ge_u32 s60, 1
    s_cbranch_scc0 L_gl1
    s_bitset1_b32 s89, 1
    buffer_load_dwordx4 v[36:39], v1, s[24:27], s73 offen offset:0 sc1
    buffer_load_dwordx4 v[40:43], v1, s[24:27], s73 offen offset:1024 sc1
    buffer_load_dwordx4 v[44:47], v1, s[24:27], s73 offen offset:2048 sc1
    buffer_load_dwordx2 v[140:141], v82, s[24:27], s79 offen sc1
L_gl1:
    s_bitcmp1_b32 s89, 2
    s_cbranch_scc1 L_gl2
    s_cmp_ge_u32 s61, 1
    s_cbranch_scc0 L_gl2
    s_bitset1_b32 s89, 2
    buffer_load_dwordx4 v[56:59], v1, s[24:27], s74 offen offset:0 sc1
    buffer_load_dwordx4 v[60:63], v1, s[24:27], s74 offen offset:1024 sc1
    buffer_load_dwordx4 v[64:67], v1, s[24:27], s74 offen offset:2048 sc1
    buffer_load_dwordx2 v[144:145], v82, s[24:27], s80 offen sc1
L_gl2:
    s_bitcmp1_b32 s89, 3
    s_cbranch_scc1 L_gl3
    s_cmp_ge_u32 s59, 2
    s_cbranch_scc0 L_gl3
    s_bitset1_b32 s89, 3
    buffer_load_dwordx4 v[28:31], v1, s[24:27], s72 offen offset:3072 sc1
    s_add_u32 s72, s72, 4096
    buffer_load_dwordx4 v[32:35], v1, s[24:27], s72 offen offset:0 sc1
L_gl3:
    s_bitcmp1_b32 s89, 4
    s_cbranch_scc1 L_gl4
    s_cmp_ge_u32 s60, 2
    s_cbranch_scc0 L_gl4
    s_bitset1_b32 s89, 4
    buffer_load_dwordx4 v[48:51], v1, s[24:27], s73 offen offset:3072 sc1
    s_add_u32 s73, s73, 4096
    buffer_load_dwordx4 v[52:55], v1, s[24:27], s73 offen offset:0 sc1
L_gl4:
    s_bitcmp1_b32 s89, 5
    s_cbranch_scc1 L_gl5
    s_cmp_ge_u32 s61, 2
    s_cbranch_scc0 L_gl5
    s_bitset1_b32 s89, 5
    buffer_load_dwordx4 v[68:71], v1, s[24:27], s74 offen offset:3072 sc1
    s_add_u32 s74, s74, 4096
    buffer_load_dwordx4 v[72:75], v1, s[24:27], s74 offen offset:0 sc1
L_gl5:
    s_cmp_eq_u32 s89, 63
    s_cbranch_scc1 L_gdone
    s_mov_b32 s59, 0
    s_mov_b32 s60, 0
    s_mov_b32 s61, 0
    s_atomic_add s59, s[12:13], s75 glc
    s_atomic_add s60, s[12:13], s76 glc
    s_atomic_add s61, s[12:13], s77 glc
    s_sub_u32 s88, s88, 1
    s_cbranch_scc0 L_gather
    s_waitcnt lgkmcnt(0)
L_gdone:
    s_waitcnt vmcnt(2)
    v_mfma_f32_16x16x32_bf16 v[100:103], v[86:89], v[16:19], v[100:103]
    v_mfma_f32_16x16x32_bf16 v[96:99], v[84:87], v[16:19], v[96:99]
    v_mfma_f32_16x16x32_bf16 v[108:111], v[86:89], v[20:23], v[108:111]
    v_mfma_f32_16x16x32_bf16 v[104:107], v[84:87], v[20:23], v[104:107]
    v_mfma_f32_16x16x32_bf16 v[240:243], v[86:89], v[24:27], v[240:243]
    v_mfma_f32_16x16x32_bf16 v[112:115], v[84:87], v[24:27], v[112:115]
    v_mfma_f32_16x16x32_bf16 v[76:79], v[86:89], v[136:139], v[76:79]
    v_mfma_f32_16x16x32_bf16 v[104:107], v[86:89], v[36:39], v[104:107]
    v_mfma_f32_16x16x32_bf16 v[108:111], v[84:87], v[36:39], v[108:111]
    v_mfma_f32_16x16x32_bf16 v[96:99], v[86:89], v[40:43], v[96:99]
    v_mfma_f32_16x16x32_bf16 v[100:103], v[84:87], v[40:43], v[100:103]
    v_mfma_f32_16x16x32_bf16 v[240:243], v[86:89], v[44:47], v[240:243]
    v_mfma_f32_16x16x32_bf16 v[112:115], v[84:87], v[44:47], v[112:115]
    v_mfma_f32_16x16x32_bf16 v[76:79], v[86:89], v[140:143], v[76:79]
    v_mfma_f32_16x16x32_bf16 v[108:111], v[86:89], v[56:59], v[108:111]
    v_mfma_f32_16x16x32_bf16 v[104:107], v[84:87], v[56:59], v[104:107]
    v_mfma_f32_16x16x32_bf16 v[100:103], v[86:89], v[60:63], v[100:103]
    v_mfma_f32_16x16x32_bf16 v[96:99], v[84:87], v[60:63], v[96:99]
    v_mfma_f32_16x16x32_bf16 v[240:243], v[86:89], v[64:67], v[240:243]
    v_mfma_f32_16x16x32_bf16 v[112:115], v[84:87], v[64:67], v[112:115]
    v_mfma_f32_16x16x32_bf16 v[76:79], v[86:89], v[144:147], v[76:79]
    s_waitcnt vmcnt(0)
    v_mfma_f32_16x16x32_bf16 v[116:119], v[86:89], v[28:31], v[116:119]
    v_mfma_f32_16x16x32_bf16 v[120:123], v[84:87], v[28:31], v[120:123]
    v_mfma_f32_16x16x32_bf16 v[124:127], v[86:89], v[32:35], v[124:127]
    v_mfma_f32_16x16x32_bf16 v[128:131], v[84:87], v[32:35], v[128:131]
    v_mfma_f32_16x16x32_bf16 v[116:119], v[86:89], v[48:51], v[116:119]
    v_mfma_f32_16x16x32_bf16 v[120:123], v[84:87], v[48:51], v[120:123]
    v_mfma_f32_16x16x32_bf16 v[124:127], v[86:89], v[52:55], v[124:127]
    v_mfma_f32_16x16x32_bf16 v[128:131], v[84:87], v[52:55], v[128:131]
    v_mfma_f32_16x16x32_bf16 v[116:119], v[86:89], v[68:71], v[116:119]
    v_mfma_f32_16x16x32_bf16 v[120:123], v[84:87], v[68:71], v[120:123]
    v_mfma_f32_16x16x32_bf16 v[124:127], v[86:89], v[72:75], v[124:127]
    v_mfma_f32_16x16x32_bf16 v[128:131], v[84:87], v[72:75], v[128:131]
    s_nop 7
    v_cvt_pk_bf16_f32 v96, v96, v97
    v_cvt_pk_bf16_f32 v97, v98, v99
    ds_write_b64 v3, v[96:97] offset:0
    v_cvt_pk_bf16_f32 v100, v100, v101
    v_cvt_pk_bf16_f32 v101, v102, v103
    ds_write_b64 v4, v[100:101] offset:0
    v_cvt_pk_bf16_f32 v104, v104, v105
    v_cvt_pk_bf16_f32 v105, v106, v107
    ds_write_b64 v5, v[104:105] offset:0
    v_cvt_pk_bf16_f32 v108, v108, v109
    v_cvt_pk_bf16_f32 v109, v110, v111
    ds_write_b64 v6, v[108:109] offset:0
    v_cvt_pk_bf16_f32 v112, v112, v113
    v_cvt_pk_bf16_f32 v113, v114, v115
    ds_write_b64 v7, v[112:113] offset:0
    v_cvt_pk_bf16_f32 v116, v116, v117
    v_cvt_pk_bf16_f32 v117, v118, v119
    ds_write_b64 v7, v[116:117] offset:32
    v_cvt_pk_bf16_f32 v120, v120, v121
    v_cvt_pk_bf16_f32 v121, v122, v123
    ds_write_b64 v7, v[120:121] offset:64
    v_cvt_pk_bf16_f32 v124, v124, v125
    v_cvt_pk_bf16_f32 v125, v126, v127
    ds_write_b64 v7, v[124:125] offset:96
    v_cvt_pk_bf16_f32 v128, v128, v129
    v_cvt_pk_bf16_f32 v129, v130, v131
    ds_write_b64 v7, v[128:129] offset:128
    ds_read_b128 v[16:19], v8 offset:0
    ds_read_b128 v[20:23], v8 offset:1024
    ds_read_b128 v[24:27], v8 offset:2048
    ds_read_b128 v[28:31], v8 offset:3072
    ds_read_b128 v[32:35], v8 offset:4096
    v_cvt_pk_bf16_f32 v240, v240, v241
    v_cvt_pk_bf16_f32 v241, v242, v243
    v_cvt_pk_bf16_f32 v76, v76, v77
    v_cvt_pk_bf16_f32 v77, v78, v79
    v_cmp_eq_u32 vcc, s38, v9
    s_waitcnt lgkmcnt(4)
    buffer_store_dwordx4 v[16:19], v90, s[28:31], s81 offen sc1
    s_waitcnt lgkmcnt(3)
    buffer_store_dwordx4 v[20:23], v91, s[28:31], s81 offen sc1
    s_waitcnt lgkmcnt(2)
    buffer_store_dwordx4 v[24:27], v92, s[28:31], s81 offen sc1
    s_waitcnt lgkmcnt(1)
    buffer_store_dwordx4 v[28:31], v93, s[28:31], s81 offen sc1
    s_waitcnt lgkmcnt(0)
    buffer_store_dwordx4 v[32:35], v94, s[28:31], s81 offen sc1
    buffer_store_dwordx2 v[240:241], v83, s[28:31], s83 offen sc1
    s_cmp_eq_u32 s37, 1
    s_cbranch_scc1 L_fin
    s_and_saveexec_b64 s[90:91], vcc
    buffer_store_dwordx2 v[76:77], v83, s[28:31], s82 offen offset:128 sc1
    s_mov_b64 exec, s[90:91]
L_fin:
    s_waitcnt vmcnt(0) lgkmcnt(0)
    s_endpgm
L_sp_dbg:
    s_mov_b32 s88, 0x40000
L_spl_dbg:
    s_sleep 1
    buffer_load_dword v11, off, s[32:35], s55 sc1
    s_waitcnt vmcnt(0)
    v_readfirstlane_b32 s3, v11
    s_cmp_ge_u32 s3, 16
    s_cbranch_scc1 L_sb_dbg
    s_sub_u32 s88, s88, 1
    s_cmp_lg_u32 s88, 0
    s_cbranch_scc1 L_spl_dbg
    s_branch L_sb_dbg
L_sp_o1:
    s_mov_b32 s88, 0x40000
L_spl_o1:
    s_sleep 1
    buffer_load_dword v15, off, s[24:27], s52 sc1
    s_waitcnt vmcnt(0)
    v_readfirstlane_b32 s54, v15
    s_cmp_ge_u32 s54, s51
    s_cbranch_scc1 L_sb_o1
    s_sub_u32 s88, s88, 1
    s_cmp_lg_u32 s88, 0
    s_cbranch_scc1 L_spl_o1
    s_branch L_sb_o1
L_sp_g0:
    s_mov_b32 s88, 0x40000
L_spl_g0:
    s_sleep 1
    buffer_load_dword v15, off, s[24:27], s52 sc1
    s_waitcnt vmcnt(0)
    v_readfirstlane_b32 s54, v15
    s_cmp_ge_u32 s54, s51
    s_cbranch_scc1 L_sb_g0
    s_sub_u32 s88, s88, 1
    s_cmp_lg_u32 s88, 0
    s_cbranch_scc1 L_spl_g0
    s_branch L_sb_g0
L_sp_g1:
    s_mov_b32 s88, 0x40000
L_spl_g1:
    s_sleep 1
    buffer_load_dword v15, off, s[24:27], s52 sc1
    s_waitcnt vmcnt(0)
    v_readfirstlane_b32 s54, v15
    s_cmp_ge_u32 s54, s51
    s_cbranch_scc1 L_sb_g1
    s_sub_u32 s88, s88, 1
    s_cmp_lg_u32 s88, 0
    s_cbranch_scc1 L_spl_g1
    s_branch L_sb_g1
L_redo0:
    s_waitcnt vmcnt(0) lgkmcnt(0)
    s_barrier
    s_mov_b32 s62, 1
    v_and_b32 v9, 7, v0
    v_mul_u32_u24 v9, 1056, v9
    v_and_b32 v14, 8, v0
    v_lshl_add_u32 v9, v14, 5, v9
    v_and_b32 v14, 48, v0
    s_mul_i32 s3, s37, 8448
    v_add3_u32 v2, v9, v14, s3
    v_bfe_u32 v9, v0, 2, 3
    v_mul_u32_u24 v9, 1056, v9
    v_and_b32 v14, 32, v0
    v_lshl_add_u32 v9, v14, 3, v9
    v_and_b32 v14, 3, v0
    v_lshl_add_u32 v9, v14, 3, v9
    s_add_u32 s3, s3, 69632
    v_add_u32 v3, s3, v9
    v_mov_b32 v16, 0xff800000
    v_mov_b32 v20, 0xff800000
    v_mov_b32 v24, 0xff800000
    v_mov_b32 v28, 0xff800000
    v_mov_b32 v32, 0xff800000
    s_mov_b32 s52, 0
    s_mov_b32 s50, s47
L_rl0:
    s_add_u32 m0, s63, 0
    s_nop 0
    buffer_load_dwordx4 v1, s[12:15], s52 offen offset:0 lds
    s_add_u32 m0, s63, 32
    s_nop 0
    buffer_load_dwordx4 v1, s[12:15], s52 offen offset:1024 lds
    s_add_u32 m0, s63, 64
    s_nop 0
    buffer_load_dwordx4 v1, s[12:15], s52 offen offset:2048 lds
    s_add_u32 m0, s63, 96
    s_nop 0
    buffer_load_dwordx4 v1, s[12:15], s52 offen offset:3072 lds
    s_waitcnt vmcnt(0)
    s_barrier
    ds_read_b128 a[160:163], v2 offset:0
    ds_read_b128 a[164:167], v2 offset:64
    ds_read_b128 a[168:171], v2 offset:128
    ds_read_b128 a[172:175], v2 offset:192
    ds_read_b128 a[176:179], v2 offset:512
    ds_read_b128 a[180:183], v2 offset:576
    ds_read_b128 a[184:187], v2 offset:640
    ds_read_b128 a[188:191], v2 offset:704
    s_waitcnt lgkmcnt(0)
    v_add_u32 v2, s50, v2
    s_sub_u32 s50, 0, s50
    v_mfma_f32_16x16x32_bf16 v[96:99], a[160:163], a[0:3], 0
    v_mfma_f32_16x16x32_bf16 v[96:99], a[164:167], a[4:7], v[96:99]
    v_mfma_f32_16x16x32_bf16 v[96:99], a[168:171], a[8:11], v[96:99]
    v_mfma_f32_16x16x32_bf16 v[96:99], a[172:175], a[12:15], v[96:99]
    v_mfma_f32_16x16x32_bf16 v[100:103], a[176:179], a[0:3], 0
    v_mfma_f32_16x16x32_bf16 v[100:103], a[180:183], a[4:7], v[100:103]
    v_mfma_f32_16x16x32_bf16 v[100:103], a[184:187], a[8:11], v[100:103]
    v_mfma_f32_16x16x32_bf16 v[100:103], a[188:191], a[12:15], v[100:103]
    v_mfma_f32_16x16x32_bf16 v[104:107], a[160:163], a[16:19], 0
    v_mfma_f32_16x16x32_bf16 v[104:107], a[164:167], a[20:23], v[104:107]
    v_mfma_f32_16x16x32_bf16 v[104:107], a[168:171], a[24:27], v[104:107]
    v_mfma_f32_16x16x32_bf16 v[104:107], a[172:175], a[28:31], v[104:107]
    v_mfma_f32_16x16x32_bf16 v[108:111], a[176:179], a[16:19], 0
    v_mfma_f32_16x16x32_bf16 v[108:111], a[180:183], a[20:23], v[108:111]
    v_mfma_f32_16x16x32_bf16 v[108:111], a[184:187], a[24:27], v[108:111]
    v_mfma_f32_16x16x32_bf16 v[108:111], a[188:191], a[28:31], v[108:111]
    v_mfma_f32_16x16x32_bf16 v[112:115], a[160:163], a[32:35], 0
    v_mfma_f32_16x16x32_bf16 v[112:115], a[164:167], a[36:39], v[112:115]
    v_mfma_f32_16x16x32_bf16 v[112:115], a[168:171], a[40:43], v[112:115]
    v_mfma_f32_16x16x32_bf16 v[112:115], a[172:175], a[44:47], v[112:115]
    v_mfma_f32_16x16x32_bf16 v[116:119], a[176:179], a[32:35], 0
    v_mfma_f32_16x16x32_bf16 v[116:119], a[180:183], a[36:39], v[116:119]
    v_mfma_f32_16x16x32_bf16 v[116:119], a[184:187], a[40:43], v[116:119]
    v_mfma_f32_16x16x32_bf16 v[116:119], a[188:191], a[44:47], v[116:119]
    v_mfma_f32_16x16x32_bf16 v[120:123], a[160:163], a[48:51], 0
    v_mfma_f32_16x16x32_bf16 v[120:123], a[164:167], a[52:55], v[120:123]
    v_mfma_f32_16x16x32_bf16 v[120:123], a[168:171], a[56:59], v[120:123]
    v_mfma_f32_16x16x32_bf16 v[120:123], a[172:175], a[60:63], v[120:123]
    v_mfma_f32_16x16x32_bf16 v[124:127], a[176:179], a[48:51], 0
    v_mfma_f32_16x16x32_bf16 v[124:127], a[180:183], a[52:55], v[124:127]
    v_mfma_f32_16x16x32_bf16 v[124:127], a[184:187], a[56:59], v[124:127]
    v_mfma_f32_16x16x32_bf16 v[124:127], a[188:191], a[60:63], v[124:127]
    v_mfma_f32_16x16x32_bf16 v[128:131], a[160:163], a[64:67], 0
    v_mfma_f32_16x16x32_bf16 v[128:131], a[164:167], a[68:71], v[128:131]
    v_mfma_f32_16x16x32_bf16 v[128:131], a[168:171], a[72:75], v[128:131]
    v_mfma_f32_16x16x32_bf16 v[128:131], a[172:175], a[76:79], v[128:131]
    v_mfma_f32_16x16x32_bf16 v[132:135], a[176:179], a[64:67], 0
    v_mfma_f32_16x16x32_bf16 v[132:135], a[180:183], a[68:71], v[132:135]
    v_mfma_f32_16x16x32_bf16 v[132:135], a[184:187], a[72:75], v[132:135]
    v_mfma_f32_16x16x32_bf16 v[132:135], a[188:191], a[76:79], v[132:135]
    s_nop 7
    v_max3_f32 v16, v96, v97, v16
    v_max3_f32 v16, v98, v99, v16
    v_max3_f32 v16, v100, v101, v16
    v_max3_f32 v16, v102, v103, v16
    v_max3_f32 v20, v104, v105, v20
    v_max3_f32 v20, v106, v107, v20
    v_max3_f32 v20, v108, v109, v20
    v_max3_f32 v20, v110, v111, v20
    v_max3_f32 v24, v112, v113, v24
    v_max3_f32 v24, v114, v115, v24
    v_max3_f32 v24, v116, v117, v24
    v_max3_f32 v24, v118, v119, v24
    v_max3_f32 v28, v120, v121, v28
    v_max3_f32 v28, v122, v123, v28
    v_max3_f32 v28, v124, v125, v28
    v_max3_f32 v28, v126, v127, v28
    v_max3_f32 v32, v128, v129, v32
    v_max3_f32 v32, v130, v131, v32
    v_max3_f32 v32, v132, v133, v32
    v_max3_f32 v32, v134, v135, v32
    ds_read_b128 a[160:163], v2 offset:0
    ds_read_b128 a[164:167], v2 offset:64
    ds_read_b128 a[168:171], v2 offset:128
    ds_read_b128 a[172:175], v2 offset:192
    ds_read_b128 a[176:179], v2 offset:512
    ds_read_b128 a[180:183], v2 offset:576
    ds_read_b128 a[184:187], v2 offset:640
    ds_read_b128 a[188:191], v2 offset:704
    s_waitcnt lgkmcnt(0)
    v_add_u32 v2, s50, v2
    s_sub_u32 s50, 0, s50
    v_mfma_f32_16x16x32_bf16 v[96:99], a[160:163], a[0:3], 0
    v_mfma_f32_16x16x32_bf16 v[96:99], a[164:167], a[4:7], v[96:99]
    v_mfma_f32_16x16x32_bf16 v[96:99], a[168:171], a[8:11], v[96:99]
    v_mfma_f32_16x16x32_bf16 v[96:99], a[172:175], a[12:15], v[96:99]
    v_mfma_f32_16x16x32_bf16 v[100:103], a[176:179], a[0:3], 0
    v_mfma_f32_16x16x32_bf16 v[100:103], a[180:183], a[4:7], v[100:103]
    v_mfma_f32_16x16x32_bf16 v[100:103], a[184:187], a[8:11], v[100:103]
    v_mfma_f32_16x16x32_bf16 v[100:103], a[188:191], a[12:15], v[100:103]
    v_mfma_f32_16x16x32_bf16 v[104:107], a[160:163], a[16:19], 0
    v_mfma_f32_16x16x32_bf16 v[104:107], a[164:167], a[20:23], v[104:107]
    v_mfma_f32_16x16x32_bf16 v[104:107], a[168:171], a[24:27], v[104:107]
    v_mfma_f32_16x16x32_bf16 v[104:107], a[172:175], a[28:31], v[104:107]
    v_mfma_f32_16x16x32_bf16 v[108:111], a[176:179], a[16:19], 0
    v_mfma_f32_16x16x32_bf16 v[108:111], a[180:183], a[20:23], v[108:111]
    v_mfma_f32_16x16x32_bf16 v[108:111], a[184:187], a[24:27], v[108:111]
    v_mfma_f32_16x16x32_bf16 v[108:111], a[188:191], a[28:31], v[108:111]
    v_mfma_f32_16x16x32_bf16 v[112:115], a[160:163], a[32:35], 0
    v_mfma_f32_16x16x32_bf16 v[112:115], a[164:167], a[36:39], v[112:115]
    v_mfma_f32_16x16x32_bf16 v[112:115], a[168:171], a[40:43], v[112:115]
    v_mfma_f32_16x16x32_bf16 v[112:115], a[172:175], a[44:47], v[112:115]
    v_mfma_f32_16x16x32_bf16 v[116:119], a[176:179], a[32:35], 0
    v_mfma_f32_16x16x32_bf16 v[116:119], a[180:183], a[36:39], v[116:119]
    v_mfma_f32_16x16x32_bf16 v[116:119], a[184:187], a[40:43], v[116:119]
    v_mfma_f32_16x16x32_bf16 v[116:119], a[188:191], a[44:47], v[116:119]
    v_mfma_f32_16x16x32_bf16 v[120:123], a[160:163], a[48:51], 0
    v_mfma_f32_16x16x32_bf16 v[120:123], a[164:167], a[52:55], v[120:123]
    v_mfma_f32_16x16x32_bf16 v[120:123], a[168:171], a[56:59], v[120:123]
    v_mfma_f32_16x16x32_bf16 v[120:123], a[172:175], a[60:63], v[120:123]
    v_mfma_f32_16x16x32_bf16 v[124:127], a[176:179], a[48:51], 0
    v_mfma_f32_16x16x32_bf16 v[124:127], a[180:183], a[52:55], v[124:127]
    v_mfma_f32_16x16x32_bf16 v[124:127], a[184:187], a[56:59], v[124:127]
    v_mfma_f32_16x16x32_bf16 v[124:127], a[188:191], a[60:63], v[124:127]
    v_mfma_f32_16x16x32_bf16 v[128:131], a[160:163], a[64:67], 0
    v_mfma_f32_16x16x32_bf16 v[128:131], a[164:167], a[68:71], v[128:131]
    v_mfma_f32_16x16x32_bf16 v[128:131], a[168:171], a[72:75], v[128:131]
    v_mfma_f32_16x16x32_bf16 v[128:131], a[172:175], a[76:79], v[128:131]
    v_mfma_f32_16x16x32_bf16 v[132:135], a[176:179], a[64:67], 0
    v_mfma_f32_16x16x32_bf16 v[132:135], a[180:183], a[68:71], v[132:135]
    v_mfma_f32_16x16x32_bf16 v[132:135], a[184:187], a[72:75], v[132:135]
    v_mfma_f32_16x16x32_bf16 v[132:135], a[188:191], a[76:79], v[132:135]
    s_nop 7
    v_max3_f32 v16, v96, v97, v16
    v_max3_f32 v16, v98, v99, v16
    v_max3_f32 v16, v100, v101, v16
    v_max3_f32 v16, v102, v103, v16
    v_max3_f32 v20, v104, v105, v20
    v_max3_f32 v20, v106, v107, v20
    v_max3_f32 v20, v108, v109, v20
    v_max3_f32 v20, v110, v111, v20
    v_max3_f32 v24, v112, v113, v24
    v_max3_f32 v24, v114, v115, v24
    v_max3_f32 v24, v116, v117, v24
    v_max3_f32 v24, v118, v119, v24
    v_max3_f32 v28, v120, v121, v28
    v_max3_f32 v28, v122, v123, v28
    v_max3_f32 v28, v124, v125, v28
    v_max3_f32 v28, v126, v127, v28
    v_max3_f32 v32, v128, v129, v32
    v_max3_f32 v32, v130, v131, v32
    v_max3_f32 v32, v132, v133, v32
    v_max3_f32 v32, v134, v135, v32
    s_barrier
    s_add_u32 s52, s52, 16384
    s_cmp_lg_u32 s52, 262144
    s_cbranch_scc1 L_rl0
    s_add_u32 m0, s63, 0
    s_mov_b32 s67, 0
    buffer_load_dwordx4 v1, s[12:15], s67 offen offset:0 nt lds
    s_add_u32 m0, s63, 32
    s_nop 0
    buffer_load_dwordx4 v1, s[12:15], s67 offen offset:1024 nt lds
    s_add_u32 m0, s63, 64
    s_nop 0
    buffer_load_dwordx4 v1, s[12:15], s67 offen offset:2048 nt lds
    s_add_u32 m0, s63, 96
    s_nop 0
    buffer_load_dwordx4 v1, s[12:15], s67 offen offset:3072 nt lds
    s_add_u32 m0, s63, 69632
    s_mov_b32 s67, 0
    buffer_load_dwordx4 v1, s[16:19], s67 offen offset:0 nt lds
    s_add_u32 m0, s63, 69664
    s_nop 0
    buffer_load_dwordx4 v1, s[16:19], s67 offen offset:1024 nt lds
    s_add_u32 m0, s63, 69696
    s_nop 0
    buffer_load_dwordx4 v1, s[16:19], s67 offen offset:2048 nt lds
    s_add_u32 m0, s63, 69728
    s_nop 0
    buffer_load_dwordx4 v1, s[16:19], s67 offen offset:3072 nt lds
    s_add_u32 m0, s63, 17408
    s_mov_b32 s67, 16384
    buffer_load_dwordx4 v1, s[12:15], s67 offen offset:0 nt lds
    s_add_u32 m0, s63, 17440
    s_nop 0
    buffer_load_dwordx4 v1, s[12:15], s67 offen offset:1024 nt lds
    s_add_u32 m0, s63, 17472
    s_nop 0
    buffer_load_dwordx4 v1, s[12:15], s67 offen offset:2048 nt lds
    s_add_u32 m0, s63, 17504
    s_nop 0
    buffer_load_dwordx4 v1, s[12:15], s67 offen offset:3072 nt lds
    s_add_u32 m0, s63, 87040
    s_mov_b32 s67, 16384
    buffer_load_dwordx4 v1, s[16:19], s67 offen offset:0 nt lds
    s_add_u32 m0, s63, 87072
    s_nop 0
    buffer_load_dwordx4 v1, s[16:19], s67 offen offset:1024 nt lds
    s_add_u32 m0, s63, 87104
    s_nop 0
    buffer_load_dwordx4 v1, s[16:19], s67 offen offset:2048 nt lds
    s_add_u32 m0, s63, 87136
    s_nop 0
    buffer_load_dwordx4 v1, s[16:19], s67 offen offset:3072 nt lds
    s_add_u32 m0, s63, 34816
    s_mov_b32 s67, 32768
    buffer_load_dwordx4 v1, s[12:15], s67 offen offset:0 nt lds
    s_add_u32 m0, s63, 34848
    s_nop 0
    buffer_load_dwordx4 v1, s[12:15], s67 offen offset:1024 nt lds
    s_add_u32 m0, s63, 34880
    s_nop 0
    buffer_load_dwordx4 v1, s[12:15], s67 offen offset:2048 nt lds
    s_add_u32 m0, s63, 34912
    s_nop 0
    buffer_load_dwordx4 v1, s[12:15], s67 offen offset:3072 nt lds
    s_add_u32 m0, s63, 104448
    s_mov_b32 s67, 32768
    buffer_load_dwordx4 v1, s[16:19], s67 offen offset:0 nt lds
    s_add_u32 m0, s63, 104480
    s_nop 0
    buffer_load_dwordx4 v1, s[16:19], s67 offen offset:1024 nt lds
    s_add_u32 m0, s63, 104512
    s_nop 0
    buffer_load_dwordx4 v1, s[16:19], s67 offen offset:2048 nt lds
    s_add_u32 m0, s63, 104544
    s_nop 0
    buffer_load_dwordx4 v1, s[16:19], s67 offen offset:3072 nt lds
    s_add_u32 m0, s63, 52224
    s_mov_b32 s67, 49152
    buffer_load_dwordx4 v1, s[12:15], s67 offen offset:0 nt lds
    s_add_u32 m0, s63, 52256
    s_nop 0
    buffer_load_dwordx4 v1, s[12:15], s67 offen offset:1024 nt lds
    s_add_u32 m0, s63, 52288
    s_nop 0
    buffer_load_dwordx4 v1, s[12:15], s67 offen offset:2048 nt lds
    s_add_u32 m0, s63, 52320
    s_nop 0
    buffer_load_dwordx4 v1, s[12:15], s67 offen offset:3072 nt lds
    s_add_u32 m0, s63, 121856
    s_mov_b32 s67, 49152
    buffer_load_dwordx4 v1, s[16:19], s67 offen offset:0 nt lds
    s_add_u32 m0, s63, 121888
    s_nop 0
    buffer_load_dwordx4 v1, s[16:19], s67 offen offset:1024 nt lds
    s_add_u32 m0, s63, 121920
    s_nop 0
    buffer_load_dwordx4 v1, s[16:19], s67 offen offset:2048 nt lds
    s_add_u32 m0, s63, 121952
    s_nop 0
    buffer_load_dwordx4 v1, s[16:19], s67 offen offset:3072 nt lds
    s_waitcnt vmcnt(0)
    s_barrier
    s_branch L_head0
L_redo1:
    s_waitcnt vmcnt(0) lgkmcnt(0)
    s_barrier
    s_mov_b32 s62, 1
    v_and_b32 v9, 7, v0
    v_mul_u32_u24 v9, 1056, v9
    v_and_b32 v14, 8, v0
    v_lshl_add_u32 v9, v14, 5, v9
    v_and_b32 v14, 48, v0
    s_mul_i32 s3, s37, 8448
    v_add3_u32 v2, v9, v14, s3
    v_bfe_u32 v9, v0, 2, 3
    v_mul_u32_u24 v9, 1056, v9
    v_and_b32 v14, 32, v0
    v_lshl_add_u32 v9, v14, 3, v9
    v_and_b32 v14, 3, v0
    v_lshl_add_u32 v9, v14, 3, v9
    s_add_u32 s3, s3, 69632
    v_add_u32 v3, s3, v9
    v_mov_b32 v16, 0xff800000
    v_mov_b32 v20, 0xff800000
    v_mov_b32 v24, 0xff800000
    v_mov_b32 v28, 0xff800000
    v_mov_b32 v32, 0xff800000
    s_mov_b32 s52, 262144
    s_mov_b32 s50, s47
L_rl1:
    s_add_u32 m0, s63, 0
    s_nop 0
    buffer_load_dwordx4 v1, s[12:15], s52 offen offset:0 lds
    s_add_u32 m0, s63, 32
    s_nop 0
    buffer_load_dwordx4 v1, s[12:15], s52 offen offset:1024 lds
    s_add_u32 m0, s63, 64
    s_nop 0
    buffer_load_dwordx4 v1, s[12:15], s52 offen offset:2048 lds
    s_add_u32 m0, s63, 96
    s_nop 0
    buffer_load_dwordx4 v1, s[12:15], s52 offen offset:3072 lds
    s_waitcnt vmcnt(0)
    s_barrier
    ds_read_b128 a[160:163], v2 offset:0
    ds_read_b128 a[164:167], v2 offset:64
    ds_read_b128 a[168:171], v2 offset:128
    ds_read_b128 a[172:175], v2 offset:192
    ds_read_b128 a[176:179], v2 offset:512
    ds_read_b128 a[180:183], v2 offset:576
    ds_read_b128 a[184:187], v2 offset:640
    ds_read_b128 a[188:191], v2 offset:704
    s_waitcnt lgkmcnt(0)
    v_add_u32 v2, s50, v2
    s_sub_u32 s50, 0, s50
    v_mfma_f32_16x16x32_bf16 v[96:99], a[160:163], a[80:83], 0
    v_mfma_f32_16x16x32_bf16 v[96:99], a[164:167], a[84:87], v[96:99]
    v_mfma_f32_16x16x32_bf16 v[96:99], a[168:171], a[88:91], v[96:99]
    v_mfma_f32_16x16x32_bf16 v[96:99], a[172:175], a[92:95], v[96:99]
    v_mfma_f32_16x16x32_bf16 v[100:103], a[176:179], a[80:83], 0
    v_mfma_f32_16x16x32_bf16 v[100:103], a[180:183], a[84:87], v[100:103]
    v_mfma_f32_16x16x32_bf16 v[100:103], a[184:187], a[88:91], v[100:103]
    v_mfma_f32_16x16x32_bf16 v[100:103], a[188:191], a[92:95], v[100:103]
    v_mfma_f32_16x16x32_bf16 v[104:107], a[160:163], a[96:99], 0
    v_mfma_f32_16x16x32_bf16 v[104:107], a[164:167], a[100:103], v[104:107]
    v_mfma_f32_16x16x32_bf16 v[104:107], a[168:171], a[104:107], v[104:107]
    v_mfma_f32_16x16x32_bf16 v[104:107], a[172:175], a[108:111], v[104:107]
    v_mfma_f32_16x16x32_bf16 v[108:111], a[176:179], a[96:99], 0
    v_mfma_f32_16x16x32_bf16 v[108:111], a[180:183], a[100:103], v[108:111]
    v_mfma_f32_16x16x32_bf16 v[108:111], a[184:187], a[104:107], v[108:111]
    v_mfma_f32_16x16x32_bf16 v[108:111], a[188:191], a[108:111], v[108:111]
    v_mfma_f32_16x16x32_bf16 v[112:115], a[160:163], a[112:115], 0
    v_mfma_f32_16x16x32_bf16 v[112:115], a[164:167], a[116:119], v[112:115]
    v_mfma_f32_16x16x32_bf16 v[112:115], a[168:171], a[120:123], v[112:115]
    v_mfma_f32_16x16x32_bf16 v[112:115], a[172:175], a[124:127], v[112:115]
    v_mfma_f32_16x16x32_bf16 v[116:119], a[176:179], a[112:115], 0
    v_mfma_f32_16x16x32_bf16 v[116:119], a[180:183], a[116:119], v[116:119]
    v_mfma_f32_16x16x32_bf16 v[116:119], a[184:187], a[120:123], v[116:119]
    v_mfma_f32_16x16x32_bf16 v[116:119], a[188:191], a[124:127], v[116:119]
    v_mfma_f32_16x16x32_bf16 v[120:123], a[160:163], a[128:131], 0
    v_mfma_f32_16x16x32_bf16 v[120:123], a[164:167], a[132:135], v[120:123]
    v_mfma_f32_16x16x32_bf16 v[120:123], a[168:171], a[136:139], v[120:123]
    v_mfma_f32_16x16x32_bf16 v[120:123], a[172:175], a[140:143], v[120:123]
    v_mfma_f32_16x16x32_bf16 v[124:127], a[176:179], a[128:131], 0
    v_mfma_f32_16x16x32_bf16 v[124:127], a[180:183], a[132:135], v[124:127]
    v_mfma_f32_16x16x32_bf16 v[124:127], a[184:187], a[136:139], v[124:127]
    v_mfma_f32_16x16x32_bf16 v[124:127], a[188:191], a[140:143], v[124:127]
    v_mfma_f32_16x16x32_bf16 v[128:131], a[160:163], a[144:147], 0
    v_mfma_f32_16x16x32_bf16 v[128:131], a[164:167], a[148:151], v[128:131]
    v_mfma_f32_16x16x32_bf16 v[128:131], a[168:171], a[152:155], v[128:131]
    v_mfma_f32_16x16x32_bf16 v[128:131], a[172:175], a[156:159], v[128:131]
    v_mfma_f32_16x16x32_bf16 v[132:135], a[176:179], a[144:147], 0
    v_mfma_f32_16x16x32_bf16 v[132:135], a[180:183], a[148:151], v[132:135]
    v_mfma_f32_16x16x32_bf16 v[132:135], a[184:187], a[152:155], v[132:135]
    v_mfma_f32_16x16x32_bf16 v[132:135], a[188:191], a[156:159], v[132:135]
    s_nop 7
    v_max3_f32 v16, v96, v97, v16
    v_max3_f32 v16, v98, v99, v16
    v_max3_f32 v16, v100, v101, v16
    v_max3_f32 v16, v102, v103, v16
    v_max3_f32 v20, v104, v105, v20
    v_max3_f32 v20, v106, v107, v20
    v_max3_f32 v20, v108, v109, v20
    v_max3_f32 v20, v110, v111, v20
    v_max3_f32 v24, v112, v113, v24
    v_max3_f32 v24, v114, v115, v24
    v_max3_f32 v24, v116, v117, v24
    v_max3_f32 v24, v118, v119, v24
    v_max3_f32 v28, v120, v121, v28
    v_max3_f32 v28, v122, v123, v28
    v_max3_f32 v28, v124, v125, v28
    v_max3_f32 v28, v126, v127, v28
    v_max3_f32 v32, v128, v129, v32
    v_max3_f32 v32, v130, v131, v32
    v_max3_f32 v32, v132, v133, v32
    v_max3_f32 v32, v134, v135, v32
    ds_read_b128 a[160:163], v2 offset:0
    ds_read_b128 a[164:167], v2 offset:64
    ds_read_b128 a[168:171], v2 offset:128
    ds_read_b128 a[172:175], v2 offset:192
    ds_read_b128 a[176:179], v2 offset:512
    ds_read_b128 a[180:183], v2 offset:576
    ds_read_b128 a[184:187], v2 offset:640
    ds_read_b128 a[188:191], v2 offset:704
    s_waitcnt lgkmcnt(0)
    v_add_u32 v2, s50, v2
    s_sub_u32 s50, 0, s50
    v_mfma_f32_16x16x32_bf16 v[96:99], a[160:163], a[80:83], 0
    v_mfma_f32_16x16x32_bf16 v[96:99], a[164:167], a[84:87], v[96:99]
    v_mfma_f32_16x16x32_bf16 v[96:99], a[168:171], a[88:91], v[96:99]
    v_mfma_f32_16x16x32_bf16 v[96:99], a[172:175], a[92:95], v[96:99]
    v_mfma_f32_16x16x32_bf16 v[100:103], a[176:179], a[80:83], 0
    v_mfma_f32_16x16x32_bf16 v[100:103], a[180:183], a[84:87], v[100:103]
    v_mfma_f32_16x16x32_bf16 v[100:103], a[184:187], a[88:91], v[100:103]
    v_mfma_f32_16x16x32_bf16 v[100:103], a[188:191], a[92:95], v[100:103]
    v_mfma_f32_16x16x32_bf16 v[104:107], a[160:163], a[96:99], 0
    v_mfma_f32_16x16x32_bf16 v[104:107], a[164:167], a[100:103], v[104:107]
    v_mfma_f32_16x16x32_bf16 v[104:107], a[168:171], a[104:107], v[104:107]
    v_mfma_f32_16x16x32_bf16 v[104:107], a[172:175], a[108:111], v[104:107]
    v_mfma_f32_16x16x32_bf16 v[108:111], a[176:179], a[96:99], 0
    v_mfma_f32_16x16x32_bf16 v[108:111], a[180:183], a[100:103], v[108:111]
    v_mfma_f32_16x16x32_bf16 v[108:111], a[184:187], a[104:107], v[108:111]
    v_mfma_f32_16x16x32_bf16 v[108:111], a[188:191], a[108:111], v[108:111]
    v_mfma_f32_16x16x32_bf16 v[112:115], a[160:163], a[112:115], 0
    v_mfma_f32_16x16x32_bf16 v[112:115], a[164:167], a[116:119], v[112:115]
    v_mfma_f32_16x16x32_bf16 v[112:115], a[168:171], a[120:123], v[112:115]
    v_mfma_f32_16x16x32_bf16 v[112:115], a[172:175], a[124:127], v[112:115]
    v_mfma_f32_16x16x32_bf16 v[116:119], a[176:179], a[112:115], 0
    v_mfma_f32_16x16x32_bf16 v[116:119], a[180:183], a[116:119], v[116:119]
    v_mfma_f32_16x16x32_bf16 v[116:119], a[184:187], a[120:123], v[116:119]
    v_mfma_f32_16x16x32_bf16 v[116:119], a[188:191], a[124:127], v[116:119]
    v_mfma_f32_16x16x32_bf16 v[120:123], a[160:163], a[128:131], 0
    v_mfma_f32_16x16x32_bf16 v[120:123], a[164:167], a[132:135], v[120:123]
    v_mfma_f32_16x16x32_bf16 v[120:123], a[168:171], a[136:139], v[120:123]
    v_mfma_f32_16x16x32_bf16 v[120:123], a[172:175], a[140:143], v[120:123]
    v_mfma_f32_16x16x32_bf16 v[124:127], a[176:179], a[128:131], 0
    v_mfma_f32_16x16x32_bf16 v[124:127], a[180:183], a[132:135], v[124:127]
    v_mfma_f32_16x16x32_bf16 v[124:127], a[184:187], a[136:139], v[124:127]
    v_mfma_f32_16x16x32_bf16 v[124:127], a[188:191], a[140:143], v[124:127]
    v_mfma_f32_16x16x32_bf16 v[128:131], a[160:163], a[144:147], 0
    v_mfma_f32_16x16x32_bf16 v[128:131], a[164:167], a[148:151], v[128:131]
    v_mfma_f32_16x16x32_bf16 v[128:131], a[168:171], a[152:155], v[128:131]
    v_mfma_f32_16x16x32_bf16 v[128:131], a[172:175], a[156:159], v[128:131]
    v_mfma_f32_16x16x32_bf16 v[132:135], a[176:179], a[144:147], 0
    v_mfma_f32_16x16x32_bf16 v[132:135], a[180:183], a[148:151], v[132:135]
    v_mfma_f32_16x16x32_bf16 v[132:135], a[184:187], a[152:155], v[132:135]
    v_mfma_f32_16x16x32_bf16 v[132:135], a[188:191], a[156:159], v[132:135]
    s_nop 7
    v_max3_f32 v16, v96, v97, v16
    v_max3_f32 v16, v98, v99, v16
    v_max3_f32 v16, v100, v101, v16
    v_max3_f32 v16, v102, v103, v16
    v_max3_f32 v20, v104, v105, v20
    v_max3_f32 v20, v106, v107, v20
    v_max3_f32 v20, v108, v109, v20
    v_max3_f32 v20, v110, v111, v20
    v_max3_f32 v24, v112, v113, v24
    v_max3_f32 v24, v114, v115, v24
    v_max3_f32 v24, v116, v117, v24
    v_max3_f32 v24, v118, v119, v24
    v_max3_f32 v28, v120, v121, v28
    v_max3_f32 v28, v122, v123, v28
    v_max3_f32 v28, v124, v125, v28
    v_max3_f32 v28, v126, v127, v28
    v_max3_f32 v32, v128, v129, v32
    v_max3_f32 v32, v130, v131, v32
    v_max3_f32 v32, v132, v133, v32
    v_max3_f32 v32, v134, v135, v32
    s_barrier
    s_add_u32 s52, s52, 16384
    s_cmp_lg_u32 s52, 524288
    s_cbranch_scc1 L_rl1
    s_add_u32 m0, s63, 0
    s_mov_b32 s67, 262144
    buffer_load_dwordx4 v1, s[12:15], s67 offen offset:0 nt lds
    s_add_u32 m0, s63, 32
    s_nop 0
    buffer_load_dwordx4 v1, s[12:15], s67 offen offset:1024 nt lds
    s_add_u32 m0, s63, 64
    s_nop 0
    buffer_load_dwordx4 v1, s[12:15], s67 offen offset:2048 nt lds
    s_add_u32 m0, s63, 96
    s_nop 0
    buffer_load_dwordx4 v1, s[12:15], s67 offen offset:3072 nt lds
    s_add_u32 m0, s63, 69632
    s_mov_b32 s67, 262144
    buffer_load_dwordx4 v1, s[16:19], s67 offen offset:0 nt lds
    s_add_u32 m0, s63, 69664
    s_nop 0
    buffer_load_dwordx4 v1, s[16:19], s67 offen offset:1024 nt lds
    s_add_u32 m0, s63, 69696
    s_nop 0
    buffer_load_dwordx4 v1, s[16:19], s67 offen offset:2048 nt lds
    s_add_u32 m0, s63, 69728
    s_nop 0
    buffer_load_dwordx4 v1, s[16:19], s67 offen offset:3072 nt lds
    s_add_u32 m0, s63, 17408
    s_mov_b32 s67, 278528
    buffer_load_dwordx4 v1, s[12:15], s67 offen offset:0 nt lds
    s_add_u32 m0, s63, 17440
    s_nop 0
    buffer_load_dwordx4 v1, s[12:15], s67 offen offset:1024 nt lds
    s_add_u32 m0, s63, 17472
    s_nop 0
    buffer_load_dwordx4 v1, s[12:15], s67 offen offset:2048 nt lds
    s_add_u32 m0, s63, 17504
    s_nop 0
    buffer_load_dwordx4 v1, s[12:15], s67 offen offset:3072 nt lds
    s_add_u32 m0, s63, 87040
    s_mov_b32 s67, 278528
    buffer_load_dwordx4 v1, s[16:19], s67 offen offset:0 nt lds
    s_add_u32 m0, s63, 87072
    s_nop 0
    buffer_load_dwordx4 v1, s[16:19], s67 offen offset:1024 nt lds
    s_add_u32 m0, s63, 87104
    s_nop 0
    buffer_load_dwordx4 v1, s[16:19], s67 offen offset:2048 nt lds
    s_add_u32 m0, s63, 87136
    s_nop 0
    buffer_load_dwordx4 v1, s[16:19], s67 offen offset:3072 nt lds
    s_add_u32 m0, s63, 34816
    s_mov_b32 s67, 294912
    buffer_load_dwordx4 v1, s[12:15], s67 offen offset:0 nt lds
    s_add_u32 m0, s63, 34848
    s_nop 0
    buffer_load_dwordx4 v1, s[12:15], s67 offen offset:1024 nt lds
    s_add_u32 m0, s63, 34880
    s_nop 0
    buffer_load_dwordx4 v1, s[12:15], s67 offen offset:2048 nt lds
    s_add_u32 m0, s63, 34912
    s_nop 0
    buffer_load_dwordx4 v1, s[12:15], s67 offen offset:3072 nt lds
    s_add_u32 m0, s63, 104448
    s_mov_b32 s67, 294912
    buffer_load_dwordx4 v1, s[16:19], s67 offen offset:0 nt lds
    s_add_u32 m0, s63, 104480
    s_nop 0
    buffer_load_dwordx4 v1, s[16:19], s67 offen offset:1024 nt lds
    s_add_u32 m0, s63, 104512
    s_nop 0
    buffer_load_dwordx4 v1, s[16:19], s67 offen offset:2048 nt lds
    s_add_u32 m0, s63, 104544
    s_nop 0
    buffer_load_dwordx4 v1, s[16:19], s67 offen offset:3072 nt lds
    s_add_u32 m0, s63, 52224
    s_mov_b32 s67, 311296
    buffer_load_dwordx4 v1, s[12:15], s67 offen offset:0 nt lds
    s_add_u32 m0, s63, 52256
    s_nop 0
    buffer_load_dwordx4 v1, s[12:15], s67 offen offset:1024 nt lds
    s_add_u32 m0, s63, 52288
    s_nop 0
    buffer_load_dwordx4 v1, s[12:15], s67 offen offset:2048 nt lds
    s_add_u32 m0, s63, 52320
    s_nop 0
    buffer_load_dwordx4 v1, s[12:15], s67 offen offset:3072 nt lds
    s_add_u32 m0, s63, 121856
    s_mov_b32 s67, 311296
    buffer_load_dwordx4 v1, s[16:19], s67 offen offset:0 nt lds
    s_add_u32 m0, s63, 121888
    s_nop 0
    buffer_load_dwordx4 v1, s[16:19], s67 offen offset:1024 nt lds
    s_add_u32 m0, s63, 121920
    s_nop 0
    buffer_load_dwordx4 v1, s[16:19], s67 offen offset:2048 nt lds
    s_add_u32 m0, s63, 121952
    s_nop 0
    buffer_load_dwordx4 v1, s[16:19], s67 offen offset:3072 nt lds
    s_waitcnt vmcnt(0)
    s_barrier
    s_branch L_head1
L_end:
    s_endpgm
.section .rodata,"a"
.p2align 6
.amdhsa_kernel concat_heads__mha_block_cached__gqa_block_cached__near_ridge_kernel
  .amdhsa_next_free_vgpr 512
  .amdhsa_next_free_sgpr 102
  .amdhsa_accum_offset 256
  .amdhsa_group_segment_fixed_size 0
  .amdhsa_kernarg_size 104
  .amdhsa_user_sgpr_count 2
  .amdhsa_user_sgpr_kernarg_segment_ptr 1
  .amdhsa_system_sgpr_workgroup_id_x 1
.end_amdhsa_kernel
```
